```python
import torch

def _softmax(x, axis=-1):
    return torch.softmax(x, dim=axis)

def _gelu(x):
    return torch.nn.functional.gelu(x, approximate='tanh')

def _silu(x):
    return torch.nn.functional.silu(x)

def _sigmoid(x):
    return torch.sigmoid(x)

def _layernorm(x, axis=-1, eps=1e-05):
    m = x.mean(dim=axis, keepdim=True)
    v = x.var(dim=axis, keepdim=True, unbiased=False)
    return (x - m) / torch.sqrt(v + eps)

def _scatter_add(tgt, idx, src, axis=0):
    return tgt.clone().index_add_(axis, idx, src)

def _segment_sum(src, seg, n):
    out = torch.zeros((n,) + src.shape[1:], dtype=src.dtype)
    return out.index_add_(0, seg, src)

def _pad(x, pw):
    flat = tuple((v for pair in reversed(pw) for v in pair))
    return torch.nn.functional.pad(x, flat)
kernel_name = 'gated_mix__compressed_kv_cla__mixer_gmlp__prompt'

def setup_inputs():

    _w = lambda a: (lambda t: t.to(torch.bfloat16) if t.is_floating_point() else t)(torch.as_tensor(a))

    def _A_setup():
        B, H, Sq, Sk, D, M = (1, 32, 2048, 2048, 128, 512)
        Dc = 4 * D
        return {'x': _w((lambda *s: torch.randn(*s, dtype=torch.bfloat16) * 0.05)(B, Sq, M)), 'c_kv': _w((lambda *s: torch.randn(*s, dtype=torch.bfloat16) * 0.8)(B, Sk, Dc)), 'w_q': _w((lambda *s: torch.randn(*s, dtype=torch.bfloat16) * 6.4)(M, H, D) * M ** (-0.5)), 'w_uk': _w((lambda *s: torch.randn(*s, dtype=torch.bfloat16) * 6.4)(Dc, H, D) * Dc ** (-0.5)), 'w_uv': _w((lambda *s: torch.randn(*s, dtype=torch.bfloat16) * 0.8)(Dc, H, D) * Dc ** (-0.5)), 'w_o': _w((lambda *s: torch.randn(*s, dtype=torch.bfloat16) * 0.8)(H, D, M) * (H * D) ** (-0.5))}
    _A_in = _A_setup()

    def _B_setup():
        B, S, D, F = (1, 2048, 512, 1792)
        Fh = F // 2
        return {'x': _w((lambda *s: torch.randn(*s, dtype=torch.bfloat16) * 0.05)(B, S, D)), 'w_in': _w((lambda *s: torch.randn(*s, dtype=torch.bfloat16) * 0.4)(D, 2 * Fh)), 'w_sp': _w(0.01 * (lambda *s: torch.randn(*s, dtype=torch.bfloat16) * 0.4)(S, S)), 'b_sp': _w(1.0 + 0.01 * (lambda *s: torch.randn(*s, dtype=torch.bfloat16) * 0.05)(S)), 'w_out': _w((lambda *s: torch.randn(*s, dtype=torch.bfloat16) * 0.05)(Fh, D))}
    _B_in = _B_setup()
    return {'A_x': _A_in['x'], 'A_c_kv': _A_in['c_kv'], 'A_w_q': _A_in['w_q'], 'A_w_uk': _A_in['w_uk'], 'A_w_uv': _A_in['w_uv'], 'A_w_o': _A_in['w_o'], 'B_x': _B_in['x'], 'B_w_in': _B_in['w_in'], 'B_w_sp': _B_in['w_sp'], 'B_b_sp': _B_in['b_sp'], 'B_w_out': _B_in['w_out'], 'gate_w': _w((lambda *s: torch.randn(*s, dtype=torch.bfloat16) * 0.05)(512) * 16.0)}

def reference(A_x, A_c_kv, A_w_q, A_w_uk, A_w_uv, A_w_o, B_x, B_w_in, B_w_sp, B_b_sp, B_w_out, gate_w):

    def _A_ref(x, c_kv, w_q, w_uk, w_uv, w_o):
        B, Sq, M = (x.shape[0], x.shape[1], x.shape[2])
        Sk = c_kv.shape[1]
        H, D = (w_q.shape[1], w_q.shape[2])
        q = torch.einsum('bqm,mhd->bhqd', x, w_q)
        k = torch.einsum('bkc,chd->bhkd', c_kv, w_uk)
        v = torch.einsum('bkc,chd->bhkd', c_kv, w_uv)
        scores = torch.einsum('bhqd,bhkd->bhqk', q, k) * D ** (-0.5)
        off = Sk - Sq
        qi = torch.arange(Sq)[:, None]
        kj = torch.arange(Sk)[None, :]
        cmask = kj <= qi + off
        scores = torch.where(cmask[None, None], scores, -1000000000.0)
        p = _softmax(scores, axis=-1)
        ctx = torch.einsum('bhqk,bhkd->bhqd', p, v)
        return torch.einsum('bhqd,hdm->bqm', ctx, w_o)

    def _B_ref(x, w_in, w_sp, b_sp, w_out):
        B, S, D = x.shape
        F = w_in.shape[-1]
        Fh = F // 2
        z = _gelu(torch.einsum('bsd,df->bsf', x, w_in))
        z1 = z[..., :Fh].clone()
        z2 = _layernorm(z[..., Fh:], axis=-1)
        g = torch.einsum('ts,bsf->btf', w_sp, z2) + b_sp[None, :, None]
        return torch.einsum('bsf,fd->bsd', z1 * g, w_out)
    x = A_x
    g = _sigmoid((x * gate_w).sum(-1, keepdims=True))
    a = _A_ref(x, A_c_kv, A_w_q, A_w_uk, A_w_uv, A_w_o)
    b = _B_ref(x, B_w_in, B_w_sp, B_b_sp, B_w_out)
    return g * a + (1 - g) * b
```

```asm
; @launch grid=(256,1,1) block=(512,1,1) lds=163840
.amdgcn_target "amdgcn-amd-amdhsa--gfx950"
.text
.globl gated_mix__compressed_kv_cla__mixer_gmlp__prompt_kernel
.p2align 8
.type gated_mix__compressed_kv_cla__mixer_gmlp__prompt_kernel,@function
gated_mix__compressed_kv_cla__mixer_gmlp__prompt_kernel:
    s_cmp_ge_u32 s2, 256
    s_cbranch_scc1 M_end
    s_load_dwordx4 s[4:7], s[0:1], 0
    s_load_dwordx2 s[40:41], s[0:1], 16
    s_load_dwordx4 s[44:47], s[0:1], 24
    s_load_dwordx2 s[42:43], s[0:1], 56
    s_load_dwordx2 s[8:9], s[0:1], 104
    s_load_dwordx2 s[14:15], s[0:1], 112
    v_and_b32 v1, 63, v0
    v_lshrrev_b32 v2, 6, v0
    s_nop 0
    v_readfirstlane_b32 s56, v2
    v_lshlrev_b32 v2, 4, v1
    s_lshr_b32 s57, s56, 2
    s_and_b32 s58, s56, 3
    s_and_b32 s63, s2, 7
    s_lshr_b32 s96, s2, 3
    s_and_b32 s59, s96, 3
    s_lshl_b32 s97, s63, 2
    s_add_u32 s59, s59, s97
    s_lshr_b32 s60, s96, 2
    s_lshl_b32 s61, s60, 1
    s_add_u32 s61, s61, 2
    s_lshl_b32 s99, s59, 19
    s_and_b32 s64, s96, 7
    s_lshr_b32 s96, s96, 3
    s_lshr_b32 s65, s96, 1
    s_and_b32 s96, s96, 1
    s_lshl_b32 s66, s63, 1
    s_add_u32 s66, s66, s96
    s_lshl_b32 s67, s56, 10
    s_lshl_b32 s68, s56, 12
    v_lshrrev_b32 v4, 3, v1
    v_and_b32 v5, 7, v1
    v_lshrrev_b32 v6, 1, v4
    v_xor_b32 v7, v5, v6
    v_lshlrev_b32 v7, 4, v7
    v_lshlrev_b32 v80, 10, v4
    v_add_u32 v80, v80, v7
    v_xor_b32 v81, 64, v80
    s_and_b32 s63, s56, 1
    s_lshl_b32 s63, s63, 6
    v_xor_b32 v3, s63, v80
    s_lshl_b32 s63, s56, 13
    v_add_u32 v3, s63, v3
    v_lshrrev_b32 v7, 1, v5
    v_and_b32 v6, 1, v6
    s_and_b32 s63, s56, 1
    s_lshl_b32 s63, s63, 1
    v_add_u32 v6, s63, v6
    v_xor_b32 v7, v7, v6
    v_lshrrev_b32 v6, 1, v7
    v_mul_u32_u24 v6, 1792, v6
    v_and_b32 v7, 1, v7
    v_lshlrev_b32 v7, 5, v7
    v_add_u32 v6, v6, v7
    v_and_b32 v5, 1, v5
    v_lshlrev_b32 v5, 4, v5
    v_add_u32 v6, v6, v5
    s_lshl_b32 s63, s56, 3
    v_add_u32 v4, s63, v4
    v_mul_u32_u24 v4, 3584, v4
    v_add_u32 v83, v4, v6
    v_lshrrev_b32 v5, 5, v1
    v_and_b32 v6, 31, v1
    v_lshrrev_b32 v7, 1, v6
    v_and_b32 v6, 1, v6
    s_and_b32 s63, s56, 1
    s_lshl_b32 s63, s63, 2
    s_add_u32 s63, s63, s57
    v_lshlrev_b32 v8, 1, v5
    v_add_u32 v8, s63, v8
    v_xor_b32 v7, v7, v8
    v_lshlrev_b32 v7, 5, v7
    v_lshlrev_b32 v6, 4, v6
    v_add_u32 v7, v7, v6
    s_lshl_b32 s63, s56, 1
    v_add_u32 v5, s63, v5
    v_lshlrev_b32 v5, 13, v5
    v_add_u32 v4, v5, v7
    v_lshrrev_b32 v6, 4, v1
    v_and_b32 v7, 15, v1
    v_lshrrev_b32 v8, 1, v7
    v_and_b32 v7, 1, v7
    s_bfe_u32 s63, s56, 65537
    v_lshlrev_b32 v5, 1, v6
    v_add_u32 v5, s63, v5
    v_xor_b32 v8, v8, v5
    v_lshlrev_b32 v8, 5, v8
    v_lshlrev_b32 v7, 4, v7
    v_add_u32 v8, v8, v7
    s_lshl_b32 s63, s56, 2
    v_add_u32 v6, s63, v6
    v_lshlrev_b32 v6, 13, v6
    v_add_u32 v82, v6, v8
    s_waitcnt lgkmcnt(0)
    s_mov_b32 s16, s6
    s_mov_b32 s17, s7
    s_mov_b32 s18, 0x200000
    s_mov_b32 s19, 0x00020000
    s_cmp_eq_u32 s65, 0
    s_cselect_b32 s20, s44, s46
    s_cselect_b32 s21, s45, s47
    s_mov_b32 s22, 0x400000
    s_mov_b32 s23, 0x00020000
    s_lshl_b32 s70, s64, 18
    s_lshl_b32 s71, s66, 9
    s_add_u32 m0, s67, 0
    s_add_u32 s63, s70, 0
    buffer_load_dwordx4 v3, s[16:19], s63 offen lds
    s_add_u32 m0, s67, 8192
    s_add_u32 s63, s70, 65536
    buffer_load_dwordx4 v3, s[16:19], s63 offen lds
    s_add_u32 m0, s67, 16384
    s_add_u32 s63, s70, 131072
    buffer_load_dwordx4 v3, s[16:19], s63 offen lds
    s_add_u32 m0, s67, 24576
    s_add_u32 s63, s70, 196608
    buffer_load_dwordx4 v3, s[16:19], s63 offen lds
    s_add_u32 m0, s67, 32768
    s_add_u32 s63, s71, 0
    buffer_load_dwordx4 v4, s[20:23], s63 offen lds
    s_add_u32 m0, s67, 40960
    s_add_u32 s63, s71, 131072
    buffer_load_dwordx4 v4, s[20:23], s63 offen lds
    s_add_u32 m0, s67, 49152
    s_add_u32 s63, s71, 262144
    buffer_load_dwordx4 v4, s[20:23], s63 offen lds
    s_add_u32 m0, s67, 57344
    s_add_u32 s63, s71, 393216
    buffer_load_dwordx4 v4, s[20:23], s63 offen lds
    s_add_u32 m0, s67, 65536
    s_add_u32 s63, s70, 128
    buffer_load_dwordx4 v3, s[16:19], s63 offen lds
    s_add_u32 m0, s67, 73728
    s_add_u32 s63, s70, 65664
    buffer_load_dwordx4 v3, s[16:19], s63 offen lds
    s_add_u32 m0, s67, 81920
    s_add_u32 s63, s70, 131200
    buffer_load_dwordx4 v3, s[16:19], s63 offen lds
    s_add_u32 m0, s67, 90112
    s_add_u32 s63, s70, 196736
    buffer_load_dwordx4 v3, s[16:19], s63 offen lds
    s_add_u32 m0, s67, 98304
    s_add_u32 s63, s71, 524288
    buffer_load_dwordx4 v4, s[20:23], s63 offen lds
    s_add_u32 m0, s67, 106496
    s_add_u32 s63, s71, 655360
    buffer_load_dwordx4 v4, s[20:23], s63 offen lds
    s_add_u32 m0, s67, 114688
    s_add_u32 s63, s71, 786432
    buffer_load_dwordx4 v4, s[20:23], s63 offen lds
    s_add_u32 m0, s67, 122880
    s_add_u32 s63, s71, 917504
    buffer_load_dwordx4 v4, s[20:23], s63 offen lds
    s_add_u32 m0, s67, 131072
    s_add_u32 s63, s70, 256
    buffer_load_dwordx4 v3, s[16:19], s63 offen lds
    s_add_u32 m0, s67, 139264
    s_add_u32 s63, s70, 65792
    buffer_load_dwordx4 v3, s[16:19], s63 offen lds
    s_add_u32 m0, s67, 147456
    s_add_u32 s63, s70, 131328
    buffer_load_dwordx4 v3, s[16:19], s63 offen lds
    s_add_u32 m0, s67, 155648
    s_add_u32 s63, s70, 196864
    buffer_load_dwordx4 v3, s[16:19], s63 offen lds
    s_cmp_eq_u32 s56, 0
    s_cbranch_scc0 M_notok
    s_memrealtime s[52:53]
    s_waitcnt lgkmcnt(0)
    s_or_b32 s3, s52, 1
    s_mov_b32 s52, s8
    s_mov_b32 s53, s9
    s_mov_b32 s54, 256
    s_mov_b32 s55, 0x00020000
    v_mov_b32 v124, s3
    v_mov_b32 v125, 0
    v_mov_b32 v126, 0
    s_mov_b64 exec, 1
    buffer_atomic_cmpswap v[124:125], v126, s[52:55], 0 offen sc0 sc1
    s_mov_b64 exec, -1
M_notok:
    s_mov_b32 s24, s4
    s_mov_b32 s25, s5
    s_mov_b32 s26, 0x200000
    s_mov_b32 s27, 0x00020000
    s_mov_b32 s28, s42
    s_mov_b32 s29, s43
    s_mov_b32 s30, 0x1c0000
    s_mov_b32 s31, 0x00020000
    s_lshl_b32 s69, s65, 24
    s_add_u32 s32, s14, s69
    s_addc_u32 s33, s15, 0
    s_mov_b32 s34, 0x1000000
    s_mov_b32 s35, 0x00020000
    s_mov_b32 s36, s40
    s_mov_b32 s37, s41
    s_mov_b32 s38, 0x400000
    s_mov_b32 s39, 0x00020000
    s_load_dwordx2 s[6:7], s[0:1], 88
    s_sub_u32 s75, 15, s60
    s_cmp_eq_u32 s57, 0
    s_cselect_b32 s75, s75, s60
    s_lshl_b32 s75, s75, 2
    s_add_u32 s75, s75, s58
    s_lshl_b32 s72, s75, 15
    s_lshl_b32 s73, s59, 8
    s_lshl_b32 s74, s59, 6
    s_lshr_b32 s76, s56, 1
    s_and_b32 s76, s76, 1
    s_lshl_b32 s69, s66, 1
    s_add_u32 s76, s76, s69
    s_lshl_b32 s76, s76, 19
    s_lshl_b32 s69, s64, 16
    s_add_u32 s76, s76, s69
    s_lshl_b32 s69, s57, 15
    s_add_u32 s76, s76, s69
    s_and_b32 s69, s56, 1
    s_lshl_b32 s69, s69, 11
    s_lshl_b32 s77, s65, 1
    s_lshl_b32 s69, s69, s77
    s_add_u32 s76, s76, s69
    s_cmp_eq_u32 s65, 0
    s_cselect_b32 s77, 8, 1
    s_cselect_b32 s78, 1, 2
    s_lshl_b32 s77, s77, 10
    s_lshl_b32 s78, s78, 10
    v_and_b32 v26, 15, v1
    v_lshrrev_b32 v27, 4, v1
    v_lshrrev_b32 v28, 1, v26
    v_xor_b32 v28, v28, v27
    v_lshlrev_b32 v28, 4, v28
    v_lshlrev_b32 v29, 7, v26
    v_add_u32 v28, v28, v29
    s_lshl_b32 s63, s57, 14
    v_add_u32 v8, s63, v28
    v_xor_b32 v9, 64, v8
    v_add_u32 v10, 65536, v8
    v_add_u32 v11, 65536, v9
    v_add_u32 v12, 131072, v8
    v_add_u32 v13, 131072, v9
    v_add_u32 v84, s68, v28
    v_add_u32 v84, 32768, v84
    v_xor_b32 v85, 64, v84
    v_lshrrev_b32 v28, 2, v26
    v_and_b32 v29, 3, v1
    v_lshlrev_b32 v29, 3, v29
    v_lshlrev_b32 v30, 3, v27
    v_add_u32 v30, v30, v28
    v_lshlrev_b32 v31, 1, v28
    v_and_b32 v7, 1, v27
    v_add_u32 v31, v31, v7
    v_lshlrev_b32 v5, 9, v30
    v_add_u32 v5, v5, v29
    s_lshl_b32 s96, s58, 2
    s_add_u32 s63, s96, 0
    v_xor_b32 v6, s63, v31
    v_lshlrev_b32 v6, 5, v6
    v_add_u32 v14, v5, v6
    v_add_u32 v18, 65536, v14
    v_add_u32 v22, 131072, v14
    s_add_u32 s63, s96, 1
    v_xor_b32 v6, s63, v31
    v_lshlrev_b32 v6, 5, v6
    v_add_u32 v15, v5, v6
    v_add_u32 v19, 65536, v15
    v_add_u32 v23, 131072, v15
    s_add_u32 s63, s96, 2
    v_xor_b32 v6, s63, v31
    v_lshlrev_b32 v6, 5, v6
    v_add_u32 v16, v5, v6
    v_add_u32 v20, 65536, v16
    v_add_u32 v24, 131072, v16
    s_add_u32 s63, s96, 3
    v_xor_b32 v6, s63, v31
    v_lshlrev_b32 v6, 5, v6
    v_add_u32 v17, v5, v6
    v_add_u32 v21, 65536, v17
    v_add_u32 v25, 131072, v17
    v_lshlrev_b32 v5, 8, v30
    v_add_u32 v5, v5, v29
    v_lshlrev_b32 v6, 5, v31
    v_add_u32 v86, v5, v6
    v_xor_b32 v87, 32, v86
    v_xor_b32 v88, 64, v86
    v_xor_b32 v89, 96, v86
    v_xor_b32 v90, 128, v86
    v_xor_b32 v91, 160, v86
    v_xor_b32 v92, 192, v86
    v_xor_b32 v93, 224, v86
    v_add_u32 v94, 98304, v86
    v_add_u32 v95, 98304, v87
    v_add_u32 v96, 98304, v88
    v_add_u32 v97, 98304, v89
    v_add_u32 v98, 98304, v90
    v_add_u32 v99, 98304, v91
    v_add_u32 v100, 98304, v92
    v_add_u32 v101, 98304, v93
    v_lshlrev_b32 v5, 7, v30
    v_add_u32 v5, v5, v29
    v_lshrrev_b32 v6, 1, v28
    v_lshlrev_b32 v7, 1, v7
    v_add_u32 v6, v6, v7
    v_lshlrev_b32 v6, 5, v6
    v_add_u32 v102, v5, v6
    v_xor_b32 v103, 32, v102
    v_xor_b32 v104, 64, v102
    v_xor_b32 v105, 96, v102
    v_add_u32 v106, 98304, v102
    v_add_u32 v107, 98304, v103
    v_add_u32 v108, 98304, v104
    v_add_u32 v109, 98304, v105
    s_lshl_b32 s90, s2, 3
    s_add_u32 s90, s90, s56
    s_lshl_b32 s91, s90, 11
    s_lshl_b32 s90, s90, 10
    buffer_load_dwordx4 v[120:123], v2, s[36:39], s91 offen
    buffer_load_dwordx4 v[120:123], v2, s[36:39], s91 offen offset:1024
    buffer_load_dwordx4 v[120:123], v2, s[24:27], s90 offen
    buffer_load_dwordx4 v[120:123], v2, s[28:31], s90 offen
    s_getpc_b64 s[52:53]
M_pc:
    s_sub_u32 s52, s52, M_pc-gated_mix__compressed_kv_cla__mixer_gmlp__prompt_kernel
    s_subb_u32 s53, s53, 0
    s_mov_b32 s54, TEXT_END-gated_mix__compressed_kv_cla__mixer_gmlp__prompt_kernel
    s_mov_b32 s55, 0x00020000
    s_lshr_b32 s94, s2, 3
    s_lshl_b32 s94, s94, 3
    s_add_u32 s94, s94, s56
    s_lshl_b32 s94, s94, 10
    buffer_load_dwordx4 v[120:123], v2, s[52:55], s94 offen
    s_waitcnt vmcnt(17)
    s_barrier
    ds_read_b64_tr_b16 v[32:33], v14 offset:32768
    ds_read_b64_tr_b16 v[34:35], v14 offset:34816
    ds_read_b64_tr_b16 v[36:37], v15 offset:32768
    ds_read_b64_tr_b16 v[38:39], v15 offset:34816
    ds_read_b64_tr_b16 v[40:41], v16 offset:32768
    ds_read_b64_tr_b16 v[42:43], v16 offset:34816
    ds_read_b64_tr_b16 v[44:45], v17 offset:32768
    ds_read_b64_tr_b16 v[46:47], v17 offset:34816
    ds_read_b128 v[64:67], v8 offset:0
    ds_read_b128 v[68:71], v8 offset:2048
    ds_read_b128 v[72:75], v8 offset:4096
    ds_read_b128 v[76:79], v8 offset:6144
    s_cmp_eq_u32 s65, 0
    s_cbranch_scc0 M_vtype
    s_setprio 2
    s_waitcnt lgkmcnt(3)
    v_mfma_f32_16x16x32_bf16 v[128:131], v[32:35], v[64:67], 0
    v_mfma_f32_16x16x32_bf16 v[132:135], v[36:39], v[64:67], 0
    v_mfma_f32_16x16x32_bf16 v[136:139], v[40:43], v[64:67], 0
    v_mfma_f32_16x16x32_bf16 v[140:143], v[44:47], v[64:67], 0
    s_waitcnt lgkmcnt(2)
    v_mfma_f32_16x16x32_bf16 v[144:147], v[32:35], v[68:71], 0
    ds_read_b128 v[64:67], v8 offset:8192
    v_mfma_f32_16x16x32_bf16 v[148:151], v[36:39], v[68:71], 0
    ds_read_b64_tr_b16 v[48:49], v14 offset:49152
    v_mfma_f32_16x16x32_bf16 v[152:155], v[40:43], v[68:71], 0
    ds_read_b64_tr_b16 v[50:51], v14 offset:51200
    v_mfma_f32_16x16x32_bf16 v[156:159], v[44:47], v[68:71], 0
    s_waitcnt lgkmcnt(4)
    v_mfma_f32_16x16x32_bf16 v[160:163], v[32:35], v[72:75], 0
    ds_read_b128 v[68:71], v8 offset:10240
    v_mfma_f32_16x16x32_bf16 v[164:167], v[36:39], v[72:75], 0
    ds_read_b64_tr_b16 v[52:53], v15 offset:49152
    v_mfma_f32_16x16x32_bf16 v[168:171], v[40:43], v[72:75], 0
    ds_read_b64_tr_b16 v[54:55], v15 offset:51200
    v_mfma_f32_16x16x32_bf16 v[172:175], v[44:47], v[72:75], 0
    s_waitcnt lgkmcnt(6)
    v_mfma_f32_16x16x32_bf16 v[176:179], v[32:35], v[76:79], 0
    ds_read_b128 v[72:75], v8 offset:12288
    v_mfma_f32_16x16x32_bf16 v[180:183], v[36:39], v[76:79], 0
    ds_read_b64_tr_b16 v[56:57], v16 offset:49152
    v_mfma_f32_16x16x32_bf16 v[184:187], v[40:43], v[76:79], 0
    ds_read_b64_tr_b16 v[58:59], v16 offset:51200
    v_mfma_f32_16x16x32_bf16 v[188:191], v[44:47], v[76:79], 0
    s_setprio 1
    s_waitcnt lgkmcnt(8)
    v_mfma_f32_16x16x32_bf16 v[192:195], v[32:35], v[64:67], 0
    ds_read_b128 v[76:79], v8 offset:14336
    v_mfma_f32_16x16x32_bf16 v[196:199], v[36:39], v[64:67], 0
    ds_read_b64_tr_b16 v[60:61], v17 offset:49152
    v_mfma_f32_16x16x32_bf16 v[200:203], v[40:43], v[64:67], 0
    ds_read_b64_tr_b16 v[62:63], v17 offset:51200
    v_mfma_f32_16x16x32_bf16 v[204:207], v[44:47], v[64:67], 0
    s_waitcnt lgkmcnt(8)
    v_mfma_f32_16x16x32_bf16 v[208:211], v[32:35], v[68:71], 0
    ds_read_b128 v[64:67], v9 offset:0
    v_mfma_f32_16x16x32_bf16 v[212:215], v[36:39], v[68:71], 0
    v_mfma_f32_16x16x32_bf16 v[216:219], v[40:43], v[68:71], 0
    v_mfma_f32_16x16x32_bf16 v[220:223], v[44:47], v[68:71], 0
    s_waitcnt lgkmcnt(6)
    v_mfma_f32_16x16x32_bf16 v[224:227], v[32:35], v[72:75], 0
    ds_read_b128 v[68:71], v9 offset:2048
    v_mfma_f32_16x16x32_bf16 v[228:231], v[36:39], v[72:75], 0
    v_mfma_f32_16x16x32_bf16 v[232:235], v[40:43], v[72:75], 0
    v_mfma_f32_16x16x32_bf16 v[236:239], v[44:47], v[72:75], 0
    s_waitcnt lgkmcnt(4)
    v_mfma_f32_16x16x32_bf16 v[240:243], v[32:35], v[76:79], 0
    ds_read_b128 v[72:75], v9 offset:4096
    v_mfma_f32_16x16x32_bf16 v[244:247], v[36:39], v[76:79], 0
    v_mfma_f32_16x16x32_bf16 v[248:251], v[40:43], v[76:79], 0
    v_mfma_f32_16x16x32_bf16 v[252:255], v[44:47], v[76:79], 0
    ds_read_b128 v[76:79], v9 offset:6144
    s_setprio 0
    s_waitcnt lgkmcnt(3)
    v_mfma_f32_16x16x32_bf16 v[128:131], v[48:51], v[64:67], v[128:131]
    v_mfma_f32_16x16x32_bf16 v[132:135], v[52:55], v[64:67], v[132:135]
    v_mfma_f32_16x16x32_bf16 v[136:139], v[56:59], v[64:67], v[136:139]
    v_mfma_f32_16x16x32_bf16 v[140:143], v[60:63], v[64:67], v[140:143]
    s_waitcnt lgkmcnt(2)
    v_mfma_f32_16x16x32_bf16 v[144:147], v[48:51], v[68:71], v[144:147]
    ds_read_b128 v[64:67], v9 offset:8192
    v_mfma_f32_16x16x32_bf16 v[148:151], v[52:55], v[68:71], v[148:151]
    v_mfma_f32_16x16x32_bf16 v[152:155], v[56:59], v[68:71], v[152:155]
    v_mfma_f32_16x16x32_bf16 v[156:159], v[60:63], v[68:71], v[156:159]
    s_waitcnt lgkmcnt(2)
    v_mfma_f32_16x16x32_bf16 v[160:163], v[48:51], v[72:75], v[160:163]
    ds_read_b128 v[68:71], v9 offset:10240
    v_mfma_f32_16x16x32_bf16 v[164:167], v[52:55], v[72:75], v[164:167]
    v_mfma_f32_16x16x32_bf16 v[168:171], v[56:59], v[72:75], v[168:171]
    v_mfma_f32_16x16x32_bf16 v[172:175], v[60:63], v[72:75], v[172:175]
    s_waitcnt lgkmcnt(2)
    v_mfma_f32_16x16x32_bf16 v[176:179], v[48:51], v[76:79], v[176:179]
    ds_read_b128 v[72:75], v9 offset:12288
    v_mfma_f32_16x16x32_bf16 v[180:183], v[52:55], v[76:79], v[180:183]
    v_mfma_f32_16x16x32_bf16 v[184:187], v[56:59], v[76:79], v[184:187]
    v_mfma_f32_16x16x32_bf16 v[188:191], v[60:63], v[76:79], v[188:191]
    s_waitcnt lgkmcnt(2)
    v_mfma_f32_16x16x32_bf16 v[192:195], v[48:51], v[64:67], v[192:195]
    ds_read_b128 v[76:79], v9 offset:14336
    v_mfma_f32_16x16x32_bf16 v[196:199], v[52:55], v[64:67], v[196:199]
    v_mfma_f32_16x16x32_bf16 v[200:203], v[56:59], v[64:67], v[200:203]
    v_mfma_f32_16x16x32_bf16 v[204:207], v[60:63], v[64:67], v[204:207]
    s_waitcnt lgkmcnt(0)
    s_waitcnt vmcnt(9)
    s_barrier
    s_setprio 3
    v_mfma_f32_16x16x32_bf16 v[208:211], v[48:51], v[68:71], v[208:211]
    ds_read_b128 v[64:67], v10 offset:0
    v_mfma_f32_16x16x32_bf16 v[212:215], v[52:55], v[68:71], v[212:215]
    ds_read_b64_tr_b16 v[32:33], v18 offset:32768
    v_mfma_f32_16x16x32_bf16 v[216:219], v[56:59], v[68:71], v[216:219]
    ds_read_b64_tr_b16 v[34:35], v18 offset:34816
    v_mfma_f32_16x16x32_bf16 v[220:223], v[60:63], v[68:71], v[220:223]
    ds_read_b64_tr_b16 v[36:37], v19 offset:32768
    s_add_u32 m0, s67, 0
    s_add_u32 s63, s71, 1048576
    buffer_load_dwordx4 v4, s[20:23], s63 offen lds
    v_mfma_f32_16x16x32_bf16 v[224:227], v[48:51], v[72:75], v[224:227]
    ds_read_b128 v[68:71], v10 offset:2048
    v_mfma_f32_16x16x32_bf16 v[228:231], v[52:55], v[72:75], v[228:231]
    ds_read_b64_tr_b16 v[38:39], v19 offset:34816
    v_mfma_f32_16x16x32_bf16 v[232:235], v[56:59], v[72:75], v[232:235]
    ds_read_b64_tr_b16 v[40:41], v20 offset:32768
    v_mfma_f32_16x16x32_bf16 v[236:239], v[60:63], v[72:75], v[236:239]
    ds_read_b64_tr_b16 v[42:43], v20 offset:34816
    v_mfma_f32_16x16x32_bf16 v[240:243], v[48:51], v[76:79], v[240:243]
    ds_read_b128 v[72:75], v10 offset:4096
    v_mfma_f32_16x16x32_bf16 v[244:247], v[52:55], v[76:79], v[244:247]
    ds_read_b64_tr_b16 v[44:45], v21 offset:32768
    v_mfma_f32_16x16x32_bf16 v[248:251], v[56:59], v[76:79], v[248:251]
    ds_read_b64_tr_b16 v[46:47], v21 offset:34816
    v_mfma_f32_16x16x32_bf16 v[252:255], v[60:63], v[76:79], v[252:255]
    s_add_u32 m0, s67, 8192
    s_add_u32 s63, s71, 1179648
    buffer_load_dwordx4 v4, s[20:23], s63 offen lds
    ds_read_b128 v[76:79], v10 offset:6144
    s_setprio 2
    s_waitcnt lgkmcnt(11)
    s_waitcnt lgkmcnt(9)
    v_mfma_f32_16x16x32_bf16 v[128:131], v[32:35], v[64:67], v[128:131]
    s_waitcnt lgkmcnt(6)
    v_mfma_f32_16x16x32_bf16 v[132:135], v[36:39], v[64:67], v[132:135]
    s_waitcnt lgkmcnt(4)
    v_mfma_f32_16x16x32_bf16 v[136:139], v[40:43], v[64:67], v[136:139]
    s_waitcnt lgkmcnt(1)
    v_mfma_f32_16x16x32_bf16 v[140:143], v[44:47], v[64:67], v[140:143]
    v_mfma_f32_16x16x32_bf16 v[144:147], v[32:35], v[68:71], v[144:147]
    ds_read_b128 v[64:67], v10 offset:8192
    v_mfma_f32_16x16x32_bf16 v[148:151], v[36:39], v[68:71], v[148:151]
    ds_read_b64_tr_b16 v[48:49], v18 offset:49152
    v_mfma_f32_16x16x32_bf16 v[152:155], v[40:43], v[68:71], v[152:155]
    ds_read_b64_tr_b16 v[50:51], v18 offset:51200
    v_mfma_f32_16x16x32_bf16 v[156:159], v[44:47], v[68:71], v[156:159]
    s_add_u32 m0, s67, 16384
    s_add_u32 s63, s71, 1310720
    buffer_load_dwordx4 v4, s[20:23], s63 offen lds
    v_mfma_f32_16x16x32_bf16 v[160:163], v[32:35], v[72:75], v[160:163]
    ds_read_b128 v[68:71], v10 offset:10240
    v_mfma_f32_16x16x32_bf16 v[164:167], v[36:39], v[72:75], v[164:167]
    ds_read_b64_tr_b16 v[52:53], v19 offset:49152
    v_mfma_f32_16x16x32_bf16 v[168:171], v[40:43], v[72:75], v[168:171]
    ds_read_b64_tr_b16 v[54:55], v19 offset:51200
    v_mfma_f32_16x16x32_bf16 v[172:175], v[44:47], v[72:75], v[172:175]
    s_waitcnt lgkmcnt(6)
    v_mfma_f32_16x16x32_bf16 v[176:179], v[32:35], v[76:79], v[176:179]
    ds_read_b128 v[72:75], v10 offset:12288
    v_mfma_f32_16x16x32_bf16 v[180:183], v[36:39], v[76:79], v[180:183]
    ds_read_b64_tr_b16 v[56:57], v20 offset:49152
    v_mfma_f32_16x16x32_bf16 v[184:187], v[40:43], v[76:79], v[184:187]
    ds_read_b64_tr_b16 v[58:59], v20 offset:51200
    v_mfma_f32_16x16x32_bf16 v[188:191], v[44:47], v[76:79], v[188:191]
    s_add_u32 m0, s67, 24576
    s_add_u32 s63, s71, 1441792
    buffer_load_dwordx4 v4, s[20:23], s63 offen lds
    s_setprio 1
    s_waitcnt lgkmcnt(8)
    v_mfma_f32_16x16x32_bf16 v[192:195], v[32:35], v[64:67], v[192:195]
    ds_read_b128 v[76:79], v10 offset:14336
    v_mfma_f32_16x16x32_bf16 v[196:199], v[36:39], v[64:67], v[196:199]
    ds_read_b64_tr_b16 v[60:61], v21 offset:49152
    v_mfma_f32_16x16x32_bf16 v[200:203], v[40:43], v[64:67], v[200:203]
    ds_read_b64_tr_b16 v[62:63], v21 offset:51200
    v_mfma_f32_16x16x32_bf16 v[204:207], v[44:47], v[64:67], v[204:207]
    s_waitcnt lgkmcnt(8)
    v_mfma_f32_16x16x32_bf16 v[208:211], v[32:35], v[68:71], v[208:211]
    ds_read_b128 v[64:67], v11 offset:0
    v_mfma_f32_16x16x32_bf16 v[212:215], v[36:39], v[68:71], v[212:215]
    v_mfma_f32_16x16x32_bf16 v[216:219], v[40:43], v[68:71], v[216:219]
    v_mfma_f32_16x16x32_bf16 v[220:223], v[44:47], v[68:71], v[220:223]
    s_add_u32 m0, s67, 32768
    s_add_u32 s63, s70, 384
    buffer_load_dwordx4 v3, s[16:19], s63 offen lds
    s_waitcnt lgkmcnt(6)
    v_mfma_f32_16x16x32_bf16 v[224:227], v[32:35], v[72:75], v[224:227]
    ds_read_b128 v[68:71], v11 offset:2048
    v_mfma_f32_16x16x32_bf16 v[228:231], v[36:39], v[72:75], v[228:231]
    v_mfma_f32_16x16x32_bf16 v[232:235], v[40:43], v[72:75], v[232:235]
    v_mfma_f32_16x16x32_bf16 v[236:239], v[44:47], v[72:75], v[236:239]
    s_waitcnt lgkmcnt(4)
    v_mfma_f32_16x16x32_bf16 v[240:243], v[32:35], v[76:79], v[240:243]
    ds_read_b128 v[72:75], v11 offset:4096
    v_mfma_f32_16x16x32_bf16 v[244:247], v[36:39], v[76:79], v[244:247]
    v_mfma_f32_16x16x32_bf16 v[248:251], v[40:43], v[76:79], v[248:251]
    v_mfma_f32_16x16x32_bf16 v[252:255], v[44:47], v[76:79], v[252:255]
    s_add_u32 m0, s67, 40960
    s_add_u32 s63, s70, 65920
    buffer_load_dwordx4 v3, s[16:19], s63 offen lds
    ds_read_b128 v[76:79], v11 offset:6144
    s_setprio 0
    s_waitcnt lgkmcnt(3)
    v_mfma_f32_16x16x32_bf16 v[128:131], v[48:51], v[64:67], v[128:131]
    v_mfma_f32_16x16x32_bf16 v[132:135], v[52:55], v[64:67], v[132:135]
    v_mfma_f32_16x16x32_bf16 v[136:139], v[56:59], v[64:67], v[136:139]
    v_mfma_f32_16x16x32_bf16 v[140:143], v[60:63], v[64:67], v[140:143]
    s_waitcnt lgkmcnt(2)
    v_mfma_f32_16x16x32_bf16 v[144:147], v[48:51], v[68:71], v[144:147]
    ds_read_b128 v[64:67], v11 offset:8192
    v_mfma_f32_16x16x32_bf16 v[148:151], v[52:55], v[68:71], v[148:151]
    v_mfma_f32_16x16x32_bf16 v[152:155], v[56:59], v[68:71], v[152:155]
    v_mfma_f32_16x16x32_bf16 v[156:159], v[60:63], v[68:71], v[156:159]
    s_add_u32 m0, s67, 49152
    s_add_u32 s63, s70, 131456
    buffer_load_dwordx4 v3, s[16:19], s63 offen lds
    s_waitcnt lgkmcnt(2)
    v_mfma_f32_16x16x32_bf16 v[160:163], v[48:51], v[72:75], v[160:163]
    ds_read_b128 v[68:71], v11 offset:10240
    v_mfma_f32_16x16x32_bf16 v[164:167], v[52:55], v[72:75], v[164:167]
    v_mfma_f32_16x16x32_bf16 v[168:171], v[56:59], v[72:75], v[168:171]
    v_mfma_f32_16x16x32_bf16 v[172:175], v[60:63], v[72:75], v[172:175]
    s_waitcnt lgkmcnt(2)
    v_mfma_f32_16x16x32_bf16 v[176:179], v[48:51], v[76:79], v[176:179]
    ds_read_b128 v[72:75], v11 offset:12288
    v_mfma_f32_16x16x32_bf16 v[180:183], v[52:55], v[76:79], v[180:183]
    v_mfma_f32_16x16x32_bf16 v[184:187], v[56:59], v[76:79], v[184:187]
    v_mfma_f32_16x16x32_bf16 v[188:191], v[60:63], v[76:79], v[188:191]
    s_add_u32 m0, s67, 57344
    s_add_u32 s63, s70, 196992
    buffer_load_dwordx4 v3, s[16:19], s63 offen lds
    s_waitcnt lgkmcnt(2)
    v_mfma_f32_16x16x32_bf16 v[192:195], v[48:51], v[64:67], v[192:195]
    ds_read_b128 v[76:79], v11 offset:14336
    v_mfma_f32_16x16x32_bf16 v[196:199], v[52:55], v[64:67], v[196:199]
    v_mfma_f32_16x16x32_bf16 v[200:203], v[56:59], v[64:67], v[200:203]
    v_mfma_f32_16x16x32_bf16 v[204:207], v[60:63], v[64:67], v[204:207]
    s_waitcnt lgkmcnt(0)
    s_waitcnt vmcnt(4)
    s_barrier
    s_setprio 3
    v_mfma_f32_16x16x32_bf16 v[208:211], v[48:51], v[68:71], v[208:211]
    ds_read_b128 v[64:67], v12 offset:0
    v_mfma_f32_16x16x32_bf16 v[212:215], v[52:55], v[68:71], v[212:215]
    ds_read_b64_tr_b16 v[32:33], v14 offset:0
    v_mfma_f32_16x16x32_bf16 v[216:219], v[56:59], v[68:71], v[216:219]
    ds_read_b64_tr_b16 v[34:35], v14 offset:2048
    v_mfma_f32_16x16x32_bf16 v[220:223], v[60:63], v[68:71], v[220:223]
    ds_read_b64_tr_b16 v[36:37], v15 offset:0
    s_add_u32 m0, s67, 65536
    s_add_u32 s63, s71, 1572864
    buffer_load_dwordx4 v4, s[20:23], s63 offen lds
    v_mfma_f32_16x16x32_bf16 v[224:227], v[48:51], v[72:75], v[224:227]
    ds_read_b128 v[68:71], v12 offset:2048
    v_mfma_f32_16x16x32_bf16 v[228:231], v[52:55], v[72:75], v[228:231]
    ds_read_b64_tr_b16 v[38:39], v15 offset:2048
    v_mfma_f32_16x16x32_bf16 v[232:235], v[56:59], v[72:75], v[232:235]
    ds_read_b64_tr_b16 v[40:41], v16 offset:0
    v_mfma_f32_16x16x32_bf16 v[236:239], v[60:63], v[72:75], v[236:239]
    ds_read_b64_tr_b16 v[42:43], v16 offset:2048
    v_mfma_f32_16x16x32_bf16 v[240:243], v[48:51], v[76:79], v[240:243]
    ds_read_b128 v[72:75], v12 offset:4096
    v_mfma_f32_16x16x32_bf16 v[244:247], v[52:55], v[76:79], v[244:247]
    ds_read_b64_tr_b16 v[44:45], v17 offset:0
    v_mfma_f32_16x16x32_bf16 v[248:251], v[56:59], v[76:79], v[248:251]
    ds_read_b64_tr_b16 v[46:47], v17 offset:2048
    v_mfma_f32_16x16x32_bf16 v[252:255], v[60:63], v[76:79], v[252:255]
    s_add_u32 m0, s67, 73728
    s_add_u32 s63, s71, 1703936
    buffer_load_dwordx4 v4, s[20:23], s63 offen lds
    ds_read_b128 v[76:79], v12 offset:6144
    s_setprio 2
    s_waitcnt lgkmcnt(11)
    s_waitcnt lgkmcnt(9)
    v_mfma_f32_16x16x32_bf16 v[128:131], v[32:35], v[64:67], v[128:131]
    s_waitcnt lgkmcnt(6)
    v_mfma_f32_16x16x32_bf16 v[132:135], v[36:39], v[64:67], v[132:135]
    s_waitcnt lgkmcnt(4)
    v_mfma_f32_16x16x32_bf16 v[136:139], v[40:43], v[64:67], v[136:139]
    s_waitcnt lgkmcnt(1)
    v_mfma_f32_16x16x32_bf16 v[140:143], v[44:47], v[64:67], v[140:143]
    v_mfma_f32_16x16x32_bf16 v[144:147], v[32:35], v[68:71], v[144:147]
    ds_read_b128 v[64:67], v12 offset:8192
    v_mfma_f32_16x16x32_bf16 v[148:151], v[36:39], v[68:71], v[148:151]
    ds_read_b64_tr_b16 v[48:49], v14 offset:16384
    v_mfma_f32_16x16x32_bf16 v[152:155], v[40:43], v[68:71], v[152:155]
    ds_read_b64_tr_b16 v[50:51], v14 offset:18432
    v_mfma_f32_16x16x32_bf16 v[156:159], v[44:47], v[68:71], v[156:159]
    s_add_u32 m0, s67, 81920
    s_add_u32 s63, s71, 1835008
    buffer_load_dwordx4 v4, s[20:23], s63 offen lds
    v_mfma_f32_16x16x32_bf16 v[160:163], v[32:35], v[72:75], v[160:163]
    ds_read_b128 v[68:71], v12 offset:10240
    v_mfma_f32_16x16x32_bf16 v[164:167], v[36:39], v[72:75], v[164:167]
    ds_read_b64_tr_b16 v[52:53], v15 offset:16384
    v_mfma_f32_16x16x32_bf16 v[168:171], v[40:43], v[72:75], v[168:171]
    ds_read_b64_tr_b16 v[54:55], v15 offset:18432
    v_mfma_f32_16x16x32_bf16 v[172:175], v[44:47], v[72:75], v[172:175]
    s_waitcnt lgkmcnt(6)
    v_mfma_f32_16x16x32_bf16 v[176:179], v[32:35], v[76:79], v[176:179]
    ds_read_b128 v[72:75], v12 offset:12288
    v_mfma_f32_16x16x32_bf16 v[180:183], v[36:39], v[76:79], v[180:183]
    ds_read_b64_tr_b16 v[56:57], v16 offset:16384
    v_mfma_f32_16x16x32_bf16 v[184:187], v[40:43], v[76:79], v[184:187]
    ds_read_b64_tr_b16 v[58:59], v16 offset:18432
    v_mfma_f32_16x16x32_bf16 v[188:191], v[44:47], v[76:79], v[188:191]
    s_add_u32 m0, s67, 90112
    s_add_u32 s63, s71, 1966080
    buffer_load_dwordx4 v4, s[20:23], s63 offen lds
    s_setprio 1
    s_waitcnt lgkmcnt(8)
    v_mfma_f32_16x16x32_bf16 v[192:195], v[32:35], v[64:67], v[192:195]
    ds_read_b128 v[76:79], v12 offset:14336
    v_mfma_f32_16x16x32_bf16 v[196:199], v[36:39], v[64:67], v[196:199]
    ds_read_b64_tr_b16 v[60:61], v17 offset:16384
    v_mfma_f32_16x16x32_bf16 v[200:203], v[40:43], v[64:67], v[200:203]
    ds_read_b64_tr_b16 v[62:63], v17 offset:18432
    v_mfma_f32_16x16x32_bf16 v[204:207], v[44:47], v[64:67], v[204:207]
    s_waitcnt lgkmcnt(8)
    v_mfma_f32_16x16x32_bf16 v[208:211], v[32:35], v[68:71], v[208:211]
    ds_read_b128 v[64:67], v13 offset:0
    v_mfma_f32_16x16x32_bf16 v[212:215], v[36:39], v[68:71], v[212:215]
    v_mfma_f32_16x16x32_bf16 v[216:219], v[40:43], v[68:71], v[216:219]
    v_mfma_f32_16x16x32_bf16 v[220:223], v[44:47], v[68:71], v[220:223]
    s_add_u32 m0, s67, 98304
    s_add_u32 s63, s70, 512
    buffer_load_dwordx4 v3, s[16:19], s63 offen lds
    s_waitcnt lgkmcnt(6)
    v_mfma_f32_16x16x32_bf16 v[224:227], v[32:35], v[72:75], v[224:227]
    ds_read_b128 v[68:71], v13 offset:2048
    v_mfma_f32_16x16x32_bf16 v[228:231], v[36:39], v[72:75], v[228:231]
    v_mfma_f32_16x16x32_bf16 v[232:235], v[40:43], v[72:75], v[232:235]
    v_mfma_f32_16x16x32_bf16 v[236:239], v[44:47], v[72:75], v[236:239]
    s_waitcnt lgkmcnt(4)
    v_mfma_f32_16x16x32_bf16 v[240:243], v[32:35], v[76:79], v[240:243]
    ds_read_b128 v[72:75], v13 offset:4096
    v_mfma_f32_16x16x32_bf16 v[244:247], v[36:39], v[76:79], v[244:247]
    v_mfma_f32_16x16x32_bf16 v[248:251], v[40:43], v[76:79], v[248:251]
    v_mfma_f32_16x16x32_bf16 v[252:255], v[44:47], v[76:79], v[252:255]
    s_add_u32 m0, s67, 106496
    s_add_u32 s63, s70, 66048
    buffer_load_dwordx4 v3, s[16:19], s63 offen lds
    ds_read_b128 v[76:79], v13 offset:6144
    s_setprio 0
    s_waitcnt lgkmcnt(3)
    v_mfma_f32_16x16x32_bf16 v[128:131], v[48:51], v[64:67], v[128:131]
    v_mfma_f32_16x16x32_bf16 v[132:135], v[52:55], v[64:67], v[132:135]
    v_mfma_f32_16x16x32_bf16 v[136:139], v[56:59], v[64:67], v[136:139]
    v_mfma_f32_16x16x32_bf16 v[140:143], v[60:63], v[64:67], v[140:143]
    s_waitcnt lgkmcnt(2)
    v_mfma_f32_16x16x32_bf16 v[144:147], v[48:51], v[68:71], v[144:147]
    ds_read_b128 v[64:67], v13 offset:8192
    v_mfma_f32_16x16x32_bf16 v[148:151], v[52:55], v[68:71], v[148:151]
    v_mfma_f32_16x16x32_bf16 v[152:155], v[56:59], v[68:71], v[152:155]
    v_mfma_f32_16x16x32_bf16 v[156:159], v[60:63], v[68:71], v[156:159]
    s_add_u32 m0, s67, 114688
    s_add_u32 s63, s70, 131584
    buffer_load_dwordx4 v3, s[16:19], s63 offen lds
    s_waitcnt lgkmcnt(2)
    v_mfma_f32_16x16x32_bf16 v[160:163], v[48:51], v[72:75], v[160:163]
    ds_read_b128 v[68:71], v13 offset:10240
    v_mfma_f32_16x16x32_bf16 v[164:167], v[52:55], v[72:75], v[164:167]
    v_mfma_f32_16x16x32_bf16 v[168:171], v[56:59], v[72:75], v[168:171]
    v_mfma_f32_16x16x32_bf16 v[172:175], v[60:63], v[72:75], v[172:175]
    s_waitcnt lgkmcnt(2)
    v_mfma_f32_16x16x32_bf16 v[176:179], v[48:51], v[76:79], v[176:179]
    ds_read_b128 v[72:75], v13 offset:12288
    v_mfma_f32_16x16x32_bf16 v[180:183], v[52:55], v[76:79], v[180:183]
    v_mfma_f32_16x16x32_bf16 v[184:187], v[56:59], v[76:79], v[184:187]
    v_mfma_f32_16x16x32_bf16 v[188:191], v[60:63], v[76:79], v[188:191]
    s_add_u32 m0, s67, 122880
    s_add_u32 s63, s70, 197120
    buffer_load_dwordx4 v3, s[16:19], s63 offen lds
    s_waitcnt lgkmcnt(2)
    v_mfma_f32_16x16x32_bf16 v[192:195], v[48:51], v[64:67], v[192:195]
    ds_read_b128 v[76:79], v13 offset:14336
    v_mfma_f32_16x16x32_bf16 v[196:199], v[52:55], v[64:67], v[196:199]
    v_mfma_f32_16x16x32_bf16 v[200:203], v[56:59], v[64:67], v[200:203]
    v_mfma_f32_16x16x32_bf16 v[204:207], v[60:63], v[64:67], v[204:207]
    s_waitcnt lgkmcnt(0)
    s_waitcnt vmcnt(4)
    s_barrier
    s_setprio 3
    v_mfma_f32_16x16x32_bf16 v[208:211], v[48:51], v[68:71], v[208:211]
    ds_read_b128 v[64:67], v8 offset:32768
    v_mfma_f32_16x16x32_bf16 v[212:215], v[52:55], v[68:71], v[212:215]
    ds_read_b64_tr_b16 v[32:33], v18 offset:0
    v_mfma_f32_16x16x32_bf16 v[216:219], v[56:59], v[68:71], v[216:219]
    ds_read_b64_tr_b16 v[34:35], v18 offset:2048
    v_mfma_f32_16x16x32_bf16 v[220:223], v[60:63], v[68:71], v[220:223]
    ds_read_b64_tr_b16 v[36:37], v19 offset:0
    s_add_u32 m0, s67, 131072
    s_add_u32 s63, s71, 2097152
    buffer_load_dwordx4 v4, s[20:23], s63 offen lds
    v_mfma_f32_16x16x32_bf16 v[224:227], v[48:51], v[72:75], v[224:227]
    ds_read_b128 v[68:71], v8 offset:34816
    v_mfma_f32_16x16x32_bf16 v[228:231], v[52:55], v[72:75], v[228:231]
    ds_read_b64_tr_b16 v[38:39], v19 offset:2048
    v_mfma_f32_16x16x32_bf16 v[232:235], v[56:59], v[72:75], v[232:235]
    ds_read_b64_tr_b16 v[40:41], v20 offset:0
    v_mfma_f32_16x16x32_bf16 v[236:239], v[60:63], v[72:75], v[236:239]
    ds_read_b64_tr_b16 v[42:43], v20 offset:2048
    v_mfma_f32_16x16x32_bf16 v[240:243], v[48:51], v[76:79], v[240:243]
    ds_read_b128 v[72:75], v8 offset:36864
    v_mfma_f32_16x16x32_bf16 v[244:247], v[52:55], v[76:79], v[244:247]
    ds_read_b64_tr_b16 v[44:45], v21 offset:0
    v_mfma_f32_16x16x32_bf16 v[248:251], v[56:59], v[76:79], v[248:251]
    ds_read_b64_tr_b16 v[46:47], v21 offset:2048
    v_mfma_f32_16x16x32_bf16 v[252:255], v[60:63], v[76:79], v[252:255]
    s_add_u32 m0, s67, 139264
    s_add_u32 s63, s71, 2228224
    buffer_load_dwordx4 v4, s[20:23], s63 offen lds
    ds_read_b128 v[76:79], v8 offset:38912
    s_setprio 2
    s_waitcnt lgkmcnt(11)
    s_waitcnt lgkmcnt(9)
    v_mfma_f32_16x16x32_bf16 v[128:131], v[32:35], v[64:67], v[128:131]
    s_waitcnt lgkmcnt(6)
    v_mfma_f32_16x16x32_bf16 v[132:135], v[36:39], v[64:67], v[132:135]
    s_waitcnt lgkmcnt(4)
    v_mfma_f32_16x16x32_bf16 v[136:139], v[40:43], v[64:67], v[136:139]
    s_waitcnt lgkmcnt(1)
    v_mfma_f32_16x16x32_bf16 v[140:143], v[44:47], v[64:67], v[140:143]
    v_mfma_f32_16x16x32_bf16 v[144:147], v[32:35], v[68:71], v[144:147]
    ds_read_b128 v[64:67], v8 offset:40960
    v_mfma_f32_16x16x32_bf16 v[148:151], v[36:39], v[68:71], v[148:151]
    ds_read_b64_tr_b16 v[48:49], v18 offset:16384
    v_mfma_f32_16x16x32_bf16 v[152:155], v[40:43], v[68:71], v[152:155]
    ds_read_b64_tr_b16 v[50:51], v18 offset:18432
    v_mfma_f32_16x16x32_bf16 v[156:159], v[44:47], v[68:71], v[156:159]
    s_add_u32 m0, s67, 147456
    s_add_u32 s63, s71, 2359296
    buffer_load_dwordx4 v4, s[20:23], s63 offen lds
    v_mfma_f32_16x16x32_bf16 v[160:163], v[32:35], v[72:75], v[160:163]
    ds_read_b128 v[68:71], v8 offset:43008
    v_mfma_f32_16x16x32_bf16 v[164:167], v[36:39], v[72:75], v[164:167]
    ds_read_b64_tr_b16 v[52:53], v19 offset:16384
    v_mfma_f32_16x16x32_bf16 v[168:171], v[40:43], v[72:75], v[168:171]
    ds_read_b64_tr_b16 v[54:55], v19 offset:18432
    v_mfma_f32_16x16x32_bf16 v[172:175], v[44:47], v[72:75], v[172:175]
    s_waitcnt lgkmcnt(6)
    v_mfma_f32_16x16x32_bf16 v[176:179], v[32:35], v[76:79], v[176:179]
    ds_read_b128 v[72:75], v8 offset:45056
    v_mfma_f32_16x16x32_bf16 v[180:183], v[36:39], v[76:79], v[180:183]
    ds_read_b64_tr_b16 v[56:57], v20 offset:16384
    v_mfma_f32_16x16x32_bf16 v[184:187], v[40:43], v[76:79], v[184:187]
    ds_read_b64_tr_b16 v[58:59], v20 offset:18432
    v_mfma_f32_16x16x32_bf16 v[188:191], v[44:47], v[76:79], v[188:191]
    s_add_u32 m0, s67, 155648
    s_add_u32 s63, s71, 2490368
    buffer_load_dwordx4 v4, s[20:23], s63 offen lds
    s_setprio 1
    s_waitcnt lgkmcnt(8)
    v_mfma_f32_16x16x32_bf16 v[192:195], v[32:35], v[64:67], v[192:195]
    ds_read_b128 v[76:79], v8 offset:47104
    v_mfma_f32_16x16x32_bf16 v[196:199], v[36:39], v[64:67], v[196:199]
    ds_read_b64_tr_b16 v[60:61], v21 offset:16384
    v_mfma_f32_16x16x32_bf16 v[200:203], v[40:43], v[64:67], v[200:203]
    ds_read_b64_tr_b16 v[62:63], v21 offset:18432
    v_mfma_f32_16x16x32_bf16 v[204:207], v[44:47], v[64:67], v[204:207]
    s_waitcnt lgkmcnt(8)
    v_mfma_f32_16x16x32_bf16 v[208:211], v[32:35], v[68:71], v[208:211]
    ds_read_b128 v[64:67], v9 offset:32768
    v_mfma_f32_16x16x32_bf16 v[212:215], v[36:39], v[68:71], v[212:215]
    v_mfma_f32_16x16x32_bf16 v[216:219], v[40:43], v[68:71], v[216:219]
    v_mfma_f32_16x16x32_bf16 v[220:223], v[44:47], v[68:71], v[220:223]
    s_add_u32 m0, s67, 0
    s_add_u32 s63, s70, 640
    buffer_load_dwordx4 v3, s[16:19], s63 offen lds
    s_waitcnt lgkmcnt(6)
    v_mfma_f32_16x16x32_bf16 v[224:227], v[32:35], v[72:75], v[224:227]
    ds_read_b128 v[68:71], v9 offset:34816
    v_mfma_f32_16x16x32_bf16 v[228:231], v[36:39], v[72:75], v[228:231]
    v_mfma_f32_16x16x32_bf16 v[232:235], v[40:43], v[72:75], v[232:235]
    v_mfma_f32_16x16x32_bf16 v[236:239], v[44:47], v[72:75], v[236:239]
    s_waitcnt lgkmcnt(4)
    v_mfma_f32_16x16x32_bf16 v[240:243], v[32:35], v[76:79], v[240:243]
    ds_read_b128 v[72:75], v9 offset:36864
    v_mfma_f32_16x16x32_bf16 v[244:247], v[36:39], v[76:79], v[244:247]
    v_mfma_f32_16x16x32_bf16 v[248:251], v[40:43], v[76:79], v[248:251]
    v_mfma_f32_16x16x32_bf16 v[252:255], v[44:47], v[76:79], v[252:255]
    s_add_u32 m0, s67, 8192
    s_add_u32 s63, s70, 66176
    buffer_load_dwordx4 v3, s[16:19], s63 offen lds
    ds_read_b128 v[76:79], v9 offset:38912
    s_setprio 0
    s_waitcnt lgkmcnt(3)
    v_mfma_f32_16x16x32_bf16 v[128:131], v[48:51], v[64:67], v[128:131]
    v_mfma_f32_16x16x32_bf16 v[132:135], v[52:55], v[64:67], v[132:135]
    v_mfma_f32_16x16x32_bf16 v[136:139], v[56:59], v[64:67], v[136:139]
    v_mfma_f32_16x16x32_bf16 v[140:143], v[60:63], v[64:67], v[140:143]
    s_waitcnt lgkmcnt(2)
    v_mfma_f32_16x16x32_bf16 v[144:147], v[48:51], v[68:71], v[144:147]
    ds_read_b128 v[64:67], v9 offset:40960
    v_mfma_f32_16x16x32_bf16 v[148:151], v[52:55], v[68:71], v[148:151]
    v_mfma_f32_16x16x32_bf16 v[152:155], v[56:59], v[68:71], v[152:155]
    v_mfma_f32_16x16x32_bf16 v[156:159], v[60:63], v[68:71], v[156:159]
    s_add_u32 m0, s67, 16384
    s_add_u32 s63, s70, 131712
    buffer_load_dwordx4 v3, s[16:19], s63 offen lds
    s_waitcnt lgkmcnt(2)
    v_mfma_f32_16x16x32_bf16 v[160:163], v[48:51], v[72:75], v[160:163]
    ds_read_b128 v[68:71], v9 offset:43008
    v_mfma_f32_16x16x32_bf16 v[164:167], v[52:55], v[72:75], v[164:167]
    v_mfma_f32_16x16x32_bf16 v[168:171], v[56:59], v[72:75], v[168:171]
    v_mfma_f32_16x16x32_bf16 v[172:175], v[60:63], v[72:75], v[172:175]
    s_waitcnt lgkmcnt(2)
    v_mfma_f32_16x16x32_bf16 v[176:179], v[48:51], v[76:79], v[176:179]
    ds_read_b128 v[72:75], v9 offset:45056
    v_mfma_f32_16x16x32_bf16 v[180:183], v[52:55], v[76:79], v[180:183]
    v_mfma_f32_16x16x32_bf16 v[184:187], v[56:59], v[76:79], v[184:187]
    v_mfma_f32_16x16x32_bf16 v[188:191], v[60:63], v[76:79], v[188:191]
    s_add_u32 m0, s67, 24576
    s_add_u32 s63, s70, 197248
    buffer_load_dwordx4 v3, s[16:19], s63 offen lds
    s_waitcnt lgkmcnt(2)
    v_mfma_f32_16x16x32_bf16 v[192:195], v[48:51], v[64:67], v[192:195]
    ds_read_b128 v[76:79], v9 offset:47104
    v_mfma_f32_16x16x32_bf16 v[196:199], v[52:55], v[64:67], v[196:199]
    v_mfma_f32_16x16x32_bf16 v[200:203], v[56:59], v[64:67], v[200:203]
    v_mfma_f32_16x16x32_bf16 v[204:207], v[60:63], v[64:67], v[204:207]
    s_waitcnt lgkmcnt(0)
    s_waitcnt vmcnt(4)
    s_barrier
    s_setprio 3
    v_mfma_f32_16x16x32_bf16 v[208:211], v[48:51], v[68:71], v[208:211]
    ds_read_b128 v[64:67], v10 offset:32768
    v_mfma_f32_16x16x32_bf16 v[212:215], v[52:55], v[68:71], v[212:215]
    ds_read_b64_tr_b16 v[32:33], v22 offset:0
    v_mfma_f32_16x16x32_bf16 v[216:219], v[56:59], v[68:71], v[216:219]
    ds_read_b64_tr_b16 v[34:35], v22 offset:2048
    v_mfma_f32_16x16x32_bf16 v[220:223], v[60:63], v[68:71], v[220:223]
    ds_read_b64_tr_b16 v[36:37], v23 offset:0
    s_add_u32 m0, s67, 32768
    s_add_u32 s63, s71, 2621440
    buffer_load_dwordx4 v4, s[20:23], s63 offen lds
    v_mfma_f32_16x16x32_bf16 v[224:227], v[48:51], v[72:75], v[224:227]
    ds_read_b128 v[68:71], v10 offset:34816
    v_mfma_f32_16x16x32_bf16 v[228:231], v[52:55], v[72:75], v[228:231]
    ds_read_b64_tr_b16 v[38:39], v23 offset:2048
    v_mfma_f32_16x16x32_bf16 v[232:235], v[56:59], v[72:75], v[232:235]
    ds_read_b64_tr_b16 v[40:41], v24 offset:0
    v_mfma_f32_16x16x32_bf16 v[236:239], v[60:63], v[72:75], v[236:239]
    ds_read_b64_tr_b16 v[42:43], v24 offset:2048
    v_mfma_f32_16x16x32_bf16 v[240:243], v[48:51], v[76:79], v[240:243]
    ds_read_b128 v[72:75], v10 offset:36864
    v_mfma_f32_16x16x32_bf16 v[244:247], v[52:55], v[76:79], v[244:247]
    ds_read_b64_tr_b16 v[44:45], v25 offset:0
    v_mfma_f32_16x16x32_bf16 v[248:251], v[56:59], v[76:79], v[248:251]
    ds_read_b64_tr_b16 v[46:47], v25 offset:2048
    v_mfma_f32_16x16x32_bf16 v[252:255], v[60:63], v[76:79], v[252:255]
    s_add_u32 m0, s67, 40960
    s_add_u32 s63, s71, 2752512
    buffer_load_dwordx4 v4, s[20:23], s63 offen lds
    ds_read_b128 v[76:79], v10 offset:38912
    s_setprio 2
    s_waitcnt lgkmcnt(11)
    s_waitcnt lgkmcnt(9)
    v_mfma_f32_16x16x32_bf16 v[128:131], v[32:35], v[64:67], v[128:131]
    s_waitcnt lgkmcnt(6)
    v_mfma_f32_16x16x32_bf16 v[132:135], v[36:39], v[64:67], v[132:135]
    s_waitcnt lgkmcnt(4)
    v_mfma_f32_16x16x32_bf16 v[136:139], v[40:43], v[64:67], v[136:139]
    s_waitcnt lgkmcnt(1)
    v_mfma_f32_16x16x32_bf16 v[140:143], v[44:47], v[64:67], v[140:143]
    v_mfma_f32_16x16x32_bf16 v[144:147], v[32:35], v[68:71], v[144:147]
    ds_read_b128 v[64:67], v10 offset:40960
    v_mfma_f32_16x16x32_bf16 v[148:151], v[36:39], v[68:71], v[148:151]
    ds_read_b64_tr_b16 v[48:49], v22 offset:16384
    v_mfma_f32_16x16x32_bf16 v[152:155], v[40:43], v[68:71], v[152:155]
    ds_read_b64_tr_b16 v[50:51], v22 offset:18432
    v_mfma_f32_16x16x32_bf16 v[156:159], v[44:47], v[68:71], v[156:159]
    s_add_u32 m0, s67, 49152
    s_add_u32 s63, s71, 2883584
    buffer_load_dwordx4 v4, s[20:23], s63 offen lds
    v_mfma_f32_16x16x32_bf16 v[160:163], v[32:35], v[72:75], v[160:163]
    ds_read_b128 v[68:71], v10 offset:43008
    v_mfma_f32_16x16x32_bf16 v[164:167], v[36:39], v[72:75], v[164:167]
    ds_read_b64_tr_b16 v[52:53], v23 offset:16384
    v_mfma_f32_16x16x32_bf16 v[168:171], v[40:43], v[72:75], v[168:171]
    ds_read_b64_tr_b16 v[54:55], v23 offset:18432
    v_mfma_f32_16x16x32_bf16 v[172:175], v[44:47], v[72:75], v[172:175]
    s_waitcnt lgkmcnt(6)
    v_mfma_f32_16x16x32_bf16 v[176:179], v[32:35], v[76:79], v[176:179]
    ds_read_b128 v[72:75], v10 offset:45056
    v_mfma_f32_16x16x32_bf16 v[180:183], v[36:39], v[76:79], v[180:183]
    ds_read_b64_tr_b16 v[56:57], v24 offset:16384
    v_mfma_f32_16x16x32_bf16 v[184:187], v[40:43], v[76:79], v[184:187]
    ds_read_b64_tr_b16 v[58:59], v24 offset:18432
    v_mfma_f32_16x16x32_bf16 v[188:191], v[44:47], v[76:79], v[188:191]
    s_add_u32 m0, s67, 57344
    s_add_u32 s63, s71, 3014656
    buffer_load_dwordx4 v4, s[20:23], s63 offen lds
    s_setprio 1
    s_waitcnt lgkmcnt(8)
    v_mfma_f32_16x16x32_bf16 v[192:195], v[32:35], v[64:67], v[192:195]
    ds_read_b128 v[76:79], v10 offset:47104
    v_mfma_f32_16x16x32_bf16 v[196:199], v[36:39], v[64:67], v[196:199]
    ds_read_b64_tr_b16 v[60:61], v25 offset:16384
    v_mfma_f32_16x16x32_bf16 v[200:203], v[40:43], v[64:67], v[200:203]
    ds_read_b64_tr_b16 v[62:63], v25 offset:18432
    v_mfma_f32_16x16x32_bf16 v[204:207], v[44:47], v[64:67], v[204:207]
    s_waitcnt lgkmcnt(8)
    v_mfma_f32_16x16x32_bf16 v[208:211], v[32:35], v[68:71], v[208:211]
    ds_read_b128 v[64:67], v11 offset:32768
    v_mfma_f32_16x16x32_bf16 v[212:215], v[36:39], v[68:71], v[212:215]
    v_mfma_f32_16x16x32_bf16 v[216:219], v[40:43], v[68:71], v[216:219]
    v_mfma_f32_16x16x32_bf16 v[220:223], v[44:47], v[68:71], v[220:223]
    s_add_u32 m0, s67, 65536
    s_add_u32 s63, s70, 768
    buffer_load_dwordx4 v3, s[16:19], s63 offen lds
    s_waitcnt lgkmcnt(6)
    v_mfma_f32_16x16x32_bf16 v[224:227], v[32:35], v[72:75], v[224:227]
    ds_read_b128 v[68:71], v11 offset:34816
    v_mfma_f32_16x16x32_bf16 v[228:231], v[36:39], v[72:75], v[228:231]
    v_mfma_f32_16x16x32_bf16 v[232:235], v[40:43], v[72:75], v[232:235]
    v_mfma_f32_16x16x32_bf16 v[236:239], v[44:47], v[72:75], v[236:239]
    s_waitcnt lgkmcnt(4)
    v_mfma_f32_16x16x32_bf16 v[240:243], v[32:35], v[76:79], v[240:243]
    ds_read_b128 v[72:75], v11 offset:36864
    v_mfma_f32_16x16x32_bf16 v[244:247], v[36:39], v[76:79], v[244:247]
    v_mfma_f32_16x16x32_bf16 v[248:251], v[40:43], v[76:79], v[248:251]
    v_mfma_f32_16x16x32_bf16 v[252:255], v[44:47], v[76:79], v[252:255]
    s_add_u32 m0, s67, 73728
    s_add_u32 s63, s70, 66304
    buffer_load_dwordx4 v3, s[16:19], s63 offen lds
    ds_read_b128 v[76:79], v11 offset:38912
    s_setprio 0
    s_waitcnt lgkmcnt(3)
    v_mfma_f32_16x16x32_bf16 v[128:131], v[48:51], v[64:67], v[128:131]
    v_mfma_f32_16x16x32_bf16 v[132:135], v[52:55], v[64:67], v[132:135]
    v_mfma_f32_16x16x32_bf16 v[136:139], v[56:59], v[64:67], v[136:139]
    v_mfma_f32_16x16x32_bf16 v[140:143], v[60:63], v[64:67], v[140:143]
    s_waitcnt lgkmcnt(2)
    v_mfma_f32_16x16x32_bf16 v[144:147], v[48:51], v[68:71], v[144:147]
    ds_read_b128 v[64:67], v11 offset:40960
    v_mfma_f32_16x16x32_bf16 v[148:151], v[52:55], v[68:71], v[148:151]
    v_mfma_f32_16x16x32_bf16 v[152:155], v[56:59], v[68:71], v[152:155]
    v_mfma_f32_16x16x32_bf16 v[156:159], v[60:63], v[68:71], v[156:159]
    s_add_u32 m0, s67, 81920
    s_add_u32 s63, s70, 131840
    buffer_load_dwordx4 v3, s[16:19], s63 offen lds
    s_waitcnt lgkmcnt(2)
    v_mfma_f32_16x16x32_bf16 v[160:163], v[48:51], v[72:75], v[160:163]
    ds_read_b128 v[68:71], v11 offset:43008
    v_mfma_f32_16x16x32_bf16 v[164:167], v[52:55], v[72:75], v[164:167]
    v_mfma_f32_16x16x32_bf16 v[168:171], v[56:59], v[72:75], v[168:171]
    v_mfma_f32_16x16x32_bf16 v[172:175], v[60:63], v[72:75], v[172:175]
    s_waitcnt lgkmcnt(2)
    v_mfma_f32_16x16x32_bf16 v[176:179], v[48:51], v[76:79], v[176:179]
    ds_read_b128 v[72:75], v11 offset:45056
    v_mfma_f32_16x16x32_bf16 v[180:183], v[52:55], v[76:79], v[180:183]
    v_mfma_f32_16x16x32_bf16 v[184:187], v[56:59], v[76:79], v[184:187]
    v_mfma_f32_16x16x32_bf16 v[188:191], v[60:63], v[76:79], v[188:191]
    s_add_u32 m0, s67, 90112
    s_add_u32 s63, s70, 197376
    buffer_load_dwordx4 v3, s[16:19], s63 offen lds
    s_waitcnt lgkmcnt(2)
    v_mfma_f32_16x16x32_bf16 v[192:195], v[48:51], v[64:67], v[192:195]
    ds_read_b128 v[76:79], v11 offset:47104
    v_mfma_f32_16x16x32_bf16 v[196:199], v[52:55], v[64:67], v[196:199]
    v_mfma_f32_16x16x32_bf16 v[200:203], v[56:59], v[64:67], v[200:203]
    v_mfma_f32_16x16x32_bf16 v[204:207], v[60:63], v[64:67], v[204:207]
    s_waitcnt lgkmcnt(0)
    s_waitcnt vmcnt(4)
    s_barrier
    s_setprio 3
    v_mfma_f32_16x16x32_bf16 v[208:211], v[48:51], v[68:71], v[208:211]
    ds_read_b128 v[64:67], v8 offset:0
    v_mfma_f32_16x16x32_bf16 v[212:215], v[52:55], v[68:71], v[212:215]
    ds_read_b64_tr_b16 v[32:33], v14 offset:32768
    v_mfma_f32_16x16x32_bf16 v[216:219], v[56:59], v[68:71], v[216:219]
    ds_read_b64_tr_b16 v[34:35], v14 offset:34816
    v_mfma_f32_16x16x32_bf16 v[220:223], v[60:63], v[68:71], v[220:223]
    ds_read_b64_tr_b16 v[36:37], v15 offset:32768
    s_add_u32 m0, s67, 98304
    s_add_u32 s63, s71, 3145728
    buffer_load_dwordx4 v4, s[20:23], s63 offen lds
    v_mfma_f32_16x16x32_bf16 v[224:227], v[48:51], v[72:75], v[224:227]
    ds_read_b128 v[68:71], v8 offset:2048
    v_mfma_f32_16x16x32_bf16 v[228:231], v[52:55], v[72:75], v[228:231]
    ds_read_b64_tr_b16 v[38:39], v15 offset:34816
    v_mfma_f32_16x16x32_bf16 v[232:235], v[56:59], v[72:75], v[232:235]
    ds_read_b64_tr_b16 v[40:41], v16 offset:32768
    v_mfma_f32_16x16x32_bf16 v[236:239], v[60:63], v[72:75], v[236:239]
    ds_read_b64_tr_b16 v[42:43], v16 offset:34816
    v_mfma_f32_16x16x32_bf16 v[240:243], v[48:51], v[76:79], v[240:243]
    ds_read_b128 v[72:75], v8 offset:4096
    v_mfma_f32_16x16x32_bf16 v[244:247], v[52:55], v[76:79], v[244:247]
    ds_read_b64_tr_b16 v[44:45], v17 offset:32768
    v_mfma_f32_16x16x32_bf16 v[248:251], v[56:59], v[76:79], v[248:251]
    ds_read_b64_tr_b16 v[46:47], v17 offset:34816
    v_mfma_f32_16x16x32_bf16 v[252:255], v[60:63], v[76:79], v[252:255]
    s_add_u32 m0, s67, 106496
    s_add_u32 s63, s71, 3276800
    buffer_load_dwordx4 v4, s[20:23], s63 offen lds
    ds_read_b128 v[76:79], v8 offset:6144
    s_setprio 2
    s_waitcnt lgkmcnt(11)
    s_waitcnt lgkmcnt(9)
    v_mfma_f32_16x16x32_bf16 v[128:131], v[32:35], v[64:67], v[128:131]
    s_waitcnt lgkmcnt(6)
    v_mfma_f32_16x16x32_bf16 v[132:135], v[36:39], v[64:67], v[132:135]
    s_waitcnt lgkmcnt(4)
    v_mfma_f32_16x16x32_bf16 v[136:139], v[40:43], v[64:67], v[136:139]
    s_waitcnt lgkmcnt(1)
    v_mfma_f32_16x16x32_bf16 v[140:143], v[44:47], v[64:67], v[140:143]
    v_mfma_f32_16x16x32_bf16 v[144:147], v[32:35], v[68:71], v[144:147]
    ds_read_b128 v[64:67], v8 offset:8192
    v_mfma_f32_16x16x32_bf16 v[148:151], v[36:39], v[68:71], v[148:151]
    ds_read_b64_tr_b16 v[48:49], v14 offset:49152
    v_mfma_f32_16x16x32_bf16 v[152:155], v[40:43], v[68:71], v[152:155]
    ds_read_b64_tr_b16 v[50:51], v14 offset:51200
    v_mfma_f32_16x16x32_bf16 v[156:159], v[44:47], v[68:71], v[156:159]
    s_add_u32 m0, s67, 114688
    s_add_u32 s63, s71, 3407872
    buffer_load_dwordx4 v4, s[20:23], s63 offen lds
    v_mfma_f32_16x16x32_bf16 v[160:163], v[32:35], v[72:75], v[160:163]
    ds_read_b128 v[68:71], v8 offset:10240
    v_mfma_f32_16x16x32_bf16 v[164:167], v[36:39], v[72:75], v[164:167]
    ds_read_b64_tr_b16 v[52:53], v15 offset:49152
    v_mfma_f32_16x16x32_bf16 v[168:171], v[40:43], v[72:75], v[168:171]
    ds_read_b64_tr_b16 v[54:55], v15 offset:51200
    v_mfma_f32_16x16x32_bf16 v[172:175], v[44:47], v[72:75], v[172:175]
    s_waitcnt lgkmcnt(6)
    v_mfma_f32_16x16x32_bf16 v[176:179], v[32:35], v[76:79], v[176:179]
    ds_read_b128 v[72:75], v8 offset:12288
    v_mfma_f32_16x16x32_bf16 v[180:183], v[36:39], v[76:79], v[180:183]
    ds_read_b64_tr_b16 v[56:57], v16 offset:49152
    v_mfma_f32_16x16x32_bf16 v[184:187], v[40:43], v[76:79], v[184:187]
    ds_read_b64_tr_b16 v[58:59], v16 offset:51200
    v_mfma_f32_16x16x32_bf16 v[188:191], v[44:47], v[76:79], v[188:191]
    s_add_u32 m0, s67, 122880
    s_add_u32 s63, s71, 3538944
    buffer_load_dwordx4 v4, s[20:23], s63 offen lds
    s_setprio 1
    s_waitcnt lgkmcnt(8)
    v_mfma_f32_16x16x32_bf16 v[192:195], v[32:35], v[64:67], v[192:195]
    ds_read_b128 v[76:79], v8 offset:14336
    v_mfma_f32_16x16x32_bf16 v[196:199], v[36:39], v[64:67], v[196:199]
    ds_read_b64_tr_b16 v[60:61], v17 offset:49152
    v_mfma_f32_16x16x32_bf16 v[200:203], v[40:43], v[64:67], v[200:203]
    ds_read_b64_tr_b16 v[62:63], v17 offset:51200
    v_mfma_f32_16x16x32_bf16 v[204:207], v[44:47], v[64:67], v[204:207]
    s_waitcnt lgkmcnt(8)
    v_mfma_f32_16x16x32_bf16 v[208:211], v[32:35], v[68:71], v[208:211]
    ds_read_b128 v[64:67], v9 offset:0
    v_mfma_f32_16x16x32_bf16 v[212:215], v[36:39], v[68:71], v[212:215]
    v_mfma_f32_16x16x32_bf16 v[216:219], v[40:43], v[68:71], v[216:219]
    v_mfma_f32_16x16x32_bf16 v[220:223], v[44:47], v[68:71], v[220:223]
    s_add_u32 m0, s67, 131072
    s_add_u32 s63, s70, 896
    buffer_load_dwordx4 v3, s[16:19], s63 offen lds
    s_waitcnt lgkmcnt(6)
    v_mfma_f32_16x16x32_bf16 v[224:227], v[32:35], v[72:75], v[224:227]
    ds_read_b128 v[68:71], v9 offset:2048
    v_mfma_f32_16x16x32_bf16 v[228:231], v[36:39], v[72:75], v[228:231]
    v_mfma_f32_16x16x32_bf16 v[232:235], v[40:43], v[72:75], v[232:235]
    v_mfma_f32_16x16x32_bf16 v[236:239], v[44:47], v[72:75], v[236:239]
    s_waitcnt lgkmcnt(4)
    v_mfma_f32_16x16x32_bf16 v[240:243], v[32:35], v[76:79], v[240:243]
    ds_read_b128 v[72:75], v9 offset:4096
    v_mfma_f32_16x16x32_bf16 v[244:247], v[36:39], v[76:79], v[244:247]
    v_mfma_f32_16x16x32_bf16 v[248:251], v[40:43], v[76:79], v[248:251]
    v_mfma_f32_16x16x32_bf16 v[252:255], v[44:47], v[76:79], v[252:255]
    s_add_u32 m0, s67, 139264
    s_add_u32 s63, s70, 66432
    buffer_load_dwordx4 v3, s[16:19], s63 offen lds
    ds_read_b128 v[76:79], v9 offset:6144
    s_setprio 0
    s_waitcnt lgkmcnt(3)
    v_mfma_f32_16x16x32_bf16 v[128:131], v[48:51], v[64:67], v[128:131]
    v_mfma_f32_16x16x32_bf16 v[132:135], v[52:55], v[64:67], v[132:135]
    v_mfma_f32_16x16x32_bf16 v[136:139], v[56:59], v[64:67], v[136:139]
    v_mfma_f32_16x16x32_bf16 v[140:143], v[60:63], v[64:67], v[140:143]
    s_waitcnt lgkmcnt(2)
    v_mfma_f32_16x16x32_bf16 v[144:147], v[48:51], v[68:71], v[144:147]
    ds_read_b128 v[64:67], v9 offset:8192
    v_mfma_f32_16x16x32_bf16 v[148:151], v[52:55], v[68:71], v[148:151]
    v_mfma_f32_16x16x32_bf16 v[152:155], v[56:59], v[68:71], v[152:155]
    v_mfma_f32_16x16x32_bf16 v[156:159], v[60:63], v[68:71], v[156:159]
    s_add_u32 m0, s67, 147456
    s_add_u32 s63, s70, 131968
    buffer_load_dwordx4 v3, s[16:19], s63 offen lds
    s_waitcnt lgkmcnt(2)
    v_mfma_f32_16x16x32_bf16 v[160:163], v[48:51], v[72:75], v[160:163]
    ds_read_b128 v[68:71], v9 offset:10240
    v_mfma_f32_16x16x32_bf16 v[164:167], v[52:55], v[72:75], v[164:167]
    v_mfma_f32_16x16x32_bf16 v[168:171], v[56:59], v[72:75], v[168:171]
    v_mfma_f32_16x16x32_bf16 v[172:175], v[60:63], v[72:75], v[172:175]
    s_waitcnt lgkmcnt(2)
    v_mfma_f32_16x16x32_bf16 v[176:179], v[48:51], v[76:79], v[176:179]
    ds_read_b128 v[72:75], v9 offset:12288
    v_mfma_f32_16x16x32_bf16 v[180:183], v[52:55], v[76:79], v[180:183]
    v_mfma_f32_16x16x32_bf16 v[184:187], v[56:59], v[76:79], v[184:187]
    v_mfma_f32_16x16x32_bf16 v[188:191], v[60:63], v[76:79], v[188:191]
    s_add_u32 m0, s67, 155648
    s_add_u32 s63, s70, 197504
    buffer_load_dwordx4 v3, s[16:19], s63 offen lds
    s_waitcnt lgkmcnt(2)
    v_mfma_f32_16x16x32_bf16 v[192:195], v[48:51], v[64:67], v[192:195]
    ds_read_b128 v[76:79], v9 offset:14336
    v_mfma_f32_16x16x32_bf16 v[196:199], v[52:55], v[64:67], v[196:199]
    v_mfma_f32_16x16x32_bf16 v[200:203], v[56:59], v[64:67], v[200:203]
    v_mfma_f32_16x16x32_bf16 v[204:207], v[60:63], v[64:67], v[204:207]
    s_waitcnt lgkmcnt(0)
    s_waitcnt vmcnt(4)
    s_barrier
    s_setprio 3
    v_mfma_f32_16x16x32_bf16 v[208:211], v[48:51], v[68:71], v[208:211]
    ds_read_b128 v[64:67], v10 offset:0
    v_mfma_f32_16x16x32_bf16 v[212:215], v[52:55], v[68:71], v[212:215]
    ds_read_b64_tr_b16 v[32:33], v18 offset:32768
    v_mfma_f32_16x16x32_bf16 v[216:219], v[56:59], v[68:71], v[216:219]
    ds_read_b64_tr_b16 v[34:35], v18 offset:34816
    v_mfma_f32_16x16x32_bf16 v[220:223], v[60:63], v[68:71], v[220:223]
    ds_read_b64_tr_b16 v[36:37], v19 offset:32768
    s_add_u32 m0, s67, 0
    s_add_u32 s63, s71, 3670016
    buffer_load_dwordx4 v4, s[20:23], s63 offen lds
    v_mfma_f32_16x16x32_bf16 v[224:227], v[48:51], v[72:75], v[224:227]
    ds_read_b128 v[68:71], v10 offset:2048
    v_mfma_f32_16x16x32_bf16 v[228:231], v[52:55], v[72:75], v[228:231]
    ds_read_b64_tr_b16 v[38:39], v19 offset:34816
    v_mfma_f32_16x16x32_bf16 v[232:235], v[56:59], v[72:75], v[232:235]
    ds_read_b64_tr_b16 v[40:41], v20 offset:32768
    v_mfma_f32_16x16x32_bf16 v[236:239], v[60:63], v[72:75], v[236:239]
    ds_read_b64_tr_b16 v[42:43], v20 offset:34816
    v_mfma_f32_16x16x32_bf16 v[240:243], v[48:51], v[76:79], v[240:243]
    ds_read_b128 v[72:75], v10 offset:4096
    v_mfma_f32_16x16x32_bf16 v[244:247], v[52:55], v[76:79], v[244:247]
    ds_read_b64_tr_b16 v[44:45], v21 offset:32768
    v_mfma_f32_16x16x32_bf16 v[248:251], v[56:59], v[76:79], v[248:251]
    ds_read_b64_tr_b16 v[46:47], v21 offset:34816
    v_mfma_f32_16x16x32_bf16 v[252:255], v[60:63], v[76:79], v[252:255]
    s_add_u32 m0, s67, 8192
    s_add_u32 s63, s71, 3801088
    buffer_load_dwordx4 v4, s[20:23], s63 offen lds
    ds_read_b128 v[76:79], v10 offset:6144
    s_setprio 2
    s_waitcnt lgkmcnt(11)
    s_waitcnt lgkmcnt(9)
    v_mfma_f32_16x16x32_bf16 v[128:131], v[32:35], v[64:67], v[128:131]
    s_waitcnt lgkmcnt(6)
    v_mfma_f32_16x16x32_bf16 v[132:135], v[36:39], v[64:67], v[132:135]
    s_waitcnt lgkmcnt(4)
    v_mfma_f32_16x16x32_bf16 v[136:139], v[40:43], v[64:67], v[136:139]
    s_waitcnt lgkmcnt(1)
    v_mfma_f32_16x16x32_bf16 v[140:143], v[44:47], v[64:67], v[140:143]
    v_mfma_f32_16x16x32_bf16 v[144:147], v[32:35], v[68:71], v[144:147]
    ds_read_b128 v[64:67], v10 offset:8192
    v_mfma_f32_16x16x32_bf16 v[148:151], v[36:39], v[68:71], v[148:151]
    ds_read_b64_tr_b16 v[48:49], v18 offset:49152
    v_mfma_f32_16x16x32_bf16 v[152:155], v[40:43], v[68:71], v[152:155]
    ds_read_b64_tr_b16 v[50:51], v18 offset:51200
    v_mfma_f32_16x16x32_bf16 v[156:159], v[44:47], v[68:71], v[156:159]
    s_add_u32 m0, s67, 16384
    s_add_u32 s63, s71, 3932160
    buffer_load_dwordx4 v4, s[20:23], s63 offen lds
    v_mfma_f32_16x16x32_bf16 v[160:163], v[32:35], v[72:75], v[160:163]
    ds_read_b128 v[68:71], v10 offset:10240
    v_mfma_f32_16x16x32_bf16 v[164:167], v[36:39], v[72:75], v[164:167]
    ds_read_b64_tr_b16 v[52:53], v19 offset:49152
    v_mfma_f32_16x16x32_bf16 v[168:171], v[40:43], v[72:75], v[168:171]
    ds_read_b64_tr_b16 v[54:55], v19 offset:51200
    v_mfma_f32_16x16x32_bf16 v[172:175], v[44:47], v[72:75], v[172:175]
    s_waitcnt lgkmcnt(6)
    v_mfma_f32_16x16x32_bf16 v[176:179], v[32:35], v[76:79], v[176:179]
    ds_read_b128 v[72:75], v10 offset:12288
    v_mfma_f32_16x16x32_bf16 v[180:183], v[36:39], v[76:79], v[180:183]
    ds_read_b64_tr_b16 v[56:57], v20 offset:49152
    v_mfma_f32_16x16x32_bf16 v[184:187], v[40:43], v[76:79], v[184:187]
    ds_read_b64_tr_b16 v[58:59], v20 offset:51200
    v_mfma_f32_16x16x32_bf16 v[188:191], v[44:47], v[76:79], v[188:191]
    s_add_u32 m0, s67, 24576
    s_add_u32 s63, s71, 4063232
    buffer_load_dwordx4 v4, s[20:23], s63 offen lds
    s_setprio 1
    s_waitcnt lgkmcnt(8)
    v_mfma_f32_16x16x32_bf16 v[192:195], v[32:35], v[64:67], v[192:195]
    ds_read_b128 v[76:79], v10 offset:14336
    v_mfma_f32_16x16x32_bf16 v[196:199], v[36:39], v[64:67], v[196:199]
    ds_read_b64_tr_b16 v[60:61], v21 offset:49152
    v_mfma_f32_16x16x32_bf16 v[200:203], v[40:43], v[64:67], v[200:203]
    ds_read_b64_tr_b16 v[62:63], v21 offset:51200
    v_mfma_f32_16x16x32_bf16 v[204:207], v[44:47], v[64:67], v[204:207]
    s_waitcnt lgkmcnt(8)
    v_mfma_f32_16x16x32_bf16 v[208:211], v[32:35], v[68:71], v[208:211]
    ds_read_b128 v[64:67], v11 offset:0
    v_mfma_f32_16x16x32_bf16 v[212:215], v[36:39], v[68:71], v[212:215]
    v_mfma_f32_16x16x32_bf16 v[216:219], v[40:43], v[68:71], v[216:219]
    v_mfma_f32_16x16x32_bf16 v[220:223], v[44:47], v[68:71], v[220:223]
    s_add_u32 m0, s68, 32768
    s_add_u32 s63, s72, 0
    buffer_load_dwordx4 v80, s[24:27], s63 offen lds
    s_waitcnt lgkmcnt(6)
    v_mfma_f32_16x16x32_bf16 v[224:227], v[32:35], v[72:75], v[224:227]
    ds_read_b128 v[68:71], v11 offset:2048
    v_mfma_f32_16x16x32_bf16 v[228:231], v[36:39], v[72:75], v[228:231]
    v_mfma_f32_16x16x32_bf16 v[232:235], v[40:43], v[72:75], v[232:235]
    v_mfma_f32_16x16x32_bf16 v[236:239], v[44:47], v[72:75], v[236:239]
    s_waitcnt lgkmcnt(4)
    v_mfma_f32_16x16x32_bf16 v[240:243], v[32:35], v[76:79], v[240:243]
    ds_read_b128 v[72:75], v11 offset:4096
    v_mfma_f32_16x16x32_bf16 v[244:247], v[36:39], v[76:79], v[244:247]
    v_mfma_f32_16x16x32_bf16 v[248:251], v[40:43], v[76:79], v[248:251]
    v_mfma_f32_16x16x32_bf16 v[252:255], v[44:47], v[76:79], v[252:255]
    s_add_u32 m0, s68, 33792
    s_add_u32 s63, s72, 8192
    buffer_load_dwordx4 v81, s[24:27], s63 offen lds
    ds_read_b128 v[76:79], v11 offset:6144
    s_setprio 0
    s_waitcnt lgkmcnt(3)
    v_mfma_f32_16x16x32_bf16 v[128:131], v[48:51], v[64:67], v[128:131]
    v_mfma_f32_16x16x32_bf16 v[132:135], v[52:55], v[64:67], v[132:135]
    v_mfma_f32_16x16x32_bf16 v[136:139], v[56:59], v[64:67], v[136:139]
    v_mfma_f32_16x16x32_bf16 v[140:143], v[60:63], v[64:67], v[140:143]
    s_waitcnt lgkmcnt(2)
    v_mfma_f32_16x16x32_bf16 v[144:147], v[48:51], v[68:71], v[144:147]
    ds_read_b128 v[64:67], v11 offset:8192
    v_mfma_f32_16x16x32_bf16 v[148:151], v[52:55], v[68:71], v[148:151]
    v_mfma_f32_16x16x32_bf16 v[152:155], v[56:59], v[68:71], v[152:155]
    v_mfma_f32_16x16x32_bf16 v[156:159], v[60:63], v[68:71], v[156:159]
    s_add_u32 m0, s68, 34816
    s_add_u32 s63, s72, 16384
    buffer_load_dwordx4 v80, s[24:27], s63 offen lds
    s_waitcnt lgkmcnt(2)
    v_mfma_f32_16x16x32_bf16 v[160:163], v[48:51], v[72:75], v[160:163]
    ds_read_b128 v[68:71], v11 offset:10240
    v_mfma_f32_16x16x32_bf16 v[164:167], v[52:55], v[72:75], v[164:167]
    v_mfma_f32_16x16x32_bf16 v[168:171], v[56:59], v[72:75], v[168:171]
    v_mfma_f32_16x16x32_bf16 v[172:175], v[60:63], v[72:75], v[172:175]
    s_waitcnt lgkmcnt(2)
    v_mfma_f32_16x16x32_bf16 v[176:179], v[48:51], v[76:79], v[176:179]
    ds_read_b128 v[72:75], v11 offset:12288
    v_mfma_f32_16x16x32_bf16 v[180:183], v[52:55], v[76:79], v[180:183]
    v_mfma_f32_16x16x32_bf16 v[184:187], v[56:59], v[76:79], v[184:187]
    v_mfma_f32_16x16x32_bf16 v[188:191], v[60:63], v[76:79], v[188:191]
    s_add_u32 m0, s68, 35840
    s_add_u32 s63, s72, 24576
    buffer_load_dwordx4 v81, s[24:27], s63 offen lds
    s_waitcnt lgkmcnt(2)
    v_mfma_f32_16x16x32_bf16 v[192:195], v[48:51], v[64:67], v[192:195]
    ds_read_b128 v[76:79], v11 offset:14336
    v_mfma_f32_16x16x32_bf16 v[196:199], v[52:55], v[64:67], v[196:199]
    v_mfma_f32_16x16x32_bf16 v[200:203], v[56:59], v[64:67], v[200:203]
    v_mfma_f32_16x16x32_bf16 v[204:207], v[60:63], v[64:67], v[204:207]
    s_waitcnt lgkmcnt(0)
    s_waitcnt vmcnt(4)
    s_barrier
    s_setprio 3
    v_mfma_f32_16x16x32_bf16 v[208:211], v[48:51], v[68:71], v[208:211]
    ds_read_b128 v[64:67], v12 offset:0
    v_mfma_f32_16x16x32_bf16 v[212:215], v[52:55], v[68:71], v[212:215]
    ds_read_b64_tr_b16 v[32:33], v14 offset:0
    v_mfma_f32_16x16x32_bf16 v[216:219], v[56:59], v[68:71], v[216:219]
    ds_read_b64_tr_b16 v[34:35], v14 offset:2048
    v_mfma_f32_16x16x32_bf16 v[220:223], v[60:63], v[68:71], v[220:223]
    ds_read_b64_tr_b16 v[36:37], v15 offset:0
    s_add_u32 m0, s67, 98304
    s_add_u32 s63, s73, 0
    buffer_load_dwordx4 v82, s[36:39], s63 offen lds
    v_mfma_f32_16x16x32_bf16 v[224:227], v[48:51], v[72:75], v[224:227]
    ds_read_b128 v[68:71], v12 offset:2048
    v_mfma_f32_16x16x32_bf16 v[228:231], v[52:55], v[72:75], v[228:231]
    ds_read_b64_tr_b16 v[38:39], v15 offset:2048
    v_mfma_f32_16x16x32_bf16 v[232:235], v[56:59], v[72:75], v[232:235]
    ds_read_b64_tr_b16 v[40:41], v16 offset:0
    v_mfma_f32_16x16x32_bf16 v[236:239], v[60:63], v[72:75], v[236:239]
    ds_read_b64_tr_b16 v[42:43], v16 offset:2048
    v_mfma_f32_16x16x32_bf16 v[240:243], v[48:51], v[76:79], v[240:243]
    ds_read_b128 v[72:75], v12 offset:4096
    v_mfma_f32_16x16x32_bf16 v[244:247], v[52:55], v[76:79], v[244:247]
    ds_read_b64_tr_b16 v[44:45], v17 offset:0
    v_mfma_f32_16x16x32_bf16 v[248:251], v[56:59], v[76:79], v[248:251]
    ds_read_b64_tr_b16 v[46:47], v17 offset:2048
    v_mfma_f32_16x16x32_bf16 v[252:255], v[60:63], v[76:79], v[252:255]
    s_add_u32 m0, s67, 106496
    s_add_u32 s63, s73, 262144
    buffer_load_dwordx4 v82, s[36:39], s63 offen lds
    ds_read_b128 v[76:79], v12 offset:6144
    s_setprio 2
    s_waitcnt lgkmcnt(11)
    s_waitcnt lgkmcnt(9)
    v_mfma_f32_16x16x32_bf16 v[128:131], v[32:35], v[64:67], v[128:131]
    s_waitcnt lgkmcnt(6)
    v_mfma_f32_16x16x32_bf16 v[132:135], v[36:39], v[64:67], v[132:135]
    s_waitcnt lgkmcnt(4)
    v_mfma_f32_16x16x32_bf16 v[136:139], v[40:43], v[64:67], v[136:139]
    s_waitcnt lgkmcnt(1)
    v_mfma_f32_16x16x32_bf16 v[140:143], v[44:47], v[64:67], v[140:143]
    v_mfma_f32_16x16x32_bf16 v[144:147], v[32:35], v[68:71], v[144:147]
    ds_read_b128 v[64:67], v12 offset:8192
    v_mfma_f32_16x16x32_bf16 v[148:151], v[36:39], v[68:71], v[148:151]
    ds_read_b64_tr_b16 v[48:49], v14 offset:16384
    v_mfma_f32_16x16x32_bf16 v[152:155], v[40:43], v[68:71], v[152:155]
    ds_read_b64_tr_b16 v[50:51], v14 offset:18432
    v_mfma_f32_16x16x32_bf16 v[156:159], v[44:47], v[68:71], v[156:159]
    s_add_u32 m0, s67, 114688
    s_add_u32 s63, s74, 0
    buffer_load_dwordx4 v83, s[28:31], s63 offen lds
    v_mfma_f32_16x16x32_bf16 v[160:163], v[32:35], v[72:75], v[160:163]
    ds_read_b128 v[68:71], v12 offset:10240
    v_mfma_f32_16x16x32_bf16 v[164:167], v[36:39], v[72:75], v[164:167]
    ds_read_b64_tr_b16 v[52:53], v15 offset:16384
    v_mfma_f32_16x16x32_bf16 v[168:171], v[40:43], v[72:75], v[168:171]
    ds_read_b64_tr_b16 v[54:55], v15 offset:18432
    v_mfma_f32_16x16x32_bf16 v[172:175], v[44:47], v[72:75], v[172:175]
    s_waitcnt lgkmcnt(6)
    v_mfma_f32_16x16x32_bf16 v[176:179], v[32:35], v[76:79], v[176:179]
    ds_read_b128 v[72:75], v12 offset:12288
    v_mfma_f32_16x16x32_bf16 v[180:183], v[36:39], v[76:79], v[180:183]
    ds_read_b64_tr_b16 v[56:57], v16 offset:16384
    v_mfma_f32_16x16x32_bf16 v[184:187], v[40:43], v[76:79], v[184:187]
    ds_read_b64_tr_b16 v[58:59], v16 offset:18432
    v_mfma_f32_16x16x32_bf16 v[188:191], v[44:47], v[76:79], v[188:191]
    s_add_u32 m0, s68, 65536
    s_add_u32 s63, s72, 128
    buffer_load_dwordx4 v80, s[24:27], s63 offen lds
    s_setprio 1
    s_waitcnt lgkmcnt(8)
    v_mfma_f32_16x16x32_bf16 v[192:195], v[32:35], v[64:67], v[192:195]
    ds_read_b128 v[76:79], v12 offset:14336
    v_mfma_f32_16x16x32_bf16 v[196:199], v[36:39], v[64:67], v[196:199]
    ds_read_b64_tr_b16 v[60:61], v17 offset:16384
    v_mfma_f32_16x16x32_bf16 v[200:203], v[40:43], v[64:67], v[200:203]
    ds_read_b64_tr_b16 v[62:63], v17 offset:18432
    v_mfma_f32_16x16x32_bf16 v[204:207], v[44:47], v[64:67], v[204:207]
    s_waitcnt lgkmcnt(8)
    v_mfma_f32_16x16x32_bf16 v[208:211], v[32:35], v[68:71], v[208:211]
    ds_read_b128 v[64:67], v13 offset:0
    v_mfma_f32_16x16x32_bf16 v[212:215], v[36:39], v[68:71], v[212:215]
    v_mfma_f32_16x16x32_bf16 v[216:219], v[40:43], v[68:71], v[216:219]
    v_mfma_f32_16x16x32_bf16 v[220:223], v[44:47], v[68:71], v[220:223]
    s_add_u32 m0, s68, 66560
    s_add_u32 s63, s72, 8320
    buffer_load_dwordx4 v81, s[24:27], s63 offen lds
    s_waitcnt lgkmcnt(6)
    v_mfma_f32_16x16x32_bf16 v[224:227], v[32:35], v[72:75], v[224:227]
    ds_read_b128 v[68:71], v13 offset:2048
    v_mfma_f32_16x16x32_bf16 v[228:231], v[36:39], v[72:75], v[228:231]
    v_mfma_f32_16x16x32_bf16 v[232:235], v[40:43], v[72:75], v[232:235]
    v_mfma_f32_16x16x32_bf16 v[236:239], v[44:47], v[72:75], v[236:239]
    s_waitcnt lgkmcnt(4)
    v_mfma_f32_16x16x32_bf16 v[240:243], v[32:35], v[76:79], v[240:243]
    ds_read_b128 v[72:75], v13 offset:4096
    v_mfma_f32_16x16x32_bf16 v[244:247], v[36:39], v[76:79], v[244:247]
    v_mfma_f32_16x16x32_bf16 v[248:251], v[40:43], v[76:79], v[248:251]
    v_mfma_f32_16x16x32_bf16 v[252:255], v[44:47], v[76:79], v[252:255]
    s_add_u32 m0, s68, 67584
    s_add_u32 s63, s72, 16512
    buffer_load_dwordx4 v80, s[24:27], s63 offen lds
    ds_read_b128 v[76:79], v13 offset:6144
    s_setprio 0
    s_waitcnt lgkmcnt(3)
    v_mfma_f32_16x16x32_bf16 v[128:131], v[48:51], v[64:67], v[128:131]
    v_mfma_f32_16x16x32_bf16 v[132:135], v[52:55], v[64:67], v[132:135]
    v_mfma_f32_16x16x32_bf16 v[136:139], v[56:59], v[64:67], v[136:139]
    v_mfma_f32_16x16x32_bf16 v[140:143], v[60:63], v[64:67], v[140:143]
    s_waitcnt lgkmcnt(2)
    v_mfma_f32_16x16x32_bf16 v[144:147], v[48:51], v[68:71], v[144:147]
    ds_read_b128 v[64:67], v13 offset:8192
    v_mfma_f32_16x16x32_bf16 v[148:151], v[52:55], v[68:71], v[148:151]
    v_mfma_f32_16x16x32_bf16 v[152:155], v[56:59], v[68:71], v[152:155]
    v_mfma_f32_16x16x32_bf16 v[156:159], v[60:63], v[68:71], v[156:159]
    s_add_u32 m0, s68, 68608
    s_add_u32 s63, s72, 24704
    buffer_load_dwordx4 v81, s[24:27], s63 offen lds
    s_waitcnt lgkmcnt(2)
    v_mfma_f32_16x16x32_bf16 v[160:163], v[48:51], v[72:75], v[160:163]
    ds_read_b128 v[68:71], v13 offset:10240
    v_mfma_f32_16x16x32_bf16 v[164:167], v[52:55], v[72:75], v[164:167]
    v_mfma_f32_16x16x32_bf16 v[168:171], v[56:59], v[72:75], v[168:171]
    v_mfma_f32_16x16x32_bf16 v[172:175], v[60:63], v[72:75], v[172:175]
    s_waitcnt lgkmcnt(2)
    v_mfma_f32_16x16x32_bf16 v[176:179], v[48:51], v[76:79], v[176:179]
    ds_read_b128 v[72:75], v13 offset:12288
    v_mfma_f32_16x16x32_bf16 v[180:183], v[52:55], v[76:79], v[180:183]
    v_mfma_f32_16x16x32_bf16 v[184:187], v[56:59], v[76:79], v[184:187]
    v_mfma_f32_16x16x32_bf16 v[188:191], v[60:63], v[76:79], v[188:191]
    s_waitcnt lgkmcnt(2)
    v_mfma_f32_16x16x32_bf16 v[192:195], v[48:51], v[64:67], v[192:195]
    ds_read_b128 v[76:79], v13 offset:14336
    v_mfma_f32_16x16x32_bf16 v[196:199], v[52:55], v[64:67], v[196:199]
    v_mfma_f32_16x16x32_bf16 v[200:203], v[56:59], v[64:67], v[200:203]
    v_mfma_f32_16x16x32_bf16 v[204:207], v[60:63], v[64:67], v[204:207]
    s_waitcnt lgkmcnt(0)
    s_waitcnt vmcnt(4)
    s_barrier
    s_setprio 3
    v_mfma_f32_16x16x32_bf16 v[208:211], v[48:51], v[68:71], v[208:211]
    v_mfma_f32_16x16x32_bf16 v[212:215], v[52:55], v[68:71], v[212:215]
    ds_read_b128 v[40:43], v84 offset:0
    ds_read_b128 v[44:47], v84 offset:2048
    v_mfma_f32_16x16x32_bf16 v[216:219], v[56:59], v[68:71], v[216:219]
    ds_read_b64_tr_b16 v[8:9], v94 offset:0
    ds_read_b64_tr_b16 v[10:11], v94 offset:1024
    v_mfma_f32_16x16x32_bf16 v[220:223], v[60:63], v[68:71], v[220:223]
    ds_read_b64_tr_b16 v[12:13], v95 offset:0
    ds_read_b64_tr_b16 v[14:15], v95 offset:1024
    s_add_u32 m0, s67, 122880
    s_add_u32 s63, s73, 524288
    buffer_load_dwordx4 v82, s[36:39], s63 offen lds
    v_mfma_f32_16x16x32_bf16 v[224:227], v[48:51], v[72:75], v[224:227]
    v_mfma_f32_16x16x32_bf16 v[228:231], v[52:55], v[72:75], v[228:231]
    ds_read_b64_tr_b16 v[16:17], v96 offset:0
    ds_read_b64_tr_b16 v[18:19], v96 offset:1024
    v_mfma_f32_16x16x32_bf16 v[232:235], v[56:59], v[72:75], v[232:235]
    ds_read_b64_tr_b16 v[20:21], v97 offset:0
    ds_read_b64_tr_b16 v[22:23], v97 offset:1024
    v_mfma_f32_16x16x32_bf16 v[236:239], v[60:63], v[72:75], v[236:239]
    ds_read_b64_tr_b16 v[24:25], v98 offset:0
    ds_read_b64_tr_b16 v[26:27], v98 offset:1024
    v_mfma_f32_16x16x32_bf16 v[240:243], v[48:51], v[76:79], v[240:243]
    v_mfma_f32_16x16x32_bf16 v[244:247], v[52:55], v[76:79], v[244:247]
    v_mfma_f32_16x16x32_bf16 v[248:251], v[56:59], v[76:79], v[248:251]
    v_mfma_f32_16x16x32_bf16 v[252:255], v[60:63], v[76:79], v[252:255]
    s_add_u32 m0, s67, 131072
    s_add_u32 s63, s73, 786432
    buffer_load_dwordx4 v82, s[36:39], s63 offen lds
    s_branch M_kvdone
M_vtype:
    s_setprio 2
    s_waitcnt lgkmcnt(3)
    v_mfma_f32_16x16x32_bf16 v[128:131], v[64:67], v[32:35], 0
    v_mfma_f32_16x16x32_bf16 v[136:139], v[64:67], v[36:39], 0
    v_mfma_f32_16x16x32_bf16 v[144:147], v[64:67], v[40:43], 0
    v_mfma_f32_16x16x32_bf16 v[152:155], v[64:67], v[44:47], 0
    s_waitcnt lgkmcnt(2)
    v_mfma_f32_16x16x32_bf16 v[132:135], v[68:71], v[32:35], 0
    ds_read_b128 v[64:67], v8 offset:8192
    v_mfma_f32_16x16x32_bf16 v[140:143], v[68:71], v[36:39], 0
    ds_read_b64_tr_b16 v[48:49], v14 offset:49152
    v_mfma_f32_16x16x32_bf16 v[148:151], v[68:71], v[40:43], 0
    ds_read_b64_tr_b16 v[50:51], v14 offset:51200
    v_mfma_f32_16x16x32_bf16 v[156:159], v[68:71], v[44:47], 0
    s_waitcnt lgkmcnt(4)
    v_mfma_f32_16x16x32_bf16 v[160:163], v[72:75], v[32:35], 0
    ds_read_b128 v[68:71], v8 offset:10240
    v_mfma_f32_16x16x32_bf16 v[168:171], v[72:75], v[36:39], 0
    ds_read_b64_tr_b16 v[52:53], v15 offset:49152
    v_mfma_f32_16x16x32_bf16 v[176:179], v[72:75], v[40:43], 0
    ds_read_b64_tr_b16 v[54:55], v15 offset:51200
    v_mfma_f32_16x16x32_bf16 v[184:187], v[72:75], v[44:47], 0
    s_waitcnt lgkmcnt(6)
    v_mfma_f32_16x16x32_bf16 v[164:167], v[76:79], v[32:35], 0
    ds_read_b128 v[72:75], v8 offset:12288
    v_mfma_f32_16x16x32_bf16 v[172:175], v[76:79], v[36:39], 0
    ds_read_b64_tr_b16 v[56:57], v16 offset:49152
    v_mfma_f32_16x16x32_bf16 v[180:183], v[76:79], v[40:43], 0
    ds_read_b64_tr_b16 v[58:59], v16 offset:51200
    v_mfma_f32_16x16x32_bf16 v[188:191], v[76:79], v[44:47], 0
    s_setprio 1
    s_waitcnt lgkmcnt(8)
    v_mfma_f32_16x16x32_bf16 v[192:195], v[64:67], v[32:35], 0
    ds_read_b128 v[76:79], v8 offset:14336
    v_mfma_f32_16x16x32_bf16 v[200:203], v[64:67], v[36:39], 0
    ds_read_b64_tr_b16 v[60:61], v17 offset:49152
    v_mfma_f32_16x16x32_bf16 v[208:211], v[64:67], v[40:43], 0
    ds_read_b64_tr_b16 v[62:63], v17 offset:51200
    v_mfma_f32_16x16x32_bf16 v[216:219], v[64:67], v[44:47], 0
    s_waitcnt lgkmcnt(8)
    v_mfma_f32_16x16x32_bf16 v[196:199], v[68:71], v[32:35], 0
    ds_read_b128 v[64:67], v9 offset:0
    v_mfma_f32_16x16x32_bf16 v[204:207], v[68:71], v[36:39], 0
    v_mfma_f32_16x16x32_bf16 v[212:215], v[68:71], v[40:43], 0
    v_mfma_f32_16x16x32_bf16 v[220:223], v[68:71], v[44:47], 0
    s_waitcnt lgkmcnt(6)
    v_mfma_f32_16x16x32_bf16 v[224:227], v[72:75], v[32:35], 0
    ds_read_b128 v[68:71], v9 offset:2048
    v_mfma_f32_16x16x32_bf16 v[232:235], v[72:75], v[36:39], 0
    v_mfma_f32_16x16x32_bf16 v[240:243], v[72:75], v[40:43], 0
    v_mfma_f32_16x16x32_bf16 v[248:251], v[72:75], v[44:47], 0
    s_waitcnt lgkmcnt(4)
    v_mfma_f32_16x16x32_bf16 v[228:231], v[76:79], v[32:35], 0
    ds_read_b128 v[72:75], v9 offset:4096
    v_mfma_f32_16x16x32_bf16 v[236:239], v[76:79], v[36:39], 0
    v_mfma_f32_16x16x32_bf16 v[244:247], v[76:79], v[40:43], 0
    v_mfma_f32_16x16x32_bf16 v[252:255], v[76:79], v[44:47], 0
    ds_read_b128 v[76:79], v9 offset:6144
    s_setprio 0
    s_waitcnt lgkmcnt(3)
    v_mfma_f32_16x16x32_bf16 v[128:131], v[64:67], v[48:51], v[128:131]
    v_mfma_f32_16x16x32_bf16 v[136:139], v[64:67], v[52:55], v[136:139]
    v_mfma_f32_16x16x32_bf16 v[144:147], v[64:67], v[56:59], v[144:147]
    v_mfma_f32_16x16x32_bf16 v[152:155], v[64:67], v[60:63], v[152:155]
    s_waitcnt lgkmcnt(2)
    v_mfma_f32_16x16x32_bf16 v[132:135], v[68:71], v[48:51], v[132:135]
    ds_read_b128 v[64:67], v9 offset:8192
    v_mfma_f32_16x16x32_bf16 v[140:143], v[68:71], v[52:55], v[140:143]
    v_mfma_f32_16x16x32_bf16 v[148:151], v[68:71], v[56:59], v[148:151]
    v_mfma_f32_16x16x32_bf16 v[156:159], v[68:71], v[60:63], v[156:159]
    s_waitcnt lgkmcnt(2)
    v_mfma_f32_16x16x32_bf16 v[160:163], v[72:75], v[48:51], v[160:163]
    ds_read_b128 v[68:71], v9 offset:10240
    v_mfma_f32_16x16x32_bf16 v[168:171], v[72:75], v[52:55], v[168:171]
    v_mfma_f32_16x16x32_bf16 v[176:179], v[72:75], v[56:59], v[176:179]
    v_mfma_f32_16x16x32_bf16 v[184:187], v[72:75], v[60:63], v[184:187]
    s_waitcnt lgkmcnt(2)
    v_mfma_f32_16x16x32_bf16 v[164:167], v[76:79], v[48:51], v[164:167]
    ds_read_b128 v[72:75], v9 offset:12288
    v_mfma_f32_16x16x32_bf16 v[172:175], v[76:79], v[52:55], v[172:175]
    v_mfma_f32_16x16x32_bf16 v[180:183], v[76:79], v[56:59], v[180:183]
    v_mfma_f32_16x16x32_bf16 v[188:191], v[76:79], v[60:63], v[188:191]
    s_waitcnt lgkmcnt(2)
    v_mfma_f32_16x16x32_bf16 v[192:195], v[64:67], v[48:51], v[192:195]
    ds_read_b128 v[76:79], v9 offset:14336
    v_mfma_f32_16x16x32_bf16 v[200:203], v[64:67], v[52:55], v[200:203]
    v_mfma_f32_16x16x32_bf16 v[208:211], v[64:67], v[56:59], v[208:211]
    v_mfma_f32_16x16x32_bf16 v[216:219], v[64:67], v[60:63], v[216:219]
    s_waitcnt lgkmcnt(0)
    s_waitcnt vmcnt(9)
    s_barrier
    s_setprio 3
    v_mfma_f32_16x16x32_bf16 v[196:199], v[68:71], v[48:51], v[196:199]
    ds_read_b128 v[64:67], v10 offset:0
    v_mfma_f32_16x16x32_bf16 v[204:207], v[68:71], v[52:55], v[204:207]
    ds_read_b64_tr_b16 v[32:33], v18 offset:32768
    v_mfma_f32_16x16x32_bf16 v[212:215], v[68:71], v[56:59], v[212:215]
    ds_read_b64_tr_b16 v[34:35], v18 offset:34816
    v_mfma_f32_16x16x32_bf16 v[220:223], v[68:71], v[60:63], v[220:223]
    ds_read_b64_tr_b16 v[36:37], v19 offset:32768
    s_add_u32 m0, s67, 0
    s_add_u32 s63, s71, 1048576
    buffer_load_dwordx4 v4, s[20:23], s63 offen lds
    v_mfma_f32_16x16x32_bf16 v[224:227], v[72:75], v[48:51], v[224:227]
    ds_read_b128 v[68:71], v10 offset:2048
    v_mfma_f32_16x16x32_bf16 v[232:235], v[72:75], v[52:55], v[232:235]
    ds_read_b64_tr_b16 v[38:39], v19 offset:34816
    v_mfma_f32_16x16x32_bf16 v[240:243], v[72:75], v[56:59], v[240:243]
    ds_read_b64_tr_b16 v[40:41], v20 offset:32768
    v_mfma_f32_16x16x32_bf16 v[248:251], v[72:75], v[60:63], v[248:251]
    ds_read_b64_tr_b16 v[42:43], v20 offset:34816
    v_mfma_f32_16x16x32_bf16 v[228:231], v[76:79], v[48:51], v[228:231]
    ds_read_b128 v[72:75], v10 offset:4096
    v_mfma_f32_16x16x32_bf16 v[236:239], v[76:79], v[52:55], v[236:239]
    ds_read_b64_tr_b16 v[44:45], v21 offset:32768
    v_mfma_f32_16x16x32_bf16 v[244:247], v[76:79], v[56:59], v[244:247]
    ds_read_b64_tr_b16 v[46:47], v21 offset:34816
    v_mfma_f32_16x16x32_bf16 v[252:255], v[76:79], v[60:63], v[252:255]
    s_add_u32 m0, s67, 8192
    s_add_u32 s63, s71, 1179648
    buffer_load_dwordx4 v4, s[20:23], s63 offen lds
    ds_read_b128 v[76:79], v10 offset:6144
    s_setprio 2
    s_waitcnt lgkmcnt(11)
    s_waitcnt lgkmcnt(9)
    v_mfma_f32_16x16x32_bf16 v[128:131], v[64:67], v[32:35], v[128:131]
    s_waitcnt lgkmcnt(6)
    v_mfma_f32_16x16x32_bf16 v[136:139], v[64:67], v[36:39], v[136:139]
    s_waitcnt lgkmcnt(4)
    v_mfma_f32_16x16x32_bf16 v[144:147], v[64:67], v[40:43], v[144:147]
    s_waitcnt lgkmcnt(1)
    v_mfma_f32_16x16x32_bf16 v[152:155], v[64:67], v[44:47], v[152:155]
    v_mfma_f32_16x16x32_bf16 v[132:135], v[68:71], v[32:35], v[132:135]
    ds_read_b128 v[64:67], v10 offset:8192
    v_mfma_f32_16x16x32_bf16 v[140:143], v[68:71], v[36:39], v[140:143]
    ds_read_b64_tr_b16 v[48:49], v18 offset:49152
    v_mfma_f32_16x16x32_bf16 v[148:151], v[68:71], v[40:43], v[148:151]
    ds_read_b64_tr_b16 v[50:51], v18 offset:51200
    v_mfma_f32_16x16x32_bf16 v[156:159], v[68:71], v[44:47], v[156:159]
    s_add_u32 m0, s67, 16384
    s_add_u32 s63, s71, 1310720
    buffer_load_dwordx4 v4, s[20:23], s63 offen lds
    v_mfma_f32_16x16x32_bf16 v[160:163], v[72:75], v[32:35], v[160:163]
    ds_read_b128 v[68:71], v10 offset:10240
    v_mfma_f32_16x16x32_bf16 v[168:171], v[72:75], v[36:39], v[168:171]
    ds_read_b64_tr_b16 v[52:53], v19 offset:49152
    v_mfma_f32_16x16x32_bf16 v[176:179], v[72:75], v[40:43], v[176:179]
    ds_read_b64_tr_b16 v[54:55], v19 offset:51200
    v_mfma_f32_16x16x32_bf16 v[184:187], v[72:75], v[44:47], v[184:187]
    s_waitcnt lgkmcnt(6)
    v_mfma_f32_16x16x32_bf16 v[164:167], v[76:79], v[32:35], v[164:167]
    ds_read_b128 v[72:75], v10 offset:12288
    v_mfma_f32_16x16x32_bf16 v[172:175], v[76:79], v[36:39], v[172:175]
    ds_read_b64_tr_b16 v[56:57], v20 offset:49152
    v_mfma_f32_16x16x32_bf16 v[180:183], v[76:79], v[40:43], v[180:183]
    ds_read_b64_tr_b16 v[58:59], v20 offset:51200
    v_mfma_f32_16x16x32_bf16 v[188:191], v[76:79], v[44:47], v[188:191]
    s_add_u32 m0, s67, 24576
    s_add_u32 s63, s71, 1441792
    buffer_load_dwordx4 v4, s[20:23], s63 offen lds
    s_setprio 1
    s_waitcnt lgkmcnt(8)
    v_mfma_f32_16x16x32_bf16 v[192:195], v[64:67], v[32:35], v[192:195]
    ds_read_b128 v[76:79], v10 offset:14336
    v_mfma_f32_16x16x32_bf16 v[200:203], v[64:67], v[36:39], v[200:203]
    ds_read_b64_tr_b16 v[60:61], v21 offset:49152
    v_mfma_f32_16x16x32_bf16 v[208:211], v[64:67], v[40:43], v[208:211]
    ds_read_b64_tr_b16 v[62:63], v21 offset:51200
    v_mfma_f32_16x16x32_bf16 v[216:219], v[64:67], v[44:47], v[216:219]
    s_waitcnt lgkmcnt(8)
    v_mfma_f32_16x16x32_bf16 v[196:199], v[68:71], v[32:35], v[196:199]
    ds_read_b128 v[64:67], v11 offset:0
    v_mfma_f32_16x16x32_bf16 v[204:207], v[68:71], v[36:39], v[204:207]
    v_mfma_f32_16x16x32_bf16 v[212:215], v[68:71], v[40:43], v[212:215]
    v_mfma_f32_16x16x32_bf16 v[220:223], v[68:71], v[44:47], v[220:223]
    s_add_u32 m0, s67, 32768
    s_add_u32 s63, s70, 384
    buffer_load_dwordx4 v3, s[16:19], s63 offen lds
    s_waitcnt lgkmcnt(6)
    v_mfma_f32_16x16x32_bf16 v[224:227], v[72:75], v[32:35], v[224:227]
    ds_read_b128 v[68:71], v11 offset:2048
    v_mfma_f32_16x16x32_bf16 v[232:235], v[72:75], v[36:39], v[232:235]
    v_mfma_f32_16x16x32_bf16 v[240:243], v[72:75], v[40:43], v[240:243]
    v_mfma_f32_16x16x32_bf16 v[248:251], v[72:75], v[44:47], v[248:251]
    s_waitcnt lgkmcnt(4)
    v_mfma_f32_16x16x32_bf16 v[228:231], v[76:79], v[32:35], v[228:231]
    ds_read_b128 v[72:75], v11 offset:4096
    v_mfma_f32_16x16x32_bf16 v[236:239], v[76:79], v[36:39], v[236:239]
    v_mfma_f32_16x16x32_bf16 v[244:247], v[76:79], v[40:43], v[244:247]
    v_mfma_f32_16x16x32_bf16 v[252:255], v[76:79], v[44:47], v[252:255]
    s_add_u32 m0, s67, 40960
    s_add_u32 s63, s70, 65920
    buffer_load_dwordx4 v3, s[16:19], s63 offen lds
    ds_read_b128 v[76:79], v11 offset:6144
    s_setprio 0
    s_waitcnt lgkmcnt(3)
    v_mfma_f32_16x16x32_bf16 v[128:131], v[64:67], v[48:51], v[128:131]
    v_mfma_f32_16x16x32_bf16 v[136:139], v[64:67], v[52:55], v[136:139]
    v_mfma_f32_16x16x32_bf16 v[144:147], v[64:67], v[56:59], v[144:147]
    v_mfma_f32_16x16x32_bf16 v[152:155], v[64:67], v[60:63], v[152:155]
    s_waitcnt lgkmcnt(2)
    v_mfma_f32_16x16x32_bf16 v[132:135], v[68:71], v[48:51], v[132:135]
    ds_read_b128 v[64:67], v11 offset:8192
    v_mfma_f32_16x16x32_bf16 v[140:143], v[68:71], v[52:55], v[140:143]
    v_mfma_f32_16x16x32_bf16 v[148:151], v[68:71], v[56:59], v[148:151]
    v_mfma_f32_16x16x32_bf16 v[156:159], v[68:71], v[60:63], v[156:159]
    s_add_u32 m0, s67, 49152
    s_add_u32 s63, s70, 131456
    buffer_load_dwordx4 v3, s[16:19], s63 offen lds
    s_waitcnt lgkmcnt(2)
    v_mfma_f32_16x16x32_bf16 v[160:163], v[72:75], v[48:51], v[160:163]
    ds_read_b128 v[68:71], v11 offset:10240
    v_mfma_f32_16x16x32_bf16 v[168:171], v[72:75], v[52:55], v[168:171]
    v_mfma_f32_16x16x32_bf16 v[176:179], v[72:75], v[56:59], v[176:179]
    v_mfma_f32_16x16x32_bf16 v[184:187], v[72:75], v[60:63], v[184:187]
    s_waitcnt lgkmcnt(2)
    v_mfma_f32_16x16x32_bf16 v[164:167], v[76:79], v[48:51], v[164:167]
    ds_read_b128 v[72:75], v11 offset:12288
    v_mfma_f32_16x16x32_bf16 v[172:175], v[76:79], v[52:55], v[172:175]
    v_mfma_f32_16x16x32_bf16 v[180:183], v[76:79], v[56:59], v[180:183]
    v_mfma_f32_16x16x32_bf16 v[188:191], v[76:79], v[60:63], v[188:191]
    s_add_u32 m0, s67, 57344
    s_add_u32 s63, s70, 196992
    buffer_load_dwordx4 v3, s[16:19], s63 offen lds
    s_waitcnt lgkmcnt(2)
    v_mfma_f32_16x16x32_bf16 v[192:195], v[64:67], v[48:51], v[192:195]
    ds_read_b128 v[76:79], v11 offset:14336
    v_mfma_f32_16x16x32_bf16 v[200:203], v[64:67], v[52:55], v[200:203]
    v_mfma_f32_16x16x32_bf16 v[208:211], v[64:67], v[56:59], v[208:211]
    v_mfma_f32_16x16x32_bf16 v[216:219], v[64:67], v[60:63], v[216:219]
    s_waitcnt lgkmcnt(0)
    s_waitcnt vmcnt(4)
    s_barrier
    s_setprio 3
    v_mfma_f32_16x16x32_bf16 v[196:199], v[68:71], v[48:51], v[196:199]
    ds_read_b128 v[64:67], v12 offset:0
    v_mfma_f32_16x16x32_bf16 v[204:207], v[68:71], v[52:55], v[204:207]
    ds_read_b64_tr_b16 v[32:33], v14 offset:0
    v_mfma_f32_16x16x32_bf16 v[212:215], v[68:71], v[56:59], v[212:215]
    ds_read_b64_tr_b16 v[34:35], v14 offset:2048
    v_mfma_f32_16x16x32_bf16 v[220:223], v[68:71], v[60:63], v[220:223]
    ds_read_b64_tr_b16 v[36:37], v15 offset:0
    s_add_u32 m0, s67, 65536
    s_add_u32 s63, s71, 1572864
    buffer_load_dwordx4 v4, s[20:23], s63 offen lds
    v_mfma_f32_16x16x32_bf16 v[224:227], v[72:75], v[48:51], v[224:227]
    ds_read_b128 v[68:71], v12 offset:2048
    v_mfma_f32_16x16x32_bf16 v[232:235], v[72:75], v[52:55], v[232:235]
    ds_read_b64_tr_b16 v[38:39], v15 offset:2048
    v_mfma_f32_16x16x32_bf16 v[240:243], v[72:75], v[56:59], v[240:243]
    ds_read_b64_tr_b16 v[40:41], v16 offset:0
    v_mfma_f32_16x16x32_bf16 v[248:251], v[72:75], v[60:63], v[248:251]
    ds_read_b64_tr_b16 v[42:43], v16 offset:2048
    v_mfma_f32_16x16x32_bf16 v[228:231], v[76:79], v[48:51], v[228:231]
    ds_read_b128 v[72:75], v12 offset:4096
    v_mfma_f32_16x16x32_bf16 v[236:239], v[76:79], v[52:55], v[236:239]
    ds_read_b64_tr_b16 v[44:45], v17 offset:0
    v_mfma_f32_16x16x32_bf16 v[244:247], v[76:79], v[56:59], v[244:247]
    ds_read_b64_tr_b16 v[46:47], v17 offset:2048
    v_mfma_f32_16x16x32_bf16 v[252:255], v[76:79], v[60:63], v[252:255]
    s_add_u32 m0, s67, 73728
    s_add_u32 s63, s71, 1703936
    buffer_load_dwordx4 v4, s[20:23], s63 offen lds
    ds_read_b128 v[76:79], v12 offset:6144
    s_setprio 2
    s_waitcnt lgkmcnt(11)
    s_waitcnt lgkmcnt(9)
    v_mfma_f32_16x16x32_bf16 v[128:131], v[64:67], v[32:35], v[128:131]
    s_waitcnt lgkmcnt(6)
    v_mfma_f32_16x16x32_bf16 v[136:139], v[64:67], v[36:39], v[136:139]
    s_waitcnt lgkmcnt(4)
    v_mfma_f32_16x16x32_bf16 v[144:147], v[64:67], v[40:43], v[144:147]
    s_waitcnt lgkmcnt(1)
    v_mfma_f32_16x16x32_bf16 v[152:155], v[64:67], v[44:47], v[152:155]
    v_mfma_f32_16x16x32_bf16 v[132:135], v[68:71], v[32:35], v[132:135]
    ds_read_b128 v[64:67], v12 offset:8192
    v_mfma_f32_16x16x32_bf16 v[140:143], v[68:71], v[36:39], v[140:143]
    ds_read_b64_tr_b16 v[48:49], v14 offset:16384
    v_mfma_f32_16x16x32_bf16 v[148:151], v[68:71], v[40:43], v[148:151]
    ds_read_b64_tr_b16 v[50:51], v14 offset:18432
    v_mfma_f32_16x16x32_bf16 v[156:159], v[68:71], v[44:47], v[156:159]
    s_add_u32 m0, s67, 81920
    s_add_u32 s63, s71, 1835008
    buffer_load_dwordx4 v4, s[20:23], s63 offen lds
    v_mfma_f32_16x16x32_bf16 v[160:163], v[72:75], v[32:35], v[160:163]
    ds_read_b128 v[68:71], v12 offset:10240
    v_mfma_f32_16x16x32_bf16 v[168:171], v[72:75], v[36:39], v[168:171]
    ds_read_b64_tr_b16 v[52:53], v15 offset:16384
    v_mfma_f32_16x16x32_bf16 v[176:179], v[72:75], v[40:43], v[176:179]
    ds_read_b64_tr_b16 v[54:55], v15 offset:18432
    v_mfma_f32_16x16x32_bf16 v[184:187], v[72:75], v[44:47], v[184:187]
    s_waitcnt lgkmcnt(6)
    v_mfma_f32_16x16x32_bf16 v[164:167], v[76:79], v[32:35], v[164:167]
    ds_read_b128 v[72:75], v12 offset:12288
    v_mfma_f32_16x16x32_bf16 v[172:175], v[76:79], v[36:39], v[172:175]
    ds_read_b64_tr_b16 v[56:57], v16 offset:16384
    v_mfma_f32_16x16x32_bf16 v[180:183], v[76:79], v[40:43], v[180:183]
    ds_read_b64_tr_b16 v[58:59], v16 offset:18432
    v_mfma_f32_16x16x32_bf16 v[188:191], v[76:79], v[44:47], v[188:191]
    s_add_u32 m0, s67, 90112
    s_add_u32 s63, s71, 1966080
    buffer_load_dwordx4 v4, s[20:23], s63 offen lds
    s_setprio 1
    s_waitcnt lgkmcnt(8)
    v_mfma_f32_16x16x32_bf16 v[192:195], v[64:67], v[32:35], v[192:195]
    ds_read_b128 v[76:79], v12 offset:14336
    v_mfma_f32_16x16x32_bf16 v[200:203], v[64:67], v[36:39], v[200:203]
    ds_read_b64_tr_b16 v[60:61], v17 offset:16384
    v_mfma_f32_16x16x32_bf16 v[208:211], v[64:67], v[40:43], v[208:211]
    ds_read_b64_tr_b16 v[62:63], v17 offset:18432
    v_mfma_f32_16x16x32_bf16 v[216:219], v[64:67], v[44:47], v[216:219]
    s_waitcnt lgkmcnt(8)
    v_mfma_f32_16x16x32_bf16 v[196:199], v[68:71], v[32:35], v[196:199]
    ds_read_b128 v[64:67], v13 offset:0
    v_mfma_f32_16x16x32_bf16 v[204:207], v[68:71], v[36:39], v[204:207]
    v_mfma_f32_16x16x32_bf16 v[212:215], v[68:71], v[40:43], v[212:215]
    v_mfma_f32_16x16x32_bf16 v[220:223], v[68:71], v[44:47], v[220:223]
    s_add_u32 m0, s67, 98304
    s_add_u32 s63, s70, 512
    buffer_load_dwordx4 v3, s[16:19], s63 offen lds
    s_waitcnt lgkmcnt(6)
    v_mfma_f32_16x16x32_bf16 v[224:227], v[72:75], v[32:35], v[224:227]
    ds_read_b128 v[68:71], v13 offset:2048
    v_mfma_f32_16x16x32_bf16 v[232:235], v[72:75], v[36:39], v[232:235]
    v_mfma_f32_16x16x32_bf16 v[240:243], v[72:75], v[40:43], v[240:243]
    v_mfma_f32_16x16x32_bf16 v[248:251], v[72:75], v[44:47], v[248:251]
    s_waitcnt lgkmcnt(4)
    v_mfma_f32_16x16x32_bf16 v[228:231], v[76:79], v[32:35], v[228:231]
    ds_read_b128 v[72:75], v13 offset:4096
    v_mfma_f32_16x16x32_bf16 v[236:239], v[76:79], v[36:39], v[236:239]
    v_mfma_f32_16x16x32_bf16 v[244:247], v[76:79], v[40:43], v[244:247]
    v_mfma_f32_16x16x32_bf16 v[252:255], v[76:79], v[44:47], v[252:255]
    s_add_u32 m0, s67, 106496
    s_add_u32 s63, s70, 66048
    buffer_load_dwordx4 v3, s[16:19], s63 offen lds
    ds_read_b128 v[76:79], v13 offset:6144
    s_setprio 0
    s_waitcnt lgkmcnt(3)
    v_mfma_f32_16x16x32_bf16 v[128:131], v[64:67], v[48:51], v[128:131]
    v_mfma_f32_16x16x32_bf16 v[136:139], v[64:67], v[52:55], v[136:139]
    v_mfma_f32_16x16x32_bf16 v[144:147], v[64:67], v[56:59], v[144:147]
    v_mfma_f32_16x16x32_bf16 v[152:155], v[64:67], v[60:63], v[152:155]
    s_waitcnt lgkmcnt(2)
    v_mfma_f32_16x16x32_bf16 v[132:135], v[68:71], v[48:51], v[132:135]
    ds_read_b128 v[64:67], v13 offset:8192
    v_mfma_f32_16x16x32_bf16 v[140:143], v[68:71], v[52:55], v[140:143]
    v_mfma_f32_16x16x32_bf16 v[148:151], v[68:71], v[56:59], v[148:151]
    v_mfma_f32_16x16x32_bf16 v[156:159], v[68:71], v[60:63], v[156:159]
    s_add_u32 m0, s67, 114688
    s_add_u32 s63, s70, 131584
    buffer_load_dwordx4 v3, s[16:19], s63 offen lds
    s_waitcnt lgkmcnt(2)
    v_mfma_f32_16x16x32_bf16 v[160:163], v[72:75], v[48:51], v[160:163]
    ds_read_b128 v[68:71], v13 offset:10240
    v_mfma_f32_16x16x32_bf16 v[168:171], v[72:75], v[52:55], v[168:171]
    v_mfma_f32_16x16x32_bf16 v[176:179], v[72:75], v[56:59], v[176:179]
    v_mfma_f32_16x16x32_bf16 v[184:187], v[72:75], v[60:63], v[184:187]
    s_waitcnt lgkmcnt(2)
    v_mfma_f32_16x16x32_bf16 v[164:167], v[76:79], v[48:51], v[164:167]
    ds_read_b128 v[72:75], v13 offset:12288
    v_mfma_f32_16x16x32_bf16 v[172:175], v[76:79], v[52:55], v[172:175]
    v_mfma_f32_16x16x32_bf16 v[180:183], v[76:79], v[56:59], v[180:183]
    v_mfma_f32_16x16x32_bf16 v[188:191], v[76:79], v[60:63], v[188:191]
    s_add_u32 m0, s67, 122880
    s_add_u32 s63, s70, 197120
    buffer_load_dwordx4 v3, s[16:19], s63 offen lds
    s_waitcnt lgkmcnt(2)
    v_mfma_f32_16x16x32_bf16 v[192:195], v[64:67], v[48:51], v[192:195]
    ds_read_b128 v[76:79], v13 offset:14336
    v_mfma_f32_16x16x32_bf16 v[200:203], v[64:67], v[52:55], v[200:203]
    v_mfma_f32_16x16x32_bf16 v[208:211], v[64:67], v[56:59], v[208:211]
    v_mfma_f32_16x16x32_bf16 v[216:219], v[64:67], v[60:63], v[216:219]
    s_waitcnt lgkmcnt(0)
    s_waitcnt vmcnt(4)
    s_barrier
    s_setprio 3
    v_mfma_f32_16x16x32_bf16 v[196:199], v[68:71], v[48:51], v[196:199]
    ds_read_b128 v[64:67], v8 offset:32768
    v_mfma_f32_16x16x32_bf16 v[204:207], v[68:71], v[52:55], v[204:207]
    ds_read_b64_tr_b16 v[32:33], v18 offset:0
    v_mfma_f32_16x16x32_bf16 v[212:215], v[68:71], v[56:59], v[212:215]
    ds_read_b64_tr_b16 v[34:35], v18 offset:2048
    v_mfma_f32_16x16x32_bf16 v[220:223], v[68:71], v[60:63], v[220:223]
    ds_read_b64_tr_b16 v[36:37], v19 offset:0
    s_add_u32 m0, s67, 131072
    s_add_u32 s63, s71, 2097152
    buffer_load_dwordx4 v4, s[20:23], s63 offen lds
    v_mfma_f32_16x16x32_bf16 v[224:227], v[72:75], v[48:51], v[224:227]
    ds_read_b128 v[68:71], v8 offset:34816
    v_mfma_f32_16x16x32_bf16 v[232:235], v[72:75], v[52:55], v[232:235]
    ds_read_b64_tr_b16 v[38:39], v19 offset:2048
    v_mfma_f32_16x16x32_bf16 v[240:243], v[72:75], v[56:59], v[240:243]
    ds_read_b64_tr_b16 v[40:41], v20 offset:0
    v_mfma_f32_16x16x32_bf16 v[248:251], v[72:75], v[60:63], v[248:251]
    ds_read_b64_tr_b16 v[42:43], v20 offset:2048
    v_mfma_f32_16x16x32_bf16 v[228:231], v[76:79], v[48:51], v[228:231]
    ds_read_b128 v[72:75], v8 offset:36864
    v_mfma_f32_16x16x32_bf16 v[236:239], v[76:79], v[52:55], v[236:239]
    ds_read_b64_tr_b16 v[44:45], v21 offset:0
    v_mfma_f32_16x16x32_bf16 v[244:247], v[76:79], v[56:59], v[244:247]
    ds_read_b64_tr_b16 v[46:47], v21 offset:2048
    v_mfma_f32_16x16x32_bf16 v[252:255], v[76:79], v[60:63], v[252:255]
    s_add_u32 m0, s67, 139264
    s_add_u32 s63, s71, 2228224
    buffer_load_dwordx4 v4, s[20:23], s63 offen lds
    ds_read_b128 v[76:79], v8 offset:38912
    s_setprio 2
    s_waitcnt lgkmcnt(11)
    s_waitcnt lgkmcnt(9)
    v_mfma_f32_16x16x32_bf16 v[128:131], v[64:67], v[32:35], v[128:131]
    s_waitcnt lgkmcnt(6)
    v_mfma_f32_16x16x32_bf16 v[136:139], v[64:67], v[36:39], v[136:139]
    s_waitcnt lgkmcnt(4)
    v_mfma_f32_16x16x32_bf16 v[144:147], v[64:67], v[40:43], v[144:147]
    s_waitcnt lgkmcnt(1)
    v_mfma_f32_16x16x32_bf16 v[152:155], v[64:67], v[44:47], v[152:155]
    v_mfma_f32_16x16x32_bf16 v[132:135], v[68:71], v[32:35], v[132:135]
    ds_read_b128 v[64:67], v8 offset:40960
    v_mfma_f32_16x16x32_bf16 v[140:143], v[68:71], v[36:39], v[140:143]
    ds_read_b64_tr_b16 v[48:49], v18 offset:16384
    v_mfma_f32_16x16x32_bf16 v[148:151], v[68:71], v[40:43], v[148:151]
    ds_read_b64_tr_b16 v[50:51], v18 offset:18432
    v_mfma_f32_16x16x32_bf16 v[156:159], v[68:71], v[44:47], v[156:159]
    s_add_u32 m0, s67, 147456
    s_add_u32 s63, s71, 2359296
    buffer_load_dwordx4 v4, s[20:23], s63 offen lds
    v_mfma_f32_16x16x32_bf16 v[160:163], v[72:75], v[32:35], v[160:163]
    ds_read_b128 v[68:71], v8 offset:43008
    v_mfma_f32_16x16x32_bf16 v[168:171], v[72:75], v[36:39], v[168:171]
    ds_read_b64_tr_b16 v[52:53], v19 offset:16384
    v_mfma_f32_16x16x32_bf16 v[176:179], v[72:75], v[40:43], v[176:179]
    ds_read_b64_tr_b16 v[54:55], v19 offset:18432
    v_mfma_f32_16x16x32_bf16 v[184:187], v[72:75], v[44:47], v[184:187]
    s_waitcnt lgkmcnt(6)
    v_mfma_f32_16x16x32_bf16 v[164:167], v[76:79], v[32:35], v[164:167]
    ds_read_b128 v[72:75], v8 offset:45056
    v_mfma_f32_16x16x32_bf16 v[172:175], v[76:79], v[36:39], v[172:175]
    ds_read_b64_tr_b16 v[56:57], v20 offset:16384
    v_mfma_f32_16x16x32_bf16 v[180:183], v[76:79], v[40:43], v[180:183]
    ds_read_b64_tr_b16 v[58:59], v20 offset:18432
    v_mfma_f32_16x16x32_bf16 v[188:191], v[76:79], v[44:47], v[188:191]
    s_add_u32 m0, s67, 155648
    s_add_u32 s63, s71, 2490368
    buffer_load_dwordx4 v4, s[20:23], s63 offen lds
    s_setprio 1
    s_waitcnt lgkmcnt(8)
    v_mfma_f32_16x16x32_bf16 v[192:195], v[64:67], v[32:35], v[192:195]
    ds_read_b128 v[76:79], v8 offset:47104
    v_mfma_f32_16x16x32_bf16 v[200:203], v[64:67], v[36:39], v[200:203]
    ds_read_b64_tr_b16 v[60:61], v21 offset:16384
    v_mfma_f32_16x16x32_bf16 v[208:211], v[64:67], v[40:43], v[208:211]
    ds_read_b64_tr_b16 v[62:63], v21 offset:18432
    v_mfma_f32_16x16x32_bf16 v[216:219], v[64:67], v[44:47], v[216:219]
    s_waitcnt lgkmcnt(8)
    v_mfma_f32_16x16x32_bf16 v[196:199], v[68:71], v[32:35], v[196:199]
    ds_read_b128 v[64:67], v9 offset:32768
    v_mfma_f32_16x16x32_bf16 v[204:207], v[68:71], v[36:39], v[204:207]
    v_mfma_f32_16x16x32_bf16 v[212:215], v[68:71], v[40:43], v[212:215]
    v_mfma_f32_16x16x32_bf16 v[220:223], v[68:71], v[44:47], v[220:223]
    s_add_u32 m0, s67, 0
    s_add_u32 s63, s70, 640
    buffer_load_dwordx4 v3, s[16:19], s63 offen lds
    s_waitcnt lgkmcnt(6)
    v_mfma_f32_16x16x32_bf16 v[224:227], v[72:75], v[32:35], v[224:227]
    ds_read_b128 v[68:71], v9 offset:34816
    v_mfma_f32_16x16x32_bf16 v[232:235], v[72:75], v[36:39], v[232:235]
    v_mfma_f32_16x16x32_bf16 v[240:243], v[72:75], v[40:43], v[240:243]
    v_mfma_f32_16x16x32_bf16 v[248:251], v[72:75], v[44:47], v[248:251]
    s_waitcnt lgkmcnt(4)
    v_mfma_f32_16x16x32_bf16 v[228:231], v[76:79], v[32:35], v[228:231]
    ds_read_b128 v[72:75], v9 offset:36864
    v_mfma_f32_16x16x32_bf16 v[236:239], v[76:79], v[36:39], v[236:239]
    v_mfma_f32_16x16x32_bf16 v[244:247], v[76:79], v[40:43], v[244:247]
    v_mfma_f32_16x16x32_bf16 v[252:255], v[76:79], v[44:47], v[252:255]
    s_add_u32 m0, s67, 8192
    s_add_u32 s63, s70, 66176
    buffer_load_dwordx4 v3, s[16:19], s63 offen lds
    ds_read_b128 v[76:79], v9 offset:38912
    s_setprio 0
    s_waitcnt lgkmcnt(3)
    v_mfma_f32_16x16x32_bf16 v[128:131], v[64:67], v[48:51], v[128:131]
    v_mfma_f32_16x16x32_bf16 v[136:139], v[64:67], v[52:55], v[136:139]
    v_mfma_f32_16x16x32_bf16 v[144:147], v[64:67], v[56:59], v[144:147]
    v_mfma_f32_16x16x32_bf16 v[152:155], v[64:67], v[60:63], v[152:155]
    s_waitcnt lgkmcnt(2)
    v_mfma_f32_16x16x32_bf16 v[132:135], v[68:71], v[48:51], v[132:135]
    ds_read_b128 v[64:67], v9 offset:40960
    v_mfma_f32_16x16x32_bf16 v[140:143], v[68:71], v[52:55], v[140:143]
    v_mfma_f32_16x16x32_bf16 v[148:151], v[68:71], v[56:59], v[148:151]
    v_mfma_f32_16x16x32_bf16 v[156:159], v[68:71], v[60:63], v[156:159]
    s_add_u32 m0, s67, 16384
    s_add_u32 s63, s70, 131712
    buffer_load_dwordx4 v3, s[16:19], s63 offen lds
    s_waitcnt lgkmcnt(2)
    v_mfma_f32_16x16x32_bf16 v[160:163], v[72:75], v[48:51], v[160:163]
    ds_read_b128 v[68:71], v9 offset:43008
    v_mfma_f32_16x16x32_bf16 v[168:171], v[72:75], v[52:55], v[168:171]
    v_mfma_f32_16x16x32_bf16 v[176:179], v[72:75], v[56:59], v[176:179]
    v_mfma_f32_16x16x32_bf16 v[184:187], v[72:75], v[60:63], v[184:187]
    s_waitcnt lgkmcnt(2)
    v_mfma_f32_16x16x32_bf16 v[164:167], v[76:79], v[48:51], v[164:167]
    ds_read_b128 v[72:75], v9 offset:45056
    v_mfma_f32_16x16x32_bf16 v[172:175], v[76:79], v[52:55], v[172:175]
    v_mfma_f32_16x16x32_bf16 v[180:183], v[76:79], v[56:59], v[180:183]
    v_mfma_f32_16x16x32_bf16 v[188:191], v[76:79], v[60:63], v[188:191]
    s_add_u32 m0, s67, 24576
    s_add_u32 s63, s70, 197248
    buffer_load_dwordx4 v3, s[16:19], s63 offen lds
    s_waitcnt lgkmcnt(2)
    v_mfma_f32_16x16x32_bf16 v[192:195], v[64:67], v[48:51], v[192:195]
    ds_read_b128 v[76:79], v9 offset:47104
    v_mfma_f32_16x16x32_bf16 v[200:203], v[64:67], v[52:55], v[200:203]
    v_mfma_f32_16x16x32_bf16 v[208:211], v[64:67], v[56:59], v[208:211]
    v_mfma_f32_16x16x32_bf16 v[216:219], v[64:67], v[60:63], v[216:219]
    s_waitcnt lgkmcnt(0)
    s_waitcnt vmcnt(4)
    s_barrier
    s_setprio 3
    v_mfma_f32_16x16x32_bf16 v[196:199], v[68:71], v[48:51], v[196:199]
    ds_read_b128 v[64:67], v10 offset:32768
    v_mfma_f32_16x16x32_bf16 v[204:207], v[68:71], v[52:55], v[204:207]
    ds_read_b64_tr_b16 v[32:33], v22 offset:0
    v_mfma_f32_16x16x32_bf16 v[212:215], v[68:71], v[56:59], v[212:215]
    ds_read_b64_tr_b16 v[34:35], v22 offset:2048
    v_mfma_f32_16x16x32_bf16 v[220:223], v[68:71], v[60:63], v[220:223]
    ds_read_b64_tr_b16 v[36:37], v23 offset:0
    s_add_u32 m0, s67, 32768
    s_add_u32 s63, s71, 2621440
    buffer_load_dwordx4 v4, s[20:23], s63 offen lds
    v_mfma_f32_16x16x32_bf16 v[224:227], v[72:75], v[48:51], v[224:227]
    ds_read_b128 v[68:71], v10 offset:34816
    v_mfma_f32_16x16x32_bf16 v[232:235], v[72:75], v[52:55], v[232:235]
    ds_read_b64_tr_b16 v[38:39], v23 offset:2048
    v_mfma_f32_16x16x32_bf16 v[240:243], v[72:75], v[56:59], v[240:243]
    ds_read_b64_tr_b16 v[40:41], v24 offset:0
    v_mfma_f32_16x16x32_bf16 v[248:251], v[72:75], v[60:63], v[248:251]
    ds_read_b64_tr_b16 v[42:43], v24 offset:2048
    v_mfma_f32_16x16x32_bf16 v[228:231], v[76:79], v[48:51], v[228:231]
    ds_read_b128 v[72:75], v10 offset:36864
    v_mfma_f32_16x16x32_bf16 v[236:239], v[76:79], v[52:55], v[236:239]
    ds_read_b64_tr_b16 v[44:45], v25 offset:0
    v_mfma_f32_16x16x32_bf16 v[244:247], v[76:79], v[56:59], v[244:247]
    ds_read_b64_tr_b16 v[46:47], v25 offset:2048
    v_mfma_f32_16x16x32_bf16 v[252:255], v[76:79], v[60:63], v[252:255]
    s_add_u32 m0, s67, 40960
    s_add_u32 s63, s71, 2752512
    buffer_load_dwordx4 v4, s[20:23], s63 offen lds
    ds_read_b128 v[76:79], v10 offset:38912
    s_setprio 2
    s_waitcnt lgkmcnt(11)
    s_waitcnt lgkmcnt(9)
    v_mfma_f32_16x16x32_bf16 v[128:131], v[64:67], v[32:35], v[128:131]
    s_waitcnt lgkmcnt(6)
    v_mfma_f32_16x16x32_bf16 v[136:139], v[64:67], v[36:39], v[136:139]
    s_waitcnt lgkmcnt(4)
    v_mfma_f32_16x16x32_bf16 v[144:147], v[64:67], v[40:43], v[144:147]
    s_waitcnt lgkmcnt(1)
    v_mfma_f32_16x16x32_bf16 v[152:155], v[64:67], v[44:47], v[152:155]
    v_mfma_f32_16x16x32_bf16 v[132:135], v[68:71], v[32:35], v[132:135]
    ds_read_b128 v[64:67], v10 offset:40960
    v_mfma_f32_16x16x32_bf16 v[140:143], v[68:71], v[36:39], v[140:143]
    ds_read_b64_tr_b16 v[48:49], v22 offset:16384
    v_mfma_f32_16x16x32_bf16 v[148:151], v[68:71], v[40:43], v[148:151]
    ds_read_b64_tr_b16 v[50:51], v22 offset:18432
    v_mfma_f32_16x16x32_bf16 v[156:159], v[68:71], v[44:47], v[156:159]
    s_add_u32 m0, s67, 49152
    s_add_u32 s63, s71, 2883584
    buffer_load_dwordx4 v4, s[20:23], s63 offen lds
    v_mfma_f32_16x16x32_bf16 v[160:163], v[72:75], v[32:35], v[160:163]
    ds_read_b128 v[68:71], v10 offset:43008
    v_mfma_f32_16x16x32_bf16 v[168:171], v[72:75], v[36:39], v[168:171]
    ds_read_b64_tr_b16 v[52:53], v23 offset:16384
    v_mfma_f32_16x16x32_bf16 v[176:179], v[72:75], v[40:43], v[176:179]
    ds_read_b64_tr_b16 v[54:55], v23 offset:18432
    v_mfma_f32_16x16x32_bf16 v[184:187], v[72:75], v[44:47], v[184:187]
    s_waitcnt lgkmcnt(6)
    v_mfma_f32_16x16x32_bf16 v[164:167], v[76:79], v[32:35], v[164:167]
    ds_read_b128 v[72:75], v10 offset:45056
    v_mfma_f32_16x16x32_bf16 v[172:175], v[76:79], v[36:39], v[172:175]
    ds_read_b64_tr_b16 v[56:57], v24 offset:16384
    v_mfma_f32_16x16x32_bf16 v[180:183], v[76:79], v[40:43], v[180:183]
    ds_read_b64_tr_b16 v[58:59], v24 offset:18432
    v_mfma_f32_16x16x32_bf16 v[188:191], v[76:79], v[44:47], v[188:191]
    s_add_u32 m0, s67, 57344
    s_add_u32 s63, s71, 3014656
    buffer_load_dwordx4 v4, s[20:23], s63 offen lds
    s_setprio 1
    s_waitcnt lgkmcnt(8)
    v_mfma_f32_16x16x32_bf16 v[192:195], v[64:67], v[32:35], v[192:195]
    ds_read_b128 v[76:79], v10 offset:47104
    v_mfma_f32_16x16x32_bf16 v[200:203], v[64:67], v[36:39], v[200:203]
    ds_read_b64_tr_b16 v[60:61], v25 offset:16384
    v_mfma_f32_16x16x32_bf16 v[208:211], v[64:67], v[40:43], v[208:211]
    ds_read_b64_tr_b16 v[62:63], v25 offset:18432
    v_mfma_f32_16x16x32_bf16 v[216:219], v[64:67], v[44:47], v[216:219]
    s_waitcnt lgkmcnt(8)
    v_mfma_f32_16x16x32_bf16 v[196:199], v[68:71], v[32:35], v[196:199]
    ds_read_b128 v[64:67], v11 offset:32768
    v_mfma_f32_16x16x32_bf16 v[204:207], v[68:71], v[36:39], v[204:207]
    v_mfma_f32_16x16x32_bf16 v[212:215], v[68:71], v[40:43], v[212:215]
    v_mfma_f32_16x16x32_bf16 v[220:223], v[68:71], v[44:47], v[220:223]
    s_add_u32 m0, s67, 65536
    s_add_u32 s63, s70, 768
    buffer_load_dwordx4 v3, s[16:19], s63 offen lds
    s_waitcnt lgkmcnt(6)
    v_mfma_f32_16x16x32_bf16 v[224:227], v[72:75], v[32:35], v[224:227]
    ds_read_b128 v[68:71], v11 offset:34816
    v_mfma_f32_16x16x32_bf16 v[232:235], v[72:75], v[36:39], v[232:235]
    v_mfma_f32_16x16x32_bf16 v[240:243], v[72:75], v[40:43], v[240:243]
    v_mfma_f32_16x16x32_bf16 v[248:251], v[72:75], v[44:47], v[248:251]
    s_waitcnt lgkmcnt(4)
    v_mfma_f32_16x16x32_bf16 v[228:231], v[76:79], v[32:35], v[228:231]
    ds_read_b128 v[72:75], v11 offset:36864
    v_mfma_f32_16x16x32_bf16 v[236:239], v[76:79], v[36:39], v[236:239]
    v_mfma_f32_16x16x32_bf16 v[244:247], v[76:79], v[40:43], v[244:247]
    v_mfma_f32_16x16x32_bf16 v[252:255], v[76:79], v[44:47], v[252:255]
    s_add_u32 m0, s67, 73728
    s_add_u32 s63, s70, 66304
    buffer_load_dwordx4 v3, s[16:19], s63 offen lds
    ds_read_b128 v[76:79], v11 offset:38912
    s_setprio 0
    s_waitcnt lgkmcnt(3)
    v_mfma_f32_16x16x32_bf16 v[128:131], v[64:67], v[48:51], v[128:131]
    v_mfma_f32_16x16x32_bf16 v[136:139], v[64:67], v[52:55], v[136:139]
    v_mfma_f32_16x16x32_bf16 v[144:147], v[64:67], v[56:59], v[144:147]
    v_mfma_f32_16x16x32_bf16 v[152:155], v[64:67], v[60:63], v[152:155]
    s_waitcnt lgkmcnt(2)
    v_mfma_f32_16x16x32_bf16 v[132:135], v[68:71], v[48:51], v[132:135]
    ds_read_b128 v[64:67], v11 offset:40960
    v_mfma_f32_16x16x32_bf16 v[140:143], v[68:71], v[52:55], v[140:143]
    v_mfma_f32_16x16x32_bf16 v[148:151], v[68:71], v[56:59], v[148:151]
    v_mfma_f32_16x16x32_bf16 v[156:159], v[68:71], v[60:63], v[156:159]
    s_add_u32 m0, s67, 81920
    s_add_u32 s63, s70, 131840
    buffer_load_dwordx4 v3, s[16:19], s63 offen lds
    s_waitcnt lgkmcnt(2)
    v_mfma_f32_16x16x32_bf16 v[160:163], v[72:75], v[48:51], v[160:163]
    ds_read_b128 v[68:71], v11 offset:43008
    v_mfma_f32_16x16x32_bf16 v[168:171], v[72:75], v[52:55], v[168:171]
    v_mfma_f32_16x16x32_bf16 v[176:179], v[72:75], v[56:59], v[176:179]
    v_mfma_f32_16x16x32_bf16 v[184:187], v[72:75], v[60:63], v[184:187]
    s_waitcnt lgkmcnt(2)
    v_mfma_f32_16x16x32_bf16 v[164:167], v[76:79], v[48:51], v[164:167]
    ds_read_b128 v[72:75], v11 offset:45056
    v_mfma_f32_16x16x32_bf16 v[172:175], v[76:79], v[52:55], v[172:175]
    v_mfma_f32_16x16x32_bf16 v[180:183], v[76:79], v[56:59], v[180:183]
    v_mfma_f32_16x16x32_bf16 v[188:191], v[76:79], v[60:63], v[188:191]
    s_add_u32 m0, s67, 90112
    s_add_u32 s63, s70, 197376
    buffer_load_dwordx4 v3, s[16:19], s63 offen lds
    s_waitcnt lgkmcnt(2)
    v_mfma_f32_16x16x32_bf16 v[192:195], v[64:67], v[48:51], v[192:195]
    ds_read_b128 v[76:79], v11 offset:47104
    v_mfma_f32_16x16x32_bf16 v[200:203], v[64:67], v[52:55], v[200:203]
    v_mfma_f32_16x16x32_bf16 v[208:211], v[64:67], v[56:59], v[208:211]
    v_mfma_f32_16x16x32_bf16 v[216:219], v[64:67], v[60:63], v[216:219]
    s_waitcnt lgkmcnt(0)
    s_waitcnt vmcnt(4)
    s_barrier
    s_setprio 3
    v_mfma_f32_16x16x32_bf16 v[196:199], v[68:71], v[48:51], v[196:199]
    ds_read_b128 v[64:67], v8 offset:0
    v_mfma_f32_16x16x32_bf16 v[204:207], v[68:71], v[52:55], v[204:207]
    ds_read_b64_tr_b16 v[32:33], v14 offset:32768
    v_mfma_f32_16x16x32_bf16 v[212:215], v[68:71], v[56:59], v[212:215]
    ds_read_b64_tr_b16 v[34:35], v14 offset:34816
    v_mfma_f32_16x16x32_bf16 v[220:223], v[68:71], v[60:63], v[220:223]
    ds_read_b64_tr_b16 v[36:37], v15 offset:32768
    s_add_u32 m0, s67, 98304
    s_add_u32 s63, s71, 3145728
    buffer_load_dwordx4 v4, s[20:23], s63 offen lds
    v_mfma_f32_16x16x32_bf16 v[224:227], v[72:75], v[48:51], v[224:227]
    ds_read_b128 v[68:71], v8 offset:2048
    v_mfma_f32_16x16x32_bf16 v[232:235], v[72:75], v[52:55], v[232:235]
    ds_read_b64_tr_b16 v[38:39], v15 offset:34816
    v_mfma_f32_16x16x32_bf16 v[240:243], v[72:75], v[56:59], v[240:243]
    ds_read_b64_tr_b16 v[40:41], v16 offset:32768
    v_mfma_f32_16x16x32_bf16 v[248:251], v[72:75], v[60:63], v[248:251]
    ds_read_b64_tr_b16 v[42:43], v16 offset:34816
    v_mfma_f32_16x16x32_bf16 v[228:231], v[76:79], v[48:51], v[228:231]
    ds_read_b128 v[72:75], v8 offset:4096
    v_mfma_f32_16x16x32_bf16 v[236:239], v[76:79], v[52:55], v[236:239]
    ds_read_b64_tr_b16 v[44:45], v17 offset:32768
    v_mfma_f32_16x16x32_bf16 v[244:247], v[76:79], v[56:59], v[244:247]
    ds_read_b64_tr_b16 v[46:47], v17 offset:34816
    v_mfma_f32_16x16x32_bf16 v[252:255], v[76:79], v[60:63], v[252:255]
    s_add_u32 m0, s67, 106496
    s_add_u32 s63, s71, 3276800
    buffer_load_dwordx4 v4, s[20:23], s63 offen lds
    ds_read_b128 v[76:79], v8 offset:6144
    s_setprio 2
    s_waitcnt lgkmcnt(11)
    s_waitcnt lgkmcnt(9)
    v_mfma_f32_16x16x32_bf16 v[128:131], v[64:67], v[32:35], v[128:131]
    s_waitcnt lgkmcnt(6)
    v_mfma_f32_16x16x32_bf16 v[136:139], v[64:67], v[36:39], v[136:139]
    s_waitcnt lgkmcnt(4)
    v_mfma_f32_16x16x32_bf16 v[144:147], v[64:67], v[40:43], v[144:147]
    s_waitcnt lgkmcnt(1)
    v_mfma_f32_16x16x32_bf16 v[152:155], v[64:67], v[44:47], v[152:155]
    v_mfma_f32_16x16x32_bf16 v[132:135], v[68:71], v[32:35], v[132:135]
    ds_read_b128 v[64:67], v8 offset:8192
    v_mfma_f32_16x16x32_bf16 v[140:143], v[68:71], v[36:39], v[140:143]
    ds_read_b64_tr_b16 v[48:49], v14 offset:49152
    v_mfma_f32_16x16x32_bf16 v[148:151], v[68:71], v[40:43], v[148:151]
    ds_read_b64_tr_b16 v[50:51], v14 offset:51200
    v_mfma_f32_16x16x32_bf16 v[156:159], v[68:71], v[44:47], v[156:159]
    s_add_u32 m0, s67, 114688
    s_add_u32 s63, s71, 3407872
    buffer_load_dwordx4 v4, s[20:23], s63 offen lds
    v_mfma_f32_16x16x32_bf16 v[160:163], v[72:75], v[32:35], v[160:163]
    ds_read_b128 v[68:71], v8 offset:10240
    v_mfma_f32_16x16x32_bf16 v[168:171], v[72:75], v[36:39], v[168:171]
    ds_read_b64_tr_b16 v[52:53], v15 offset:49152
    v_mfma_f32_16x16x32_bf16 v[176:179], v[72:75], v[40:43], v[176:179]
    ds_read_b64_tr_b16 v[54:55], v15 offset:51200
    v_mfma_f32_16x16x32_bf16 v[184:187], v[72:75], v[44:47], v[184:187]
    s_waitcnt lgkmcnt(6)
    v_mfma_f32_16x16x32_bf16 v[164:167], v[76:79], v[32:35], v[164:167]
    ds_read_b128 v[72:75], v8 offset:12288
    v_mfma_f32_16x16x32_bf16 v[172:175], v[76:79], v[36:39], v[172:175]
    ds_read_b64_tr_b16 v[56:57], v16 offset:49152
    v_mfma_f32_16x16x32_bf16 v[180:183], v[76:79], v[40:43], v[180:183]
    ds_read_b64_tr_b16 v[58:59], v16 offset:51200
    v_mfma_f32_16x16x32_bf16 v[188:191], v[76:79], v[44:47], v[188:191]
    s_add_u32 m0, s67, 122880
    s_add_u32 s63, s71, 3538944
    buffer_load_dwordx4 v4, s[20:23], s63 offen lds
    s_setprio 1
    s_waitcnt lgkmcnt(8)
    v_mfma_f32_16x16x32_bf16 v[192:195], v[64:67], v[32:35], v[192:195]
    ds_read_b128 v[76:79], v8 offset:14336
    v_mfma_f32_16x16x32_bf16 v[200:203], v[64:67], v[36:39], v[200:203]
    ds_read_b64_tr_b16 v[60:61], v17 offset:49152
    v_mfma_f32_16x16x32_bf16 v[208:211], v[64:67], v[40:43], v[208:211]
    ds_read_b64_tr_b16 v[62:63], v17 offset:51200
    v_mfma_f32_16x16x32_bf16 v[216:219], v[64:67], v[44:47], v[216:219]
    s_waitcnt lgkmcnt(8)
    v_mfma_f32_16x16x32_bf16 v[196:199], v[68:71], v[32:35], v[196:199]
    ds_read_b128 v[64:67], v9 offset:0
    v_mfma_f32_16x16x32_bf16 v[204:207], v[68:71], v[36:39], v[204:207]
    v_mfma_f32_16x16x32_bf16 v[212:215], v[68:71], v[40:43], v[212:215]
    v_mfma_f32_16x16x32_bf16 v[220:223], v[68:71], v[44:47], v[220:223]
    s_add_u32 m0, s67, 131072
    s_add_u32 s63, s70, 896
    buffer_load_dwordx4 v3, s[16:19], s63 offen lds
    s_waitcnt lgkmcnt(6)
    v_mfma_f32_16x16x32_bf16 v[224:227], v[72:75], v[32:35], v[224:227]
    ds_read_b128 v[68:71], v9 offset:2048
    v_mfma_f32_16x16x32_bf16 v[232:235], v[72:75], v[36:39], v[232:235]
    v_mfma_f32_16x16x32_bf16 v[240:243], v[72:75], v[40:43], v[240:243]
    v_mfma_f32_16x16x32_bf16 v[248:251], v[72:75], v[44:47], v[248:251]
    s_waitcnt lgkmcnt(4)
    v_mfma_f32_16x16x32_bf16 v[228:231], v[76:79], v[32:35], v[228:231]
    ds_read_b128 v[72:75], v9 offset:4096
    v_mfma_f32_16x16x32_bf16 v[236:239], v[76:79], v[36:39], v[236:239]
    v_mfma_f32_16x16x32_bf16 v[244:247], v[76:79], v[40:43], v[244:247]
    v_mfma_f32_16x16x32_bf16 v[252:255], v[76:79], v[44:47], v[252:255]
    s_add_u32 m0, s67, 139264
    s_add_u32 s63, s70, 66432
    buffer_load_dwordx4 v3, s[16:19], s63 offen lds
    ds_read_b128 v[76:79], v9 offset:6144
    s_setprio 0
    s_waitcnt lgkmcnt(3)
    v_mfma_f32_16x16x32_bf16 v[128:131], v[64:67], v[48:51], v[128:131]
    v_mfma_f32_16x16x32_bf16 v[136:139], v[64:67], v[52:55], v[136:139]
    v_mfma_f32_16x16x32_bf16 v[144:147], v[64:67], v[56:59], v[144:147]
    v_mfma_f32_16x16x32_bf16 v[152:155], v[64:67], v[60:63], v[152:155]
    s_waitcnt lgkmcnt(2)
    v_mfma_f32_16x16x32_bf16 v[132:135], v[68:71], v[48:51], v[132:135]
    ds_read_b128 v[64:67], v9 offset:8192
    v_mfma_f32_16x16x32_bf16 v[140:143], v[68:71], v[52:55], v[140:143]
    v_mfma_f32_16x16x32_bf16 v[148:151], v[68:71], v[56:59], v[148:151]
    v_mfma_f32_16x16x32_bf16 v[156:159], v[68:71], v[60:63], v[156:159]
    s_add_u32 m0, s67, 147456
    s_add_u32 s63, s70, 131968
    buffer_load_dwordx4 v3, s[16:19], s63 offen lds
    s_waitcnt lgkmcnt(2)
    v_mfma_f32_16x16x32_bf16 v[160:163], v[72:75], v[48:51], v[160:163]
    ds_read_b128 v[68:71], v9 offset:10240
    v_mfma_f32_16x16x32_bf16 v[168:171], v[72:75], v[52:55], v[168:171]
    v_mfma_f32_16x16x32_bf16 v[176:179], v[72:75], v[56:59], v[176:179]
    v_mfma_f32_16x16x32_bf16 v[184:187], v[72:75], v[60:63], v[184:187]
    s_waitcnt lgkmcnt(2)
    v_mfma_f32_16x16x32_bf16 v[164:167], v[76:79], v[48:51], v[164:167]
    ds_read_b128 v[72:75], v9 offset:12288
    v_mfma_f32_16x16x32_bf16 v[172:175], v[76:79], v[52:55], v[172:175]
    v_mfma_f32_16x16x32_bf16 v[180:183], v[76:79], v[56:59], v[180:183]
    v_mfma_f32_16x16x32_bf16 v[188:191], v[76:79], v[60:63], v[188:191]
    s_add_u32 m0, s67, 155648
    s_add_u32 s63, s70, 197504
    buffer_load_dwordx4 v3, s[16:19], s63 offen lds
    s_waitcnt lgkmcnt(2)
    v_mfma_f32_16x16x32_bf16 v[192:195], v[64:67], v[48:51], v[192:195]
    ds_read_b128 v[76:79], v9 offset:14336
    v_mfma_f32_16x16x32_bf16 v[200:203], v[64:67], v[52:55], v[200:203]
    v_mfma_f32_16x16x32_bf16 v[208:211], v[64:67], v[56:59], v[208:211]
    v_mfma_f32_16x16x32_bf16 v[216:219], v[64:67], v[60:63], v[216:219]
    s_waitcnt lgkmcnt(0)
    s_waitcnt vmcnt(4)
    s_barrier
    s_setprio 3
    v_mfma_f32_16x16x32_bf16 v[196:199], v[68:71], v[48:51], v[196:199]
    ds_read_b128 v[64:67], v10 offset:0
    v_mfma_f32_16x16x32_bf16 v[204:207], v[68:71], v[52:55], v[204:207]
    ds_read_b64_tr_b16 v[32:33], v18 offset:32768
    v_mfma_f32_16x16x32_bf16 v[212:215], v[68:71], v[56:59], v[212:215]
    ds_read_b64_tr_b16 v[34:35], v18 offset:34816
    v_mfma_f32_16x16x32_bf16 v[220:223], v[68:71], v[60:63], v[220:223]
    ds_read_b64_tr_b16 v[36:37], v19 offset:32768
    s_add_u32 m0, s67, 0
    s_add_u32 s63, s71, 3670016
    buffer_load_dwordx4 v4, s[20:23], s63 offen lds
    v_mfma_f32_16x16x32_bf16 v[224:227], v[72:75], v[48:51], v[224:227]
    ds_read_b128 v[68:71], v10 offset:2048
    v_mfma_f32_16x16x32_bf16 v[232:235], v[72:75], v[52:55], v[232:235]
    ds_read_b64_tr_b16 v[38:39], v19 offset:34816
    v_mfma_f32_16x16x32_bf16 v[240:243], v[72:75], v[56:59], v[240:243]
    ds_read_b64_tr_b16 v[40:41], v20 offset:32768
    v_mfma_f32_16x16x32_bf16 v[248:251], v[72:75], v[60:63], v[248:251]
    ds_read_b64_tr_b16 v[42:43], v20 offset:34816
    v_mfma_f32_16x16x32_bf16 v[228:231], v[76:79], v[48:51], v[228:231]
    ds_read_b128 v[72:75], v10 offset:4096
    v_mfma_f32_16x16x32_bf16 v[236:239], v[76:79], v[52:55], v[236:239]
    ds_read_b64_tr_b16 v[44:45], v21 offset:32768
    v_mfma_f32_16x16x32_bf16 v[244:247], v[76:79], v[56:59], v[244:247]
    ds_read_b64_tr_b16 v[46:47], v21 offset:34816
    v_mfma_f32_16x16x32_bf16 v[252:255], v[76:79], v[60:63], v[252:255]
    s_add_u32 m0, s67, 8192
    s_add_u32 s63, s71, 3801088
    buffer_load_dwordx4 v4, s[20:23], s63 offen lds
    ds_read_b128 v[76:79], v10 offset:6144
    s_setprio 2
    s_waitcnt lgkmcnt(11)
    s_waitcnt lgkmcnt(9)
    v_mfma_f32_16x16x32_bf16 v[128:131], v[64:67], v[32:35], v[128:131]
    s_waitcnt lgkmcnt(6)
    v_mfma_f32_16x16x32_bf16 v[136:139], v[64:67], v[36:39], v[136:139]
    s_waitcnt lgkmcnt(4)
    v_mfma_f32_16x16x32_bf16 v[144:147], v[64:67], v[40:43], v[144:147]
    s_waitcnt lgkmcnt(1)
    v_mfma_f32_16x16x32_bf16 v[152:155], v[64:67], v[44:47], v[152:155]
    v_mfma_f32_16x16x32_bf16 v[132:135], v[68:71], v[32:35], v[132:135]
    ds_read_b128 v[64:67], v10 offset:8192
    v_mfma_f32_16x16x32_bf16 v[140:143], v[68:71], v[36:39], v[140:143]
    ds_read_b64_tr_b16 v[48:49], v18 offset:49152
    v_mfma_f32_16x16x32_bf16 v[148:151], v[68:71], v[40:43], v[148:151]
    ds_read_b64_tr_b16 v[50:51], v18 offset:51200
    v_mfma_f32_16x16x32_bf16 v[156:159], v[68:71], v[44:47], v[156:159]
    s_add_u32 m0, s67, 16384
    s_add_u32 s63, s71, 3932160
    buffer_load_dwordx4 v4, s[20:23], s63 offen lds
    v_mfma_f32_16x16x32_bf16 v[160:163], v[72:75], v[32:35], v[160:163]
    ds_read_b128 v[68:71], v10 offset:10240
    v_mfma_f32_16x16x32_bf16 v[168:171], v[72:75], v[36:39], v[168:171]
    ds_read_b64_tr_b16 v[52:53], v19 offset:49152
    v_mfma_f32_16x16x32_bf16 v[176:179], v[72:75], v[40:43], v[176:179]
    ds_read_b64_tr_b16 v[54:55], v19 offset:51200
    v_mfma_f32_16x16x32_bf16 v[184:187], v[72:75], v[44:47], v[184:187]
    s_waitcnt lgkmcnt(6)
    v_mfma_f32_16x16x32_bf16 v[164:167], v[76:79], v[32:35], v[164:167]
    ds_read_b128 v[72:75], v10 offset:12288
    v_mfma_f32_16x16x32_bf16 v[172:175], v[76:79], v[36:39], v[172:175]
    ds_read_b64_tr_b16 v[56:57], v20 offset:49152
    v_mfma_f32_16x16x32_bf16 v[180:183], v[76:79], v[40:43], v[180:183]
    ds_read_b64_tr_b16 v[58:59], v20 offset:51200
    v_mfma_f32_16x16x32_bf16 v[188:191], v[76:79], v[44:47], v[188:191]
    s_add_u32 m0, s67, 24576
    s_add_u32 s63, s71, 4063232
    buffer_load_dwordx4 v4, s[20:23], s63 offen lds
    s_setprio 1
    s_waitcnt lgkmcnt(8)
    v_mfma_f32_16x16x32_bf16 v[192:195], v[64:67], v[32:35], v[192:195]
    ds_read_b128 v[76:79], v10 offset:14336
    v_mfma_f32_16x16x32_bf16 v[200:203], v[64:67], v[36:39], v[200:203]
    ds_read_b64_tr_b16 v[60:61], v21 offset:49152
    v_mfma_f32_16x16x32_bf16 v[208:211], v[64:67], v[40:43], v[208:211]
    ds_read_b64_tr_b16 v[62:63], v21 offset:51200
    v_mfma_f32_16x16x32_bf16 v[216:219], v[64:67], v[44:47], v[216:219]
    s_waitcnt lgkmcnt(8)
    v_mfma_f32_16x16x32_bf16 v[196:199], v[68:71], v[32:35], v[196:199]
    ds_read_b128 v[64:67], v11 offset:0
    v_mfma_f32_16x16x32_bf16 v[204:207], v[68:71], v[36:39], v[204:207]
    v_mfma_f32_16x16x32_bf16 v[212:215], v[68:71], v[40:43], v[212:215]
    v_mfma_f32_16x16x32_bf16 v[220:223], v[68:71], v[44:47], v[220:223]
    s_add_u32 m0, s68, 32768
    s_add_u32 s63, s72, 0
    buffer_load_dwordx4 v80, s[24:27], s63 offen lds
    s_waitcnt lgkmcnt(6)
    v_mfma_f32_16x16x32_bf16 v[224:227], v[72:75], v[32:35], v[224:227]
    ds_read_b128 v[68:71], v11 offset:2048
    v_mfma_f32_16x16x32_bf16 v[232:235], v[72:75], v[36:39], v[232:235]
    v_mfma_f32_16x16x32_bf16 v[240:243], v[72:75], v[40:43], v[240:243]
    v_mfma_f32_16x16x32_bf16 v[248:251], v[72:75], v[44:47], v[248:251]
    s_waitcnt lgkmcnt(4)
    v_mfma_f32_16x16x32_bf16 v[228:231], v[76:79], v[32:35], v[228:231]
    ds_read_b128 v[72:75], v11 offset:4096
    v_mfma_f32_16x16x32_bf16 v[236:239], v[76:79], v[36:39], v[236:239]
    v_mfma_f32_16x16x32_bf16 v[244:247], v[76:79], v[40:43], v[244:247]
    v_mfma_f32_16x16x32_bf16 v[252:255], v[76:79], v[44:47], v[252:255]
    s_add_u32 m0, s68, 33792
    s_add_u32 s63, s72, 8192
    buffer_load_dwordx4 v81, s[24:27], s63 offen lds
    ds_read_b128 v[76:79], v11 offset:6144
    s_setprio 0
    s_waitcnt lgkmcnt(3)
    v_mfma_f32_16x16x32_bf16 v[128:131], v[64:67], v[48:51], v[128:131]
    v_mfma_f32_16x16x32_bf16 v[136:139], v[64:67], v[52:55], v[136:139]
    v_mfma_f32_16x16x32_bf16 v[144:147], v[64:67], v[56:59], v[144:147]
    v_mfma_f32_16x16x32_bf16 v[152:155], v[64:67], v[60:63], v[152:155]
    s_waitcnt lgkmcnt(2)
    v_mfma_f32_16x16x32_bf16 v[132:135], v[68:71], v[48:51], v[132:135]
    ds_read_b128 v[64:67], v11 offset:8192
    v_mfma_f32_16x16x32_bf16 v[140:143], v[68:71], v[52:55], v[140:143]
    v_mfma_f32_16x16x32_bf16 v[148:151], v[68:71], v[56:59], v[148:151]
    v_mfma_f32_16x16x32_bf16 v[156:159], v[68:71], v[60:63], v[156:159]
    s_add_u32 m0, s68, 34816
    s_add_u32 s63, s72, 16384
    buffer_load_dwordx4 v80, s[24:27], s63 offen lds
    s_waitcnt lgkmcnt(2)
    v_mfma_f32_16x16x32_bf16 v[160:163], v[72:75], v[48:51], v[160:163]
    ds_read_b128 v[68:71], v11 offset:10240
    v_mfma_f32_16x16x32_bf16 v[168:171], v[72:75], v[52:55], v[168:171]
    v_mfma_f32_16x16x32_bf16 v[176:179], v[72:75], v[56:59], v[176:179]
    v_mfma_f32_16x16x32_bf16 v[184:187], v[72:75], v[60:63], v[184:187]
    s_waitcnt lgkmcnt(2)
    v_mfma_f32_16x16x32_bf16 v[164:167], v[76:79], v[48:51], v[164:167]
    ds_read_b128 v[72:75], v11 offset:12288
    v_mfma_f32_16x16x32_bf16 v[172:175], v[76:79], v[52:55], v[172:175]
    v_mfma_f32_16x16x32_bf16 v[180:183], v[76:79], v[56:59], v[180:183]
    v_mfma_f32_16x16x32_bf16 v[188:191], v[76:79], v[60:63], v[188:191]
    s_add_u32 m0, s68, 35840
    s_add_u32 s63, s72, 24576
    buffer_load_dwordx4 v81, s[24:27], s63 offen lds
    s_waitcnt lgkmcnt(2)
    v_mfma_f32_16x16x32_bf16 v[192:195], v[64:67], v[48:51], v[192:195]
    ds_read_b128 v[76:79], v11 offset:14336
    v_mfma_f32_16x16x32_bf16 v[200:203], v[64:67], v[52:55], v[200:203]
    v_mfma_f32_16x16x32_bf16 v[208:211], v[64:67], v[56:59], v[208:211]
    v_mfma_f32_16x16x32_bf16 v[216:219], v[64:67], v[60:63], v[216:219]
    s_waitcnt lgkmcnt(0)
    s_waitcnt vmcnt(4)
    s_barrier
    s_setprio 3
    v_mfma_f32_16x16x32_bf16 v[196:199], v[68:71], v[48:51], v[196:199]
    ds_read_b128 v[64:67], v12 offset:0
    v_mfma_f32_16x16x32_bf16 v[204:207], v[68:71], v[52:55], v[204:207]
    ds_read_b64_tr_b16 v[32:33], v14 offset:0
    v_mfma_f32_16x16x32_bf16 v[212:215], v[68:71], v[56:59], v[212:215]
    ds_read_b64_tr_b16 v[34:35], v14 offset:2048
    v_mfma_f32_16x16x32_bf16 v[220:223], v[68:71], v[60:63], v[220:223]
    ds_read_b64_tr_b16 v[36:37], v15 offset:0
    s_add_u32 m0, s67, 98304
    s_add_u32 s63, s73, 0
    buffer_load_dwordx4 v82, s[36:39], s63 offen lds
    v_mfma_f32_16x16x32_bf16 v[224:227], v[72:75], v[48:51], v[224:227]
    ds_read_b128 v[68:71], v12 offset:2048
    v_mfma_f32_16x16x32_bf16 v[232:235], v[72:75], v[52:55], v[232:235]
    ds_read_b64_tr_b16 v[38:39], v15 offset:2048
    v_mfma_f32_16x16x32_bf16 v[240:243], v[72:75], v[56:59], v[240:243]
    ds_read_b64_tr_b16 v[40:41], v16 offset:0
    v_mfma_f32_16x16x32_bf16 v[248:251], v[72:75], v[60:63], v[248:251]
    ds_read_b64_tr_b16 v[42:43], v16 offset:2048
    v_mfma_f32_16x16x32_bf16 v[228:231], v[76:79], v[48:51], v[228:231]
    ds_read_b128 v[72:75], v12 offset:4096
    v_mfma_f32_16x16x32_bf16 v[236:239], v[76:79], v[52:55], v[236:239]
    ds_read_b64_tr_b16 v[44:45], v17 offset:0
    v_mfma_f32_16x16x32_bf16 v[244:247], v[76:79], v[56:59], v[244:247]
    ds_read_b64_tr_b16 v[46:47], v17 offset:2048
    v_mfma_f32_16x16x32_bf16 v[252:255], v[76:79], v[60:63], v[252:255]
    s_add_u32 m0, s67, 106496
    s_add_u32 s63, s73, 262144
    buffer_load_dwordx4 v82, s[36:39], s63 offen lds
    ds_read_b128 v[76:79], v12 offset:6144
    s_setprio 2
    s_waitcnt lgkmcnt(11)
    s_waitcnt lgkmcnt(9)
    v_mfma_f32_16x16x32_bf16 v[128:131], v[64:67], v[32:35], v[128:131]
    s_waitcnt lgkmcnt(6)
    v_mfma_f32_16x16x32_bf16 v[136:139], v[64:67], v[36:39], v[136:139]
    s_waitcnt lgkmcnt(4)
    v_mfma_f32_16x16x32_bf16 v[144:147], v[64:67], v[40:43], v[144:147]
    s_waitcnt lgkmcnt(1)
    v_mfma_f32_16x16x32_bf16 v[152:155], v[64:67], v[44:47], v[152:155]
    v_mfma_f32_16x16x32_bf16 v[132:135], v[68:71], v[32:35], v[132:135]
    ds_read_b128 v[64:67], v12 offset:8192
    v_mfma_f32_16x16x32_bf16 v[140:143], v[68:71], v[36:39], v[140:143]
    ds_read_b64_tr_b16 v[48:49], v14 offset:16384
    v_mfma_f32_16x16x32_bf16 v[148:151], v[68:71], v[40:43], v[148:151]
    ds_read_b64_tr_b16 v[50:51], v14 offset:18432
    v_mfma_f32_16x16x32_bf16 v[156:159], v[68:71], v[44:47], v[156:159]
    s_add_u32 m0, s67, 114688
    s_add_u32 s63, s74, 0
    buffer_load_dwordx4 v83, s[28:31], s63 offen lds
    v_mfma_f32_16x16x32_bf16 v[160:163], v[72:75], v[32:35], v[160:163]
    ds_read_b128 v[68:71], v12 offset:10240
    v_mfma_f32_16x16x32_bf16 v[168:171], v[72:75], v[36:39], v[168:171]
    ds_read_b64_tr_b16 v[52:53], v15 offset:16384
    v_mfma_f32_16x16x32_bf16 v[176:179], v[72:75], v[40:43], v[176:179]
    ds_read_b64_tr_b16 v[54:55], v15 offset:18432
    v_mfma_f32_16x16x32_bf16 v[184:187], v[72:75], v[44:47], v[184:187]
    s_waitcnt lgkmcnt(6)
    v_mfma_f32_16x16x32_bf16 v[164:167], v[76:79], v[32:35], v[164:167]
    ds_read_b128 v[72:75], v12 offset:12288
    v_mfma_f32_16x16x32_bf16 v[172:175], v[76:79], v[36:39], v[172:175]
    ds_read_b64_tr_b16 v[56:57], v16 offset:16384
    v_mfma_f32_16x16x32_bf16 v[180:183], v[76:79], v[40:43], v[180:183]
    ds_read_b64_tr_b16 v[58:59], v16 offset:18432
    v_mfma_f32_16x16x32_bf16 v[188:191], v[76:79], v[44:47], v[188:191]
    s_add_u32 m0, s68, 65536
    s_add_u32 s63, s72, 128
    buffer_load_dwordx4 v80, s[24:27], s63 offen lds
    s_setprio 1
    s_waitcnt lgkmcnt(8)
    v_mfma_f32_16x16x32_bf16 v[192:195], v[64:67], v[32:35], v[192:195]
    ds_read_b128 v[76:79], v12 offset:14336
    v_mfma_f32_16x16x32_bf16 v[200:203], v[64:67], v[36:39], v[200:203]
    ds_read_b64_tr_b16 v[60:61], v17 offset:16384
    v_mfma_f32_16x16x32_bf16 v[208:211], v[64:67], v[40:43], v[208:211]
    ds_read_b64_tr_b16 v[62:63], v17 offset:18432
    v_mfma_f32_16x16x32_bf16 v[216:219], v[64:67], v[44:47], v[216:219]
    s_waitcnt lgkmcnt(8)
    v_mfma_f32_16x16x32_bf16 v[196:199], v[68:71], v[32:35], v[196:199]
    ds_read_b128 v[64:67], v13 offset:0
    v_mfma_f32_16x16x32_bf16 v[204:207], v[68:71], v[36:39], v[204:207]
    v_mfma_f32_16x16x32_bf16 v[212:215], v[68:71], v[40:43], v[212:215]
    v_mfma_f32_16x16x32_bf16 v[220:223], v[68:71], v[44:47], v[220:223]
    s_add_u32 m0, s68, 66560
    s_add_u32 s63, s72, 8320
    buffer_load_dwordx4 v81, s[24:27], s63 offen lds
    s_waitcnt lgkmcnt(6)
    v_mfma_f32_16x16x32_bf16 v[224:227], v[72:75], v[32:35], v[224:227]
    ds_read_b128 v[68:71], v13 offset:2048
    v_mfma_f32_16x16x32_bf16 v[232:235], v[72:75], v[36:39], v[232:235]
    v_mfma_f32_16x16x32_bf16 v[240:243], v[72:75], v[40:43], v[240:243]
    v_mfma_f32_16x16x32_bf16 v[248:251], v[72:75], v[44:47], v[248:251]
    s_waitcnt lgkmcnt(4)
    v_mfma_f32_16x16x32_bf16 v[228:231], v[76:79], v[32:35], v[228:231]
    ds_read_b128 v[72:75], v13 offset:4096
    v_mfma_f32_16x16x32_bf16 v[236:239], v[76:79], v[36:39], v[236:239]
    v_mfma_f32_16x16x32_bf16 v[244:247], v[76:79], v[40:43], v[244:247]
    v_mfma_f32_16x16x32_bf16 v[252:255], v[76:79], v[44:47], v[252:255]
    s_add_u32 m0, s68, 67584
    s_add_u32 s63, s72, 16512
    buffer_load_dwordx4 v80, s[24:27], s63 offen lds
    ds_read_b128 v[76:79], v13 offset:6144
    s_setprio 0
    s_waitcnt lgkmcnt(3)
    v_mfma_f32_16x16x32_bf16 v[128:131], v[64:67], v[48:51], v[128:131]
    v_mfma_f32_16x16x32_bf16 v[136:139], v[64:67], v[52:55], v[136:139]
    v_mfma_f32_16x16x32_bf16 v[144:147], v[64:67], v[56:59], v[144:147]
    v_mfma_f32_16x16x32_bf16 v[152:155], v[64:67], v[60:63], v[152:155]
    s_waitcnt lgkmcnt(2)
    v_mfma_f32_16x16x32_bf16 v[132:135], v[68:71], v[48:51], v[132:135]
    ds_read_b128 v[64:67], v13 offset:8192
    v_mfma_f32_16x16x32_bf16 v[140:143], v[68:71], v[52:55], v[140:143]
    v_mfma_f32_16x16x32_bf16 v[148:151], v[68:71], v[56:59], v[148:151]
    v_mfma_f32_16x16x32_bf16 v[156:159], v[68:71], v[60:63], v[156:159]
    s_add_u32 m0, s68, 68608
    s_add_u32 s63, s72, 24704
    buffer_load_dwordx4 v81, s[24:27], s63 offen lds
    s_waitcnt lgkmcnt(2)
    v_mfma_f32_16x16x32_bf16 v[160:163], v[72:75], v[48:51], v[160:163]
    ds_read_b128 v[68:71], v13 offset:10240
    v_mfma_f32_16x16x32_bf16 v[168:171], v[72:75], v[52:55], v[168:171]
    v_mfma_f32_16x16x32_bf16 v[176:179], v[72:75], v[56:59], v[176:179]
    v_mfma_f32_16x16x32_bf16 v[184:187], v[72:75], v[60:63], v[184:187]
    s_waitcnt lgkmcnt(2)
    v_mfma_f32_16x16x32_bf16 v[164:167], v[76:79], v[48:51], v[164:167]
    ds_read_b128 v[72:75], v13 offset:12288
    v_mfma_f32_16x16x32_bf16 v[172:175], v[76:79], v[52:55], v[172:175]
    v_mfma_f32_16x16x32_bf16 v[180:183], v[76:79], v[56:59], v[180:183]
    v_mfma_f32_16x16x32_bf16 v[188:191], v[76:79], v[60:63], v[188:191]
    s_waitcnt lgkmcnt(2)
    v_mfma_f32_16x16x32_bf16 v[192:195], v[64:67], v[48:51], v[192:195]
    ds_read_b128 v[76:79], v13 offset:14336
    v_mfma_f32_16x16x32_bf16 v[200:203], v[64:67], v[52:55], v[200:203]
    v_mfma_f32_16x16x32_bf16 v[208:211], v[64:67], v[56:59], v[208:211]
    v_mfma_f32_16x16x32_bf16 v[216:219], v[64:67], v[60:63], v[216:219]
    s_waitcnt lgkmcnt(0)
    s_waitcnt vmcnt(4)
    s_barrier
    s_setprio 3
    v_mfma_f32_16x16x32_bf16 v[196:199], v[68:71], v[48:51], v[196:199]
    v_mfma_f32_16x16x32_bf16 v[204:207], v[68:71], v[52:55], v[204:207]
    ds_read_b128 v[40:43], v84 offset:0
    ds_read_b128 v[44:47], v84 offset:2048
    v_mfma_f32_16x16x32_bf16 v[212:215], v[68:71], v[56:59], v[212:215]
    ds_read_b64_tr_b16 v[8:9], v94 offset:0
    ds_read_b64_tr_b16 v[10:11], v94 offset:1024
    v_mfma_f32_16x16x32_bf16 v[220:223], v[68:71], v[60:63], v[220:223]
    ds_read_b64_tr_b16 v[12:13], v95 offset:0
    ds_read_b64_tr_b16 v[14:15], v95 offset:1024
    s_add_u32 m0, s67, 122880
    s_add_u32 s63, s73, 524288
    buffer_load_dwordx4 v82, s[36:39], s63 offen lds
    v_mfma_f32_16x16x32_bf16 v[224:227], v[72:75], v[48:51], v[224:227]
    v_mfma_f32_16x16x32_bf16 v[232:235], v[72:75], v[52:55], v[232:235]
    ds_read_b64_tr_b16 v[16:17], v96 offset:0
    ds_read_b64_tr_b16 v[18:19], v96 offset:1024
    v_mfma_f32_16x16x32_bf16 v[240:243], v[72:75], v[56:59], v[240:243]
    ds_read_b64_tr_b16 v[20:21], v97 offset:0
    ds_read_b64_tr_b16 v[22:23], v97 offset:1024
    v_mfma_f32_16x16x32_bf16 v[248:251], v[72:75], v[60:63], v[248:251]
    ds_read_b64_tr_b16 v[24:25], v98 offset:0
    ds_read_b64_tr_b16 v[26:27], v98 offset:1024
    v_mfma_f32_16x16x32_bf16 v[228:231], v[76:79], v[48:51], v[228:231]
    v_mfma_f32_16x16x32_bf16 v[236:239], v[76:79], v[52:55], v[236:239]
    v_mfma_f32_16x16x32_bf16 v[244:247], v[76:79], v[56:59], v[244:247]
    v_mfma_f32_16x16x32_bf16 v[252:255], v[76:79], v[60:63], v[252:255]
    s_add_u32 m0, s67, 131072
    s_add_u32 s63, s73, 786432
    buffer_load_dwordx4 v82, s[36:39], s63 offen lds
M_kvdone:
    s_add_u32 m0, s67, 139264
    s_add_u32 s63, s74, 229376
    buffer_load_dwordx4 v83, s[28:31], s63 offen lds
    s_add_u32 m0, s67, 0
    s_add_u32 s63, s73, 1048576
    buffer_load_dwordx4 v82, s[36:39], s63 offen lds
    s_add_u32 m0, s67, 8192
    s_add_u32 s63, s73, 1310720
    buffer_load_dwordx4 v82, s[36:39], s63 offen lds
    s_add_u32 m0, s67, 16384
    s_add_u32 s63, s74, 458752
    buffer_load_dwordx4 v83, s[28:31], s63 offen lds
    s_add_u32 m0, s67, 147456
    s_add_u32 s63, s73, 1572864
    buffer_load_dwordx4 v82, s[36:39], s63 offen lds
    s_add_u32 m0, s67, 155648
    s_add_u32 s63, s73, 1835008
    buffer_load_dwordx4 v82, s[36:39], s63 offen lds
    s_add_u32 m0, s67, 24576
    s_add_u32 s63, s74, 688128
    buffer_load_dwordx4 v83, s[28:31], s63 offen lds
    s_cmp_eq_u32 s56, 0
    s_cbranch_scc0 M_notok2
    v_readfirstlane_b32 s63, v124
    s_cmp_eq_u32 s63, 0
    s_cselect_b32 s3, s3, s63
M_notok2:
    s_nop 7
    v_cvt_pk_bf16_f32 v255, v254, v255
    v_cvt_pk_bf16_f32 v254, v252, v253
    v_cvt_pk_bf16_f32 v253, v250, v251
    v_cvt_pk_bf16_f32 v252, v248, v249
    v_cvt_pk_bf16_f32 v251, v246, v247
    v_cvt_pk_bf16_f32 v250, v244, v245
    v_cvt_pk_bf16_f32 v249, v242, v243
    v_cvt_pk_bf16_f32 v248, v240, v241
    v_cvt_pk_bf16_f32 v247, v238, v239
    v_cvt_pk_bf16_f32 v246, v236, v237
    v_cvt_pk_bf16_f32 v245, v234, v235
    v_cvt_pk_bf16_f32 v244, v232, v233
    v_cvt_pk_bf16_f32 v243, v230, v231
    v_cvt_pk_bf16_f32 v242, v228, v229
    v_cvt_pk_bf16_f32 v241, v226, v227
    v_cvt_pk_bf16_f32 v240, v224, v225
    v_cvt_pk_bf16_f32 v239, v222, v223
    v_cvt_pk_bf16_f32 v238, v220, v221
    v_cvt_pk_bf16_f32 v237, v218, v219
    v_cvt_pk_bf16_f32 v236, v216, v217
    v_cvt_pk_bf16_f32 v235, v214, v215
    v_cvt_pk_bf16_f32 v234, v212, v213
    v_cvt_pk_bf16_f32 v233, v210, v211
    v_cvt_pk_bf16_f32 v232, v208, v209
    v_cvt_pk_bf16_f32 v231, v206, v207
    v_cvt_pk_bf16_f32 v230, v204, v205
    v_cvt_pk_bf16_f32 v229, v202, v203
    v_cvt_pk_bf16_f32 v228, v200, v201
    v_cvt_pk_bf16_f32 v227, v198, v199
    v_cvt_pk_bf16_f32 v226, v196, v197
    v_cvt_pk_bf16_f32 v225, v194, v195
    v_cvt_pk_bf16_f32 v224, v192, v193
    v_cvt_pk_bf16_f32 v223, v190, v191
    v_cvt_pk_bf16_f32 v222, v188, v189
    v_cvt_pk_bf16_f32 v221, v186, v187
    v_cvt_pk_bf16_f32 v220, v184, v185
    v_cvt_pk_bf16_f32 v219, v182, v183
    v_cvt_pk_bf16_f32 v218, v180, v181
    v_cvt_pk_bf16_f32 v217, v178, v179
    v_cvt_pk_bf16_f32 v216, v176, v177
    v_cvt_pk_bf16_f32 v215, v174, v175
    v_cvt_pk_bf16_f32 v214, v172, v173
    v_cvt_pk_bf16_f32 v213, v170, v171
    v_cvt_pk_bf16_f32 v212, v168, v169
    v_cvt_pk_bf16_f32 v211, v166, v167
    v_cvt_pk_bf16_f32 v210, v164, v165
    v_cvt_pk_bf16_f32 v209, v162, v163
    v_cvt_pk_bf16_f32 v208, v160, v161
    v_cvt_pk_bf16_f32 v207, v158, v159
    v_cvt_pk_bf16_f32 v206, v156, v157
    v_cvt_pk_bf16_f32 v205, v154, v155
    v_cvt_pk_bf16_f32 v204, v152, v153
    v_cvt_pk_bf16_f32 v203, v150, v151
    v_cvt_pk_bf16_f32 v202, v148, v149
    v_cvt_pk_bf16_f32 v201, v146, v147
    v_cvt_pk_bf16_f32 v200, v144, v145
    v_cvt_pk_bf16_f32 v199, v142, v143
    v_cvt_pk_bf16_f32 v198, v140, v141
    v_cvt_pk_bf16_f32 v197, v138, v139
    v_cvt_pk_bf16_f32 v196, v136, v137
    v_cvt_pk_bf16_f32 v195, v134, v135
    v_cvt_pk_bf16_f32 v194, v132, v133
    v_cvt_pk_bf16_f32 v193, v130, v131
    v_cvt_pk_bf16_f32 v192, v128, v129
    s_lshr_b32 s79, s64, 1
    s_lshl_b32 s69, s66, 7
    s_lshl_b32 s80, s65, 3
    s_add_u32 s80, s80, s64
    s_lshl_b32 s80, s80, 2
    s_add_u32 s80, s80, s69
    s_mov_b32 s16, s14
    s_mov_b32 s17, s15
    s_mov_b32 s18, 0x2000000
    s_mov_b32 s19, 0x00020000
    s_lshl_b32 s81, s56, 11
    s_add_u32 s82, s99, s81
    s_setprio 2
    s_waitcnt lgkmcnt(10)
    s_waitcnt lgkmcnt(8)
    v_mfma_f32_16x16x32_bf16 v[128:131], v[8:11], v[40:43], 0
    ds_read_b64_tr_b16 v[28:29], v99 offset:0
    ds_read_b64_tr_b16 v[30:31], v99 offset:1024
    v_mfma_f32_16x16x32_bf16 v[136:139], v[8:11], v[44:47], 0
    s_cmp_eq_u32 s79, 0
    s_cbranch_scc0 M_st_1
    s_add_u32 s96, s76, 0
    buffer_store_dwordx4 v[192:195], v2, s[32:35], s96 offen sc1
M_st_1:
    s_waitcnt lgkmcnt(8)
    v_mfma_f32_16x16x32_bf16 v[132:135], v[12:15], v[40:43], 0
    ds_read_b64_tr_b16 v[32:33], v100 offset:0
    ds_read_b64_tr_b16 v[34:35], v100 offset:1024
    v_mfma_f32_16x16x32_bf16 v[140:143], v[12:15], v[44:47], 0
    s_waitcnt lgkmcnt(8)
    v_mfma_f32_16x16x32_bf16 v[144:147], v[16:19], v[40:43], 0
    ds_read_b64_tr_b16 v[36:37], v101 offset:0
    ds_read_b64_tr_b16 v[38:39], v101 offset:1024
    v_mfma_f32_16x16x32_bf16 v[152:155], v[16:19], v[44:47], 0
    s_waitcnt lgkmcnt(8)
    v_mfma_f32_16x16x32_bf16 v[148:151], v[20:23], v[40:43], 0
    ds_read_b64_tr_b16 v[8:9], v106 offset:16384
    ds_read_b64_tr_b16 v[10:11], v106 offset:16896
    v_mfma_f32_16x16x32_bf16 v[156:159], v[20:23], v[44:47], 0
    s_cmp_eq_u32 s79, 0
    s_cbranch_scc0 M_st_2
    s_add_u32 s96, s76, 0
    s_add_u32 s96, s96, s78
    buffer_store_dwordx4 v[196:199], v2, s[32:35], s96 offen sc1
M_st_2:
    s_waitcnt lgkmcnt(8)
    v_mfma_f32_16x16x32_bf16 v[160:163], v[24:27], v[40:43], 0
    ds_read_b64_tr_b16 v[12:13], v107 offset:16384
    ds_read_b64_tr_b16 v[14:15], v107 offset:16896
    v_mfma_f32_16x16x32_bf16 v[168:171], v[24:27], v[44:47], 0
    s_waitcnt lgkmcnt(8)
    v_mfma_f32_16x16x32_bf16 v[164:167], v[28:31], v[40:43], 0
    ds_read_b64_tr_b16 v[16:17], v108 offset:16384
    ds_read_b64_tr_b16 v[18:19], v108 offset:16896
    v_mfma_f32_16x16x32_bf16 v[172:175], v[28:31], v[44:47], 0
    s_setprio 1
    s_waitcnt lgkmcnt(8)
    v_mfma_f32_16x16x32_bf16 v[176:179], v[32:35], v[40:43], 0
    ds_read_b64_tr_b16 v[20:21], v109 offset:16384
    ds_read_b64_tr_b16 v[22:23], v109 offset:16896
    v_mfma_f32_16x16x32_bf16 v[184:187], v[32:35], v[44:47], 0
    s_cmp_eq_u32 s79, 0
    s_cbranch_scc0 M_st_3
    s_add_u32 s96, s76, 4096
    buffer_store_dwordx4 v[200:203], v2, s[32:35], s96 offen sc1
M_st_3:
    s_waitcnt lgkmcnt(8)
    v_mfma_f32_16x16x32_bf16 v[180:183], v[36:39], v[40:43], 0
    ds_read_b64_tr_b16 v[24:25], v94 offset:8192
    ds_read_b64_tr_b16 v[26:27], v94 offset:9216
    v_mfma_f32_16x16x32_bf16 v[188:191], v[36:39], v[44:47], 0
    s_waitcnt lgkmcnt(8)
    v_mfma_f32_16x16x32_bf16 v[48:51], v[8:11], v[40:43], 0
    ds_read_b64_tr_b16 v[28:29], v95 offset:8192
    ds_read_b64_tr_b16 v[30:31], v95 offset:9216
    v_mfma_f32_16x16x32_bf16 v[56:59], v[8:11], v[44:47], 0
    ds_read_b128 v[112:115], v85 offset:0
    s_waitcnt lgkmcnt(9)
    v_mfma_f32_16x16x32_bf16 v[52:55], v[12:15], v[40:43], 0
    ds_read_b64_tr_b16 v[32:33], v96 offset:8192
    ds_read_b64_tr_b16 v[34:35], v96 offset:9216
    v_mfma_f32_16x16x32_bf16 v[60:63], v[12:15], v[44:47], 0
    ds_read_b128 v[116:119], v85 offset:2048
    s_cmp_eq_u32 s79, 0
    s_cbranch_scc0 M_st_4
    s_add_u32 s96, s76, 4096
    s_add_u32 s96, s96, s78
    buffer_store_dwordx4 v[204:207], v2, s[32:35], s96 offen sc1
M_st_4:
    s_waitcnt lgkmcnt(10)
    v_mfma_f32_16x16x32_bf16 v[64:67], v[40:43], v[16:19], 0
    ds_read_b64_tr_b16 v[36:37], v97 offset:8192
    ds_read_b64_tr_b16 v[38:39], v97 offset:9216
    v_mfma_f32_16x16x32_bf16 v[68:71], v[44:47], v[16:19], 0
    s_waitcnt lgkmcnt(10)
    v_mfma_f32_16x16x32_bf16 v[72:75], v[40:43], v[20:23], 0
    ds_read_b64_tr_b16 v[8:9], v98 offset:8192
    ds_read_b64_tr_b16 v[10:11], v98 offset:9216
    v_mfma_f32_16x16x32_bf16 v[76:79], v[44:47], v[20:23], 0
    s_setprio 0
    s_waitcnt lgkmcnt(4)
    v_mfma_f32_16x16x32_bf16 v[128:131], v[24:27], v[112:115], v[128:131]
    ds_read_b64_tr_b16 v[12:13], v99 offset:8192
    ds_read_b64_tr_b16 v[14:15], v99 offset:9216
    v_mfma_f32_16x16x32_bf16 v[136:139], v[24:27], v[116:119], v[136:139]
    s_cmp_eq_u32 s79, 0
    s_cbranch_scc0 M_st_5
    s_add_u32 s96, s76, 0
    s_add_u32 s96, s96, s77
    buffer_store_dwordx4 v[208:211], v2, s[32:35], s96 offen sc1
M_st_5:
    v_mfma_f32_16x16x32_bf16 v[132:135], v[28:31], v[112:115], v[132:135]
    ds_read_b64_tr_b16 v[16:17], v100 offset:8192
    ds_read_b64_tr_b16 v[18:19], v100 offset:9216
    v_mfma_f32_16x16x32_bf16 v[140:143], v[28:31], v[116:119], v[140:143]
    v_mfma_f32_16x16x32_bf16 v[144:147], v[32:35], v[112:115], v[144:147]
    ds_read_b64_tr_b16 v[20:21], v101 offset:8192
    ds_read_b64_tr_b16 v[22:23], v101 offset:9216
    v_mfma_f32_16x16x32_bf16 v[152:155], v[32:35], v[116:119], v[152:155]
    s_waitcnt lgkmcnt(8)
    v_mfma_f32_16x16x32_bf16 v[148:151], v[36:39], v[112:115], v[148:151]
    ds_read_b64_tr_b16 v[24:25], v106 offset:20480
    ds_read_b64_tr_b16 v[26:27], v106 offset:20992
    v_mfma_f32_16x16x32_bf16 v[156:159], v[36:39], v[116:119], v[156:159]
    s_cmp_eq_u32 s79, 0
    s_cbranch_scc0 M_st_6
    s_add_u32 s96, s76, 0
    s_add_u32 s96, s96, s77
    s_add_u32 s96, s96, s78
    buffer_store_dwordx4 v[212:215], v2, s[32:35], s96 offen sc1
M_st_6:
    s_waitcnt lgkmcnt(8)
    v_mfma_f32_16x16x32_bf16 v[160:163], v[8:11], v[112:115], v[160:163]
    ds_read_b64_tr_b16 v[28:29], v107 offset:20480
    ds_read_b64_tr_b16 v[30:31], v107 offset:20992
    v_mfma_f32_16x16x32_bf16 v[168:171], v[8:11], v[116:119], v[168:171]
    s_waitcnt lgkmcnt(8)
    v_mfma_f32_16x16x32_bf16 v[164:167], v[12:15], v[112:115], v[164:167]
    ds_read_b64_tr_b16 v[32:33], v108 offset:20480
    ds_read_b64_tr_b16 v[34:35], v108 offset:20992
    v_mfma_f32_16x16x32_bf16 v[172:175], v[12:15], v[116:119], v[172:175]
    s_waitcnt lgkmcnt(8)
    v_mfma_f32_16x16x32_bf16 v[176:179], v[16:19], v[112:115], v[176:179]
    ds_read_b64_tr_b16 v[36:37], v109 offset:20480
    ds_read_b64_tr_b16 v[38:39], v109 offset:20992
    v_mfma_f32_16x16x32_bf16 v[184:187], v[16:19], v[116:119], v[184:187]
    s_cmp_eq_u32 s79, 0
    s_cbranch_scc0 M_st_7
    s_add_u32 s96, s76, 4096
    s_add_u32 s96, s96, s77
    buffer_store_dwordx4 v[216:219], v2, s[32:35], s96 offen sc1
M_st_7:
    s_waitcnt lgkmcnt(0)
    s_waitcnt vmcnt(6)
    s_barrier
    s_setprio 3
    v_mfma_f32_16x16x32_bf16 v[180:183], v[20:23], v[112:115], v[180:183]
    ds_read_b64_tr_b16 v[8:9], v94 offset:24576
    ds_read_b64_tr_b16 v[10:11], v94 offset:25600
    v_mfma_f32_16x16x32_bf16 v[188:191], v[20:23], v[116:119], v[188:191]
    s_add_u32 m0, s68, 32768
    s_add_u32 s63, s72, 256
    buffer_load_dwordx4 v80, s[24:27], s63 offen lds
    v_mfma_f32_16x16x32_bf16 v[48:51], v[24:27], v[112:115], v[48:51]
    ds_read_b64_tr_b16 v[12:13], v95 offset:24576
    ds_read_b64_tr_b16 v[14:15], v95 offset:25600
    v_mfma_f32_16x16x32_bf16 v[56:59], v[24:27], v[116:119], v[56:59]
    ds_read_b128 v[40:43], v84 offset:32768
    s_add_u32 m0, s68, 33792
    s_add_u32 s63, s72, 8448
    buffer_load_dwordx4 v81, s[24:27], s63 offen lds
    v_mfma_f32_16x16x32_bf16 v[52:55], v[28:31], v[112:115], v[52:55]
    ds_read_b64_tr_b16 v[16:17], v96 offset:24576
    ds_read_b64_tr_b16 v[18:19], v96 offset:25600
    v_mfma_f32_16x16x32_bf16 v[60:63], v[28:31], v[116:119], v[60:63]
    ds_read_b128 v[44:47], v84 offset:34816
    s_cmp_eq_u32 s79, 0
    s_cbranch_scc0 M_st_8
    s_add_u32 s96, s76, 4096
    s_add_u32 s96, s96, s77
    s_add_u32 s96, s96, s78
    buffer_store_dwordx4 v[220:223], v2, s[32:35], s96 offen sc1
M_st_8:
    v_mfma_f32_16x16x32_bf16 v[64:67], v[112:115], v[32:35], v[64:67]
    ds_read_b64_tr_b16 v[20:21], v97 offset:24576
    ds_read_b64_tr_b16 v[22:23], v97 offset:25600
    v_mfma_f32_16x16x32_bf16 v[68:71], v[116:119], v[32:35], v[68:71]
    s_add_u32 m0, s68, 34816
    s_add_u32 s63, s72, 16640
    buffer_load_dwordx4 v80, s[24:27], s63 offen lds
    v_mfma_f32_16x16x32_bf16 v[72:75], v[112:115], v[36:39], v[72:75]
    ds_read_b64_tr_b16 v[24:25], v98 offset:24576
    ds_read_b64_tr_b16 v[26:27], v98 offset:25600
    v_mfma_f32_16x16x32_bf16 v[76:79], v[116:119], v[36:39], v[76:79]
    s_add_u32 m0, s68, 35840
    s_add_u32 s63, s72, 24832
    buffer_load_dwordx4 v81, s[24:27], s63 offen lds
    s_setprio 2
    s_waitcnt lgkmcnt(4)
    v_mfma_f32_16x16x32_bf16 v[128:131], v[8:11], v[40:43], v[128:131]
    ds_read_b64_tr_b16 v[28:29], v99 offset:24576
    ds_read_b64_tr_b16 v[30:31], v99 offset:25600
    v_mfma_f32_16x16x32_bf16 v[136:139], v[8:11], v[44:47], v[136:139]
    s_cmp_eq_u32 s79, 0
    s_cbranch_scc0 M_st_9
    s_add_u32 s96, s76, 16384
    buffer_store_dwordx4 v[224:227], v2, s[32:35], s96 offen sc1
M_st_9:
    v_mfma_f32_16x16x32_bf16 v[132:135], v[12:15], v[40:43], v[132:135]
    ds_read_b64_tr_b16 v[32:33], v100 offset:24576
    ds_read_b64_tr_b16 v[34:35], v100 offset:25600
    v_mfma_f32_16x16x32_bf16 v[140:143], v[12:15], v[44:47], v[140:143]
    s_add_u32 m0, s67, 98304
    s_add_u32 s63, s73, 2097152
    buffer_load_dwordx4 v82, s[36:39], s63 offen lds
    v_mfma_f32_16x16x32_bf16 v[144:147], v[16:19], v[40:43], v[144:147]
    ds_read_b64_tr_b16 v[36:37], v101 offset:24576
    ds_read_b64_tr_b16 v[38:39], v101 offset:25600
    v_mfma_f32_16x16x32_bf16 v[152:155], v[16:19], v[44:47], v[152:155]
    s_add_u32 m0, s67, 106496
    s_add_u32 s63, s73, 2359296
    buffer_load_dwordx4 v82, s[36:39], s63 offen lds
    s_waitcnt lgkmcnt(8)
    v_mfma_f32_16x16x32_bf16 v[148:151], v[20:23], v[40:43], v[148:151]
    ds_read_b64_tr_b16 v[8:9], v106 offset:40960
    ds_read_b64_tr_b16 v[10:11], v106 offset:41472
    v_mfma_f32_16x16x32_bf16 v[156:159], v[20:23], v[44:47], v[156:159]
    s_cmp_eq_u32 s79, 0
    s_cbranch_scc0 M_st_10
    s_add_u32 s96, s76, 16384
    s_add_u32 s96, s96, s78
    buffer_store_dwordx4 v[228:231], v2, s[32:35], s96 offen sc1
M_st_10:
    s_waitcnt lgkmcnt(8)
    v_mfma_f32_16x16x32_bf16 v[160:163], v[24:27], v[40:43], v[160:163]
    ds_read_b64_tr_b16 v[12:13], v107 offset:40960
    ds_read_b64_tr_b16 v[14:15], v107 offset:41472
    v_mfma_f32_16x16x32_bf16 v[168:171], v[24:27], v[44:47], v[168:171]
    s_add_u32 m0, s67, 114688
    s_add_u32 s63, s74, 917504
    buffer_load_dwordx4 v83, s[28:31], s63 offen lds
    s_waitcnt lgkmcnt(8)
    v_mfma_f32_16x16x32_bf16 v[164:167], v[28:31], v[40:43], v[164:167]
    ds_read_b64_tr_b16 v[16:17], v108 offset:40960
    ds_read_b64_tr_b16 v[18:19], v108 offset:41472
    v_mfma_f32_16x16x32_bf16 v[172:175], v[28:31], v[44:47], v[172:175]
    s_setprio 1
    s_waitcnt lgkmcnt(8)
    v_mfma_f32_16x16x32_bf16 v[176:179], v[32:35], v[40:43], v[176:179]
    ds_read_b64_tr_b16 v[20:21], v109 offset:40960
    ds_read_b64_tr_b16 v[22:23], v109 offset:41472
    v_mfma_f32_16x16x32_bf16 v[184:187], v[32:35], v[44:47], v[184:187]
    s_cmp_eq_u32 s79, 0
    s_cbranch_scc0 M_st_11
    s_add_u32 s96, s76, 20480
    buffer_store_dwordx4 v[232:235], v2, s[32:35], s96 offen sc1
M_st_11:
    s_waitcnt lgkmcnt(8)
    v_mfma_f32_16x16x32_bf16 v[180:183], v[36:39], v[40:43], v[180:183]
    ds_read_b64_tr_b16 v[24:25], v94 offset:32768
    ds_read_b64_tr_b16 v[26:27], v94 offset:33792
    v_mfma_f32_16x16x32_bf16 v[188:191], v[36:39], v[44:47], v[188:191]
    s_waitcnt lgkmcnt(8)
    v_mfma_f32_16x16x32_bf16 v[48:51], v[8:11], v[40:43], v[48:51]
    ds_read_b64_tr_b16 v[28:29], v95 offset:32768
    ds_read_b64_tr_b16 v[30:31], v95 offset:33792
    v_mfma_f32_16x16x32_bf16 v[56:59], v[8:11], v[44:47], v[56:59]
    ds_read_b128 v[112:115], v85 offset:32768
    s_waitcnt lgkmcnt(9)
    v_mfma_f32_16x16x32_bf16 v[52:55], v[12:15], v[40:43], v[52:55]
    ds_read_b64_tr_b16 v[32:33], v96 offset:32768
    ds_read_b64_tr_b16 v[34:35], v96 offset:33792
    v_mfma_f32_16x16x32_bf16 v[60:63], v[12:15], v[44:47], v[60:63]
    ds_read_b128 v[116:119], v85 offset:34816
    s_cmp_eq_u32 s79, 0
    s_cbranch_scc0 M_st_12
    s_add_u32 s96, s76, 20480
    s_add_u32 s96, s96, s78
    buffer_store_dwordx4 v[236:239], v2, s[32:35], s96 offen sc1
M_st_12:
    s_waitcnt lgkmcnt(10)
    v_mfma_f32_16x16x32_bf16 v[64:67], v[40:43], v[16:19], v[64:67]
    ds_read_b64_tr_b16 v[36:37], v97 offset:32768
    ds_read_b64_tr_b16 v[38:39], v97 offset:33792
    v_mfma_f32_16x16x32_bf16 v[68:71], v[44:47], v[16:19], v[68:71]
    s_waitcnt lgkmcnt(10)
    v_mfma_f32_16x16x32_bf16 v[72:75], v[40:43], v[20:23], v[72:75]
    ds_read_b64_tr_b16 v[8:9], v98 offset:32768
    ds_read_b64_tr_b16 v[10:11], v98 offset:33792
    v_mfma_f32_16x16x32_bf16 v[76:79], v[44:47], v[20:23], v[76:79]
    s_setprio 0
    s_waitcnt lgkmcnt(4)
    v_mfma_f32_16x16x32_bf16 v[128:131], v[24:27], v[112:115], v[128:131]
    ds_read_b64_tr_b16 v[12:13], v99 offset:32768
    ds_read_b64_tr_b16 v[14:15], v99 offset:33792
    v_mfma_f32_16x16x32_bf16 v[136:139], v[24:27], v[116:119], v[136:139]
    s_cmp_eq_u32 s79, 0
    s_cbranch_scc0 M_st_13
    s_add_u32 s96, s76, 16384
    s_add_u32 s96, s96, s77
    buffer_store_dwordx4 v[240:243], v2, s[32:35], s96 offen sc1
M_st_13:
    v_mfma_f32_16x16x32_bf16 v[132:135], v[28:31], v[112:115], v[132:135]
    ds_read_b64_tr_b16 v[16:17], v100 offset:32768
    ds_read_b64_tr_b16 v[18:19], v100 offset:33792
    v_mfma_f32_16x16x32_bf16 v[140:143], v[28:31], v[116:119], v[140:143]
    v_mfma_f32_16x16x32_bf16 v[144:147], v[32:35], v[112:115], v[144:147]
    ds_read_b64_tr_b16 v[20:21], v101 offset:32768
    ds_read_b64_tr_b16 v[22:23], v101 offset:33792
    v_mfma_f32_16x16x32_bf16 v[152:155], v[32:35], v[116:119], v[152:155]
    s_waitcnt lgkmcnt(8)
    v_mfma_f32_16x16x32_bf16 v[148:151], v[36:39], v[112:115], v[148:151]
    ds_read_b64_tr_b16 v[24:25], v106 offset:45056
    ds_read_b64_tr_b16 v[26:27], v106 offset:45568
    v_mfma_f32_16x16x32_bf16 v[156:159], v[36:39], v[116:119], v[156:159]
    s_cmp_eq_u32 s79, 0
    s_cbranch_scc0 M_st_14
    s_add_u32 s96, s76, 16384
    s_add_u32 s96, s96, s77
    s_add_u32 s96, s96, s78
    buffer_store_dwordx4 v[244:247], v2, s[32:35], s96 offen sc1
M_st_14:
    s_waitcnt lgkmcnt(8)
    v_mfma_f32_16x16x32_bf16 v[160:163], v[8:11], v[112:115], v[160:163]
    ds_read_b64_tr_b16 v[28:29], v107 offset:45056
    ds_read_b64_tr_b16 v[30:31], v107 offset:45568
    v_mfma_f32_16x16x32_bf16 v[168:171], v[8:11], v[116:119], v[168:171]
    s_waitcnt lgkmcnt(8)
    v_mfma_f32_16x16x32_bf16 v[164:167], v[12:15], v[112:115], v[164:167]
    ds_read_b64_tr_b16 v[32:33], v108 offset:45056
    ds_read_b64_tr_b16 v[34:35], v108 offset:45568
    v_mfma_f32_16x16x32_bf16 v[172:175], v[12:15], v[116:119], v[172:175]
    s_waitcnt lgkmcnt(8)
    v_mfma_f32_16x16x32_bf16 v[176:179], v[16:19], v[112:115], v[176:179]
    ds_read_b64_tr_b16 v[36:37], v109 offset:45056
    ds_read_b64_tr_b16 v[38:39], v109 offset:45568
    v_mfma_f32_16x16x32_bf16 v[184:187], v[16:19], v[116:119], v[184:187]
    s_cmp_eq_u32 s79, 0
    s_cbranch_scc0 M_st_15
    s_add_u32 s96, s76, 20480
    s_add_u32 s96, s96, s77
    buffer_store_dwordx4 v[248:251], v2, s[32:35], s96 offen sc1
M_st_15:
    s_waitcnt lgkmcnt(0)
    s_waitcnt vmcnt(3)
    s_barrier
    s_setprio 3
    v_mfma_f32_16x16x32_bf16 v[180:183], v[20:23], v[112:115], v[180:183]
    ds_read_b64_tr_b16 v[8:9], v86 offset:0
    ds_read_b64_tr_b16 v[10:11], v86 offset:1024
    v_mfma_f32_16x16x32_bf16 v[188:191], v[20:23], v[116:119], v[188:191]
    s_add_u32 m0, s68, 65536
    s_add_u32 s63, s72, 384
    buffer_load_dwordx4 v80, s[24:27], s63 offen lds
    v_mfma_f32_16x16x32_bf16 v[48:51], v[24:27], v[112:115], v[48:51]
    ds_read_b64_tr_b16 v[12:13], v87 offset:0
    ds_read_b64_tr_b16 v[14:15], v87 offset:1024
    v_mfma_f32_16x16x32_bf16 v[56:59], v[24:27], v[116:119], v[56:59]
    ds_read_b128 v[40:43], v84 offset:0
    s_add_u32 m0, s68, 66560
    s_add_u32 s63, s72, 8576
    buffer_load_dwordx4 v81, s[24:27], s63 offen lds
    v_mfma_f32_16x16x32_bf16 v[52:55], v[28:31], v[112:115], v[52:55]
    ds_read_b64_tr_b16 v[16:17], v88 offset:0
    ds_read_b64_tr_b16 v[18:19], v88 offset:1024
    v_mfma_f32_16x16x32_bf16 v[60:63], v[28:31], v[116:119], v[60:63]
    ds_read_b128 v[44:47], v84 offset:2048
    s_cmp_eq_u32 s79, 0
    s_cbranch_scc0 M_st_16
    s_add_u32 s96, s76, 20480
    s_add_u32 s96, s96, s77
    s_add_u32 s96, s96, s78
    buffer_store_dwordx4 v[252:255], v2, s[32:35], s96 offen sc1
M_st_16:
    v_mfma_f32_16x16x32_bf16 v[64:67], v[112:115], v[32:35], v[64:67]
    ds_read_b64_tr_b16 v[20:21], v89 offset:0
    ds_read_b64_tr_b16 v[22:23], v89 offset:1024
    v_mfma_f32_16x16x32_bf16 v[68:71], v[116:119], v[32:35], v[68:71]
    s_add_u32 m0, s68, 67584
    s_add_u32 s63, s72, 16768
    buffer_load_dwordx4 v80, s[24:27], s63 offen lds
    v_mfma_f32_16x16x32_bf16 v[72:75], v[112:115], v[36:39], v[72:75]
    ds_read_b64_tr_b16 v[24:25], v90 offset:0
    ds_read_b64_tr_b16 v[26:27], v90 offset:1024
    v_mfma_f32_16x16x32_bf16 v[76:79], v[116:119], v[36:39], v[76:79]
    s_add_u32 m0, s68, 68608
    s_add_u32 s63, s72, 24960
    buffer_load_dwordx4 v81, s[24:27], s63 offen lds
    s_setprio 2
    s_waitcnt lgkmcnt(4)
    v_mfma_f32_16x16x32_bf16 v[128:131], v[8:11], v[40:43], v[128:131]
    ds_read_b64_tr_b16 v[28:29], v91 offset:0
    ds_read_b64_tr_b16 v[30:31], v91 offset:1024
    v_mfma_f32_16x16x32_bf16 v[136:139], v[8:11], v[44:47], v[136:139]
    s_cmp_eq_u32 s79, 1
    s_cbranch_scc0 M_st_17
    s_add_u32 s96, s76, 0
    buffer_store_dwordx4 v[192:195], v2, s[32:35], s96 offen sc1
M_st_17:
    v_mfma_f32_16x16x32_bf16 v[132:135], v[12:15], v[40:43], v[132:135]
    ds_read_b64_tr_b16 v[32:33], v92 offset:0
    ds_read_b64_tr_b16 v[34:35], v92 offset:1024
    v_mfma_f32_16x16x32_bf16 v[140:143], v[12:15], v[44:47], v[140:143]
    s_add_u32 m0, s67, 122880
    s_add_u32 s63, s73, 2621440
    buffer_load_dwordx4 v82, s[36:39], s63 offen lds
    v_mfma_f32_16x16x32_bf16 v[144:147], v[16:19], v[40:43], v[144:147]
    ds_read_b64_tr_b16 v[36:37], v93 offset:0
    ds_read_b64_tr_b16 v[38:39], v93 offset:1024
    v_mfma_f32_16x16x32_bf16 v[152:155], v[16:19], v[44:47], v[152:155]
    s_add_u32 m0, s67, 131072
    s_add_u32 s63, s73, 2883584
    buffer_load_dwordx4 v82, s[36:39], s63 offen lds
    s_waitcnt lgkmcnt(8)
    v_mfma_f32_16x16x32_bf16 v[148:151], v[20:23], v[40:43], v[148:151]
    ds_read_b64_tr_b16 v[8:9], v102 offset:16384
    ds_read_b64_tr_b16 v[10:11], v102 offset:16896
    v_mfma_f32_16x16x32_bf16 v[156:159], v[20:23], v[44:47], v[156:159]
    s_cmp_eq_u32 s79, 1
    s_cbranch_scc0 M_st_18
    s_add_u32 s96, s76, 0
    s_add_u32 s96, s96, s78
    buffer_store_dwordx4 v[196:199], v2, s[32:35], s96 offen sc1
M_st_18:
    s_waitcnt lgkmcnt(8)
    v_mfma_f32_16x16x32_bf16 v[160:163], v[24:27], v[40:43], v[160:163]
    ds_read_b64_tr_b16 v[12:13], v103 offset:16384
    ds_read_b64_tr_b16 v[14:15], v103 offset:16896
    v_mfma_f32_16x16x32_bf16 v[168:171], v[24:27], v[44:47], v[168:171]
    s_add_u32 m0, s67, 139264
    s_add_u32 s63, s74, 1146880
    buffer_load_dwordx4 v83, s[28:31], s63 offen lds
    s_waitcnt lgkmcnt(8)
    v_mfma_f32_16x16x32_bf16 v[164:167], v[28:31], v[40:43], v[164:167]
    ds_read_b64_tr_b16 v[16:17], v104 offset:16384
    ds_read_b64_tr_b16 v[18:19], v104 offset:16896
    v_mfma_f32_16x16x32_bf16 v[172:175], v[28:31], v[44:47], v[172:175]
    s_setprio 1
    s_waitcnt lgkmcnt(8)
    v_mfma_f32_16x16x32_bf16 v[176:179], v[32:35], v[40:43], v[176:179]
    ds_read_b64_tr_b16 v[20:21], v105 offset:16384
    ds_read_b64_tr_b16 v[22:23], v105 offset:16896
    v_mfma_f32_16x16x32_bf16 v[184:187], v[32:35], v[44:47], v[184:187]
    s_cmp_eq_u32 s79, 1
    s_cbranch_scc0 M_st_19
    s_add_u32 s96, s76, 4096
    buffer_store_dwordx4 v[200:203], v2, s[32:35], s96 offen sc1
M_st_19:
    s_waitcnt lgkmcnt(8)
    v_mfma_f32_16x16x32_bf16 v[180:183], v[36:39], v[40:43], v[180:183]
    ds_read_b64_tr_b16 v[24:25], v86 offset:8192
    ds_read_b64_tr_b16 v[26:27], v86 offset:9216
    v_mfma_f32_16x16x32_bf16 v[188:191], v[36:39], v[44:47], v[188:191]
    s_waitcnt lgkmcnt(8)
    v_mfma_f32_16x16x32_bf16 v[48:51], v[8:11], v[40:43], v[48:51]
    ds_read_b64_tr_b16 v[28:29], v87 offset:8192
    ds_read_b64_tr_b16 v[30:31], v87 offset:9216
    v_mfma_f32_16x16x32_bf16 v[56:59], v[8:11], v[44:47], v[56:59]
    ds_read_b128 v[112:115], v85 offset:0
    s_waitcnt lgkmcnt(9)
    v_mfma_f32_16x16x32_bf16 v[52:55], v[12:15], v[40:43], v[52:55]
    ds_read_b64_tr_b16 v[32:33], v88 offset:8192
    ds_read_b64_tr_b16 v[34:35], v88 offset:9216
    v_mfma_f32_16x16x32_bf16 v[60:63], v[12:15], v[44:47], v[60:63]
    ds_read_b128 v[116:119], v85 offset:2048
    s_cmp_eq_u32 s79, 1
    s_cbranch_scc0 M_st_20
    s_add_u32 s96, s76, 4096
    s_add_u32 s96, s96, s78
    buffer_store_dwordx4 v[204:207], v2, s[32:35], s96 offen sc1
M_st_20:
    s_waitcnt lgkmcnt(10)
    v_mfma_f32_16x16x32_bf16 v[64:67], v[40:43], v[16:19], v[64:67]
    ds_read_b64_tr_b16 v[36:37], v89 offset:8192
    ds_read_b64_tr_b16 v[38:39], v89 offset:9216
    v_mfma_f32_16x16x32_bf16 v[68:71], v[44:47], v[16:19], v[68:71]
    s_waitcnt lgkmcnt(10)
    v_mfma_f32_16x16x32_bf16 v[72:75], v[40:43], v[20:23], v[72:75]
    ds_read_b64_tr_b16 v[8:9], v90 offset:8192
    ds_read_b64_tr_b16 v[10:11], v90 offset:9216
    v_mfma_f32_16x16x32_bf16 v[76:79], v[44:47], v[20:23], v[76:79]
    s_setprio 0
    s_waitcnt lgkmcnt(4)
    v_mfma_f32_16x16x32_bf16 v[128:131], v[24:27], v[112:115], v[128:131]
    ds_read_b64_tr_b16 v[12:13], v91 offset:8192
    ds_read_b64_tr_b16 v[14:15], v91 offset:9216
    v_mfma_f32_16x16x32_bf16 v[136:139], v[24:27], v[116:119], v[136:139]
    s_cmp_eq_u32 s79, 1
    s_cbranch_scc0 M_st_21
    s_add_u32 s96, s76, 0
    s_add_u32 s96, s96, s77
    buffer_store_dwordx4 v[208:211], v2, s[32:35], s96 offen sc1
M_st_21:
    v_mfma_f32_16x16x32_bf16 v[132:135], v[28:31], v[112:115], v[132:135]
    ds_read_b64_tr_b16 v[16:17], v92 offset:8192
    ds_read_b64_tr_b16 v[18:19], v92 offset:9216
    v_mfma_f32_16x16x32_bf16 v[140:143], v[28:31], v[116:119], v[140:143]
    v_mfma_f32_16x16x32_bf16 v[144:147], v[32:35], v[112:115], v[144:147]
    ds_read_b64_tr_b16 v[20:21], v93 offset:8192
    ds_read_b64_tr_b16 v[22:23], v93 offset:9216
    v_mfma_f32_16x16x32_bf16 v[152:155], v[32:35], v[116:119], v[152:155]
    s_waitcnt lgkmcnt(8)
    v_mfma_f32_16x16x32_bf16 v[148:151], v[36:39], v[112:115], v[148:151]
    ds_read_b64_tr_b16 v[24:25], v102 offset:20480
    ds_read_b64_tr_b16 v[26:27], v102 offset:20992
    v_mfma_f32_16x16x32_bf16 v[156:159], v[36:39], v[116:119], v[156:159]
    s_cmp_eq_u32 s79, 1
    s_cbranch_scc0 M_st_22
    s_add_u32 s96, s76, 0
    s_add_u32 s96, s96, s77
    s_add_u32 s96, s96, s78
    buffer_store_dwordx4 v[212:215], v2, s[32:35], s96 offen sc1
M_st_22:
    s_waitcnt lgkmcnt(8)
    v_mfma_f32_16x16x32_bf16 v[160:163], v[8:11], v[112:115], v[160:163]
    ds_read_b64_tr_b16 v[28:29], v103 offset:20480
    ds_read_b64_tr_b16 v[30:31], v103 offset:20992
    v_mfma_f32_16x16x32_bf16 v[168:171], v[8:11], v[116:119], v[168:171]
    s_waitcnt lgkmcnt(8)
    v_mfma_f32_16x16x32_bf16 v[164:167], v[12:15], v[112:115], v[164:167]
    ds_read_b64_tr_b16 v[32:33], v104 offset:20480
    ds_read_b64_tr_b16 v[34:35], v104 offset:20992
    v_mfma_f32_16x16x32_bf16 v[172:175], v[12:15], v[116:119], v[172:175]
    s_waitcnt lgkmcnt(8)
    v_mfma_f32_16x16x32_bf16 v[176:179], v[16:19], v[112:115], v[176:179]
    ds_read_b64_tr_b16 v[36:37], v105 offset:20480
    ds_read_b64_tr_b16 v[38:39], v105 offset:20992
    v_mfma_f32_16x16x32_bf16 v[184:187], v[16:19], v[116:119], v[184:187]
    s_cmp_eq_u32 s79, 1
    s_cbranch_scc0 M_st_23
    s_add_u32 s96, s76, 4096
    s_add_u32 s96, s96, s77
    buffer_store_dwordx4 v[216:219], v2, s[32:35], s96 offen sc1
M_st_23:
    s_cmp_eq_u32 s79, 0
    s_cbranch_scc0 M_sw_24
    s_waitcnt vmcnt(0)
M_sw_24:
    s_waitcnt lgkmcnt(0)
    s_waitcnt vmcnt(3)
    s_barrier
    s_setprio 3
    s_cmp_eq_u32 s79, 0
    s_cbranch_scc0 M_sg_25
    s_cmp_eq_u32 s56, 0
    s_cbranch_scc0 M_sig_26
    s_add_u32 s52, s14, 0x6400000
    s_addc_u32 s53, s15, 0
    s_mov_b32 s54, 0x4000
    s_mov_b32 s55, 0x00020000
    v_mov_b32 v124, s3
    v_mov_b32 v125, 0
    s_mov_b64 exec, 1
    buffer_store_dword v124, v125, s[52:55], s80 offen sc1
    s_mov_b64 exec, -1
M_sig_26:
M_sg_25:
    v_mfma_f32_16x16x32_bf16 v[180:183], v[20:23], v[112:115], v[180:183]
    ds_read_b64_tr_b16 v[8:9], v94 offset:49152
    ds_read_b64_tr_b16 v[10:11], v94 offset:50176
    v_mfma_f32_16x16x32_bf16 v[188:191], v[20:23], v[116:119], v[188:191]
    s_add_u32 m0, s68, 32768
    s_add_u32 s63, s72, 512
    buffer_load_dwordx4 v80, s[24:27], s63 offen lds
    v_mfma_f32_16x16x32_bf16 v[48:51], v[24:27], v[112:115], v[48:51]
    ds_read_b64_tr_b16 v[12:13], v95 offset:49152
    ds_read_b64_tr_b16 v[14:15], v95 offset:50176
    v_mfma_f32_16x16x32_bf16 v[56:59], v[24:27], v[116:119], v[56:59]
    ds_read_b128 v[40:43], v84 offset:32768
    s_add_u32 m0, s68, 33792
    s_add_u32 s63, s72, 8704
    buffer_load_dwordx4 v81, s[24:27], s63 offen lds
    v_mfma_f32_16x16x32_bf16 v[52:55], v[28:31], v[112:115], v[52:55]
    ds_read_b64_tr_b16 v[16:17], v96 offset:49152
    ds_read_b64_tr_b16 v[18:19], v96 offset:50176
    v_mfma_f32_16x16x32_bf16 v[60:63], v[28:31], v[116:119], v[60:63]
    ds_read_b128 v[44:47], v84 offset:34816
    s_cmp_eq_u32 s79, 1
    s_cbranch_scc0 M_st_27
    s_add_u32 s96, s76, 4096
    s_add_u32 s96, s96, s77
    s_add_u32 s96, s96, s78
    buffer_store_dwordx4 v[220:223], v2, s[32:35], s96 offen sc1
M_st_27:
    v_mfma_f32_16x16x32_bf16 v[64:67], v[112:115], v[32:35], v[64:67]
    ds_read_b64_tr_b16 v[20:21], v97 offset:49152
    ds_read_b64_tr_b16 v[22:23], v97 offset:50176
    v_mfma_f32_16x16x32_bf16 v[68:71], v[116:119], v[32:35], v[68:71]
    s_add_u32 m0, s68, 34816
    s_add_u32 s63, s72, 16896
    buffer_load_dwordx4 v80, s[24:27], s63 offen lds
    v_mfma_f32_16x16x32_bf16 v[72:75], v[112:115], v[36:39], v[72:75]
    ds_read_b64_tr_b16 v[24:25], v98 offset:49152
    ds_read_b64_tr_b16 v[26:27], v98 offset:50176
    v_mfma_f32_16x16x32_bf16 v[76:79], v[116:119], v[36:39], v[76:79]
    s_add_u32 m0, s68, 35840
    s_add_u32 s63, s72, 25088
    buffer_load_dwordx4 v81, s[24:27], s63 offen lds
    s_setprio 2
    s_waitcnt lgkmcnt(4)
    v_mfma_f32_16x16x32_bf16 v[128:131], v[8:11], v[40:43], v[128:131]
    ds_read_b64_tr_b16 v[28:29], v99 offset:49152
    ds_read_b64_tr_b16 v[30:31], v99 offset:50176
    v_mfma_f32_16x16x32_bf16 v[136:139], v[8:11], v[44:47], v[136:139]
    s_cmp_eq_u32 s79, 1
    s_cbranch_scc0 M_st_28
    s_add_u32 s96, s76, 16384
    buffer_store_dwordx4 v[224:227], v2, s[32:35], s96 offen sc1
M_st_28:
    v_mfma_f32_16x16x32_bf16 v[132:135], v[12:15], v[40:43], v[132:135]
    ds_read_b64_tr_b16 v[32:33], v100 offset:49152
    ds_read_b64_tr_b16 v[34:35], v100 offset:50176
    v_mfma_f32_16x16x32_bf16 v[140:143], v[12:15], v[44:47], v[140:143]
    s_add_u32 m0, s67, 0
    s_add_u32 s63, s73, 3145728
    buffer_load_dwordx4 v82, s[36:39], s63 offen lds
    v_mfma_f32_16x16x32_bf16 v[144:147], v[16:19], v[40:43], v[144:147]
    ds_read_b64_tr_b16 v[36:37], v101 offset:49152
    ds_read_b64_tr_b16 v[38:39], v101 offset:50176
    v_mfma_f32_16x16x32_bf16 v[152:155], v[16:19], v[44:47], v[152:155]
    s_add_u32 m0, s67, 8192
    s_add_u32 s63, s73, 3407872
    buffer_load_dwordx4 v82, s[36:39], s63 offen lds
    s_waitcnt lgkmcnt(8)
    v_mfma_f32_16x16x32_bf16 v[148:151], v[20:23], v[40:43], v[148:151]
    ds_read_b64_tr_b16 v[8:9], v102 offset:24576
    ds_read_b64_tr_b16 v[10:11], v102 offset:25088
    v_mfma_f32_16x16x32_bf16 v[156:159], v[20:23], v[44:47], v[156:159]
    s_cmp_eq_u32 s79, 1
    s_cbranch_scc0 M_st_29
    s_add_u32 s96, s76, 16384
    s_add_u32 s96, s96, s78
    buffer_store_dwordx4 v[228:231], v2, s[32:35], s96 offen sc1
M_st_29:
    s_waitcnt lgkmcnt(8)
    v_mfma_f32_16x16x32_bf16 v[160:163], v[24:27], v[40:43], v[160:163]
    ds_read_b64_tr_b16 v[12:13], v103 offset:24576
    ds_read_b64_tr_b16 v[14:15], v103 offset:25088
    v_mfma_f32_16x16x32_bf16 v[168:171], v[24:27], v[44:47], v[168:171]
    s_add_u32 m0, s67, 16384
    s_add_u32 s63, s74, 1376256
    buffer_load_dwordx4 v83, s[28:31], s63 offen lds
    s_waitcnt lgkmcnt(8)
    v_mfma_f32_16x16x32_bf16 v[164:167], v[28:31], v[40:43], v[164:167]
    ds_read_b64_tr_b16 v[16:17], v104 offset:24576
    ds_read_b64_tr_b16 v[18:19], v104 offset:25088
    v_mfma_f32_16x16x32_bf16 v[172:175], v[28:31], v[44:47], v[172:175]
    s_setprio 1
    s_waitcnt lgkmcnt(8)
    v_mfma_f32_16x16x32_bf16 v[176:179], v[32:35], v[40:43], v[176:179]
    ds_read_b64_tr_b16 v[20:21], v105 offset:24576
    ds_read_b64_tr_b16 v[22:23], v105 offset:25088
    v_mfma_f32_16x16x32_bf16 v[184:187], v[32:35], v[44:47], v[184:187]
    s_cmp_eq_u32 s79, 1
    s_cbranch_scc0 M_st_30
    s_add_u32 s96, s76, 20480
    buffer_store_dwordx4 v[232:235], v2, s[32:35], s96 offen sc1
M_st_30:
    s_waitcnt lgkmcnt(8)
    v_mfma_f32_16x16x32_bf16 v[180:183], v[36:39], v[40:43], v[180:183]
    ds_read_b64_tr_b16 v[24:25], v94 offset:57344
    ds_read_b64_tr_b16 v[26:27], v94 offset:58368
    v_mfma_f32_16x16x32_bf16 v[188:191], v[36:39], v[44:47], v[188:191]
    s_waitcnt lgkmcnt(8)
    v_mfma_f32_16x16x32_bf16 v[48:51], v[8:11], v[40:43], v[48:51]
    ds_read_b64_tr_b16 v[28:29], v95 offset:57344
    ds_read_b64_tr_b16 v[30:31], v95 offset:58368
    v_mfma_f32_16x16x32_bf16 v[56:59], v[8:11], v[44:47], v[56:59]
    ds_read_b128 v[112:115], v85 offset:32768
    s_waitcnt lgkmcnt(9)
    v_mfma_f32_16x16x32_bf16 v[52:55], v[12:15], v[40:43], v[52:55]
    ds_read_b64_tr_b16 v[32:33], v96 offset:57344
    ds_read_b64_tr_b16 v[34:35], v96 offset:58368
    v_mfma_f32_16x16x32_bf16 v[60:63], v[12:15], v[44:47], v[60:63]
    ds_read_b128 v[116:119], v85 offset:34816
    s_cmp_eq_u32 s79, 1
    s_cbranch_scc0 M_st_31
    s_add_u32 s96, s76, 20480
    s_add_u32 s96, s96, s78
    buffer_store_dwordx4 v[236:239], v2, s[32:35], s96 offen sc1
M_st_31:
    s_waitcnt lgkmcnt(10)
    v_mfma_f32_16x16x32_bf16 v[64:67], v[40:43], v[16:19], v[64:67]
    ds_read_b64_tr_b16 v[36:37], v97 offset:57344
    ds_read_b64_tr_b16 v[38:39], v97 offset:58368
    v_mfma_f32_16x16x32_bf16 v[68:71], v[44:47], v[16:19], v[68:71]
    s_waitcnt lgkmcnt(10)
    v_mfma_f32_16x16x32_bf16 v[72:75], v[40:43], v[20:23], v[72:75]
    ds_read_b64_tr_b16 v[8:9], v98 offset:57344
    ds_read_b64_tr_b16 v[10:11], v98 offset:58368
    v_mfma_f32_16x16x32_bf16 v[76:79], v[44:47], v[20:23], v[76:79]
    s_setprio 0
    s_waitcnt lgkmcnt(4)
    v_mfma_f32_16x16x32_bf16 v[128:131], v[24:27], v[112:115], v[128:131]
    ds_read_b64_tr_b16 v[12:13], v99 offset:57344
    ds_read_b64_tr_b16 v[14:15], v99 offset:58368
    v_mfma_f32_16x16x32_bf16 v[136:139], v[24:27], v[116:119], v[136:139]
    s_cmp_eq_u32 s79, 1
    s_cbranch_scc0 M_st_32
    s_add_u32 s96, s76, 16384
    s_add_u32 s96, s96, s77
    buffer_store_dwordx4 v[240:243], v2, s[32:35], s96 offen sc1
M_st_32:
    v_mfma_f32_16x16x32_bf16 v[132:135], v[28:31], v[112:115], v[132:135]
    ds_read_b64_tr_b16 v[16:17], v100 offset:57344
    ds_read_b64_tr_b16 v[18:19], v100 offset:58368
    v_mfma_f32_16x16x32_bf16 v[140:143], v[28:31], v[116:119], v[140:143]
    v_mfma_f32_16x16x32_bf16 v[144:147], v[32:35], v[112:115], v[144:147]
    ds_read_b64_tr_b16 v[20:21], v101 offset:57344
    ds_read_b64_tr_b16 v[22:23], v101 offset:58368
    v_mfma_f32_16x16x32_bf16 v[152:155], v[32:35], v[116:119], v[152:155]
    s_waitcnt lgkmcnt(8)
    v_mfma_f32_16x16x32_bf16 v[148:151], v[36:39], v[112:115], v[148:151]
    ds_read_b64_tr_b16 v[24:25], v102 offset:28672
    ds_read_b64_tr_b16 v[26:27], v102 offset:29184
    v_mfma_f32_16x16x32_bf16 v[156:159], v[36:39], v[116:119], v[156:159]
    s_cmp_eq_u32 s79, 1
    s_cbranch_scc0 M_st_33
    s_add_u32 s96, s76, 16384
    s_add_u32 s96, s96, s77
    s_add_u32 s96, s96, s78
    buffer_store_dwordx4 v[244:247], v2, s[32:35], s96 offen sc1
M_st_33:
    s_waitcnt lgkmcnt(8)
    v_mfma_f32_16x16x32_bf16 v[160:163], v[8:11], v[112:115], v[160:163]
    ds_read_b64_tr_b16 v[28:29], v103 offset:28672
    ds_read_b64_tr_b16 v[30:31], v103 offset:29184
    v_mfma_f32_16x16x32_bf16 v[168:171], v[8:11], v[116:119], v[168:171]
    s_waitcnt lgkmcnt(8)
    v_mfma_f32_16x16x32_bf16 v[164:167], v[12:15], v[112:115], v[164:167]
    ds_read_b64_tr_b16 v[32:33], v104 offset:28672
    ds_read_b64_tr_b16 v[34:35], v104 offset:29184
    v_mfma_f32_16x16x32_bf16 v[172:175], v[12:15], v[116:119], v[172:175]
    s_waitcnt lgkmcnt(8)
    v_mfma_f32_16x16x32_bf16 v[176:179], v[16:19], v[112:115], v[176:179]
    ds_read_b64_tr_b16 v[36:37], v105 offset:28672
    ds_read_b64_tr_b16 v[38:39], v105 offset:29184
    v_mfma_f32_16x16x32_bf16 v[184:187], v[16:19], v[116:119], v[184:187]
    s_cmp_eq_u32 s79, 1
    s_cbranch_scc0 M_st_34
    s_add_u32 s96, s76, 20480
    s_add_u32 s96, s96, s77
    buffer_store_dwordx4 v[248:251], v2, s[32:35], s96 offen sc1
M_st_34:
    s_waitcnt lgkmcnt(0)
    s_waitcnt vmcnt(3)
    s_barrier
    s_setprio 3
    v_mfma_f32_16x16x32_bf16 v[180:183], v[20:23], v[112:115], v[180:183]
    ds_read_b64_tr_b16 v[8:9], v94 offset:0
    ds_read_b64_tr_b16 v[10:11], v94 offset:1024
    v_mfma_f32_16x16x32_bf16 v[188:191], v[20:23], v[116:119], v[188:191]
    s_add_u32 m0, s68, 65536
    s_add_u32 s63, s72, 640
    buffer_load_dwordx4 v80, s[24:27], s63 offen lds
    v_mfma_f32_16x16x32_bf16 v[48:51], v[24:27], v[112:115], v[48:51]
    ds_read_b64_tr_b16 v[12:13], v95 offset:0
    ds_read_b64_tr_b16 v[14:15], v95 offset:1024
    v_mfma_f32_16x16x32_bf16 v[56:59], v[24:27], v[116:119], v[56:59]
    ds_read_b128 v[40:43], v84 offset:0
    s_add_u32 m0, s68, 66560
    s_add_u32 s63, s72, 8832
    buffer_load_dwordx4 v81, s[24:27], s63 offen lds
    v_mfma_f32_16x16x32_bf16 v[52:55], v[28:31], v[112:115], v[52:55]
    ds_read_b64_tr_b16 v[16:17], v96 offset:0
    ds_read_b64_tr_b16 v[18:19], v96 offset:1024
    v_mfma_f32_16x16x32_bf16 v[60:63], v[28:31], v[116:119], v[60:63]
    ds_read_b128 v[44:47], v84 offset:2048
    s_cmp_eq_u32 s79, 1
    s_cbranch_scc0 M_st_35
    s_add_u32 s96, s76, 20480
    s_add_u32 s96, s96, s77
    s_add_u32 s96, s96, s78
    buffer_store_dwordx4 v[252:255], v2, s[32:35], s96 offen sc1
M_st_35:
    v_mfma_f32_16x16x32_bf16 v[64:67], v[112:115], v[32:35], v[64:67]
    ds_read_b64_tr_b16 v[20:21], v97 offset:0
    ds_read_b64_tr_b16 v[22:23], v97 offset:1024
    v_mfma_f32_16x16x32_bf16 v[68:71], v[116:119], v[32:35], v[68:71]
    s_add_u32 m0, s68, 67584
    s_add_u32 s63, s72, 17024
    buffer_load_dwordx4 v80, s[24:27], s63 offen lds
    v_mfma_f32_16x16x32_bf16 v[72:75], v[112:115], v[36:39], v[72:75]
    ds_read_b64_tr_b16 v[24:25], v98 offset:0
    ds_read_b64_tr_b16 v[26:27], v98 offset:1024
    v_mfma_f32_16x16x32_bf16 v[76:79], v[116:119], v[36:39], v[76:79]
    s_add_u32 m0, s68, 68608
    s_add_u32 s63, s72, 25216
    buffer_load_dwordx4 v81, s[24:27], s63 offen lds
    s_setprio 2
    s_waitcnt lgkmcnt(4)
    v_mfma_f32_16x16x32_bf16 v[128:131], v[8:11], v[40:43], v[128:131]
    ds_read_b64_tr_b16 v[28:29], v99 offset:0
    ds_read_b64_tr_b16 v[30:31], v99 offset:1024
    v_mfma_f32_16x16x32_bf16 v[136:139], v[8:11], v[44:47], v[136:139]
    s_cmp_eq_u32 s79, 2
    s_cbranch_scc0 M_st_36
    s_add_u32 s96, s76, 0
    buffer_store_dwordx4 v[192:195], v2, s[32:35], s96 offen sc1
M_st_36:
    v_mfma_f32_16x16x32_bf16 v[132:135], v[12:15], v[40:43], v[132:135]
    ds_read_b64_tr_b16 v[32:33], v100 offset:0
    ds_read_b64_tr_b16 v[34:35], v100 offset:1024
    v_mfma_f32_16x16x32_bf16 v[140:143], v[12:15], v[44:47], v[140:143]
    s_add_u32 m0, s67, 147456
    s_add_u32 s63, s73, 3670016
    buffer_load_dwordx4 v82, s[36:39], s63 offen lds
    v_mfma_f32_16x16x32_bf16 v[144:147], v[16:19], v[40:43], v[144:147]
    ds_read_b64_tr_b16 v[36:37], v101 offset:0
    ds_read_b64_tr_b16 v[38:39], v101 offset:1024
    v_mfma_f32_16x16x32_bf16 v[152:155], v[16:19], v[44:47], v[152:155]
    s_add_u32 m0, s67, 155648
    s_add_u32 s63, s73, 3932160
    buffer_load_dwordx4 v82, s[36:39], s63 offen lds
    s_waitcnt lgkmcnt(8)
    v_mfma_f32_16x16x32_bf16 v[148:151], v[20:23], v[40:43], v[148:151]
    ds_read_b64_tr_b16 v[8:9], v106 offset:16384
    ds_read_b64_tr_b16 v[10:11], v106 offset:16896
    v_mfma_f32_16x16x32_bf16 v[156:159], v[20:23], v[44:47], v[156:159]
    s_cmp_eq_u32 s79, 2
    s_cbranch_scc0 M_st_37
    s_add_u32 s96, s76, 0
    s_add_u32 s96, s96, s78
    buffer_store_dwordx4 v[196:199], v2, s[32:35], s96 offen sc1
M_st_37:
    s_waitcnt lgkmcnt(8)
    v_mfma_f32_16x16x32_bf16 v[160:163], v[24:27], v[40:43], v[160:163]
    ds_read_b64_tr_b16 v[12:13], v107 offset:16384
    ds_read_b64_tr_b16 v[14:15], v107 offset:16896
    v_mfma_f32_16x16x32_bf16 v[168:171], v[24:27], v[44:47], v[168:171]
    s_add_u32 m0, s67, 24576
    s_add_u32 s63, s74, 1605632
    buffer_load_dwordx4 v83, s[28:31], s63 offen lds
    s_waitcnt lgkmcnt(8)
    v_mfma_f32_16x16x32_bf16 v[164:167], v[28:31], v[40:43], v[164:167]
    ds_read_b64_tr_b16 v[16:17], v108 offset:16384
    ds_read_b64_tr_b16 v[18:19], v108 offset:16896
    v_mfma_f32_16x16x32_bf16 v[172:175], v[28:31], v[44:47], v[172:175]
    s_setprio 1
    s_waitcnt lgkmcnt(8)
    v_mfma_f32_16x16x32_bf16 v[176:179], v[32:35], v[40:43], v[176:179]
    ds_read_b64_tr_b16 v[20:21], v109 offset:16384
    ds_read_b64_tr_b16 v[22:23], v109 offset:16896
    v_mfma_f32_16x16x32_bf16 v[184:187], v[32:35], v[44:47], v[184:187]
    s_cmp_eq_u32 s79, 2
    s_cbranch_scc0 M_st_38
    s_add_u32 s96, s76, 4096
    buffer_store_dwordx4 v[200:203], v2, s[32:35], s96 offen sc1
M_st_38:
    s_waitcnt lgkmcnt(8)
    v_mfma_f32_16x16x32_bf16 v[180:183], v[36:39], v[40:43], v[180:183]
    ds_read_b64_tr_b16 v[24:25], v94 offset:8192
    ds_read_b64_tr_b16 v[26:27], v94 offset:9216
    v_mfma_f32_16x16x32_bf16 v[188:191], v[36:39], v[44:47], v[188:191]
    s_waitcnt lgkmcnt(8)
    v_mfma_f32_16x16x32_bf16 v[48:51], v[8:11], v[40:43], v[48:51]
    ds_read_b64_tr_b16 v[28:29], v95 offset:8192
    ds_read_b64_tr_b16 v[30:31], v95 offset:9216
    v_mfma_f32_16x16x32_bf16 v[56:59], v[8:11], v[44:47], v[56:59]
    ds_read_b128 v[112:115], v85 offset:0
    s_waitcnt lgkmcnt(9)
    v_mfma_f32_16x16x32_bf16 v[52:55], v[12:15], v[40:43], v[52:55]
    ds_read_b64_tr_b16 v[32:33], v96 offset:8192
    ds_read_b64_tr_b16 v[34:35], v96 offset:9216
    v_mfma_f32_16x16x32_bf16 v[60:63], v[12:15], v[44:47], v[60:63]
    ds_read_b128 v[116:119], v85 offset:2048
    s_cmp_eq_u32 s79, 2
    s_cbranch_scc0 M_st_39
    s_add_u32 s96, s76, 4096
    s_add_u32 s96, s96, s78
    buffer_store_dwordx4 v[204:207], v2, s[32:35], s96 offen sc1
M_st_39:
    s_waitcnt lgkmcnt(10)
    v_mfma_f32_16x16x32_bf16 v[64:67], v[40:43], v[16:19], v[64:67]
    ds_read_b64_tr_b16 v[36:37], v97 offset:8192
    ds_read_b64_tr_b16 v[38:39], v97 offset:9216
    v_mfma_f32_16x16x32_bf16 v[68:71], v[44:47], v[16:19], v[68:71]
    s_waitcnt lgkmcnt(10)
    v_mfma_f32_16x16x32_bf16 v[72:75], v[40:43], v[20:23], v[72:75]
    ds_read_b64_tr_b16 v[8:9], v98 offset:8192
    ds_read_b64_tr_b16 v[10:11], v98 offset:9216
    v_mfma_f32_16x16x32_bf16 v[76:79], v[44:47], v[20:23], v[76:79]
    s_setprio 0
    s_waitcnt lgkmcnt(4)
    v_mfma_f32_16x16x32_bf16 v[128:131], v[24:27], v[112:115], v[128:131]
    ds_read_b64_tr_b16 v[12:13], v99 offset:8192
    ds_read_b64_tr_b16 v[14:15], v99 offset:9216
    v_mfma_f32_16x16x32_bf16 v[136:139], v[24:27], v[116:119], v[136:139]
    s_cmp_eq_u32 s79, 2
    s_cbranch_scc0 M_st_40
    s_add_u32 s96, s76, 0
    s_add_u32 s96, s96, s77
    buffer_store_dwordx4 v[208:211], v2, s[32:35], s96 offen sc1
M_st_40:
    v_mfma_f32_16x16x32_bf16 v[132:135], v[28:31], v[112:115], v[132:135]
    ds_read_b64_tr_b16 v[16:17], v100 offset:8192
    ds_read_b64_tr_b16 v[18:19], v100 offset:9216
    v_mfma_f32_16x16x32_bf16 v[140:143], v[28:31], v[116:119], v[140:143]
    v_mfma_f32_16x16x32_bf16 v[144:147], v[32:35], v[112:115], v[144:147]
    ds_read_b64_tr_b16 v[20:21], v101 offset:8192
    ds_read_b64_tr_b16 v[22:23], v101 offset:9216
    v_mfma_f32_16x16x32_bf16 v[152:155], v[32:35], v[116:119], v[152:155]
    s_waitcnt lgkmcnt(8)
    v_mfma_f32_16x16x32_bf16 v[148:151], v[36:39], v[112:115], v[148:151]
    ds_read_b64_tr_b16 v[24:25], v106 offset:20480
    ds_read_b64_tr_b16 v[26:27], v106 offset:20992
    v_mfma_f32_16x16x32_bf16 v[156:159], v[36:39], v[116:119], v[156:159]
    s_cmp_eq_u32 s79, 2
    s_cbranch_scc0 M_st_41
    s_add_u32 s96, s76, 0
    s_add_u32 s96, s96, s77
    s_add_u32 s96, s96, s78
    buffer_store_dwordx4 v[212:215], v2, s[32:35], s96 offen sc1
M_st_41:
    s_waitcnt lgkmcnt(8)
    v_mfma_f32_16x16x32_bf16 v[160:163], v[8:11], v[112:115], v[160:163]
    ds_read_b64_tr_b16 v[28:29], v107 offset:20480
    ds_read_b64_tr_b16 v[30:31], v107 offset:20992
    v_mfma_f32_16x16x32_bf16 v[168:171], v[8:11], v[116:119], v[168:171]
    s_waitcnt lgkmcnt(8)
    v_mfma_f32_16x16x32_bf16 v[164:167], v[12:15], v[112:115], v[164:167]
    ds_read_b64_tr_b16 v[32:33], v108 offset:20480
    ds_read_b64_tr_b16 v[34:35], v108 offset:20992
    v_mfma_f32_16x16x32_bf16 v[172:175], v[12:15], v[116:119], v[172:175]
    s_waitcnt lgkmcnt(8)
    v_mfma_f32_16x16x32_bf16 v[176:179], v[16:19], v[112:115], v[176:179]
    ds_read_b64_tr_b16 v[36:37], v109 offset:20480
    ds_read_b64_tr_b16 v[38:39], v109 offset:20992
    v_mfma_f32_16x16x32_bf16 v[184:187], v[16:19], v[116:119], v[184:187]
    s_cmp_eq_u32 s79, 2
    s_cbranch_scc0 M_st_42
    s_add_u32 s96, s76, 4096
    s_add_u32 s96, s96, s77
    buffer_store_dwordx4 v[216:219], v2, s[32:35], s96 offen sc1
M_st_42:
    s_cmp_eq_u32 s79, 1
    s_cbranch_scc0 M_sw_43
    s_waitcnt vmcnt(0)
M_sw_43:
    s_waitcnt lgkmcnt(0)
    s_waitcnt vmcnt(3)
    s_barrier
    s_setprio 3
    s_cmp_eq_u32 s79, 1
    s_cbranch_scc0 M_sg_44
    s_cmp_eq_u32 s56, 0
    s_cbranch_scc0 M_sig_45
    s_add_u32 s52, s14, 0x6400000
    s_addc_u32 s53, s15, 0
    s_mov_b32 s54, 0x4000
    s_mov_b32 s55, 0x00020000
    v_mov_b32 v124, s3
    v_mov_b32 v125, 0
    s_mov_b64 exec, 1
    buffer_store_dword v124, v125, s[52:55], s80 offen sc1
    s_mov_b64 exec, -1
M_sig_45:
M_sg_44:
    v_mfma_f32_16x16x32_bf16 v[180:183], v[20:23], v[112:115], v[180:183]
    ds_read_b64_tr_b16 v[8:9], v94 offset:24576
    ds_read_b64_tr_b16 v[10:11], v94 offset:25600
    v_mfma_f32_16x16x32_bf16 v[188:191], v[20:23], v[116:119], v[188:191]
    s_add_u32 m0, s68, 32768
    s_add_u32 s63, s72, 768
    buffer_load_dwordx4 v80, s[24:27], s63 offen lds
    v_mfma_f32_16x16x32_bf16 v[48:51], v[24:27], v[112:115], v[48:51]
    ds_read_b64_tr_b16 v[12:13], v95 offset:24576
    ds_read_b64_tr_b16 v[14:15], v95 offset:25600
    v_mfma_f32_16x16x32_bf16 v[56:59], v[24:27], v[116:119], v[56:59]
    ds_read_b128 v[40:43], v84 offset:32768
    s_add_u32 m0, s68, 33792
    s_add_u32 s63, s72, 8960
    buffer_load_dwordx4 v81, s[24:27], s63 offen lds
    v_mfma_f32_16x16x32_bf16 v[52:55], v[28:31], v[112:115], v[52:55]
    ds_read_b64_tr_b16 v[16:17], v96 offset:24576
    ds_read_b64_tr_b16 v[18:19], v96 offset:25600
    v_mfma_f32_16x16x32_bf16 v[60:63], v[28:31], v[116:119], v[60:63]
    ds_read_b128 v[44:47], v84 offset:34816
    s_cmp_eq_u32 s79, 2
    s_cbranch_scc0 M_st_46
    s_add_u32 s96, s76, 4096
    s_add_u32 s96, s96, s77
    s_add_u32 s96, s96, s78
    buffer_store_dwordx4 v[220:223], v2, s[32:35], s96 offen sc1
M_st_46:
    v_mfma_f32_16x16x32_bf16 v[64:67], v[112:115], v[32:35], v[64:67]
    ds_read_b64_tr_b16 v[20:21], v97 offset:24576
    ds_read_b64_tr_b16 v[22:23], v97 offset:25600
    v_mfma_f32_16x16x32_bf16 v[68:71], v[116:119], v[32:35], v[68:71]
    s_add_u32 m0, s68, 34816
    s_add_u32 s63, s72, 17152
    buffer_load_dwordx4 v80, s[24:27], s63 offen lds
    v_mfma_f32_16x16x32_bf16 v[72:75], v[112:115], v[36:39], v[72:75]
    ds_read_b64_tr_b16 v[24:25], v98 offset:24576
    ds_read_b64_tr_b16 v[26:27], v98 offset:25600
    v_mfma_f32_16x16x32_bf16 v[76:79], v[116:119], v[36:39], v[76:79]
    s_add_u32 m0, s68, 35840
    s_add_u32 s63, s72, 25344
    buffer_load_dwordx4 v81, s[24:27], s63 offen lds
    s_setprio 2
    s_waitcnt lgkmcnt(4)
    v_mfma_f32_16x16x32_bf16 v[128:131], v[8:11], v[40:43], v[128:131]
    ds_read_b64_tr_b16 v[28:29], v99 offset:24576
    ds_read_b64_tr_b16 v[30:31], v99 offset:25600
    v_mfma_f32_16x16x32_bf16 v[136:139], v[8:11], v[44:47], v[136:139]
    s_cmp_eq_u32 s79, 2
    s_cbranch_scc0 M_st_47
    s_add_u32 s96, s76, 16384
    buffer_store_dwordx4 v[224:227], v2, s[32:35], s96 offen sc1
M_st_47:
    v_mfma_f32_16x16x32_bf16 v[132:135], v[12:15], v[40:43], v[132:135]
    ds_read_b64_tr_b16 v[32:33], v100 offset:24576
    ds_read_b64_tr_b16 v[34:35], v100 offset:25600
    v_mfma_f32_16x16x32_bf16 v[140:143], v[12:15], v[44:47], v[140:143]
    v_mfma_f32_16x16x32_bf16 v[144:147], v[16:19], v[40:43], v[144:147]
    ds_read_b64_tr_b16 v[36:37], v101 offset:24576
    ds_read_b64_tr_b16 v[38:39], v101 offset:25600
    v_mfma_f32_16x16x32_bf16 v[152:155], v[16:19], v[44:47], v[152:155]
    s_waitcnt lgkmcnt(8)
    v_mfma_f32_16x16x32_bf16 v[148:151], v[20:23], v[40:43], v[148:151]
    ds_read_b64_tr_b16 v[8:9], v106 offset:40960
    ds_read_b64_tr_b16 v[10:11], v106 offset:41472
    v_mfma_f32_16x16x32_bf16 v[156:159], v[20:23], v[44:47], v[156:159]
    s_cmp_eq_u32 s79, 2
    s_cbranch_scc0 M_st_48
    s_add_u32 s96, s76, 16384
    s_add_u32 s96, s96, s78
    buffer_store_dwordx4 v[228:231], v2, s[32:35], s96 offen sc1
M_st_48:
    s_waitcnt lgkmcnt(8)
    v_mfma_f32_16x16x32_bf16 v[160:163], v[24:27], v[40:43], v[160:163]
    ds_read_b64_tr_b16 v[12:13], v107 offset:40960
    ds_read_b64_tr_b16 v[14:15], v107 offset:41472
    v_mfma_f32_16x16x32_bf16 v[168:171], v[24:27], v[44:47], v[168:171]
    s_waitcnt lgkmcnt(8)
    v_mfma_f32_16x16x32_bf16 v[164:167], v[28:31], v[40:43], v[164:167]
    ds_read_b64_tr_b16 v[16:17], v108 offset:40960
    ds_read_b64_tr_b16 v[18:19], v108 offset:41472
    v_mfma_f32_16x16x32_bf16 v[172:175], v[28:31], v[44:47], v[172:175]
    s_setprio 1
    s_waitcnt lgkmcnt(8)
    v_mfma_f32_16x16x32_bf16 v[176:179], v[32:35], v[40:43], v[176:179]
    ds_read_b64_tr_b16 v[20:21], v109 offset:40960
    ds_read_b64_tr_b16 v[22:23], v109 offset:41472
    v_mfma_f32_16x16x32_bf16 v[184:187], v[32:35], v[44:47], v[184:187]
    s_cmp_eq_u32 s79, 2
    s_cbranch_scc0 M_st_49
    s_add_u32 s96, s76, 20480
    buffer_store_dwordx4 v[232:235], v2, s[32:35], s96 offen sc1
M_st_49:
    s_waitcnt lgkmcnt(8)
    v_mfma_f32_16x16x32_bf16 v[180:183], v[36:39], v[40:43], v[180:183]
    ds_read_b64_tr_b16 v[24:25], v94 offset:32768
    ds_read_b64_tr_b16 v[26:27], v94 offset:33792
    v_mfma_f32_16x16x32_bf16 v[188:191], v[36:39], v[44:47], v[188:191]
    s_waitcnt lgkmcnt(8)
    v_mfma_f32_16x16x32_bf16 v[48:51], v[8:11], v[40:43], v[48:51]
    ds_read_b64_tr_b16 v[28:29], v95 offset:32768
    ds_read_b64_tr_b16 v[30:31], v95 offset:33792
    v_mfma_f32_16x16x32_bf16 v[56:59], v[8:11], v[44:47], v[56:59]
    ds_read_b128 v[112:115], v85 offset:32768
    s_waitcnt lgkmcnt(9)
    v_mfma_f32_16x16x32_bf16 v[52:55], v[12:15], v[40:43], v[52:55]
    ds_read_b64_tr_b16 v[32:33], v96 offset:32768
    ds_read_b64_tr_b16 v[34:35], v96 offset:33792
    v_mfma_f32_16x16x32_bf16 v[60:63], v[12:15], v[44:47], v[60:63]
    ds_read_b128 v[116:119], v85 offset:34816
    s_cmp_eq_u32 s79, 2
    s_cbranch_scc0 M_st_50
    s_add_u32 s96, s76, 20480
    s_add_u32 s96, s96, s78
    buffer_store_dwordx4 v[236:239], v2, s[32:35], s96 offen sc1
M_st_50:
    s_waitcnt lgkmcnt(10)
    v_mfma_f32_16x16x32_bf16 v[64:67], v[40:43], v[16:19], v[64:67]
    ds_read_b64_tr_b16 v[36:37], v97 offset:32768
    ds_read_b64_tr_b16 v[38:39], v97 offset:33792
    v_mfma_f32_16x16x32_bf16 v[68:71], v[44:47], v[16:19], v[68:71]
    s_waitcnt lgkmcnt(10)
    v_mfma_f32_16x16x32_bf16 v[72:75], v[40:43], v[20:23], v[72:75]
    ds_read_b64_tr_b16 v[8:9], v98 offset:32768
    ds_read_b64_tr_b16 v[10:11], v98 offset:33792
    v_mfma_f32_16x16x32_bf16 v[76:79], v[44:47], v[20:23], v[76:79]
    s_setprio 0
    s_waitcnt lgkmcnt(4)
    v_mfma_f32_16x16x32_bf16 v[128:131], v[24:27], v[112:115], v[128:131]
    ds_read_b64_tr_b16 v[12:13], v99 offset:32768
    ds_read_b64_tr_b16 v[14:15], v99 offset:33792
    v_mfma_f32_16x16x32_bf16 v[136:139], v[24:27], v[116:119], v[136:139]
    s_cmp_eq_u32 s79, 2
    s_cbranch_scc0 M_st_51
    s_add_u32 s96, s76, 16384
    s_add_u32 s96, s96, s77
    buffer_store_dwordx4 v[240:243], v2, s[32:35], s96 offen sc1
M_st_51:
    v_mfma_f32_16x16x32_bf16 v[132:135], v[28:31], v[112:115], v[132:135]
    ds_read_b64_tr_b16 v[16:17], v100 offset:32768
    ds_read_b64_tr_b16 v[18:19], v100 offset:33792
    v_mfma_f32_16x16x32_bf16 v[140:143], v[28:31], v[116:119], v[140:143]
    v_mfma_f32_16x16x32_bf16 v[144:147], v[32:35], v[112:115], v[144:147]
    ds_read_b64_tr_b16 v[20:21], v101 offset:32768
    ds_read_b64_tr_b16 v[22:23], v101 offset:33792
    v_mfma_f32_16x16x32_bf16 v[152:155], v[32:35], v[116:119], v[152:155]
    s_waitcnt lgkmcnt(8)
    v_mfma_f32_16x16x32_bf16 v[148:151], v[36:39], v[112:115], v[148:151]
    ds_read_b64_tr_b16 v[24:25], v106 offset:45056
    ds_read_b64_tr_b16 v[26:27], v106 offset:45568
    v_mfma_f32_16x16x32_bf16 v[156:159], v[36:39], v[116:119], v[156:159]
    s_cmp_eq_u32 s79, 2
    s_cbranch_scc0 M_st_52
    s_add_u32 s96, s76, 16384
    s_add_u32 s96, s96, s77
    s_add_u32 s96, s96, s78
    buffer_store_dwordx4 v[244:247], v2, s[32:35], s96 offen sc1
M_st_52:
    s_waitcnt lgkmcnt(8)
    v_mfma_f32_16x16x32_bf16 v[160:163], v[8:11], v[112:115], v[160:163]
    ds_read_b64_tr_b16 v[28:29], v107 offset:45056
    ds_read_b64_tr_b16 v[30:31], v107 offset:45568
    v_mfma_f32_16x16x32_bf16 v[168:171], v[8:11], v[116:119], v[168:171]
    s_waitcnt lgkmcnt(8)
    v_mfma_f32_16x16x32_bf16 v[164:167], v[12:15], v[112:115], v[164:167]
    ds_read_b64_tr_b16 v[32:33], v108 offset:45056
    ds_read_b64_tr_b16 v[34:35], v108 offset:45568
    v_mfma_f32_16x16x32_bf16 v[172:175], v[12:15], v[116:119], v[172:175]
    s_waitcnt lgkmcnt(8)
    v_mfma_f32_16x16x32_bf16 v[176:179], v[16:19], v[112:115], v[176:179]
    ds_read_b64_tr_b16 v[36:37], v109 offset:45056
    ds_read_b64_tr_b16 v[38:39], v109 offset:45568
    v_mfma_f32_16x16x32_bf16 v[184:187], v[16:19], v[116:119], v[184:187]
    s_cmp_eq_u32 s79, 2
    s_cbranch_scc0 M_st_53
    s_add_u32 s96, s76, 20480
    s_add_u32 s96, s96, s77
    buffer_store_dwordx4 v[248:251], v2, s[32:35], s96 offen sc1
M_st_53:
    s_waitcnt lgkmcnt(0)
    s_waitcnt vmcnt(0)
    s_barrier
    s_setprio 3
    v_mfma_f32_16x16x32_bf16 v[180:183], v[20:23], v[112:115], v[180:183]
    ds_read_b64_tr_b16 v[8:9], v86 offset:0
    ds_read_b64_tr_b16 v[10:11], v86 offset:1024
    v_mfma_f32_16x16x32_bf16 v[188:191], v[20:23], v[116:119], v[188:191]
    s_add_u32 m0, s68, 65536
    s_add_u32 s63, s72, 896
    buffer_load_dwordx4 v80, s[24:27], s63 offen lds
    v_mfma_f32_16x16x32_bf16 v[48:51], v[24:27], v[112:115], v[48:51]
    ds_read_b64_tr_b16 v[12:13], v87 offset:0
    ds_read_b64_tr_b16 v[14:15], v87 offset:1024
    v_mfma_f32_16x16x32_bf16 v[56:59], v[24:27], v[116:119], v[56:59]
    ds_read_b128 v[40:43], v84 offset:0
    s_add_u32 m0, s68, 66560
    s_add_u32 s63, s72, 9088
    buffer_load_dwordx4 v81, s[24:27], s63 offen lds
    v_mfma_f32_16x16x32_bf16 v[52:55], v[28:31], v[112:115], v[52:55]
    ds_read_b64_tr_b16 v[16:17], v88 offset:0
    ds_read_b64_tr_b16 v[18:19], v88 offset:1024
    v_mfma_f32_16x16x32_bf16 v[60:63], v[28:31], v[116:119], v[60:63]
    ds_read_b128 v[44:47], v84 offset:2048
    s_cmp_eq_u32 s79, 2
    s_cbranch_scc0 M_st_54
    s_add_u32 s96, s76, 20480
    s_add_u32 s96, s96, s77
    s_add_u32 s96, s96, s78
    buffer_store_dwordx4 v[252:255], v2, s[32:35], s96 offen sc1
M_st_54:
    v_mfma_f32_16x16x32_bf16 v[64:67], v[112:115], v[32:35], v[64:67]
    ds_read_b64_tr_b16 v[20:21], v89 offset:0
    ds_read_b64_tr_b16 v[22:23], v89 offset:1024
    v_mfma_f32_16x16x32_bf16 v[68:71], v[116:119], v[32:35], v[68:71]
    s_add_u32 m0, s68, 67584
    s_add_u32 s63, s72, 17280
    buffer_load_dwordx4 v80, s[24:27], s63 offen lds
    v_mfma_f32_16x16x32_bf16 v[72:75], v[112:115], v[36:39], v[72:75]
    ds_read_b64_tr_b16 v[24:25], v90 offset:0
    ds_read_b64_tr_b16 v[26:27], v90 offset:1024
    v_mfma_f32_16x16x32_bf16 v[76:79], v[116:119], v[36:39], v[76:79]
    s_add_u32 m0, s68, 68608
    s_add_u32 s63, s72, 25472
    buffer_load_dwordx4 v81, s[24:27], s63 offen lds
    s_setprio 2
    s_waitcnt lgkmcnt(4)
    v_mfma_f32_16x16x32_bf16 v[128:131], v[8:11], v[40:43], v[128:131]
    ds_read_b64_tr_b16 v[28:29], v91 offset:0
    ds_read_b64_tr_b16 v[30:31], v91 offset:1024
    v_mfma_f32_16x16x32_bf16 v[136:139], v[8:11], v[44:47], v[136:139]
    s_cmp_eq_u32 s79, 3
    s_cbranch_scc0 M_st_55
    s_add_u32 s96, s76, 0
    buffer_store_dwordx4 v[192:195], v2, s[32:35], s96 offen sc1
M_st_55:
    v_mfma_f32_16x16x32_bf16 v[132:135], v[12:15], v[40:43], v[132:135]
    ds_read_b64_tr_b16 v[32:33], v92 offset:0
    ds_read_b64_tr_b16 v[34:35], v92 offset:1024
    v_mfma_f32_16x16x32_bf16 v[140:143], v[12:15], v[44:47], v[140:143]
    v_mfma_f32_16x16x32_bf16 v[144:147], v[16:19], v[40:43], v[144:147]
    ds_read_b64_tr_b16 v[36:37], v93 offset:0
    ds_read_b64_tr_b16 v[38:39], v93 offset:1024
    v_mfma_f32_16x16x32_bf16 v[152:155], v[16:19], v[44:47], v[152:155]
    s_waitcnt lgkmcnt(8)
    v_mfma_f32_16x16x32_bf16 v[148:151], v[20:23], v[40:43], v[148:151]
    ds_read_b64_tr_b16 v[8:9], v102 offset:16384
    ds_read_b64_tr_b16 v[10:11], v102 offset:16896
    v_mfma_f32_16x16x32_bf16 v[156:159], v[20:23], v[44:47], v[156:159]
    s_cmp_eq_u32 s79, 3
    s_cbranch_scc0 M_st_56
    s_add_u32 s96, s76, 0
    s_add_u32 s96, s96, s78
    buffer_store_dwordx4 v[196:199], v2, s[32:35], s96 offen sc1
M_st_56:
    s_waitcnt lgkmcnt(8)
    v_mfma_f32_16x16x32_bf16 v[160:163], v[24:27], v[40:43], v[160:163]
    ds_read_b64_tr_b16 v[12:13], v103 offset:16384
    ds_read_b64_tr_b16 v[14:15], v103 offset:16896
    v_mfma_f32_16x16x32_bf16 v[168:171], v[24:27], v[44:47], v[168:171]
    s_waitcnt lgkmcnt(8)
    v_mfma_f32_16x16x32_bf16 v[164:167], v[28:31], v[40:43], v[164:167]
    ds_read_b64_tr_b16 v[16:17], v104 offset:16384
    ds_read_b64_tr_b16 v[18:19], v104 offset:16896
    v_mfma_f32_16x16x32_bf16 v[172:175], v[28:31], v[44:47], v[172:175]
    s_setprio 1
    s_waitcnt lgkmcnt(8)
    v_mfma_f32_16x16x32_bf16 v[176:179], v[32:35], v[40:43], v[176:179]
    ds_read_b64_tr_b16 v[20:21], v105 offset:16384
    ds_read_b64_tr_b16 v[22:23], v105 offset:16896
    v_mfma_f32_16x16x32_bf16 v[184:187], v[32:35], v[44:47], v[184:187]
    s_cmp_eq_u32 s79, 3
    s_cbranch_scc0 M_st_57
    s_add_u32 s96, s76, 4096
    buffer_store_dwordx4 v[200:203], v2, s[32:35], s96 offen sc1
M_st_57:
    s_waitcnt lgkmcnt(8)
    v_mfma_f32_16x16x32_bf16 v[180:183], v[36:39], v[40:43], v[180:183]
    ds_read_b64_tr_b16 v[24:25], v86 offset:8192
    ds_read_b64_tr_b16 v[26:27], v86 offset:9216
    v_mfma_f32_16x16x32_bf16 v[188:191], v[36:39], v[44:47], v[188:191]
    s_waitcnt lgkmcnt(8)
    v_mfma_f32_16x16x32_bf16 v[48:51], v[8:11], v[40:43], v[48:51]
    ds_read_b64_tr_b16 v[28:29], v87 offset:8192
    ds_read_b64_tr_b16 v[30:31], v87 offset:9216
    v_mfma_f32_16x16x32_bf16 v[56:59], v[8:11], v[44:47], v[56:59]
    ds_read_b128 v[112:115], v85 offset:0
    s_waitcnt lgkmcnt(9)
    v_mfma_f32_16x16x32_bf16 v[52:55], v[12:15], v[40:43], v[52:55]
    ds_read_b64_tr_b16 v[32:33], v88 offset:8192
    ds_read_b64_tr_b16 v[34:35], v88 offset:9216
    v_mfma_f32_16x16x32_bf16 v[60:63], v[12:15], v[44:47], v[60:63]
    ds_read_b128 v[116:119], v85 offset:2048
    s_cmp_eq_u32 s79, 3
    s_cbranch_scc0 M_st_58
    s_add_u32 s96, s76, 4096
    s_add_u32 s96, s96, s78
    buffer_store_dwordx4 v[204:207], v2, s[32:35], s96 offen sc1
M_st_58:
    s_waitcnt lgkmcnt(10)
    v_mfma_f32_16x16x32_bf16 v[64:67], v[40:43], v[16:19], v[64:67]
    ds_read_b64_tr_b16 v[36:37], v89 offset:8192
    ds_read_b64_tr_b16 v[38:39], v89 offset:9216
    v_mfma_f32_16x16x32_bf16 v[68:71], v[44:47], v[16:19], v[68:71]
    s_waitcnt lgkmcnt(10)
    v_mfma_f32_16x16x32_bf16 v[72:75], v[40:43], v[20:23], v[72:75]
    ds_read_b64_tr_b16 v[8:9], v90 offset:8192
    ds_read_b64_tr_b16 v[10:11], v90 offset:9216
    v_mfma_f32_16x16x32_bf16 v[76:79], v[44:47], v[20:23], v[76:79]
    s_setprio 0
    s_waitcnt lgkmcnt(4)
    v_mfma_f32_16x16x32_bf16 v[128:131], v[24:27], v[112:115], v[128:131]
    ds_read_b64_tr_b16 v[12:13], v91 offset:8192
    ds_read_b64_tr_b16 v[14:15], v91 offset:9216
    v_mfma_f32_16x16x32_bf16 v[136:139], v[24:27], v[116:119], v[136:139]
    s_cmp_eq_u32 s79, 3
    s_cbranch_scc0 M_st_59
    s_add_u32 s96, s76, 0
    s_add_u32 s96, s96, s77
    buffer_store_dwordx4 v[208:211], v2, s[32:35], s96 offen sc1
M_st_59:
    v_mfma_f32_16x16x32_bf16 v[132:135], v[28:31], v[112:115], v[132:135]
    ds_read_b64_tr_b16 v[16:17], v92 offset:8192
    ds_read_b64_tr_b16 v[18:19], v92 offset:9216
    v_mfma_f32_16x16x32_bf16 v[140:143], v[28:31], v[116:119], v[140:143]
    v_mfma_f32_16x16x32_bf16 v[144:147], v[32:35], v[112:115], v[144:147]
    ds_read_b64_tr_b16 v[20:21], v93 offset:8192
    ds_read_b64_tr_b16 v[22:23], v93 offset:9216
    v_mfma_f32_16x16x32_bf16 v[152:155], v[32:35], v[116:119], v[152:155]
    s_waitcnt lgkmcnt(8)
    v_mfma_f32_16x16x32_bf16 v[148:151], v[36:39], v[112:115], v[148:151]
    ds_read_b64_tr_b16 v[24:25], v102 offset:20480
    ds_read_b64_tr_b16 v[26:27], v102 offset:20992
    v_mfma_f32_16x16x32_bf16 v[156:159], v[36:39], v[116:119], v[156:159]
    s_cmp_eq_u32 s79, 3
    s_cbranch_scc0 M_st_60
    s_add_u32 s96, s76, 0
    s_add_u32 s96, s96, s77
    s_add_u32 s96, s96, s78
    buffer_store_dwordx4 v[212:215], v2, s[32:35], s96 offen sc1
M_st_60:
    s_waitcnt lgkmcnt(8)
    v_mfma_f32_16x16x32_bf16 v[160:163], v[8:11], v[112:115], v[160:163]
    ds_read_b64_tr_b16 v[28:29], v103 offset:20480
    ds_read_b64_tr_b16 v[30:31], v103 offset:20992
    v_mfma_f32_16x16x32_bf16 v[168:171], v[8:11], v[116:119], v[168:171]
    s_waitcnt lgkmcnt(8)
    v_mfma_f32_16x16x32_bf16 v[164:167], v[12:15], v[112:115], v[164:167]
    ds_read_b64_tr_b16 v[32:33], v104 offset:20480
    ds_read_b64_tr_b16 v[34:35], v104 offset:20992
    v_mfma_f32_16x16x32_bf16 v[172:175], v[12:15], v[116:119], v[172:175]
    s_waitcnt lgkmcnt(8)
    v_mfma_f32_16x16x32_bf16 v[176:179], v[16:19], v[112:115], v[176:179]
    ds_read_b64_tr_b16 v[36:37], v105 offset:20480
    ds_read_b64_tr_b16 v[38:39], v105 offset:20992
    v_mfma_f32_16x16x32_bf16 v[184:187], v[16:19], v[116:119], v[184:187]
    s_cmp_eq_u32 s79, 3
    s_cbranch_scc0 M_st_61
    s_add_u32 s96, s76, 4096
    s_add_u32 s96, s96, s77
    buffer_store_dwordx4 v[216:219], v2, s[32:35], s96 offen sc1
M_st_61:
    s_cmp_eq_u32 s79, 2
    s_cbranch_scc0 M_sw_62
    s_waitcnt vmcnt(0)
M_sw_62:
    s_lshr_b32 s69, s59, 1
    s_lshl_b32 s69, s69, 7
    s_cmp_eq_u32 s56, 0
    s_cbranch_scc0 M_poll_63
    s_add_u32 s52, s14, 0x6400000
    s_addc_u32 s53, s15, 0
    s_mov_b32 s54, 0x4000
    s_mov_b32 s55, 0x00020000
    s_mov_b32 s97, 0
    v_and_b32 v125, 11, v1
    v_lshlrev_b32 v125, 2, v125
M_pl_64:
    buffer_load_dword v124, v125, s[52:55], s69 offen sc1
    s_waitcnt vmcnt(0)
    v_cmp_ne_u32 vcc, s3, v124
    s_add_u32 s97, s97, 1
    s_cbranch_vccz M_pd_65
    s_cmp_ge_u32 s97, 0x40000
    s_cbranch_scc1 M_pd_65
    s_sleep 4
    s_branch M_pl_64
M_pd_65:
M_poll_63:
    s_waitcnt lgkmcnt(0)
    s_waitcnt vmcnt(0)
    s_barrier
    s_setprio 3
    s_cmp_eq_u32 s79, 2
    s_cbranch_scc0 M_sg_66
    s_cmp_eq_u32 s56, 0
    s_cbranch_scc0 M_sig_67
    s_add_u32 s52, s14, 0x6400000
    s_addc_u32 s53, s15, 0
    s_mov_b32 s54, 0x4000
    s_mov_b32 s55, 0x00020000
    v_mov_b32 v124, s3
    v_mov_b32 v125, 0
    s_mov_b64 exec, 1
    buffer_store_dword v124, v125, s[52:55], s80 offen sc1
    s_mov_b64 exec, -1
M_sig_67:
M_sg_66:
    v_mfma_f32_16x16x32_bf16 v[180:183], v[20:23], v[112:115], v[180:183]
    ds_read_b64_tr_b16 v[8:9], v94 offset:49152
    ds_read_b64_tr_b16 v[10:11], v94 offset:50176
    v_mfma_f32_16x16x32_bf16 v[188:191], v[20:23], v[116:119], v[188:191]
    s_add_u32 m0, s81, 131072
    s_add_u32 s63, s82, 0
    buffer_load_dwordx4 v2, s[16:19], s63 offen offset:0 sc1 lds
    v_mfma_f32_16x16x32_bf16 v[48:51], v[24:27], v[112:115], v[48:51]
    ds_read_b64_tr_b16 v[12:13], v95 offset:49152
    ds_read_b64_tr_b16 v[14:15], v95 offset:50176
    v_mfma_f32_16x16x32_bf16 v[56:59], v[24:27], v[116:119], v[56:59]
    ds_read_b128 v[40:43], v84 offset:32768
    s_add_u32 m0, s81, 131072
    s_add_u32 s63, s82, 0
    buffer_load_dwordx4 v2, s[16:19], s63 offen offset:1024 sc1 lds
    v_mfma_f32_16x16x32_bf16 v[52:55], v[28:31], v[112:115], v[52:55]
    ds_read_b64_tr_b16 v[16:17], v96 offset:49152
    ds_read_b64_tr_b16 v[18:19], v96 offset:50176
    v_mfma_f32_16x16x32_bf16 v[60:63], v[28:31], v[116:119], v[60:63]
    ds_read_b128 v[44:47], v84 offset:34816
    s_cmp_eq_u32 s79, 3
    s_cbranch_scc0 M_st_68
    s_add_u32 s96, s76, 4096
    s_add_u32 s96, s96, s77
    s_add_u32 s96, s96, s78
    buffer_store_dwordx4 v[220:223], v2, s[32:35], s96 offen sc1
M_st_68:
    v_mfma_f32_16x16x32_bf16 v[64:67], v[112:115], v[32:35], v[64:67]
    ds_read_b64_tr_b16 v[20:21], v97 offset:49152
    ds_read_b64_tr_b16 v[22:23], v97 offset:50176
    v_mfma_f32_16x16x32_bf16 v[68:71], v[116:119], v[32:35], v[68:71]
    s_add_u32 m0, s81, 98304
    s_add_u32 s63, s82, 16384
    buffer_load_dwordx4 v2, s[16:19], s63 offen offset:0 sc1 lds
    v_mfma_f32_16x16x32_bf16 v[72:75], v[112:115], v[36:39], v[72:75]
    ds_read_b64_tr_b16 v[24:25], v98 offset:49152
    ds_read_b64_tr_b16 v[26:27], v98 offset:50176
    v_mfma_f32_16x16x32_bf16 v[76:79], v[116:119], v[36:39], v[76:79]
    s_add_u32 m0, s81, 98304
    s_add_u32 s63, s82, 16384
    buffer_load_dwordx4 v2, s[16:19], s63 offen offset:1024 sc1 lds
    s_setprio 2
    s_waitcnt lgkmcnt(4)
    v_mfma_f32_16x16x32_bf16 v[128:131], v[8:11], v[40:43], v[128:131]
    ds_read_b64_tr_b16 v[28:29], v99 offset:49152
    ds_read_b64_tr_b16 v[30:31], v99 offset:50176
    v_mfma_f32_16x16x32_bf16 v[136:139], v[8:11], v[44:47], v[136:139]
    s_cmp_eq_u32 s79, 3
    s_cbranch_scc0 M_st_69
    s_add_u32 s96, s76, 16384
    buffer_store_dwordx4 v[224:227], v2, s[32:35], s96 offen sc1
M_st_69:
    v_mfma_f32_16x16x32_bf16 v[132:135], v[12:15], v[40:43], v[132:135]
    ds_read_b64_tr_b16 v[32:33], v100 offset:49152
    ds_read_b64_tr_b16 v[34:35], v100 offset:50176
    v_mfma_f32_16x16x32_bf16 v[140:143], v[12:15], v[44:47], v[140:143]
    s_add_u32 m0, s81, 0
    s_add_u32 s63, s82, 16777216
    buffer_load_dwordx4 v2, s[16:19], s63 offen offset:0 sc1 lds
    v_mfma_f32_16x16x32_bf16 v[144:147], v[16:19], v[40:43], v[144:147]
    ds_read_b64_tr_b16 v[36:37], v101 offset:49152
    ds_read_b64_tr_b16 v[38:39], v101 offset:50176
    v_mfma_f32_16x16x32_bf16 v[152:155], v[16:19], v[44:47], v[152:155]
    s_add_u32 m0, s81, 0
    s_add_u32 s63, s82, 16777216
    buffer_load_dwordx4 v2, s[16:19], s63 offen offset:1024 sc1 lds
    s_waitcnt lgkmcnt(8)
    v_mfma_f32_16x16x32_bf16 v[148:151], v[20:23], v[40:43], v[148:151]
    ds_read_b64_tr_b16 v[8:9], v102 offset:24576
    ds_read_b64_tr_b16 v[10:11], v102 offset:25088
    v_mfma_f32_16x16x32_bf16 v[156:159], v[20:23], v[44:47], v[156:159]
    s_cmp_eq_u32 s79, 3
    s_cbranch_scc0 M_st_70
    s_add_u32 s96, s76, 16384
    s_add_u32 s96, s96, s78
    buffer_store_dwordx4 v[228:231], v2, s[32:35], s96 offen sc1
M_st_70:
    s_waitcnt lgkmcnt(8)
    v_mfma_f32_16x16x32_bf16 v[160:163], v[24:27], v[40:43], v[160:163]
    ds_read_b64_tr_b16 v[12:13], v103 offset:24576
    ds_read_b64_tr_b16 v[14:15], v103 offset:25088
    v_mfma_f32_16x16x32_bf16 v[168:171], v[24:27], v[44:47], v[168:171]
    s_waitcnt lgkmcnt(8)
    v_mfma_f32_16x16x32_bf16 v[164:167], v[28:31], v[40:43], v[164:167]
    ds_read_b64_tr_b16 v[16:17], v104 offset:24576
    ds_read_b64_tr_b16 v[18:19], v104 offset:25088
    v_mfma_f32_16x16x32_bf16 v[172:175], v[28:31], v[44:47], v[172:175]
    s_setprio 1
    s_waitcnt lgkmcnt(8)
    v_mfma_f32_16x16x32_bf16 v[176:179], v[32:35], v[40:43], v[176:179]
    ds_read_b64_tr_b16 v[20:21], v105 offset:24576
    ds_read_b64_tr_b16 v[22:23], v105 offset:25088
    v_mfma_f32_16x16x32_bf16 v[184:187], v[32:35], v[44:47], v[184:187]
    s_cmp_eq_u32 s79, 3
    s_cbranch_scc0 M_st_71
    s_add_u32 s96, s76, 20480
    buffer_store_dwordx4 v[232:235], v2, s[32:35], s96 offen sc1
M_st_71:
    s_waitcnt lgkmcnt(8)
    v_mfma_f32_16x16x32_bf16 v[180:183], v[36:39], v[40:43], v[180:183]
    ds_read_b64_tr_b16 v[24:25], v94 offset:57344
    ds_read_b64_tr_b16 v[26:27], v94 offset:58368
    v_mfma_f32_16x16x32_bf16 v[188:191], v[36:39], v[44:47], v[188:191]
    s_waitcnt lgkmcnt(8)
    v_mfma_f32_16x16x32_bf16 v[48:51], v[8:11], v[40:43], v[48:51]
    ds_read_b64_tr_b16 v[28:29], v95 offset:57344
    ds_read_b64_tr_b16 v[30:31], v95 offset:58368
    v_mfma_f32_16x16x32_bf16 v[56:59], v[8:11], v[44:47], v[56:59]
    ds_read_b128 v[112:115], v85 offset:32768
    s_waitcnt lgkmcnt(9)
    v_mfma_f32_16x16x32_bf16 v[52:55], v[12:15], v[40:43], v[52:55]
    ds_read_b64_tr_b16 v[32:33], v96 offset:57344
    ds_read_b64_tr_b16 v[34:35], v96 offset:58368
    v_mfma_f32_16x16x32_bf16 v[60:63], v[12:15], v[44:47], v[60:63]
    ds_read_b128 v[116:119], v85 offset:34816
    s_cmp_eq_u32 s79, 3
    s_cbranch_scc0 M_st_72
    s_add_u32 s96, s76, 20480
    s_add_u32 s96, s96, s78
    buffer_store_dwordx4 v[236:239], v2, s[32:35], s96 offen sc1
M_st_72:
    s_waitcnt lgkmcnt(10)
    v_mfma_f32_16x16x32_bf16 v[64:67], v[40:43], v[16:19], v[64:67]
    ds_read_b64_tr_b16 v[36:37], v97 offset:57344
    ds_read_b64_tr_b16 v[38:39], v97 offset:58368
    v_mfma_f32_16x16x32_bf16 v[68:71], v[44:47], v[16:19], v[68:71]
    s_waitcnt lgkmcnt(10)
    v_mfma_f32_16x16x32_bf16 v[72:75], v[40:43], v[20:23], v[72:75]
    ds_read_b64_tr_b16 v[8:9], v98 offset:57344
    ds_read_b64_tr_b16 v[10:11], v98 offset:58368
    v_mfma_f32_16x16x32_bf16 v[76:79], v[44:47], v[20:23], v[76:79]
    s_setprio 0
    s_waitcnt lgkmcnt(4)
    v_mfma_f32_16x16x32_bf16 v[128:131], v[24:27], v[112:115], v[128:131]
    ds_read_b64_tr_b16 v[12:13], v99 offset:57344
    ds_read_b64_tr_b16 v[14:15], v99 offset:58368
    v_mfma_f32_16x16x32_bf16 v[136:139], v[24:27], v[116:119], v[136:139]
    s_cmp_eq_u32 s79, 3
    s_cbranch_scc0 M_st_73
    s_add_u32 s96, s76, 16384
    s_add_u32 s96, s96, s77
    buffer_store_dwordx4 v[240:243], v2, s[32:35], s96 offen sc1
M_st_73:
    v_mfma_f32_16x16x32_bf16 v[132:135], v[28:31], v[112:115], v[132:135]
    ds_read_b64_tr_b16 v[16:17], v100 offset:57344
    ds_read_b64_tr_b16 v[18:19], v100 offset:58368
    v_mfma_f32_16x16x32_bf16 v[140:143], v[28:31], v[116:119], v[140:143]
    v_mfma_f32_16x16x32_bf16 v[144:147], v[32:35], v[112:115], v[144:147]
    ds_read_b64_tr_b16 v[20:21], v101 offset:57344
    ds_read_b64_tr_b16 v[22:23], v101 offset:58368
    v_mfma_f32_16x16x32_bf16 v[152:155], v[32:35], v[116:119], v[152:155]
    s_waitcnt lgkmcnt(8)
    v_mfma_f32_16x16x32_bf16 v[148:151], v[36:39], v[112:115], v[148:151]
    ds_read_b64_tr_b16 v[24:25], v102 offset:28672
    ds_read_b64_tr_b16 v[26:27], v102 offset:29184
    v_mfma_f32_16x16x32_bf16 v[156:159], v[36:39], v[116:119], v[156:159]
    s_cmp_eq_u32 s79, 3
    s_cbranch_scc0 M_st_74
    s_add_u32 s96, s76, 16384
    s_add_u32 s96, s96, s77
    s_add_u32 s96, s96, s78
    buffer_store_dwordx4 v[244:247], v2, s[32:35], s96 offen sc1
M_st_74:
    s_waitcnt lgkmcnt(8)
    v_mfma_f32_16x16x32_bf16 v[160:163], v[8:11], v[112:115], v[160:163]
    ds_read_b64_tr_b16 v[28:29], v103 offset:28672
    ds_read_b64_tr_b16 v[30:31], v103 offset:29184
    v_mfma_f32_16x16x32_bf16 v[168:171], v[8:11], v[116:119], v[168:171]
    s_waitcnt lgkmcnt(8)
    v_mfma_f32_16x16x32_bf16 v[164:167], v[12:15], v[112:115], v[164:167]
    ds_read_b64_tr_b16 v[32:33], v104 offset:28672
    ds_read_b64_tr_b16 v[34:35], v104 offset:29184
    v_mfma_f32_16x16x32_bf16 v[172:175], v[12:15], v[116:119], v[172:175]
    s_waitcnt lgkmcnt(8)
    v_mfma_f32_16x16x32_bf16 v[176:179], v[16:19], v[112:115], v[176:179]
    ds_read_b64_tr_b16 v[36:37], v105 offset:28672
    ds_read_b64_tr_b16 v[38:39], v105 offset:29184
    v_mfma_f32_16x16x32_bf16 v[184:187], v[16:19], v[116:119], v[184:187]
    s_cmp_eq_u32 s79, 3
    s_cbranch_scc0 M_st_75
    s_add_u32 s96, s76, 20480
    s_add_u32 s96, s96, s77
    buffer_store_dwordx4 v[248:251], v2, s[32:35], s96 offen sc1
M_st_75:
    s_waitcnt lgkmcnt(8)
    v_mfma_f32_16x16x32_bf16 v[180:183], v[20:23], v[112:115], v[180:183]
    v_mfma_f32_16x16x32_bf16 v[188:191], v[20:23], v[116:119], v[188:191]
    s_waitcnt lgkmcnt(6)
    v_mfma_f32_16x16x32_bf16 v[48:51], v[24:27], v[112:115], v[48:51]
    v_mfma_f32_16x16x32_bf16 v[56:59], v[24:27], v[116:119], v[56:59]
    s_waitcnt lgkmcnt(4)
    v_mfma_f32_16x16x32_bf16 v[52:55], v[28:31], v[112:115], v[52:55]
    v_mfma_f32_16x16x32_bf16 v[60:63], v[28:31], v[116:119], v[60:63]
    s_cmp_eq_u32 s79, 3
    s_cbranch_scc0 M_st_76
    s_add_u32 s96, s76, 20480
    s_add_u32 s96, s96, s77
    s_add_u32 s96, s96, s78
    buffer_store_dwordx4 v[252:255], v2, s[32:35], s96 offen sc1
M_st_76:
    s_waitcnt lgkmcnt(2)
    v_mfma_f32_16x16x32_bf16 v[64:67], v[112:115], v[32:35], v[64:67]
    v_mfma_f32_16x16x32_bf16 v[68:71], v[116:119], v[32:35], v[68:71]
    s_waitcnt lgkmcnt(0)
    v_mfma_f32_16x16x32_bf16 v[72:75], v[112:115], v[36:39], v[72:75]
    v_mfma_f32_16x16x32_bf16 v[76:79], v[116:119], v[36:39], v[76:79]
    s_setprio 0
    s_mov_b32 s20, s14
    s_mov_b32 s21, s15
    s_mov_b32 s22, 0x1000000
    s_mov_b32 s23, 0x00020000
    s_add_u32 s24, s14, 0x1000000
    s_addc_u32 s25, s15, 0
    s_mov_b32 s26, 0x1000000
    s_mov_b32 s27, 0x00020000
    s_add_u32 s28, s14, 0x2000000
    s_addc_u32 s29, s15, 0
    s_mov_b32 s30, 0x1000000
    s_mov_b32 s31, 0x00020000
    s_mul_i32 s49, s75, 57344
    s_lshl_b32 s63, s59, 11
    s_add_u32 s49, s49, s63
    s_lshl_b32 s43, s59, 17
    s_lshl_b32 s63, s75, 11
    s_add_u32 s43, s43, s63
    s_mov_b32 s63, 0x3e0293ee
    v_mov_b32 v120, s63
    v_mul_f32 v128, v128, v120
    v_mul_f32 v129, v129, v120
    v_mul_f32 v130, v130, v120
    v_mul_f32 v131, v131, v120
    v_mul_f32 v132, v132, v120
    v_mul_f32 v133, v133, v120
    v_mul_f32 v134, v134, v120
    v_mul_f32 v135, v135, v120
    v_mul_f32 v136, v136, v120
    v_mul_f32 v137, v137, v120
    v_mul_f32 v138, v138, v120
    v_mul_f32 v139, v139, v120
    v_mul_f32 v140, v140, v120
    v_mul_f32 v141, v141, v120
    v_mul_f32 v142, v142, v120
    v_mul_f32 v143, v143, v120
    v_mul_f32 v144, v144, v120
    v_mul_f32 v145, v145, v120
    v_mul_f32 v146, v146, v120
    v_mul_f32 v147, v147, v120
    v_mul_f32 v148, v148, v120
    v_mul_f32 v149, v149, v120
    v_mul_f32 v150, v150, v120
    v_mul_f32 v151, v151, v120
    v_mul_f32 v152, v152, v120
    v_mul_f32 v153, v153, v120
    v_mul_f32 v154, v154, v120
    v_mul_f32 v155, v155, v120
    v_mul_f32 v156, v156, v120
    v_mul_f32 v157, v157, v120
    v_mul_f32 v158, v158, v120
    v_mul_f32 v159, v159, v120
    v_mul_f32 v160, v160, v120
    v_mul_f32 v161, v161, v120
    v_mul_f32 v162, v162, v120
    v_mul_f32 v163, v163, v120
    v_mul_f32 v164, v164, v120
    v_mul_f32 v165, v165, v120
    v_mul_f32 v166, v166, v120
    v_mul_f32 v167, v167, v120
    v_mul_f32 v168, v168, v120
    v_mul_f32 v169, v169, v120
    v_mul_f32 v170, v170, v120
    v_mul_f32 v171, v171, v120
    v_mul_f32 v172, v172, v120
    v_mul_f32 v173, v173, v120
    v_mul_f32 v174, v174, v120
    v_mul_f32 v175, v175, v120
    v_mul_f32 v176, v176, v120
    v_mul_f32 v177, v177, v120
    v_mul_f32 v178, v178, v120
    v_mul_f32 v179, v179, v120
    v_mul_f32 v180, v180, v120
    v_mul_f32 v181, v181, v120
    v_mul_f32 v182, v182, v120
    v_mul_f32 v183, v183, v120
    v_mul_f32 v184, v184, v120
    v_mul_f32 v185, v185, v120
    v_mul_f32 v186, v186, v120
    v_mul_f32 v187, v187, v120
    v_mul_f32 v188, v188, v120
    v_mul_f32 v189, v189, v120
    v_mul_f32 v190, v190, v120
    v_mul_f32 v191, v191, v120
    v_mov_b32 v224, v48
    v_mov_b32 v225, v49
    v_mov_b32 v226, v50
    v_mov_b32 v227, v51
    v_mov_b32 v228, v52
    v_mov_b32 v229, v53
    v_mov_b32 v230, v54
    v_mov_b32 v231, v55
    v_mov_b32 v232, v56
    v_mov_b32 v233, v57
    v_mov_b32 v234, v58
    v_mov_b32 v235, v59
    v_mov_b32 v236, v60
    v_mov_b32 v237, v61
    v_mov_b32 v238, v62
    v_mov_b32 v239, v63
    v_mov_b32 v240, v64
    v_mov_b32 v241, v65
    v_mov_b32 v242, v66
    v_mov_b32 v243, v67
    v_mov_b32 v244, v68
    v_mov_b32 v245, v69
    v_mov_b32 v246, v70
    v_mov_b32 v247, v71
    v_mov_b32 v248, v72
    v_mov_b32 v249, v73
    v_mov_b32 v250, v74
    v_mov_b32 v251, v75
    v_mov_b32 v252, v76
    v_mov_b32 v253, v77
    v_mov_b32 v254, v78
    v_mov_b32 v255, v79
    v_cvt_pk_bf16_f32 v32, v128, v129
    v_cvt_pk_bf16_f32 v33, v130, v131
    v_cvt_pk_bf16_f32 v34, v132, v133
    v_cvt_pk_bf16_f32 v35, v134, v135
    v_cvt_pk_bf16_f32 v36, v136, v137
    v_cvt_pk_bf16_f32 v37, v138, v139
    v_cvt_pk_bf16_f32 v38, v140, v141
    v_cvt_pk_bf16_f32 v39, v142, v143
    v_cvt_pk_bf16_f32 v40, v144, v145
    v_cvt_pk_bf16_f32 v41, v146, v147
    v_cvt_pk_bf16_f32 v42, v148, v149
    v_cvt_pk_bf16_f32 v43, v150, v151
    v_cvt_pk_bf16_f32 v44, v152, v153
    v_cvt_pk_bf16_f32 v45, v154, v155
    v_cvt_pk_bf16_f32 v46, v156, v157
    v_cvt_pk_bf16_f32 v47, v158, v159
    v_cvt_pk_bf16_f32 v48, v160, v161
    v_cvt_pk_bf16_f32 v49, v162, v163
    v_cvt_pk_bf16_f32 v50, v164, v165
    v_cvt_pk_bf16_f32 v51, v166, v167
    v_cvt_pk_bf16_f32 v52, v168, v169
    v_cvt_pk_bf16_f32 v53, v170, v171
    v_cvt_pk_bf16_f32 v54, v172, v173
    v_cvt_pk_bf16_f32 v55, v174, v175
    v_cvt_pk_bf16_f32 v56, v176, v177
    v_cvt_pk_bf16_f32 v57, v178, v179
    v_cvt_pk_bf16_f32 v58, v180, v181
    v_cvt_pk_bf16_f32 v59, v182, v183
    v_cvt_pk_bf16_f32 v60, v184, v185
    v_cvt_pk_bf16_f32 v61, v186, v187
    v_cvt_pk_bf16_f32 v62, v188, v189
    v_cvt_pk_bf16_f32 v63, v190, v191
    v_mov_b32 v16, 0
    v_mov_b32 v17, 0
    v_mov_b32 v18, 0
    v_mov_b32 v19, 0
    v_mov_b32 v20, 0
    v_mov_b32 v21, 0
    v_mov_b32 v22, 0
    v_mov_b32 v23, 0
    v_add_u32 v3, 131072, v2
    s_lshl_b32 s63, s58, 13
    s_add_u32 s63, s63, 65536
    v_add_u32 v15, s63, v2
    s_cmp_eq_u32 s79, 3
    s_cbranch_scc1 M_w3
    s_waitcnt vmcnt(0)
M_w3:
    s_waitcnt vmcnt(7)
    s_barrier
    ds_read_b128 v[64:67], v3 offset:0
    ds_read_b128 v[68:71], v3 offset:1024
    ds_read_b128 v[72:75], v3 offset:2048
    ds_read_b128 v[76:79], v3 offset:3072
    ds_read_b128 v[80:83], v3 offset:4096
    ds_read_b128 v[84:87], v3 offset:5120
    ds_read_b128 v[88:91], v3 offset:6144
    s_mov_b32 s62, -1
    s_add_u32 s63, s62, 1
    s_mov_b32 s100, -16
    s_sub_u32 s96, s63, s61
    s_add_u32 s96, s96, 2
    s_cmp_lt_u32 s96, 2
    s_cselect_b32 s97, s57, 0
    s_lshl_b32 s96, s96, 1
    s_sub_u32 s96, s96, s58
    s_lshl_b32 s96, s96, 1
    s_cmp_eq_u32 s97, 1
    s_cselect_b32 s100, s96, s100
    s_lshl_b32 s96, s57, 1
    s_sub_u32 s96, s96, s58
    s_lshl_b32 s96, s96, 1
    s_cmp_eq_u32 s63, 16
    s_cselect_b32 s100, s96, s100
    s_cmp_eq_u32 s63, s61
    s_cselect_b32 s101, s57, 0
    s_cmp_eq_u32 s63, 0
    s_cselect_b32 s101, 1, s101
    s_waitcnt lgkmcnt(6)
    v_mfma_f32_16x16x32_bf16 v[96:99], v[64:67], v[32:35], v[16:19]
    ds_read_b128 v[92:95], v3 offset:7168
    v_mfma_f32_16x16x32_bf16 v[104:107], v[64:67], v[36:39], v[20:23]
    s_lshl_b32 s48, s2, 3
    s_add_u32 s48, s48, s56
    s_lshl_b32 s48, s48, 10
    s_cmp_ge_u32 s61, 8
    s_cselect_b32 s50, 49152, 0
    s_cselect_b32 s63, 0, 65536
    s_add_u32 s50, s50, s63
    s_lshr_b32 s16, s2, 1
    s_lshl_b32 s16, s16, 10
    s_and_b32 s63, s2, 1
    s_lshl_b32 s63, s63, 9
    s_add_u32 s16, s16, s63
    v_and_b32 v9, 15, v1
    v_lshrrev_b32 v10, 4, v1
    v_lshlrev_b32 v193, 2, v10
    v_sub_u32 v193, v9, v193
    s_mov_b32 s17, 0xbdd2d3e8
    v_mov_b32 v192, 0xc0135761
    v_lshlrev_b32 v9, 4, v9
    v_lshlrev_b32 v12, 9, v10
    v_add_u32 v12, v12, v9
    v_mov_b32 v5, 0
    v_mov_b32 v6, 0
    v_mov_b32 v11, 1.0
    v_mov_b32 v7, 1.0
    v_mov_b32 v13, 0xff800000
    s_mov_b32 s98, 0
    v_mul_f32 v160, v224, v224
    v_mul_f32 v161, v225, v225
    v_mul_f32 v162, v226, v226
    v_mul_f32 v163, v227, v227
    s_waitcnt lgkmcnt(6)
    v_mfma_f32_16x16x32_bf16 v[96:99], v[68:71], v[40:43], v[96:99]
    ds_read_b128 v[64:67], v3 offset:8192
    v_mfma_f32_16x16x32_bf16 v[104:107], v[68:71], v[44:47], v[104:107]
    v_mul_f32 v164, v228, v228
    v_mul_f32 v165, v229, v229
    v_mul_f32 v166, v230, v230
    v_mul_f32 v167, v231, v231
    v_mul_f32 v168, v232, v232
    v_mul_f32 v169, v233, v233
    v_mul_f32 v170, v234, v234
    v_mul_f32 v171, v235, v235
    s_waitcnt lgkmcnt(6)
    v_mfma_f32_16x16x32_bf16 v[96:99], v[72:75], v[48:51], v[96:99]
    ds_read_b128 v[68:71], v3 offset:9216
    v_mfma_f32_16x16x32_bf16 v[104:107], v[72:75], v[52:55], v[104:107]
    v_mul_f32 v172, v236, v236
    v_mul_f32 v173, v237, v237
    v_mul_f32 v174, v238, v238
    v_mul_f32 v175, v239, v239
    v_mul_f32 v176, v240, v240
    v_mul_f32 v177, v241, v241
    v_mul_f32 v178, v242, v242
    v_mul_f32 v179, v243, v243
    s_waitcnt lgkmcnt(6)
    v_mfma_f32_16x16x32_bf16 v[96:99], v[76:79], v[56:59], v[96:99]
    ds_read_b128 v[72:75], v3 offset:10240
    v_mfma_f32_16x16x32_bf16 v[104:107], v[76:79], v[60:63], v[104:107]
    v_mul_f32 v180, v244, v244
    v_mul_f32 v181, v245, v245
    v_mul_f32 v182, v246, v246
    v_mul_f32 v183, v247, v247
    v_mul_f32 v184, v248, v248
    v_mul_f32 v185, v249, v249
    v_mul_f32 v186, v250, v250
    v_mul_f32 v187, v251, v251
    v_mul_f32 v188, v252, v252
    s_waitcnt lgkmcnt(6)
    v_mfma_f32_16x16x32_bf16 v[100:103], v[80:83], v[32:35], v[16:19]
    ds_read_b128 v[76:79], v3 offset:11264
    v_mfma_f32_16x16x32_bf16 v[108:111], v[80:83], v[36:39], v[20:23]
    v_mul_f32 v189, v253, v253
    v_mul_f32 v190, v254, v254
    v_mul_f32 v191, v255, v255
    v_fma_f32 v160, v160, s17, v192
    v_fma_f32 v161, v161, s17, v192
    v_fma_f32 v162, v162, s17, v192
    v_fma_f32 v163, v163, s17, v192
    v_fma_f32 v164, v164, s17, v192
    s_waitcnt lgkmcnt(6)
    v_mfma_f32_16x16x32_bf16 v[100:103], v[84:87], v[40:43], v[100:103]
    ds_read_b128 v[80:83], v3 offset:12288
    v_mfma_f32_16x16x32_bf16 v[108:111], v[84:87], v[44:47], v[108:111]
    v_fma_f32 v165, v165, s17, v192
    v_fma_f32 v166, v166, s17, v192
    v_fma_f32 v167, v167, s17, v192
    v_fma_f32 v168, v168, s17, v192
    v_fma_f32 v169, v169, s17, v192
    v_fma_f32 v170, v170, s17, v192
    v_fma_f32 v171, v171, s17, v192
    v_fma_f32 v172, v172, s17, v192
    s_waitcnt lgkmcnt(6)
    v_mfma_f32_16x16x32_bf16 v[100:103], v[88:91], v[48:51], v[100:103]
    ds_read_b128 v[84:87], v3 offset:13312
    v_mfma_f32_16x16x32_bf16 v[108:111], v[88:91], v[52:55], v[108:111]
    v_fma_f32 v173, v173, s17, v192
    v_fma_f32 v174, v174, s17, v192
    v_fma_f32 v175, v175, s17, v192
    v_fma_f32 v176, v176, s17, v192
    v_fma_f32 v177, v177, s17, v192
    v_fma_f32 v178, v178, s17, v192
    v_fma_f32 v179, v179, s17, v192
    v_fma_f32 v180, v180, s17, v192
    v_fma_f32 v181, v181, s17, v192
    s_waitcnt lgkmcnt(6)
    v_mfma_f32_16x16x32_bf16 v[100:103], v[92:95], v[56:59], v[100:103]
    ds_read_b128 v[88:91], v3 offset:14336
    v_mfma_f32_16x16x32_bf16 v[108:111], v[92:95], v[60:63], v[108:111]
    v_fma_f32 v182, v182, s17, v192
    v_fma_f32 v183, v183, s17, v192
    v_fma_f32 v184, v184, s17, v192
    v_fma_f32 v185, v185, s17, v192
    v_fma_f32 v186, v186, s17, v192
    v_fma_f32 v187, v187, s17, v192
    v_fma_f32 v188, v188, s17, v192
    v_fma_f32 v189, v189, s17, v192
    s_waitcnt lgkmcnt(6)
    v_mfma_f32_16x16x32_bf16 v[112:115], v[64:67], v[32:35], v[16:19]
    ds_read_b128 v[92:95], v3 offset:15360
    v_mfma_f32_16x16x32_bf16 v[120:123], v[64:67], v[36:39], v[20:23]
    v_fma_f32 v190, v190, s17, v192
    v_fma_f32 v191, v191, s17, v192
    v_mul_f32 v160, v160, v224
    v_mul_f32 v161, v161, v225
    v_mul_f32 v162, v162, v226
    v_mul_f32 v163, v163, v227
    v_mul_f32 v164, v164, v228
    v_mul_f32 v165, v165, v229
    s_waitcnt lgkmcnt(6)
    v_mfma_f32_16x16x32_bf16 v[112:115], v[68:71], v[40:43], v[112:115]
    v_mfma_f32_16x16x32_bf16 v[120:123], v[68:71], v[44:47], v[120:123]
    v_mul_f32 v166, v166, v230
    v_mul_f32 v167, v167, v231
    v_mul_f32 v168, v168, v232
    v_mul_f32 v169, v169, v233
    v_mul_f32 v170, v170, v234
    v_mul_f32 v171, v171, v235
    v_mul_f32 v172, v172, v236
    v_mul_f32 v173, v173, v237
    v_mul_f32 v174, v174, v238
    s_waitcnt lgkmcnt(5)
    v_mfma_f32_16x16x32_bf16 v[112:115], v[72:75], v[48:51], v[112:115]
    v_mfma_f32_16x16x32_bf16 v[120:123], v[72:75], v[52:55], v[120:123]
    v_mul_f32 v175, v175, v239
    v_mul_f32 v176, v176, v240
    v_mul_f32 v177, v177, v241
    v_mul_f32 v178, v178, v242
    v_mul_f32 v179, v179, v243
    v_mul_f32 v180, v180, v244
    v_mul_f32 v181, v181, v245
    v_mul_f32 v182, v182, v246
    s_waitcnt lgkmcnt(4)
    v_mfma_f32_16x16x32_bf16 v[112:115], v[76:79], v[56:59], v[112:115]
    v_mfma_f32_16x16x32_bf16 v[120:123], v[76:79], v[60:63], v[120:123]
    v_mul_f32 v183, v183, v247
    v_mul_f32 v184, v184, v248
    v_mul_f32 v185, v185, v249
    v_mul_f32 v186, v186, v250
    v_mul_f32 v187, v187, v251
    v_mul_f32 v188, v188, v252
    v_mul_f32 v189, v189, v253
    v_mul_f32 v190, v190, v254
    s_waitcnt lgkmcnt(3)
    v_mfma_f32_16x16x32_bf16 v[116:119], v[80:83], v[32:35], v[16:19]
    v_mfma_f32_16x16x32_bf16 v[124:127], v[80:83], v[36:39], v[20:23]
    v_mul_f32 v191, v191, v255
    v_exp_f32 v160, v160
    v_exp_f32 v161, v161
    v_exp_f32 v162, v162
    v_exp_f32 v163, v163
    v_exp_f32 v164, v164
    v_exp_f32 v165, v165
    v_exp_f32 v166, v166
    v_exp_f32 v167, v167
    s_waitcnt lgkmcnt(2)
    v_mfma_f32_16x16x32_bf16 v[116:119], v[84:87], v[40:43], v[116:119]
    v_mfma_f32_16x16x32_bf16 v[124:127], v[84:87], v[44:47], v[124:127]
    v_exp_f32 v168, v168
    v_exp_f32 v169, v169
    v_exp_f32 v170, v170
    v_exp_f32 v171, v171
    v_exp_f32 v172, v172
    v_exp_f32 v173, v173
    v_exp_f32 v174, v174
    v_exp_f32 v175, v175
    s_waitcnt lgkmcnt(1)
    v_mfma_f32_16x16x32_bf16 v[116:119], v[88:91], v[48:51], v[116:119]
    v_mfma_f32_16x16x32_bf16 v[124:127], v[88:91], v[52:55], v[124:127]
    v_exp_f32 v176, v176
    v_exp_f32 v177, v177
    v_exp_f32 v178, v178
    v_exp_f32 v179, v179
    v_exp_f32 v180, v180
    v_exp_f32 v181, v181
    v_exp_f32 v182, v182
    v_exp_f32 v183, v183
    s_waitcnt lgkmcnt(0)
    v_mfma_f32_16x16x32_bf16 v[116:119], v[92:95], v[56:59], v[116:119]
    v_mfma_f32_16x16x32_bf16 v[124:127], v[92:95], v[60:63], v[124:127]
    v_exp_f32 v184, v184
    v_exp_f32 v185, v185
    v_exp_f32 v186, v186
    v_exp_f32 v187, v187
    v_exp_f32 v188, v188
    v_exp_f32 v189, v189
    v_exp_f32 v190, v190
    v_exp_f32 v191, v191
    s_cmp_eq_u32 s57, 0
    s_cbranch_scc0 A_noqx
    ds_write_b128 v15, v[32:35] offset:0
    ds_write_b128 v15, v[36:39] offset:1024
    ds_write_b128 v15, v[40:43] offset:2048
    ds_write_b128 v15, v[44:47] offset:3072
    ds_write_b128 v15, v[48:51] offset:4096
    ds_write_b128 v15, v[52:55] offset:5120
    ds_write_b128 v15, v[56:59] offset:6144
    ds_write_b128 v15, v[60:63] offset:7168
A_noqx:
    s_lshl_b32 s9, s56, 12
    s_lshl_b32 s45, s57, 14
    s_lshr_b32 s19, s9, 1
    s_add_u32 s18, s99, s19
    s_add_u32 s18, s18, 16384
    s_mov_b32 s32, 2
    s_mov_b32 s12, 0
    s_mov_b32 s13, 0
    s_lshl_b32 s44, 15, s61
    s_lshr_b32 s44, s44, 3
    s_cmp_eq_u32 s57, 0
    s_cselect_b32 s44, 0, s44
    s_or_b32 s44, s44, 32769
    s_waitcnt lgkmcnt(0)
    s_barrier
    s_mov_b32 s62, 0
    s_mov_b32 s33, s18
    s_mov_b32 s34, s19
    s_mov_b32 s35, s32
    s_mov_b32 s8, s13
    s_mov_b32 s13, s12
    s_add_u32 s63, s62, 2
    s_lshl_b32 s96, s63, 1
    s_sub_u32 s96, s96, s61
    s_lshr_b32 s19, s9, 1
    s_cmp_ge_u32 s63, s61
    s_cselect_b32 s96, s96, s63
    s_cselect_b32 s19, s9, s19
    s_cselect_b32 s32, 4, 2
    s_cselect_b32 s12, s45, 0
    s_lshl_b32 s96, s96, 14
    s_add_u32 s18, s96, s19
    s_add_u32 s18, s18, s99
    s_cmp_gt_u32 s63, 16
    s_cselect_b32 s32, 0, s32
    v_add_u32 v3, 98304, v2
    ds_read_b128 v[64:67], v3 offset:0
    ds_read_b128 v[68:71], v3 offset:1024
    ds_read_b128 v[72:75], v3 offset:2048
    ds_read_b128 v[76:79], v3 offset:3072
    ds_read_b128 v[80:83], v3 offset:4096
    ds_read_b128 v[84:87], v3 offset:5120
    ds_read_b128 v[88:91], v3 offset:6144
    s_add_u32 m0, s19, 131072
    s_cmp_le_u32 s32, 0
    s_cbranch_scc1 A_d_94
    buffer_load_dwordx4 v2, s[20:23], s18 offen offset:0 sc1 lds
A_d_94:
    s_add_u32 m0, s19, 131072
    s_cmp_le_u32 s32, 1
    s_cbranch_scc1 A_d_95
    buffer_load_dwordx4 v2, s[20:23], s18 offen offset:1024 sc1 lds
A_d_95:
    s_add_u32 m0, s19, 131072
    s_cmp_le_u32 s32, 2
    s_cbranch_scc1 A_d_96
    buffer_load_dwordx4 v2, s[20:23], s18 offen offset:2048 sc1 lds
A_d_96:
    s_cmp_ge_i32 s100, -3
    s_cbranch_scc0 A_pm_97
    v_and_b32 v9, 15, v1
    v_lshrrev_b32 v10, 4, v1
    v_lshlrev_b32 v10, 2, v10
    s_lshl_b32 s63, s100, 4
    v_sub_u32 v9, v9, v10
    v_subrev_u32 v9, s63, v9
    v_cmp_le_i32 s[64:65], -16, v9
    v_cmp_le_i32 s[66:67], -15, v9
    v_cmp_le_i32 s[68:69], -14, v9
    v_cmp_le_i32 s[70:71], -13, v9
    v_cmp_le_i32 s[72:73], 0, v9
    v_cmp_le_i32 s[74:75], 1, v9
    v_cmp_le_i32 s[76:77], 2, v9
    v_cmp_le_i32 s[78:79], 3, v9
    v_cmp_le_i32 s[80:81], 16, v9
    v_cmp_le_i32 s[82:83], 17, v9
    v_cmp_le_i32 s[84:85], 18, v9
    v_cmp_le_i32 s[86:87], 19, v9
    v_cmp_le_i32 s[88:89], 32, v9
    v_cmp_le_i32 s[90:91], 33, v9
    v_cmp_le_i32 s[92:93], 34, v9
    v_cmp_le_i32 s[94:95], 35, v9
    v_cndmask_b32 v104, v13, v104, s[64:65]
    v_cndmask_b32 v105, v13, v105, s[66:67]
    v_cndmask_b32 v106, v13, v106, s[68:69]
    v_cndmask_b32 v107, v13, v107, s[70:71]
    v_cmp_le_i32 s[64:65], 48, v9
    v_cmp_le_i32 s[66:67], 49, v9
    v_cmp_le_i32 s[68:69], 50, v9
    v_cmp_le_i32 s[70:71], 51, v9
    v_cndmask_b32 v96, v13, v96, s[72:73]
    v_cndmask_b32 v97, v13, v97, s[74:75]
    v_cndmask_b32 v98, v13, v98, s[76:77]
    v_cndmask_b32 v99, v13, v99, s[78:79]
    v_cndmask_b32 v108, v13, v108, s[72:73]
    v_cndmask_b32 v109, v13, v109, s[74:75]
    v_cndmask_b32 v110, v13, v110, s[76:77]
    v_cndmask_b32 v111, v13, v111, s[78:79]
    v_cndmask_b32 v100, v13, v100, s[80:81]
    v_cndmask_b32 v101, v13, v101, s[82:83]
    v_cndmask_b32 v102, v13, v102, s[84:85]
    v_cndmask_b32 v103, v13, v103, s[86:87]
    v_cndmask_b32 v120, v13, v120, s[80:81]
    v_cndmask_b32 v121, v13, v121, s[82:83]
    v_cndmask_b32 v122, v13, v122, s[84:85]
    v_cndmask_b32 v123, v13, v123, s[86:87]
    v_cndmask_b32 v112, v13, v112, s[88:89]
    v_cndmask_b32 v113, v13, v113, s[90:91]
    v_cndmask_b32 v114, v13, v114, s[92:93]
    v_cndmask_b32 v115, v13, v115, s[94:95]
    v_cndmask_b32 v124, v13, v124, s[88:89]
    v_cndmask_b32 v125, v13, v125, s[90:91]
    v_cndmask_b32 v126, v13, v126, s[92:93]
    v_cndmask_b32 v127, v13, v127, s[94:95]
    v_cndmask_b32 v116, v13, v116, s[64:65]
    v_cndmask_b32 v117, v13, v117, s[66:67]
    v_cndmask_b32 v118, v13, v118, s[68:69]
    v_cndmask_b32 v119, v13, v119, s[70:71]
A_pm_97:
    v_max3_f32 v8, v96, v97, v98
    v_max3_f32 v8, v8, v99, v100
    v_max3_f32 v8, v8, v101, v102
    v_max3_f32 v8, v8, v103, v104
    v_max3_f32 v8, v8, v105, v106
    v_max3_f32 v8, v8, v107, v108
    v_max3_f32 v8, v8, v109, v110
    v_max3_f32 v14, v111, v112, v113
    v_max3_f32 v14, v14, v114, v115
    v_max3_f32 v14, v14, v116, v117
    v_max3_f32 v14, v14, v118, v119
    v_max3_f32 v14, v14, v120, v121
    v_max3_f32 v14, v14, v122, v123
    v_max3_f32 v14, v14, v124, v125
    v_max3_f32 v14, v14, v126, v127
    v_max_f32 v8, v8, v14
    v_cmp_lt_f32 vcc, 0x41000000, v8
    s_cmp_eq_u32 s101, 1
    s_cbranch_scc1 A_slow_98
    s_cbranch_vccnz A_slow_98
A_slowret_99:
    v_exp_f32 v96, v96
    v_exp_f32 v97, v97
    v_exp_f32 v98, v98
    v_exp_f32 v99, v99
    v_cvt_pk_bf16_f32 v96, v96, v97
    v_exp_f32 v100, v100
    v_exp_f32 v101, v101
    v_cvt_pk_bf16_f32 v97, v98, v99
    v_exp_f32 v102, v102
    v_exp_f32 v103, v103
    v_cvt_pk_bf16_f32 v98, v100, v101
    v_exp_f32 v104, v104
    v_exp_f32 v105, v105
    v_cvt_pk_bf16_f32 v99, v102, v103
    v_exp_f32 v106, v106
    v_exp_f32 v107, v107
    v_cvt_pk_bf16_f32 v104, v104, v105
    v_exp_f32 v108, v108
    v_exp_f32 v109, v109
    v_cvt_pk_bf16_f32 v105, v106, v107
    v_exp_f32 v110, v110
    v_exp_f32 v111, v111
    v_cvt_pk_bf16_f32 v106, v108, v109
    s_nop 0
    v_cvt_pk_bf16_f32 v107, v110, v111
    s_cmp_lg_u32 s98, 0
    s_cbranch_scc1 A_resc_102
A_rescret_103:
    s_add_u32 s63, s8, 0
    v_add_u32 v4, s63, v2
    s_waitcnt lgkmcnt(5)
    v_mfma_f32_16x16x32_bf16 v[128:131], v[64:67], v[32:35], v[16:19]
    ds_read_b128 v[92:95], v3 offset:7168
    v_exp_f32 v112, v112
    v_mfma_f32_16x16x32_bf16 v[136:139], v[64:67], v[36:39], v[20:23]
    v_exp_f32 v113, v113
    v_add_f32 v160, 1.0, v160
    v_add_f32 v161, 1.0, v161
    v_add_f32 v162, 1.0, v162
    v_add_f32 v163, 1.0, v163
    v_add_f32 v164, 1.0, v164
    v_add_f32 v165, 1.0, v165
    v_add_f32 v166, 1.0, v166
    v_add_f32 v167, 1.0, v167
    v_mfma_f32_16x16x32_bf16 v[128:131], v[68:71], v[40:43], v[128:131]
    ds_read_b128 v[64:67], v3 offset:8192
    v_exp_f32 v114, v114
    v_mfma_f32_16x16x32_bf16 v[136:139], v[68:71], v[44:47], v[136:139]
    v_exp_f32 v115, v115
    v_add_f32 v168, 1.0, v168
    v_add_f32 v169, 1.0, v169
    v_add_f32 v170, 1.0, v170
    v_add_f32 v171, 1.0, v171
    v_add_f32 v172, 1.0, v172
    v_add_f32 v173, 1.0, v173
    v_add_f32 v174, 1.0, v174
    v_add_f32 v175, 1.0, v175
    s_add_u32 m0, s19, 131072
    s_cmp_le_u32 s32, 3
    s_cbranch_scc1 A_d_105
    buffer_load_dwordx4 v2, s[20:23], s18 offen offset:3072 sc1 lds
A_d_105:
    s_waitcnt lgkmcnt(5)
    v_mfma_f32_16x16x32_bf16 v[128:131], v[72:75], v[48:51], v[128:131]
    ds_read_b128 v[68:71], v3 offset:9216
    v_cvt_pk_bf16_f32 v112, v112, v113
    v_mfma_f32_16x16x32_bf16 v[136:139], v[72:75], v[52:55], v[136:139]
    v_add_f32 v176, 1.0, v176
    v_add_f32 v177, 1.0, v177
    v_add_f32 v178, 1.0, v178
    v_add_f32 v179, 1.0, v179
    v_add_f32 v180, 1.0, v180
    v_add_f32 v181, 1.0, v181
    v_add_f32 v182, 1.0, v182
    v_add_f32 v183, 1.0, v183
    v_mfma_f32_16x16x32_bf16 v[128:131], v[76:79], v[56:59], v[128:131]
    s_setprio 2
    ds_read_b128 v[72:75], v3 offset:10240
    v_exp_f32 v116, v116
    v_mfma_f32_16x16x32_bf16 v[136:139], v[76:79], v[60:63], v[136:139]
    v_exp_f32 v117, v117
    v_add_f32 v184, 1.0, v184
    v_add_f32 v185, 1.0, v185
    v_add_f32 v186, 1.0, v186
    v_add_f32 v187, 1.0, v187
    v_add_f32 v188, 1.0, v188
    v_add_f32 v189, 1.0, v189
    v_add_f32 v190, 1.0, v190
    s_add_u32 m0, s34, 32768
    s_cmp_le_u32 s35, 0
    s_cbranch_scc1 A_d_106
    buffer_load_dwordx4 v2, s[24:27], s33 offen offset:0 sc1 lds
A_d_106:
    s_waitcnt lgkmcnt(5)
    v_mfma_f32_16x16x32_bf16 v[132:135], v[80:83], v[32:35], v[16:19]
    ds_read_b128 v[76:79], v3 offset:11264
    v_cvt_pk_bf16_f32 v113, v114, v115
    v_mfma_f32_16x16x32_bf16 v[140:143], v[80:83], v[36:39], v[20:23]
    v_add_f32 v191, 1.0, v191
    v_rcp_f32 v160, v160
    v_rcp_f32 v161, v161
    v_rcp_f32 v162, v162
    v_rcp_f32 v163, v163
    v_rcp_f32 v164, v164
    v_rcp_f32 v165, v165
    v_rcp_f32 v166, v166
    v_mfma_f32_16x16x32_bf16 v[132:135], v[84:87], v[40:43], v[132:135]
    ds_read_b128 v[80:83], v3 offset:12288
    v_exp_f32 v118, v118
    v_mfma_f32_16x16x32_bf16 v[140:143], v[84:87], v[44:47], v[140:143]
    v_exp_f32 v119, v119
    v_rcp_f32 v167, v167
    v_rcp_f32 v168, v168
    v_rcp_f32 v169, v169
    v_rcp_f32 v170, v170
    v_rcp_f32 v171, v171
    v_rcp_f32 v172, v172
    v_rcp_f32 v173, v173
    v_rcp_f32 v174, v174
    s_add_u32 m0, s34, 32768
    s_cmp_le_u32 s35, 1
    s_cbranch_scc1 A_d_107
    buffer_load_dwordx4 v2, s[24:27], s33 offen offset:1024 sc1 lds
A_d_107:
    s_waitcnt lgkmcnt(5)
    v_mfma_f32_16x16x32_bf16 v[132:135], v[88:91], v[48:51], v[132:135]
    ds_read_b128 v[84:87], v3 offset:13312
    v_cvt_pk_bf16_f32 v114, v116, v117
    v_mfma_f32_16x16x32_bf16 v[140:143], v[88:91], v[52:55], v[140:143]
    v_rcp_f32 v175, v175
    v_rcp_f32 v176, v176
    v_rcp_f32 v177, v177
    v_rcp_f32 v178, v178
    v_rcp_f32 v179, v179
    v_rcp_f32 v180, v180
    v_rcp_f32 v181, v181
    v_rcp_f32 v182, v182
    v_mfma_f32_16x16x32_bf16 v[132:135], v[92:95], v[56:59], v[132:135]
    ds_read_b128 v[88:91], v3 offset:14336
    v_exp_f32 v120, v120
    v_mfma_f32_16x16x32_bf16 v[140:143], v[92:95], v[60:63], v[140:143]
    v_exp_f32 v121, v121
    v_rcp_f32 v183, v183
    v_rcp_f32 v184, v184
    v_rcp_f32 v185, v185
    v_rcp_f32 v186, v186
    v_rcp_f32 v187, v187
    v_rcp_f32 v188, v188
    v_rcp_f32 v189, v189
    s_add_u32 m0, s34, 32768
    s_cmp_le_u32 s35, 2
    s_cbranch_scc1 A_d_108
    buffer_load_dwordx4 v2, s[24:27], s33 offen offset:2048 sc1 lds
A_d_108:
    s_waitcnt lgkmcnt(5)
    v_mfma_f32_16x16x32_bf16 v[144:147], v[64:67], v[32:35], v[16:19]
    ds_read_b128 v[92:95], v3 offset:15360
    v_cvt_pk_bf16_f32 v115, v118, v119
    v_mfma_f32_16x16x32_bf16 v[152:155], v[64:67], v[36:39], v[20:23]
    v_exp_f32 v122, v122
    v_rcp_f32 v190, v190
    v_rcp_f32 v191, v191
    v_mul_f32 v224, v224, v160
    v_mul_f32 v225, v225, v161
    v_mul_f32 v226, v226, v162
    v_mul_f32 v227, v227, v163
    v_mul_f32 v228, v228, v164
    v_mul_f32 v229, v229, v165
    v_mfma_f32_16x16x32_bf16 v[144:147], v[68:71], v[40:43], v[144:147]
    ds_read_b128 v[64:67], v4 offset:0
    v_exp_f32 v123, v123
    v_mfma_f32_16x16x32_bf16 v[152:155], v[68:71], v[44:47], v[152:155]
    v_mul_f32 v230, v230, v166
    v_mul_f32 v231, v231, v167
    v_mul_f32 v232, v232, v168
    v_mul_f32 v233, v233, v169
    v_mul_f32 v234, v234, v170
    v_mul_f32 v235, v235, v171
    v_mul_f32 v236, v236, v172
    v_mul_f32 v237, v237, v173
    s_add_u32 m0, s34, 32768
    s_cmp_le_u32 s35, 3
    s_cbranch_scc1 A_d_109
    buffer_load_dwordx4 v2, s[24:27], s33 offen offset:3072 sc1 lds
A_d_109:
    s_waitcnt lgkmcnt(5)
    v_mfma_f32_16x16x32_bf16 v[144:147], v[72:75], v[48:51], v[144:147]
    ds_read_b128 v[68:71], v4 offset:2048
    v_cvt_pk_bf16_f32 v120, v120, v121
    v_mfma_f32_16x16x32_bf16 v[152:155], v[72:75], v[52:55], v[152:155]
    v_exp_f32 v124, v124
    v_mul_f32 v238, v238, v174
    v_mul_f32 v239, v239, v175
    v_mul_f32 v240, v240, v176
    v_mul_f32 v241, v241, v177
    v_mul_f32 v242, v242, v178
    v_mul_f32 v243, v243, v179
    v_mul_f32 v244, v244, v180
    v_mul_f32 v245, v245, v181
    v_mfma_f32_16x16x32_bf16 v[144:147], v[76:79], v[56:59], v[144:147]
    s_setprio 1
    ds_read_b128 v[72:75], v4 offset:4096
    v_exp_f32 v125, v125
    v_mfma_f32_16x16x32_bf16 v[152:155], v[76:79], v[60:63], v[152:155]
    v_mul_f32 v246, v246, v182
    v_mul_f32 v247, v247, v183
    v_mul_f32 v248, v248, v184
    v_mul_f32 v249, v249, v185
    v_mul_f32 v250, v250, v186
    v_mul_f32 v251, v251, v187
    v_mul_f32 v252, v252, v188
    s_waitcnt lgkmcnt(5)
    v_mfma_f32_16x16x32_bf16 v[148:151], v[80:83], v[32:35], v[16:19]
    ds_read_b128 v[76:79], v4 offset:6144
    v_cvt_pk_bf16_f32 v121, v122, v123
    v_mfma_f32_16x16x32_bf16 v[156:159], v[80:83], v[36:39], v[20:23]
    v_exp_f32 v126, v126
    v_mul_f32 v253, v253, v189
    v_mul_f32 v254, v254, v190
    v_mul_f32 v255, v255, v191
    v_cvt_pk_bf16_f32 v231, v230, v231
    v_cvt_pk_bf16_f32 v230, v228, v229
    v_cvt_pk_bf16_f32 v229, v226, v227
    v_cvt_pk_bf16_f32 v228, v224, v225
    v_mov_b32 v224, 0x3f803f80
    v_mfma_f32_16x16x32_bf16 v[148:151], v[84:87], v[40:43], v[148:151]
    ds_read_b128 v[80:83], v4 offset:8192
    v_exp_f32 v127, v127
    v_mfma_f32_16x16x32_bf16 v[156:159], v[84:87], v[44:47], v[156:159]
    v_mov_b32 v225, 0x3f803f80
    v_mov_b32 v226, 0x3f803f80
    v_mov_b32 v227, 0x3f803f80
    v_cvt_pk_bf16_f32 v232, v232, v233
    v_cvt_pk_bf16_f32 v233, v234, v235
    v_cvt_pk_bf16_f32 v234, v236, v237
    v_cvt_pk_bf16_f32 v235, v238, v239
    v_cvt_pk_bf16_f32 v240, v240, v241
    s_waitcnt lgkmcnt(5)
    v_mfma_f32_16x16x32_bf16 v[148:151], v[88:91], v[48:51], v[148:151]
    ds_read_b128 v[84:87], v4 offset:10240
    v_cvt_pk_bf16_f32 v122, v124, v125
    v_mfma_f32_16x16x32_bf16 v[156:159], v[88:91], v[52:55], v[156:159]
    s_nop 0
    v_cvt_pk_bf16_f32 v241, v242, v243
    v_cvt_pk_bf16_f32 v242, v244, v245
    v_cvt_pk_bf16_f32 v243, v246, v247
    v_cvt_pk_bf16_f32 v248, v248, v249
    v_cvt_pk_bf16_f32 v249, v250, v251
    v_cvt_pk_bf16_f32 v250, v252, v253
    v_cvt_pk_bf16_f32 v251, v254, v255
    v_lshrrev_b32 v237, 4, v1
    v_mfma_f32_16x16x32_bf16 v[148:151], v[92:95], v[56:59], v[148:151]
    ds_read_b128 v[88:91], v4 offset:12288
    v_cvt_pk_bf16_f32 v123, v126, v127
    v_mfma_f32_16x16x32_bf16 v[156:159], v[92:95], v[60:63], v[156:159]
    v_and_b32 v238, 15, v1
    v_lshlrev_b32 v238, 4, v238
    v_and_b32 v236, 1, v237
    v_lshlrev_b32 v236, 10, v236
    v_lshrrev_b32 v237, 1, v237
    v_lshlrev_b32 v237, 9, v237
    v_add3_u32 v236, v236, v237, v238
    s_bitcmp1_b32 s44, s62
    s_cbranch_scc1 A_evb_110
A_evbret_111:
    s_waitcnt lgkmcnt(5)
    v_mfma_f32_16x16x32_bf16 v[160:163], v[64:67], v[96:99], 0
    ds_read_b128 v[92:95], v4 offset:14336
    v_max3_f32 v8, v128, v129, v130
    v_max3_f32 v8, v8, v131, v132
    v_mfma_f32_16x16x32_bf16 v[168:171], v[64:67], v[104:107], 0
    v_max3_f32 v8, v8, v133, v134
    v_max3_f32 v8, v8, v135, v136
    v_mfma_f32_16x16x32_bf16 v[164:167], v[68:71], v[96:99], 0
    ds_read_b128 v[64:67], v4 offset:1024
    v_max3_f32 v8, v8, v137, v138
    v_mfma_f32_16x16x32_bf16 v[172:175], v[68:71], v[104:107], 0
    v_max3_f32 v8, v8, v139, v140
    v_max3_f32 v8, v8, v141, v142
    s_waitcnt lgkmcnt(5)
    v_mfma_f32_16x16x32_bf16 v[176:179], v[72:75], v[96:99], 0
    ds_read_b128 v[68:71], v4 offset:3072
    v_max3_f32 v14, v143, v144, v145
    v_max3_f32 v14, v14, v146, v147
    v_mfma_f32_16x16x32_bf16 v[184:187], v[72:75], v[104:107], 0
    v_max3_f32 v14, v14, v148, v149
    v_max3_f32 v14, v14, v150, v151
    v_max3_f32 v14, v14, v152, v153
    v_mfma_f32_16x16x32_bf16 v[180:183], v[76:79], v[96:99], 0
    ds_read_b128 v[72:75], v4 offset:5120
    v_max3_f32 v14, v14, v154, v155
    v_max3_f32 v14, v14, v156, v157
    v_mfma_f32_16x16x32_bf16 v[188:191], v[76:79], v[104:107], 0
    s_setprio 0
    v_max3_f32 v14, v14, v158, v159
    v_max_f32 v8, v8, v14
    v_cmp_lt_f32 vcc, 0x41000000, v8
    s_cmp_eq_u32 s101, 1
    s_cbranch_scc1 A_slow_113
    s_cbranch_vccnz A_slow_113
A_slowret_114:
    s_waitcnt lgkmcnt(5)
    v_mfma_f32_16x16x32_bf16 v[192:195], v[80:83], v[96:99], 0
    ds_read_b128 v[76:79], v4 offset:7168
    v_exp_f32 v128, v128
    v_mfma_f32_16x16x32_bf16 v[200:203], v[80:83], v[104:107], 0
    v_exp_f32 v129, v129
    s_add_u32 s63, s12, 131072
    v_add_u32 v3, s63, v2
    s_add_u32 s62, s62, 1
    s_mov_b32 s33, s18
    s_mov_b32 s34, s19
    s_mov_b32 s35, s32
    s_mov_b32 s8, s13
    s_mov_b32 s13, s12
    v_mfma_f32_16x16x32_bf16 v[196:199], v[84:87], v[96:99], 0
    ds_read_b128 v[80:83], v4 offset:9216
    v_exp_f32 v130, v130
    v_mfma_f32_16x16x32_bf16 v[204:207], v[84:87], v[104:107], 0
    v_exp_f32 v131, v131
    v_mfma_f32_16x16x32_bf16 v[24:27], v[224:227], v[96:99], 0
    v_permlane16_swap_b32 v240, v242
    v_permlane16_swap_b32 v241, v243
    v_permlane16_swap_b32 v248, v250
    v_permlane16_swap_b32 v249, v251
    s_waitcnt lgkmcnt(5)
    v_mfma_f32_16x16x32_bf16 v[208:211], v[88:91], v[96:99], 0
    ds_read_b128 v[84:87], v4 offset:11264
    v_cvt_pk_bf16_f32 v128, v128, v129
    v_mfma_f32_16x16x32_bf16 v[216:219], v[88:91], v[104:107], 0
    v_exp_f32 v132, v132
    v_mfma_f32_16x16x32_bf16 v[28:31], v[224:227], v[104:107], 0
    v_mfma_f32_16x16x32_bf16 v[212:215], v[92:95], v[96:99], 0
    ds_read_b128 v[88:91], v4 offset:13312
    v_exp_f32 v133, v133
    v_mfma_f32_16x16x32_bf16 v[220:223], v[92:95], v[104:107], 0
    v_cvt_pk_bf16_f32 v129, v130, v131
    s_add_u32 s63, s62, 2
    s_lshl_b32 s96, s63, 1
    s_sub_u32 s96, s96, s61
    s_lshr_b32 s19, s9, 1
    s_cmp_ge_u32 s63, s61
    s_cselect_b32 s96, s96, s63
    s_cselect_b32 s19, s9, s19
    s_cselect_b32 s32, 4, 2
    s_cselect_b32 s12, s45, 0
    s_lshl_b32 s96, s96, 14
    s_add_u32 s18, s96, s19
    s_add_u32 s18, s18, s99
    s_cmp_gt_u32 s63, 16
    s_cselect_b32 s32, 0, s32
    s_waitcnt lgkmcnt(5)
    v_mfma_f32_16x16x32_bf16 v[160:163], v[64:67], v[112:115], v[160:163]
    ds_read_b128 v[92:95], v4 offset:15360
    v_exp_f32 v134, v134
    v_mfma_f32_16x16x32_bf16 v[168:171], v[64:67], v[120:123], v[168:171]
    v_exp_f32 v135, v135
    v_mfma_f32_16x16x32_bf16 v[164:167], v[68:71], v[112:115], v[164:167]
    v_cvt_pk_bf16_f32 v130, v132, v133
    v_mfma_f32_16x16x32_bf16 v[172:175], v[68:71], v[120:123], v[172:175]
    v_exp_f32 v136, v136
    s_waitcnt lgkmcnt(4)
    v_mfma_f32_16x16x32_bf16 v[176:179], v[72:75], v[112:115], v[176:179]
    v_exp_f32 v137, v137
    v_mfma_f32_16x16x32_bf16 v[184:187], v[72:75], v[120:123], v[184:187]
    s_waitcnt vmcnt(0) lgkmcnt(0)
    s_barrier
    s_setprio 3
    s_cmp_ge_u32 s59, 28
    s_cbranch_scc1 A_noz_77
    s_add_u32 s52, s14, 0x6000000
    s_addc_u32 s53, s15, 0
    s_mov_b32 s54, 0x380000
    s_mov_b32 s55, 0x00020000
    buffer_store_dwordx4 v[228:231], v12, s[52:55], s49 offen offset:0 sc1
    buffer_store_dwordx4 v[232:235], v12, s[52:55], s49 offen offset:256 sc1
    s_add_u32 s52, s14, 0x3000000
    s_addc_u32 s53, s15, 0
    s_mov_b32 s54, 0x380000
    s_mov_b32 s55, 0x00020000
    buffer_store_dwordx4 v[240:243], v236, s[52:55], s43 offen offset:0 sc1
    buffer_store_dwordx4 v[248:251], v236, s[52:55], s43 offen offset:256 sc1
A_noz_77:
    s_load_dwordx2 s[40:41], s[0:1], 40
    s_load_dwordx2 s[42:43], s[0:1], 80
    s_load_dwordx2 s[46:47], s[0:1], 64
    ds_read_b128 v[64:67], v3 offset:0
    ds_read_b128 v[68:71], v3 offset:1024
    v_cvt_pk_bf16_f32 v131, v134, v135
    v_mfma_f32_16x16x32_bf16 v[180:183], v[76:79], v[112:115], v[180:183]
    ds_read_b128 v[72:75], v3 offset:2048
    v_exp_f32 v138, v138
    v_mfma_f32_16x16x32_bf16 v[188:191], v[76:79], v[120:123], v[188:191]
    v_exp_f32 v139, v139
    s_add_u32 m0, s19, 98304
    s_cmp_le_u32 s32, 0
    s_cbranch_scc1 A_d_117
    buffer_load_dwordx4 v2, s[20:23], s18 offen offset:0 sc1 lds
A_d_117:
    v_mfma_f32_16x16x32_bf16 v[192:195], v[80:83], v[112:115], v[192:195]
    ds_read_b128 v[76:79], v3 offset:3072
    v_cvt_pk_bf16_f32 v136, v136, v137
    v_mfma_f32_16x16x32_bf16 v[200:203], v[80:83], v[120:123], v[200:203]
    v_exp_f32 v140, v140
    v_mfma_f32_16x16x32_bf16 v[24:27], v[224:227], v[112:115], v[24:27]
    v_mfma_f32_16x16x32_bf16 v[196:199], v[84:87], v[112:115], v[196:199]
    ds_read_b128 v[80:83], v3 offset:4096
    v_exp_f32 v141, v141
    v_mfma_f32_16x16x32_bf16 v[204:207], v[84:87], v[120:123], v[204:207]
    v_cvt_pk_bf16_f32 v137, v138, v139
    s_add_u32 m0, s19, 98304
    s_cmp_le_u32 s32, 1
    s_cbranch_scc1 A_d_118
    buffer_load_dwordx4 v2, s[20:23], s18 offen offset:1024 sc1 lds
A_d_118:
    v_mfma_f32_16x16x32_bf16 v[208:211], v[88:91], v[112:115], v[208:211]
    ds_read_b128 v[84:87], v3 offset:5120
    v_exp_f32 v142, v142
    v_mfma_f32_16x16x32_bf16 v[216:219], v[88:91], v[120:123], v[216:219]
    v_exp_f32 v143, v143
    v_mfma_f32_16x16x32_bf16 v[28:31], v[224:227], v[120:123], v[28:31]
    v_mfma_f32_16x16x32_bf16 v[212:215], v[92:95], v[112:115], v[212:215]
    ds_read_b128 v[88:91], v3 offset:6144
    v_cvt_pk_bf16_f32 v138, v140, v141
    v_mfma_f32_16x16x32_bf16 v[220:223], v[92:95], v[120:123], v[220:223]
    s_nop 0
    v_cvt_pk_bf16_f32 v139, v142, v143
    s_add_u32 m0, s19, 98304
    s_cmp_le_u32 s32, 2
    s_cbranch_scc1 A_d_119
    buffer_load_dwordx4 v2, s[20:23], s18 offen offset:2048 sc1 lds
A_d_119:
    s_cmp_lg_u32 s98, 0
    s_cbranch_scc1 A_resc_120
A_rescret_121:
    s_add_u32 s63, s8, 32768
    v_add_u32 v4, s63, v2
    s_waitcnt lgkmcnt(5)
    v_mfma_f32_16x16x32_bf16 v[96:99], v[64:67], v[32:35], v[16:19]
    ds_read_b128 v[92:95], v3 offset:7168
    v_exp_f32 v144, v144
    v_mfma_f32_16x16x32_bf16 v[104:107], v[64:67], v[36:39], v[20:23]
    v_exp_f32 v145, v145
    v_mfma_f32_16x16x32_bf16 v[96:99], v[68:71], v[40:43], v[96:99]
    ds_read_b128 v[64:67], v3 offset:8192
    v_exp_f32 v146, v146
    v_mfma_f32_16x16x32_bf16 v[104:107], v[68:71], v[44:47], v[104:107]
    v_exp_f32 v147, v147
    s_add_u32 m0, s19, 98304
    s_cmp_le_u32 s32, 3
    s_cbranch_scc1 A_d_123
    buffer_load_dwordx4 v2, s[20:23], s18 offen offset:3072 sc1 lds
A_d_123:
    s_waitcnt lgkmcnt(5)
    v_mfma_f32_16x16x32_bf16 v[96:99], v[72:75], v[48:51], v[96:99]
    ds_read_b128 v[68:71], v3 offset:9216
    v_cvt_pk_bf16_f32 v144, v144, v145
    v_mfma_f32_16x16x32_bf16 v[104:107], v[72:75], v[52:55], v[104:107]
    v_mfma_f32_16x16x32_bf16 v[96:99], v[76:79], v[56:59], v[96:99]
    s_setprio 2
    ds_read_b128 v[72:75], v3 offset:10240
    v_exp_f32 v148, v148
    v_mfma_f32_16x16x32_bf16 v[104:107], v[76:79], v[60:63], v[104:107]
    v_exp_f32 v149, v149
    s_add_u32 m0, s34, 0
    s_cmp_le_u32 s35, 0
    s_cbranch_scc1 A_d_124
    buffer_load_dwordx4 v2, s[24:27], s33 offen offset:0 sc1 lds
A_d_124:
    s_waitcnt lgkmcnt(5)
    v_mfma_f32_16x16x32_bf16 v[100:103], v[80:83], v[32:35], v[16:19]
    ds_read_b128 v[76:79], v3 offset:11264
    v_cvt_pk_bf16_f32 v145, v146, v147
    v_mfma_f32_16x16x32_bf16 v[108:111], v[80:83], v[36:39], v[20:23]
    v_mfma_f32_16x16x32_bf16 v[100:103], v[84:87], v[40:43], v[100:103]
    ds_read_b128 v[80:83], v3 offset:12288
    v_exp_f32 v150, v150
    v_mfma_f32_16x16x32_bf16 v[108:111], v[84:87], v[44:47], v[108:111]
    v_exp_f32 v151, v151
    s_add_u32 m0, s34, 0
    s_cmp_le_u32 s35, 1
    s_cbranch_scc1 A_d_125
    buffer_load_dwordx4 v2, s[24:27], s33 offen offset:1024 sc1 lds
A_d_125:
    s_waitcnt lgkmcnt(5)
    v_mfma_f32_16x16x32_bf16 v[100:103], v[88:91], v[48:51], v[100:103]
    ds_read_b128 v[84:87], v3 offset:13312
    v_cvt_pk_bf16_f32 v146, v148, v149
    v_mfma_f32_16x16x32_bf16 v[108:111], v[88:91], v[52:55], v[108:111]
    v_mfma_f32_16x16x32_bf16 v[100:103], v[92:95], v[56:59], v[100:103]
    ds_read_b128 v[88:91], v3 offset:14336
    v_exp_f32 v152, v152
    v_mfma_f32_16x16x32_bf16 v[108:111], v[92:95], v[60:63], v[108:111]
    v_exp_f32 v153, v153
    s_add_u32 m0, s34, 0
    s_cmp_le_u32 s35, 2
    s_cbranch_scc1 A_d_126
    buffer_load_dwordx4 v2, s[24:27], s33 offen offset:2048 sc1 lds
A_d_126:
    s_waitcnt lgkmcnt(5)
    v_mfma_f32_16x16x32_bf16 v[112:115], v[64:67], v[32:35], v[16:19]
    ds_read_b128 v[92:95], v3 offset:15360
    v_cvt_pk_bf16_f32 v147, v150, v151
    v_mfma_f32_16x16x32_bf16 v[120:123], v[64:67], v[36:39], v[20:23]
    v_exp_f32 v154, v154
    v_mfma_f32_16x16x32_bf16 v[112:115], v[68:71], v[40:43], v[112:115]
    ds_read_b128 v[64:67], v4 offset:0
    v_exp_f32 v155, v155
    v_mfma_f32_16x16x32_bf16 v[120:123], v[68:71], v[44:47], v[120:123]
    s_add_u32 m0, s34, 0
    s_cmp_le_u32 s35, 3
    s_cbranch_scc1 A_d_127
    buffer_load_dwordx4 v2, s[24:27], s33 offen offset:3072 sc1 lds
A_d_127:
    s_waitcnt lgkmcnt(5)
    v_mfma_f32_16x16x32_bf16 v[112:115], v[72:75], v[48:51], v[112:115]
    ds_read_b128 v[68:71], v4 offset:2048
    v_cvt_pk_bf16_f32 v152, v152, v153
    v_mfma_f32_16x16x32_bf16 v[120:123], v[72:75], v[52:55], v[120:123]
    v_exp_f32 v156, v156
    v_mfma_f32_16x16x32_bf16 v[112:115], v[76:79], v[56:59], v[112:115]
    s_setprio 1
    ds_read_b128 v[72:75], v4 offset:4096
    v_exp_f32 v157, v157
    v_mfma_f32_16x16x32_bf16 v[120:123], v[76:79], v[60:63], v[120:123]
    s_waitcnt lgkmcnt(5)
    v_mfma_f32_16x16x32_bf16 v[116:119], v[80:83], v[32:35], v[16:19]
    ds_read_b128 v[76:79], v4 offset:6144
    v_cvt_pk_bf16_f32 v153, v154, v155
    v_mfma_f32_16x16x32_bf16 v[124:127], v[80:83], v[36:39], v[20:23]
    v_exp_f32 v158, v158
    v_mfma_f32_16x16x32_bf16 v[116:119], v[84:87], v[40:43], v[116:119]
    ds_read_b128 v[80:83], v4 offset:8192
    v_exp_f32 v159, v159
    v_mfma_f32_16x16x32_bf16 v[124:127], v[84:87], v[44:47], v[124:127]
    s_waitcnt lgkmcnt(5)
    v_mfma_f32_16x16x32_bf16 v[116:119], v[88:91], v[48:51], v[116:119]
    ds_read_b128 v[84:87], v4 offset:10240
    v_cvt_pk_bf16_f32 v154, v156, v157
    v_mfma_f32_16x16x32_bf16 v[124:127], v[88:91], v[52:55], v[124:127]
    s_nop 0
    v_mfma_f32_16x16x32_bf16 v[116:119], v[92:95], v[56:59], v[116:119]
    ds_read_b128 v[88:91], v4 offset:12288
    v_cvt_pk_bf16_f32 v155, v158, v159
    v_mfma_f32_16x16x32_bf16 v[124:127], v[92:95], v[60:63], v[124:127]
    s_bitcmp1_b32 s44, s62
    s_cbranch_scc1 A_evb_128
A_evbret_129:
    s_waitcnt lgkmcnt(5)
    v_mfma_f32_16x16x32_bf16 v[160:163], v[64:67], v[128:131], v[160:163]
    ds_read_b128 v[92:95], v4 offset:14336
    v_max3_f32 v8, v96, v97, v98
    v_max3_f32 v8, v8, v99, v100
    v_mfma_f32_16x16x32_bf16 v[168:171], v[64:67], v[136:139], v[168:171]
    v_max3_f32 v8, v8, v101, v102
    v_max3_f32 v8, v8, v103, v104
    v_mfma_f32_16x16x32_bf16 v[164:167], v[68:71], v[128:131], v[164:167]
    ds_read_b128 v[64:67], v4 offset:1024
    v_max3_f32 v8, v8, v105, v106
    v_mfma_f32_16x16x32_bf16 v[172:175], v[68:71], v[136:139], v[172:175]
    v_max3_f32 v8, v8, v107, v108
    v_max3_f32 v8, v8, v109, v110
    s_waitcnt lgkmcnt(5)
    v_mfma_f32_16x16x32_bf16 v[176:179], v[72:75], v[128:131], v[176:179]
    ds_read_b128 v[68:71], v4 offset:3072
    v_max3_f32 v14, v111, v112, v113
    v_max3_f32 v14, v14, v114, v115
    v_mfma_f32_16x16x32_bf16 v[184:187], v[72:75], v[136:139], v[184:187]
    v_max3_f32 v14, v14, v116, v117
    v_max3_f32 v14, v14, v118, v119
    v_max3_f32 v14, v14, v120, v121
    v_mfma_f32_16x16x32_bf16 v[180:183], v[76:79], v[128:131], v[180:183]
    ds_read_b128 v[72:75], v4 offset:5120
    v_max3_f32 v14, v14, v122, v123
    v_max3_f32 v14, v14, v124, v125
    v_mfma_f32_16x16x32_bf16 v[188:191], v[76:79], v[136:139], v[188:191]
    s_setprio 0
    v_max3_f32 v14, v14, v126, v127
    v_max_f32 v8, v8, v14
    v_cmp_lt_f32 vcc, 0x41000000, v8
    s_cmp_eq_u32 s101, 1
    s_cbranch_scc1 A_slow_131
    s_cbranch_vccnz A_slow_131
A_slowret_132:
    s_waitcnt lgkmcnt(5)
    v_mfma_f32_16x16x32_bf16 v[192:195], v[80:83], v[128:131], v[192:195]
    ds_read_b128 v[76:79], v4 offset:7168
    v_exp_f32 v96, v96
    v_mfma_f32_16x16x32_bf16 v[200:203], v[80:83], v[136:139], v[200:203]
    v_exp_f32 v97, v97
    s_add_u32 s63, s12, 98304
    v_add_u32 v3, s63, v2
    s_add_u32 s62, s62, 1
    s_mov_b32 s33, s18
    s_mov_b32 s34, s19
    s_mov_b32 s35, s32
    s_mov_b32 s8, s13
    s_mov_b32 s13, s12
    v_mfma_f32_16x16x32_bf16 v[196:199], v[84:87], v[128:131], v[196:199]
    ds_read_b128 v[80:83], v4 offset:9216
    v_exp_f32 v98, v98
    v_mfma_f32_16x16x32_bf16 v[204:207], v[84:87], v[136:139], v[204:207]
    v_exp_f32 v99, v99
    v_mfma_f32_16x16x32_bf16 v[24:27], v[224:227], v[128:131], v[24:27]
    s_waitcnt lgkmcnt(5)
    v_mfma_f32_16x16x32_bf16 v[208:211], v[88:91], v[128:131], v[208:211]
    ds_read_b128 v[84:87], v4 offset:11264
    v_cvt_pk_bf16_f32 v96, v96, v97
    v_mfma_f32_16x16x32_bf16 v[216:219], v[88:91], v[136:139], v[216:219]
    v_exp_f32 v100, v100
    v_mfma_f32_16x16x32_bf16 v[28:31], v[224:227], v[136:139], v[28:31]
    v_mfma_f32_16x16x32_bf16 v[212:215], v[92:95], v[128:131], v[212:215]
    ds_read_b128 v[88:91], v4 offset:13312
    v_exp_f32 v101, v101
    v_mfma_f32_16x16x32_bf16 v[220:223], v[92:95], v[136:139], v[220:223]
    v_cvt_pk_bf16_f32 v97, v98, v99
    s_add_u32 s63, s62, 2
    s_lshl_b32 s96, s63, 1
    s_sub_u32 s96, s96, s61
    s_lshr_b32 s19, s9, 1
    s_cmp_ge_u32 s63, s61
    s_cselect_b32 s96, s96, s63
    s_cselect_b32 s19, s9, s19
    s_cselect_b32 s32, 4, 2
    s_cselect_b32 s12, s45, 0
    s_lshl_b32 s96, s96, 14
    s_add_u32 s18, s96, s19
    s_add_u32 s18, s18, s99
    s_cmp_gt_u32 s63, 16
    s_cselect_b32 s32, 0, s32
    s_waitcnt lgkmcnt(5)
    v_mfma_f32_16x16x32_bf16 v[160:163], v[64:67], v[144:147], v[160:163]
    ds_read_b128 v[92:95], v4 offset:15360
    v_exp_f32 v102, v102
    v_mfma_f32_16x16x32_bf16 v[168:171], v[64:67], v[152:155], v[168:171]
    v_exp_f32 v103, v103
    v_mfma_f32_16x16x32_bf16 v[164:167], v[68:71], v[144:147], v[164:167]
    v_cvt_pk_bf16_f32 v98, v100, v101
    v_mfma_f32_16x16x32_bf16 v[172:175], v[68:71], v[152:155], v[172:175]
    v_exp_f32 v104, v104
    s_waitcnt lgkmcnt(4)
    v_mfma_f32_16x16x32_bf16 v[176:179], v[72:75], v[144:147], v[176:179]
    v_exp_f32 v105, v105
    v_mfma_f32_16x16x32_bf16 v[184:187], v[72:75], v[152:155], v[184:187]
    s_waitcnt vmcnt(0) lgkmcnt(0)
    s_barrier
    s_setprio 3
    s_lshl_b32 s51, s60, 7
    s_lshl_b32 s96, s59, 2
    s_add_u32 s51, s51, s96
    s_add_u32 s51, s51, 4096
    s_cmp_eq_u32 s56, 0
    s_cbranch_scc0 M_sig_78
    s_add_u32 s52, s14, 0x6400000
    s_addc_u32 s53, s15, 0
    s_mov_b32 s54, 0x4000
    s_mov_b32 s55, 0x00020000
    v_mov_b32 v9, s3
    v_mov_b32 v10, 0
    s_mov_b64 exec, 1
    buffer_store_dword v9, v10, s[52:55], s51 offen sc1
    s_mov_b64 exec, -1
M_sig_78:
    s_bfe_u32 s63, s2, 196611
    s_cmp_ge_u32 s63, 6
    s_cbranch_scc0 A_nok_79
    s_lshr_b32 s96, s2, 7
    s_lshl_b32 s96, s96, 3
    s_add_u32 s63, s63, s96
    s_lshl_b32 s63, s63, 2
    s_and_b32 s51, s2, 7
    s_lshl_b32 s51, s51, 1
    s_bfe_u32 s96, s2, 65542
    s_add_u32 s51, s51, s96
    s_lshl_b32 s51, s51, 7
    s_add_u32 s51, s51, s63
    s_cmp_eq_u32 s56, 0
    s_cbranch_scc0 M_sig_80
    s_add_u32 s52, s14, 0x6400000
    s_addc_u32 s53, s15, 0
    s_mov_b32 s54, 0x4000
    s_mov_b32 s55, 0x00020000
    v_mov_b32 v9, s3
    v_mov_b32 v10, 0
    s_mov_b64 exec, 1
    buffer_store_dword v9, v10, s[52:55], s51 offen sc1
    s_mov_b64 exec, -1
M_sig_80:
A_nok_79:
    ds_read_b128 v[64:67], v3 offset:0
    ds_read_b128 v[68:71], v3 offset:1024
    v_cvt_pk_bf16_f32 v99, v102, v103
    v_mfma_f32_16x16x32_bf16 v[180:183], v[76:79], v[144:147], v[180:183]
    ds_read_b128 v[72:75], v3 offset:2048
    v_exp_f32 v106, v106
    v_mfma_f32_16x16x32_bf16 v[188:191], v[76:79], v[152:155], v[188:191]
    v_exp_f32 v107, v107
    s_add_u32 m0, s19, 131072
    s_cmp_le_u32 s32, 0
    s_cbranch_scc1 A_d_135
    buffer_load_dwordx4 v2, s[20:23], s18 offen offset:0 sc1 lds
A_d_135:
    v_mfma_f32_16x16x32_bf16 v[192:195], v[80:83], v[144:147], v[192:195]
    ds_read_b128 v[76:79], v3 offset:3072
    v_cvt_pk_bf16_f32 v104, v104, v105
    v_mfma_f32_16x16x32_bf16 v[200:203], v[80:83], v[152:155], v[200:203]
    v_exp_f32 v108, v108
    v_mfma_f32_16x16x32_bf16 v[24:27], v[224:227], v[144:147], v[24:27]
    v_mfma_f32_16x16x32_bf16 v[196:199], v[84:87], v[144:147], v[196:199]
    ds_read_b128 v[80:83], v3 offset:4096
    v_exp_f32 v109, v109
    v_mfma_f32_16x16x32_bf16 v[204:207], v[84:87], v[152:155], v[204:207]
    v_cvt_pk_bf16_f32 v105, v106, v107
    s_add_u32 m0, s19, 131072
    s_cmp_le_u32 s32, 1
    s_cbranch_scc1 A_d_136
    buffer_load_dwordx4 v2, s[20:23], s18 offen offset:1024 sc1 lds
A_d_136:
    v_mfma_f32_16x16x32_bf16 v[208:211], v[88:91], v[144:147], v[208:211]
    ds_read_b128 v[84:87], v3 offset:5120
    v_exp_f32 v110, v110
    v_mfma_f32_16x16x32_bf16 v[216:219], v[88:91], v[152:155], v[216:219]
    v_exp_f32 v111, v111
    v_mfma_f32_16x16x32_bf16 v[28:31], v[224:227], v[152:155], v[28:31]
    v_mfma_f32_16x16x32_bf16 v[212:215], v[92:95], v[144:147], v[212:215]
    ds_read_b128 v[88:91], v3 offset:6144
    v_cvt_pk_bf16_f32 v106, v108, v109
    v_mfma_f32_16x16x32_bf16 v[220:223], v[92:95], v[152:155], v[220:223]
    s_nop 0
    v_cvt_pk_bf16_f32 v107, v110, v111
    s_add_u32 m0, s19, 131072
    s_cmp_le_u32 s32, 2
    s_cbranch_scc1 A_d_137
    buffer_load_dwordx4 v2, s[20:23], s18 offen offset:2048 sc1 lds
A_d_137:
    s_cmp_lg_u32 s98, 0
    s_cbranch_scc1 A_resc_138
A_rescret_139:
    s_add_u32 s63, s8, 0
    v_add_u32 v4, s63, v2
    s_waitcnt lgkmcnt(5)
    v_mfma_f32_16x16x32_bf16 v[128:131], v[64:67], v[32:35], v[16:19]
    ds_read_b128 v[92:95], v3 offset:7168
    v_exp_f32 v112, v112
    v_mfma_f32_16x16x32_bf16 v[136:139], v[64:67], v[36:39], v[20:23]
    v_exp_f32 v113, v113
    s_cmp_lt_u32 s56, 4
    s_cselect_b64 s[36:37], s[46:47], s[40:41]
    s_cselect_b32 s38, 2, 1
    s_lshl_b32 s38, s38, 22
    s_and_b32 s63, s56, 3
    s_lshl_b32 s63, s63, 21
    s_cmp_eq_u32 s56, 6
    s_cselect_b64 s[36:37], s[42:43], s[36:37]
    s_cselect_b32 s38, 917504, s38
    s_cselect_b32 s63, 0, s63
    s_cmp_eq_u32 s56, 7
    s_cselect_b32 s38, 0, s38
    s_mov_b32 s39, 0x00020000
    s_lshl_b32 s96, s2, 13
    s_add_u32 s42, s63, s96
    v_mfma_f32_16x16x32_bf16 v[128:131], v[68:71], v[40:43], v[128:131]
    ds_read_b128 v[64:67], v3 offset:8192
    v_exp_f32 v114, v114
    v_mfma_f32_16x16x32_bf16 v[136:139], v[68:71], v[44:47], v[136:139]
    v_exp_f32 v115, v115
    s_add_u32 m0, s19, 131072
    s_cmp_le_u32 s32, 3
    s_cbranch_scc1 A_d_141
    buffer_load_dwordx4 v2, s[20:23], s18 offen offset:3072 sc1 lds
A_d_141:
    s_waitcnt lgkmcnt(5)
    v_mfma_f32_16x16x32_bf16 v[128:131], v[72:75], v[48:51], v[128:131]
    ds_read_b128 v[68:71], v3 offset:9216
    v_cvt_pk_bf16_f32 v112, v112, v113
    v_mfma_f32_16x16x32_bf16 v[136:139], v[72:75], v[52:55], v[136:139]
    v_mfma_f32_16x16x32_bf16 v[128:131], v[76:79], v[56:59], v[128:131]
    s_setprio 2
    ds_read_b128 v[72:75], v3 offset:10240
    v_exp_f32 v116, v116
    v_mfma_f32_16x16x32_bf16 v[136:139], v[76:79], v[60:63], v[136:139]
    v_exp_f32 v117, v117
    s_add_u32 m0, s34, 32768
    s_cmp_le_u32 s35, 0
    s_cbranch_scc1 A_d_142
    buffer_load_dwordx4 v2, s[24:27], s33 offen offset:0 sc1 lds
A_d_142:
    s_waitcnt lgkmcnt(5)
    v_mfma_f32_16x16x32_bf16 v[132:135], v[80:83], v[32:35], v[16:19]
    ds_read_b128 v[76:79], v3 offset:11264
    v_cvt_pk_bf16_f32 v113, v114, v115
    v_mfma_f32_16x16x32_bf16 v[140:143], v[80:83], v[36:39], v[20:23]
    v_mfma_f32_16x16x32_bf16 v[132:135], v[84:87], v[40:43], v[132:135]
    ds_read_b128 v[80:83], v3 offset:12288
    v_exp_f32 v118, v118
    v_mfma_f32_16x16x32_bf16 v[140:143], v[84:87], v[44:47], v[140:143]
    v_exp_f32 v119, v119
    s_add_u32 m0, s34, 32768
    s_cmp_le_u32 s35, 1
    s_cbranch_scc1 A_d_143
    buffer_load_dwordx4 v2, s[24:27], s33 offen offset:1024 sc1 lds
A_d_143:
    s_waitcnt lgkmcnt(5)
    v_mfma_f32_16x16x32_bf16 v[132:135], v[88:91], v[48:51], v[132:135]
    ds_read_b128 v[84:87], v3 offset:13312
    v_cvt_pk_bf16_f32 v114, v116, v117
    v_mfma_f32_16x16x32_bf16 v[140:143], v[88:91], v[52:55], v[140:143]
    v_mfma_f32_16x16x32_bf16 v[132:135], v[92:95], v[56:59], v[132:135]
    ds_read_b128 v[88:91], v3 offset:14336
    v_exp_f32 v120, v120
    v_mfma_f32_16x16x32_bf16 v[140:143], v[92:95], v[60:63], v[140:143]
    v_exp_f32 v121, v121
    s_add_u32 m0, s34, 32768
    s_cmp_le_u32 s35, 2
    s_cbranch_scc1 A_d_144
    buffer_load_dwordx4 v2, s[24:27], s33 offen offset:2048 sc1 lds
A_d_144:
    s_waitcnt lgkmcnt(5)
    v_mfma_f32_16x16x32_bf16 v[144:147], v[64:67], v[32:35], v[16:19]
    ds_read_b128 v[92:95], v3 offset:15360
    v_cvt_pk_bf16_f32 v115, v118, v119
    v_mfma_f32_16x16x32_bf16 v[152:155], v[64:67], v[36:39], v[20:23]
    v_exp_f32 v122, v122
    v_mfma_f32_16x16x32_bf16 v[144:147], v[68:71], v[40:43], v[144:147]
    ds_read_b128 v[64:67], v4 offset:0
    v_exp_f32 v123, v123
    v_mfma_f32_16x16x32_bf16 v[152:155], v[68:71], v[44:47], v[152:155]
    s_add_u32 m0, s34, 32768
    s_cmp_le_u32 s35, 3
    s_cbranch_scc1 A_d_145
    buffer_load_dwordx4 v2, s[24:27], s33 offen offset:3072 sc1 lds
A_d_145:
    s_waitcnt lgkmcnt(5)
    v_mfma_f32_16x16x32_bf16 v[144:147], v[72:75], v[48:51], v[144:147]
    ds_read_b128 v[68:71], v4 offset:2048
    v_cvt_pk_bf16_f32 v120, v120, v121
    v_mfma_f32_16x16x32_bf16 v[152:155], v[72:75], v[52:55], v[152:155]
    v_exp_f32 v124, v124
    v_mfma_f32_16x16x32_bf16 v[144:147], v[76:79], v[56:59], v[144:147]
    s_setprio 1
    ds_read_b128 v[72:75], v4 offset:4096
    v_exp_f32 v125, v125
    v_mfma_f32_16x16x32_bf16 v[152:155], v[76:79], v[60:63], v[152:155]
    buffer_load_dwordx4 v[236:239], v2, s[36:39], s42 offen
    s_add_u32 s42, s42, 1024
    s_waitcnt lgkmcnt(5)
    v_mfma_f32_16x16x32_bf16 v[148:151], v[80:83], v[32:35], v[16:19]
    ds_read_b128 v[76:79], v4 offset:6144
    v_cvt_pk_bf16_f32 v121, v122, v123
    v_mfma_f32_16x16x32_bf16 v[156:159], v[80:83], v[36:39], v[20:23]
    v_exp_f32 v126, v126
    v_mfma_f32_16x16x32_bf16 v[148:151], v[84:87], v[40:43], v[148:151]
    ds_read_b128 v[80:83], v4 offset:8192
    v_exp_f32 v127, v127
    v_mfma_f32_16x16x32_bf16 v[156:159], v[84:87], v[44:47], v[156:159]
    buffer_load_dwordx4 v[236:239], v2, s[36:39], s42 offen
    s_add_u32 s42, s42, 1024
    s_waitcnt lgkmcnt(5)
    v_mfma_f32_16x16x32_bf16 v[148:151], v[88:91], v[48:51], v[148:151]
    ds_read_b128 v[84:87], v4 offset:10240
    v_cvt_pk_bf16_f32 v122, v124, v125
    v_mfma_f32_16x16x32_bf16 v[156:159], v[88:91], v[52:55], v[156:159]
    s_nop 0
    v_mfma_f32_16x16x32_bf16 v[148:151], v[92:95], v[56:59], v[148:151]
    ds_read_b128 v[88:91], v4 offset:12288
    v_cvt_pk_bf16_f32 v123, v126, v127
    v_mfma_f32_16x16x32_bf16 v[156:159], v[92:95], v[60:63], v[156:159]
    buffer_load_dwordx4 v[236:239], v2, s[36:39], s42 offen
    s_add_u32 s42, s42, 1024
    s_bitcmp1_b32 s44, s62
    s_cbranch_scc1 A_evb_146
A_evbret_147:
    s_waitcnt lgkmcnt(5)
    v_mfma_f32_16x16x32_bf16 v[160:163], v[64:67], v[96:99], v[160:163]
    ds_read_b128 v[92:95], v4 offset:14336
    v_max3_f32 v8, v128, v129, v130
    v_max3_f32 v8, v8, v131, v132
    v_mfma_f32_16x16x32_bf16 v[168:171], v[64:67], v[104:107], v[168:171]
    v_max3_f32 v8, v8, v133, v134
    v_max3_f32 v8, v8, v135, v136
    v_mfma_f32_16x16x32_bf16 v[164:167], v[68:71], v[96:99], v[164:167]
    ds_read_b128 v[64:67], v4 offset:1024
    v_max3_f32 v8, v8, v137, v138
    v_mfma_f32_16x16x32_bf16 v[172:175], v[68:71], v[104:107], v[172:175]
    v_max3_f32 v8, v8, v139, v140
    v_max3_f32 v8, v8, v141, v142
    s_waitcnt lgkmcnt(5)
    v_mfma_f32_16x16x32_bf16 v[176:179], v[72:75], v[96:99], v[176:179]
    ds_read_b128 v[68:71], v4 offset:3072
    v_max3_f32 v14, v143, v144, v145
    v_max3_f32 v14, v14, v146, v147
    v_mfma_f32_16x16x32_bf16 v[184:187], v[72:75], v[104:107], v[184:187]
    v_max3_f32 v14, v14, v148, v149
    v_max3_f32 v14, v14, v150, v151
    v_max3_f32 v14, v14, v152, v153
    v_mfma_f32_16x16x32_bf16 v[180:183], v[76:79], v[96:99], v[180:183]
    ds_read_b128 v[72:75], v4 offset:5120
    v_max3_f32 v14, v14, v154, v155
    v_max3_f32 v14, v14, v156, v157
    v_mfma_f32_16x16x32_bf16 v[188:191], v[76:79], v[104:107], v[188:191]
    s_setprio 0
    v_max3_f32 v14, v14, v158, v159
    v_max_f32 v8, v8, v14
    v_cmp_lt_f32 vcc, 0x41000000, v8
    s_cmp_eq_u32 s101, 1
    s_cbranch_scc1 A_slow_149
    s_cbranch_vccnz A_slow_149
A_slowret_150:
    s_waitcnt lgkmcnt(5)
    v_mfma_f32_16x16x32_bf16 v[192:195], v[80:83], v[96:99], v[192:195]
    ds_read_b128 v[76:79], v4 offset:7168
    v_exp_f32 v128, v128
    v_mfma_f32_16x16x32_bf16 v[200:203], v[80:83], v[104:107], v[200:203]
    v_exp_f32 v129, v129
    s_add_u32 s63, s12, 131072
    v_add_u32 v3, s63, v2
    s_add_u32 s62, s62, 1
    s_mov_b32 s33, s18
    s_mov_b32 s34, s19
    s_mov_b32 s35, s32
    s_mov_b32 s8, s13
    s_mov_b32 s13, s12
    v_mfma_f32_16x16x32_bf16 v[196:199], v[84:87], v[96:99], v[196:199]
    ds_read_b128 v[80:83], v4 offset:9216
    v_exp_f32 v130, v130
    v_mfma_f32_16x16x32_bf16 v[204:207], v[84:87], v[104:107], v[204:207]
    v_exp_f32 v131, v131
    v_mfma_f32_16x16x32_bf16 v[24:27], v[224:227], v[96:99], v[24:27]
    s_waitcnt lgkmcnt(5)
    v_mfma_f32_16x16x32_bf16 v[208:211], v[88:91], v[96:99], v[208:211]
    ds_read_b128 v[84:87], v4 offset:11264
    v_cvt_pk_bf16_f32 v128, v128, v129
    v_mfma_f32_16x16x32_bf16 v[216:219], v[88:91], v[104:107], v[216:219]
    v_exp_f32 v132, v132
    v_mfma_f32_16x16x32_bf16 v[28:31], v[224:227], v[104:107], v[28:31]
    v_mfma_f32_16x16x32_bf16 v[212:215], v[92:95], v[96:99], v[212:215]
    ds_read_b128 v[88:91], v4 offset:13312
    v_exp_f32 v133, v133
    v_mfma_f32_16x16x32_bf16 v[220:223], v[92:95], v[104:107], v[220:223]
    v_cvt_pk_bf16_f32 v129, v130, v131
    s_add_u32 s63, s62, 2
    s_lshl_b32 s96, s63, 1
    s_sub_u32 s96, s96, s61
    s_lshr_b32 s19, s9, 1
    s_cmp_ge_u32 s63, s61
    s_cselect_b32 s96, s96, s63
    s_cselect_b32 s19, s9, s19
    s_cselect_b32 s32, 4, 2
    s_cselect_b32 s12, s45, 0
    s_lshl_b32 s96, s96, 14
    s_add_u32 s18, s96, s19
    s_add_u32 s18, s18, s99
    s_cmp_gt_u32 s63, 16
    s_cselect_b32 s32, 0, s32
    s_waitcnt lgkmcnt(5)
    v_mfma_f32_16x16x32_bf16 v[160:163], v[64:67], v[112:115], v[160:163]
    ds_read_b128 v[92:95], v4 offset:15360
    v_exp_f32 v134, v134
    v_mfma_f32_16x16x32_bf16 v[168:171], v[64:67], v[120:123], v[168:171]
    v_exp_f32 v135, v135
    v_mfma_f32_16x16x32_bf16 v[164:167], v[68:71], v[112:115], v[164:167]
    v_cvt_pk_bf16_f32 v130, v132, v133
    v_mfma_f32_16x16x32_bf16 v[172:175], v[68:71], v[120:123], v[172:175]
    v_exp_f32 v136, v136
    s_waitcnt lgkmcnt(4)
    v_mfma_f32_16x16x32_bf16 v[176:179], v[72:75], v[112:115], v[176:179]
    v_exp_f32 v137, v137
    v_mfma_f32_16x16x32_bf16 v[184:187], v[72:75], v[120:123], v[184:187]
    s_waitcnt vmcnt(3) lgkmcnt(0)
    s_barrier
    s_setprio 3
    s_cmp_eq_u32 s56, 0
    s_cbranch_scc0 A_fl_81
    s_lshr_b32 s51, s59, 1
    s_lshl_b32 s51, s51, 7
    v_and_b32 v254, 15, v1
    v_lshlrev_b32 v254, 2, v254
    s_add_u32 s52, s14, 0x6400000
    s_addc_u32 s53, s15, 0
    s_mov_b32 s54, 0x4000
    s_mov_b32 s55, 0x00020000
    buffer_load_dword v253, v254, s[52:55], s51 offen sc1
A_fl_81:
    ds_read_b128 v[64:67], v3 offset:0
    ds_read_b128 v[68:71], v3 offset:1024
    v_cvt_pk_bf16_f32 v131, v134, v135
    v_mfma_f32_16x16x32_bf16 v[180:183], v[76:79], v[112:115], v[180:183]
    ds_read_b128 v[72:75], v3 offset:2048
    v_exp_f32 v138, v138
    v_mfma_f32_16x16x32_bf16 v[188:191], v[76:79], v[120:123], v[188:191]
    v_exp_f32 v139, v139
    s_add_u32 m0, s19, 98304
    s_cmp_le_u32 s32, 0
    s_cbranch_scc1 A_d_153
    buffer_load_dwordx4 v2, s[20:23], s18 offen offset:0 sc1 lds
A_d_153:
    v_mfma_f32_16x16x32_bf16 v[192:195], v[80:83], v[112:115], v[192:195]
    ds_read_b128 v[76:79], v3 offset:3072
    v_cvt_pk_bf16_f32 v136, v136, v137
    v_mfma_f32_16x16x32_bf16 v[200:203], v[80:83], v[120:123], v[200:203]
    v_exp_f32 v140, v140
    v_mfma_f32_16x16x32_bf16 v[24:27], v[224:227], v[112:115], v[24:27]
    v_mfma_f32_16x16x32_bf16 v[196:199], v[84:87], v[112:115], v[196:199]
    ds_read_b128 v[80:83], v3 offset:4096
    v_exp_f32 v141, v141
    v_mfma_f32_16x16x32_bf16 v[204:207], v[84:87], v[120:123], v[204:207]
    v_cvt_pk_bf16_f32 v137, v138, v139
    s_add_u32 m0, s19, 98304
    s_cmp_le_u32 s32, 1
    s_cbranch_scc1 A_d_154
    buffer_load_dwordx4 v2, s[20:23], s18 offen offset:1024 sc1 lds
A_d_154:
    v_mfma_f32_16x16x32_bf16 v[208:211], v[88:91], v[112:115], v[208:211]
    ds_read_b128 v[84:87], v3 offset:5120
    v_exp_f32 v142, v142
    v_mfma_f32_16x16x32_bf16 v[216:219], v[88:91], v[120:123], v[216:219]
    v_exp_f32 v143, v143
    v_mfma_f32_16x16x32_bf16 v[28:31], v[224:227], v[120:123], v[28:31]
    v_mfma_f32_16x16x32_bf16 v[212:215], v[92:95], v[112:115], v[212:215]
    ds_read_b128 v[88:91], v3 offset:6144
    v_cvt_pk_bf16_f32 v138, v140, v141
    v_mfma_f32_16x16x32_bf16 v[220:223], v[92:95], v[120:123], v[220:223]
    s_nop 0
    v_cvt_pk_bf16_f32 v139, v142, v143
    s_add_u32 m0, s19, 98304
    s_cmp_le_u32 s32, 2
    s_cbranch_scc1 A_d_155
    buffer_load_dwordx4 v2, s[20:23], s18 offen offset:2048 sc1 lds
A_d_155:
    s_cmp_lg_u32 s98, 0
    s_cbranch_scc1 A_resc_156
A_rescret_157:
    s_add_u32 s63, s8, 32768
    v_add_u32 v4, s63, v2
    s_waitcnt lgkmcnt(5)
    v_mfma_f32_16x16x32_bf16 v[96:99], v[64:67], v[32:35], v[16:19]
    ds_read_b128 v[92:95], v3 offset:7168
    v_exp_f32 v144, v144
    v_mfma_f32_16x16x32_bf16 v[104:107], v[64:67], v[36:39], v[20:23]
    v_exp_f32 v145, v145
    v_mfma_f32_16x16x32_bf16 v[96:99], v[68:71], v[40:43], v[96:99]
    ds_read_b128 v[64:67], v3 offset:8192
    v_exp_f32 v146, v146
    v_mfma_f32_16x16x32_bf16 v[104:107], v[68:71], v[44:47], v[104:107]
    v_exp_f32 v147, v147
    s_add_u32 m0, s19, 98304
    s_cmp_le_u32 s32, 3
    s_cbranch_scc1 A_d_159
    buffer_load_dwordx4 v2, s[20:23], s18 offen offset:3072 sc1 lds
A_d_159:
    s_waitcnt lgkmcnt(5)
    v_mfma_f32_16x16x32_bf16 v[96:99], v[72:75], v[48:51], v[96:99]
    ds_read_b128 v[68:71], v3 offset:9216
    v_cvt_pk_bf16_f32 v144, v144, v145
    v_mfma_f32_16x16x32_bf16 v[104:107], v[72:75], v[52:55], v[104:107]
    v_mfma_f32_16x16x32_bf16 v[96:99], v[76:79], v[56:59], v[96:99]
    s_setprio 2
    ds_read_b128 v[72:75], v3 offset:10240
    v_exp_f32 v148, v148
    v_mfma_f32_16x16x32_bf16 v[104:107], v[76:79], v[60:63], v[104:107]
    v_exp_f32 v149, v149
    s_add_u32 m0, s34, 0
    s_cmp_le_u32 s35, 0
    s_cbranch_scc1 A_d_160
    buffer_load_dwordx4 v2, s[24:27], s33 offen offset:0 sc1 lds
A_d_160:
    s_waitcnt lgkmcnt(5)
    v_mfma_f32_16x16x32_bf16 v[100:103], v[80:83], v[32:35], v[16:19]
    ds_read_b128 v[76:79], v3 offset:11264
    v_cvt_pk_bf16_f32 v145, v146, v147
    v_mfma_f32_16x16x32_bf16 v[108:111], v[80:83], v[36:39], v[20:23]
    v_mfma_f32_16x16x32_bf16 v[100:103], v[84:87], v[40:43], v[100:103]
    ds_read_b128 v[80:83], v3 offset:12288
    v_exp_f32 v150, v150
    v_mfma_f32_16x16x32_bf16 v[108:111], v[84:87], v[44:47], v[108:111]
    v_exp_f32 v151, v151
    s_add_u32 m0, s34, 0
    s_cmp_le_u32 s35, 1
    s_cbranch_scc1 A_d_161
    buffer_load_dwordx4 v2, s[24:27], s33 offen offset:1024 sc1 lds
A_d_161:
    s_waitcnt lgkmcnt(5)
    v_mfma_f32_16x16x32_bf16 v[100:103], v[88:91], v[48:51], v[100:103]
    ds_read_b128 v[84:87], v3 offset:13312
    v_cvt_pk_bf16_f32 v146, v148, v149
    v_mfma_f32_16x16x32_bf16 v[108:111], v[88:91], v[52:55], v[108:111]
    v_mfma_f32_16x16x32_bf16 v[100:103], v[92:95], v[56:59], v[100:103]
    ds_read_b128 v[88:91], v3 offset:14336
    v_exp_f32 v152, v152
    v_mfma_f32_16x16x32_bf16 v[108:111], v[92:95], v[60:63], v[108:111]
    v_exp_f32 v153, v153
    s_add_u32 m0, s34, 0
    s_cmp_le_u32 s35, 2
    s_cbranch_scc1 A_d_162
    buffer_load_dwordx4 v2, s[24:27], s33 offen offset:2048 sc1 lds
A_d_162:
    s_waitcnt lgkmcnt(5)
    v_mfma_f32_16x16x32_bf16 v[112:115], v[64:67], v[32:35], v[16:19]
    ds_read_b128 v[92:95], v3 offset:15360
    v_cvt_pk_bf16_f32 v147, v150, v151
    v_mfma_f32_16x16x32_bf16 v[120:123], v[64:67], v[36:39], v[20:23]
    v_exp_f32 v154, v154
    v_mfma_f32_16x16x32_bf16 v[112:115], v[68:71], v[40:43], v[112:115]
    ds_read_b128 v[64:67], v4 offset:0
    v_exp_f32 v155, v155
    v_mfma_f32_16x16x32_bf16 v[120:123], v[68:71], v[44:47], v[120:123]
    s_add_u32 m0, s34, 0
    s_cmp_le_u32 s35, 3
    s_cbranch_scc1 A_d_163
    buffer_load_dwordx4 v2, s[24:27], s33 offen offset:3072 sc1 lds
A_d_163:
    s_waitcnt lgkmcnt(5)
    v_mfma_f32_16x16x32_bf16 v[112:115], v[72:75], v[48:51], v[112:115]
    ds_read_b128 v[68:71], v4 offset:2048
    v_cvt_pk_bf16_f32 v152, v152, v153
    v_mfma_f32_16x16x32_bf16 v[120:123], v[72:75], v[52:55], v[120:123]
    v_exp_f32 v156, v156
    v_mfma_f32_16x16x32_bf16 v[112:115], v[76:79], v[56:59], v[112:115]
    s_setprio 1
    ds_read_b128 v[72:75], v4 offset:4096
    v_exp_f32 v157, v157
    v_mfma_f32_16x16x32_bf16 v[120:123], v[76:79], v[60:63], v[120:123]
    buffer_load_dwordx4 v[236:239], v2, s[36:39], s42 offen
    s_add_u32 s42, s42, 1024
    s_waitcnt lgkmcnt(5)
    v_mfma_f32_16x16x32_bf16 v[116:119], v[80:83], v[32:35], v[16:19]
    ds_read_b128 v[76:79], v4 offset:6144
    v_cvt_pk_bf16_f32 v153, v154, v155
    v_mfma_f32_16x16x32_bf16 v[124:127], v[80:83], v[36:39], v[20:23]
    v_exp_f32 v158, v158
    v_mfma_f32_16x16x32_bf16 v[116:119], v[84:87], v[40:43], v[116:119]
    ds_read_b128 v[80:83], v4 offset:8192
    v_exp_f32 v159, v159
    v_mfma_f32_16x16x32_bf16 v[124:127], v[84:87], v[44:47], v[124:127]
    buffer_load_dwordx4 v[236:239], v2, s[36:39], s42 offen
    s_add_u32 s42, s42, 1024
    s_waitcnt lgkmcnt(5)
    v_mfma_f32_16x16x32_bf16 v[116:119], v[88:91], v[48:51], v[116:119]
    ds_read_b128 v[84:87], v4 offset:10240
    v_cvt_pk_bf16_f32 v154, v156, v157
    v_mfma_f32_16x16x32_bf16 v[124:127], v[88:91], v[52:55], v[124:127]
    s_nop 0
    v_mfma_f32_16x16x32_bf16 v[116:119], v[92:95], v[56:59], v[116:119]
    ds_read_b128 v[88:91], v4 offset:12288
    v_cvt_pk_bf16_f32 v155, v158, v159
    v_mfma_f32_16x16x32_bf16 v[124:127], v[92:95], v[60:63], v[124:127]
    buffer_load_dwordx4 v[236:239], v2, s[36:39], s42 offen
    s_add_u32 s42, s42, 1024
    s_bitcmp1_b32 s44, s62
    s_cbranch_scc1 A_evb_164
A_evbret_165:
    s_waitcnt lgkmcnt(5)
    v_mfma_f32_16x16x32_bf16 v[160:163], v[64:67], v[128:131], v[160:163]
    ds_read_b128 v[92:95], v4 offset:14336
    v_max3_f32 v8, v96, v97, v98
    v_max3_f32 v8, v8, v99, v100
    v_mfma_f32_16x16x32_bf16 v[168:171], v[64:67], v[136:139], v[168:171]
    v_max3_f32 v8, v8, v101, v102
    v_max3_f32 v8, v8, v103, v104
    v_mfma_f32_16x16x32_bf16 v[164:167], v[68:71], v[128:131], v[164:167]
    ds_read_b128 v[64:67], v4 offset:1024
    v_max3_f32 v8, v8, v105, v106
    v_mfma_f32_16x16x32_bf16 v[172:175], v[68:71], v[136:139], v[172:175]
    v_max3_f32 v8, v8, v107, v108
    v_max3_f32 v8, v8, v109, v110
    s_waitcnt lgkmcnt(5)
    v_mfma_f32_16x16x32_bf16 v[176:179], v[72:75], v[128:131], v[176:179]
    ds_read_b128 v[68:71], v4 offset:3072
    v_max3_f32 v14, v111, v112, v113
    v_max3_f32 v14, v14, v114, v115
    v_mfma_f32_16x16x32_bf16 v[184:187], v[72:75], v[136:139], v[184:187]
    v_max3_f32 v14, v14, v116, v117
    v_max3_f32 v14, v14, v118, v119
    v_max3_f32 v14, v14, v120, v121
    v_mfma_f32_16x16x32_bf16 v[180:183], v[76:79], v[128:131], v[180:183]
    ds_read_b128 v[72:75], v4 offset:5120
    v_max3_f32 v14, v14, v122, v123
    v_max3_f32 v14, v14, v124, v125
    v_mfma_f32_16x16x32_bf16 v[188:191], v[76:79], v[136:139], v[188:191]
    s_setprio 0
    v_max3_f32 v14, v14, v126, v127
    v_max_f32 v8, v8, v14
    v_cmp_lt_f32 vcc, 0x41000000, v8
    s_cmp_eq_u32 s101, 1
    s_cbranch_scc1 A_slow_167
    s_cbranch_vccnz A_slow_167
A_slowret_168:
    s_waitcnt lgkmcnt(5)
    v_mfma_f32_16x16x32_bf16 v[192:195], v[80:83], v[128:131], v[192:195]
    ds_read_b128 v[76:79], v4 offset:7168
    v_exp_f32 v96, v96
    v_mfma_f32_16x16x32_bf16 v[200:203], v[80:83], v[136:139], v[200:203]
    v_exp_f32 v97, v97
    s_add_u32 s63, s12, 98304
    v_add_u32 v3, s63, v2
    s_add_u32 s62, s62, 1
    s_mov_b32 s33, s18
    s_mov_b32 s34, s19
    s_mov_b32 s35, s32
    s_mov_b32 s8, s13
    s_mov_b32 s13, s12
    v_mfma_f32_16x16x32_bf16 v[196:199], v[84:87], v[128:131], v[196:199]
    ds_read_b128 v[80:83], v4 offset:9216
    v_exp_f32 v98, v98
    v_mfma_f32_16x16x32_bf16 v[204:207], v[84:87], v[136:139], v[204:207]
    v_exp_f32 v99, v99
    v_mfma_f32_16x16x32_bf16 v[24:27], v[224:227], v[128:131], v[24:27]
    s_waitcnt lgkmcnt(5)
    v_mfma_f32_16x16x32_bf16 v[208:211], v[88:91], v[128:131], v[208:211]
    ds_read_b128 v[84:87], v4 offset:11264
    v_cvt_pk_bf16_f32 v96, v96, v97
    v_mfma_f32_16x16x32_bf16 v[216:219], v[88:91], v[136:139], v[216:219]
    v_exp_f32 v100, v100
    v_mfma_f32_16x16x32_bf16 v[28:31], v[224:227], v[136:139], v[28:31]
    v_mfma_f32_16x16x32_bf16 v[212:215], v[92:95], v[128:131], v[212:215]
    ds_read_b128 v[88:91], v4 offset:13312
    v_exp_f32 v101, v101
    v_mfma_f32_16x16x32_bf16 v[220:223], v[92:95], v[136:139], v[220:223]
    v_cvt_pk_bf16_f32 v97, v98, v99
    s_add_u32 s63, s62, 2
    s_lshl_b32 s96, s63, 1
    s_sub_u32 s96, s96, s61
    s_lshr_b32 s19, s9, 1
    s_cmp_ge_u32 s63, s61
    s_cselect_b32 s96, s96, s63
    s_cselect_b32 s19, s9, s19
    s_cselect_b32 s32, 4, 2
    s_cselect_b32 s12, s45, 0
    s_lshl_b32 s96, s96, 14
    s_add_u32 s18, s96, s19
    s_add_u32 s18, s18, s99
    s_cmp_gt_u32 s63, 16
    s_cselect_b32 s32, 0, s32
    s_waitcnt lgkmcnt(5)
    v_mfma_f32_16x16x32_bf16 v[160:163], v[64:67], v[144:147], v[160:163]
    ds_read_b128 v[92:95], v4 offset:15360
    v_exp_f32 v102, v102
    v_mfma_f32_16x16x32_bf16 v[168:171], v[64:67], v[152:155], v[168:171]
    v_exp_f32 v103, v103
    v_mfma_f32_16x16x32_bf16 v[164:167], v[68:71], v[144:147], v[164:167]
    v_cvt_pk_bf16_f32 v98, v100, v101
    v_mfma_f32_16x16x32_bf16 v[172:175], v[68:71], v[152:155], v[172:175]
    v_exp_f32 v104, v104
    s_waitcnt lgkmcnt(4)
    v_mfma_f32_16x16x32_bf16 v[176:179], v[72:75], v[144:147], v[176:179]
    v_exp_f32 v105, v105
    v_mfma_f32_16x16x32_bf16 v[184:187], v[72:75], v[152:155], v[184:187]
    s_waitcnt vmcnt(3) lgkmcnt(0)
    s_cmp_eq_u32 s56, 0
    s_cbranch_scc0 A_fcret_83
    v_cmp_ne_u32 vcc, s3, v253
    s_nop 1
    s_cbranch_vccnz A_fc_82
A_fcret_83:
    s_barrier
    s_setprio 3
    s_mov_b32 s52, s4
    s_mov_b32 s53, s5
    s_mov_b32 s54, 0x200000
    s_mov_b32 s55, 0x00020000
    buffer_load_dwordx4 v[240:243], v2, s[52:55], s48 offen
    s_mov_b32 s52, s6
    s_mov_b32 s53, s7
    s_mov_b32 s54, 0x400
    s_mov_b32 s55, 0x00020000
    buffer_load_dwordx4 v[244:247], v2, s[52:55], 0 offen
    s_cmp_eq_u32 s56, 0
    s_cbranch_scc0 A_fl_87
    s_lshr_b32 s63, s2, 4
    s_sub_u32 s51, 15, s63
    s_min_u32 s51, s51, s63
    s_lshl_b32 s51, s51, 7
    s_add_u32 s51, s51, 4096
    v_and_b32 v254, 31, v1
    v_lshlrev_b32 v254, 2, v254
    s_add_u32 s52, s14, 0x6400000
    s_addc_u32 s53, s15, 0
    s_mov_b32 s54, 0x4000
    s_mov_b32 s55, 0x00020000
    buffer_load_dword v253, v254, s[52:55], s51 offen sc1
A_fl_87:
    ds_read_b128 v[64:67], v3 offset:0
    ds_read_b128 v[68:71], v3 offset:1024
    v_cvt_pk_bf16_f32 v99, v102, v103
    v_mfma_f32_16x16x32_bf16 v[180:183], v[76:79], v[144:147], v[180:183]
    ds_read_b128 v[72:75], v3 offset:2048
    v_exp_f32 v106, v106
    v_mfma_f32_16x16x32_bf16 v[188:191], v[76:79], v[152:155], v[188:191]
    v_exp_f32 v107, v107
    s_add_u32 m0, s19, 131072
    s_cmp_le_u32 s32, 0
    s_cbranch_scc1 A_d_171
    buffer_load_dwordx4 v2, s[20:23], s18 offen offset:0 sc1 lds
A_d_171:
    v_mfma_f32_16x16x32_bf16 v[192:195], v[80:83], v[144:147], v[192:195]
    ds_read_b128 v[76:79], v3 offset:3072
    v_cvt_pk_bf16_f32 v104, v104, v105
    v_mfma_f32_16x16x32_bf16 v[200:203], v[80:83], v[152:155], v[200:203]
    v_exp_f32 v108, v108
    v_mfma_f32_16x16x32_bf16 v[24:27], v[224:227], v[144:147], v[24:27]
    v_mfma_f32_16x16x32_bf16 v[196:199], v[84:87], v[144:147], v[196:199]
    ds_read_b128 v[80:83], v3 offset:4096
    v_exp_f32 v109, v109
    v_mfma_f32_16x16x32_bf16 v[204:207], v[84:87], v[152:155], v[204:207]
    v_cvt_pk_bf16_f32 v105, v106, v107
    s_add_u32 m0, s19, 131072
    s_cmp_le_u32 s32, 1
    s_cbranch_scc1 A_d_172
    buffer_load_dwordx4 v2, s[20:23], s18 offen offset:1024 sc1 lds
A_d_172:
    v_mfma_f32_16x16x32_bf16 v[208:211], v[88:91], v[144:147], v[208:211]
    ds_read_b128 v[84:87], v3 offset:5120
    v_exp_f32 v110, v110
    v_mfma_f32_16x16x32_bf16 v[216:219], v[88:91], v[152:155], v[216:219]
    v_exp_f32 v111, v111
    v_mfma_f32_16x16x32_bf16 v[28:31], v[224:227], v[152:155], v[28:31]
    v_mfma_f32_16x16x32_bf16 v[212:215], v[92:95], v[144:147], v[212:215]
    ds_read_b128 v[88:91], v3 offset:6144
    v_cvt_pk_bf16_f32 v106, v108, v109
    v_mfma_f32_16x16x32_bf16 v[220:223], v[92:95], v[152:155], v[220:223]
    s_nop 0
    v_cvt_pk_bf16_f32 v107, v110, v111
    s_add_u32 m0, s19, 131072
    s_cmp_le_u32 s32, 2
    s_cbranch_scc1 A_d_173
    buffer_load_dwordx4 v2, s[20:23], s18 offen offset:2048 sc1 lds
A_d_173:
    s_cmp_lg_u32 s98, 0
    s_cbranch_scc1 A_resc_174
A_rescret_175:
    s_add_u32 s63, s8, 0
    v_add_u32 v4, s63, v2
    s_waitcnt lgkmcnt(5)
    v_mfma_f32_16x16x32_bf16 v[128:131], v[64:67], v[32:35], v[16:19]
    ds_read_b128 v[92:95], v3 offset:7168
    v_exp_f32 v112, v112
    v_mfma_f32_16x16x32_bf16 v[136:139], v[64:67], v[36:39], v[20:23]
    v_exp_f32 v113, v113
    v_lshrrev_b32 v248, 5, v1
    s_lshl_b32 s63, s56, 1
    v_add_u32 v248, s63, v248
    v_lshlrev_b32 v248, 17, v248
    v_mfma_f32_16x16x32_bf16 v[128:131], v[68:71], v[40:43], v[128:131]
    ds_read_b128 v[64:67], v3 offset:8192
    v_exp_f32 v114, v114
    v_mfma_f32_16x16x32_bf16 v[136:139], v[68:71], v[44:47], v[136:139]
    v_exp_f32 v115, v115
    s_add_u32 m0, s19, 131072
    s_cmp_le_u32 s32, 3
    s_cbranch_scc1 A_d_177
    buffer_load_dwordx4 v2, s[20:23], s18 offen offset:3072 sc1 lds
A_d_177:
    s_waitcnt lgkmcnt(5)
    v_mfma_f32_16x16x32_bf16 v[128:131], v[72:75], v[48:51], v[128:131]
    ds_read_b128 v[68:71], v3 offset:9216
    v_cvt_pk_bf16_f32 v112, v112, v113
    v_mfma_f32_16x16x32_bf16 v[136:139], v[72:75], v[52:55], v[136:139]
    v_mfma_f32_16x16x32_bf16 v[128:131], v[76:79], v[56:59], v[128:131]
    s_setprio 2
    ds_read_b128 v[72:75], v3 offset:10240
    v_exp_f32 v116, v116
    v_mfma_f32_16x16x32_bf16 v[136:139], v[76:79], v[60:63], v[136:139]
    v_exp_f32 v117, v117
    s_add_u32 m0, s34, 32768
    s_cmp_le_u32 s35, 0
    s_cbranch_scc1 A_d_178
    buffer_load_dwordx4 v2, s[24:27], s33 offen offset:0 sc1 lds
A_d_178:
    s_waitcnt lgkmcnt(5)
    v_mfma_f32_16x16x32_bf16 v[132:135], v[80:83], v[32:35], v[16:19]
    ds_read_b128 v[76:79], v3 offset:11264
    v_cvt_pk_bf16_f32 v113, v114, v115
    v_mfma_f32_16x16x32_bf16 v[140:143], v[80:83], v[36:39], v[20:23]
    v_mfma_f32_16x16x32_bf16 v[132:135], v[84:87], v[40:43], v[132:135]
    ds_read_b128 v[80:83], v3 offset:12288
    v_exp_f32 v118, v118
    v_mfma_f32_16x16x32_bf16 v[140:143], v[84:87], v[44:47], v[140:143]
    v_exp_f32 v119, v119
    s_add_u32 m0, s34, 32768
    s_cmp_le_u32 s35, 1
    s_cbranch_scc1 A_d_179
    buffer_load_dwordx4 v2, s[24:27], s33 offen offset:1024 sc1 lds
A_d_179:
    s_waitcnt lgkmcnt(5)
    v_mfma_f32_16x16x32_bf16 v[132:135], v[88:91], v[48:51], v[132:135]
    ds_read_b128 v[84:87], v3 offset:13312
    v_cvt_pk_bf16_f32 v114, v116, v117
    v_mfma_f32_16x16x32_bf16 v[140:143], v[88:91], v[52:55], v[140:143]
    v_mfma_f32_16x16x32_bf16 v[132:135], v[92:95], v[56:59], v[132:135]
    ds_read_b128 v[88:91], v3 offset:14336
    v_exp_f32 v120, v120
    v_mfma_f32_16x16x32_bf16 v[140:143], v[92:95], v[60:63], v[140:143]
    v_exp_f32 v121, v121
    s_add_u32 m0, s34, 32768
    s_cmp_le_u32 s35, 2
    s_cbranch_scc1 A_d_180
    buffer_load_dwordx4 v2, s[24:27], s33 offen offset:2048 sc1 lds
A_d_180:
    s_waitcnt lgkmcnt(5)
    v_mfma_f32_16x16x32_bf16 v[144:147], v[64:67], v[32:35], v[16:19]
    ds_read_b128 v[92:95], v3 offset:15360
    v_cvt_pk_bf16_f32 v115, v118, v119
    v_mfma_f32_16x16x32_bf16 v[152:155], v[64:67], v[36:39], v[20:23]
    v_exp_f32 v122, v122
    v_and_b32 v249, 31, v1
    v_lshlrev_b32 v249, 4, v249
    v_add_u32 v248, v248, v249
    v_add_u32 v249, 2097152, v248
    v_mfma_f32_16x16x32_bf16 v[144:147], v[68:71], v[40:43], v[144:147]
    ds_read_b128 v[64:67], v4 offset:0
    v_exp_f32 v123, v123
    v_mfma_f32_16x16x32_bf16 v[152:155], v[68:71], v[44:47], v[152:155]
    s_add_u32 m0, s34, 32768
    s_cmp_le_u32 s35, 3
    s_cbranch_scc1 A_d_181
    buffer_load_dwordx4 v2, s[24:27], s33 offen offset:3072 sc1 lds
A_d_181:
    s_waitcnt lgkmcnt(5)
    v_mfma_f32_16x16x32_bf16 v[144:147], v[72:75], v[48:51], v[144:147]
    ds_read_b128 v[68:71], v4 offset:2048
    v_cvt_pk_bf16_f32 v120, v120, v121
    v_mfma_f32_16x16x32_bf16 v[152:155], v[72:75], v[52:55], v[152:155]
    v_exp_f32 v124, v124
    v_mfma_f32_16x16x32_bf16 v[144:147], v[76:79], v[56:59], v[144:147]
    s_setprio 1
    ds_read_b128 v[72:75], v4 offset:4096
    v_exp_f32 v125, v125
    v_mfma_f32_16x16x32_bf16 v[152:155], v[76:79], v[60:63], v[152:155]
    buffer_load_dwordx4 v[236:239], v2, s[36:39], s42 offen
    s_add_u32 s42, s42, 1024
    s_waitcnt lgkmcnt(5)
    v_mfma_f32_16x16x32_bf16 v[148:151], v[80:83], v[32:35], v[16:19]
    ds_read_b128 v[76:79], v4 offset:6144
    v_cvt_pk_bf16_f32 v121, v122, v123
    v_mfma_f32_16x16x32_bf16 v[156:159], v[80:83], v[36:39], v[20:23]
    v_exp_f32 v126, v126
    v_mfma_f32_16x16x32_bf16 v[148:151], v[84:87], v[40:43], v[148:151]
    ds_read_b128 v[80:83], v4 offset:8192
    v_exp_f32 v127, v127
    v_mfma_f32_16x16x32_bf16 v[156:159], v[84:87], v[44:47], v[156:159]
    buffer_load_dwordx4 v[236:239], v2, s[36:39], s42 offen
    s_add_u32 s42, s42, 1024
    s_waitcnt lgkmcnt(5)
    v_mfma_f32_16x16x32_bf16 v[148:151], v[88:91], v[48:51], v[148:151]
    ds_read_b128 v[84:87], v4 offset:10240
    v_cvt_pk_bf16_f32 v122, v124, v125
    v_mfma_f32_16x16x32_bf16 v[156:159], v[88:91], v[52:55], v[156:159]
    s_nop 0
    v_mfma_f32_16x16x32_bf16 v[148:151], v[92:95], v[56:59], v[148:151]
    ds_read_b128 v[88:91], v4 offset:12288
    v_cvt_pk_bf16_f32 v123, v126, v127
    v_mfma_f32_16x16x32_bf16 v[156:159], v[92:95], v[60:63], v[156:159]
    s_bitcmp1_b32 s44, s62
    s_cbranch_scc1 A_evb_182
A_evbret_183:
    s_waitcnt lgkmcnt(5)
    v_mfma_f32_16x16x32_bf16 v[160:163], v[64:67], v[96:99], v[160:163]
    ds_read_b128 v[92:95], v4 offset:14336
    v_max3_f32 v8, v128, v129, v130
    v_max3_f32 v8, v8, v131, v132
    v_mfma_f32_16x16x32_bf16 v[168:171], v[64:67], v[104:107], v[168:171]
    v_max3_f32 v8, v8, v133, v134
    v_max3_f32 v8, v8, v135, v136
    v_mfma_f32_16x16x32_bf16 v[164:167], v[68:71], v[96:99], v[164:167]
    ds_read_b128 v[64:67], v4 offset:1024
    v_max3_f32 v8, v8, v137, v138
    v_mfma_f32_16x16x32_bf16 v[172:175], v[68:71], v[104:107], v[172:175]
    v_max3_f32 v8, v8, v139, v140
    v_max3_f32 v8, v8, v141, v142
    s_waitcnt lgkmcnt(5)
    v_mfma_f32_16x16x32_bf16 v[176:179], v[72:75], v[96:99], v[176:179]
    ds_read_b128 v[68:71], v4 offset:3072
    v_max3_f32 v14, v143, v144, v145
    v_max3_f32 v14, v14, v146, v147
    v_mfma_f32_16x16x32_bf16 v[184:187], v[72:75], v[104:107], v[184:187]
    v_max3_f32 v14, v14, v148, v149
    v_max3_f32 v14, v14, v150, v151
    v_max3_f32 v14, v14, v152, v153
    v_mfma_f32_16x16x32_bf16 v[180:183], v[76:79], v[96:99], v[180:183]
    ds_read_b128 v[72:75], v4 offset:5120
    v_max3_f32 v14, v14, v154, v155
    v_max3_f32 v14, v14, v156, v157
    v_mfma_f32_16x16x32_bf16 v[188:191], v[76:79], v[104:107], v[188:191]
    s_setprio 0
    v_max3_f32 v14, v14, v158, v159
    v_max_f32 v8, v8, v14
    v_cmp_lt_f32 vcc, 0x41000000, v8
    s_cmp_eq_u32 s101, 1
    s_cbranch_scc1 A_slow_185
    s_cbranch_vccnz A_slow_185
A_slowret_186:
    s_waitcnt lgkmcnt(5)
    v_mfma_f32_16x16x32_bf16 v[192:195], v[80:83], v[96:99], v[192:195]
    ds_read_b128 v[76:79], v4 offset:7168
    v_exp_f32 v128, v128
    v_mfma_f32_16x16x32_bf16 v[200:203], v[80:83], v[104:107], v[200:203]
    v_exp_f32 v129, v129
    s_add_u32 s63, s12, 131072
    v_add_u32 v3, s63, v2
    s_add_u32 s62, s62, 1
    s_mov_b32 s33, s18
    s_mov_b32 s34, s19
    s_mov_b32 s35, s32
    s_mov_b32 s8, s13
    s_mov_b32 s13, s12
    v_mfma_f32_16x16x32_bf16 v[196:199], v[84:87], v[96:99], v[196:199]
    ds_read_b128 v[80:83], v4 offset:9216
    v_exp_f32 v130, v130
    v_mfma_f32_16x16x32_bf16 v[204:207], v[84:87], v[104:107], v[204:207]
    v_exp_f32 v131, v131
    v_mfma_f32_16x16x32_bf16 v[24:27], v[224:227], v[96:99], v[24:27]
    s_waitcnt lgkmcnt(5)
    v_mfma_f32_16x16x32_bf16 v[208:211], v[88:91], v[96:99], v[208:211]
    ds_read_b128 v[84:87], v4 offset:11264
    v_cvt_pk_bf16_f32 v128, v128, v129
    v_mfma_f32_16x16x32_bf16 v[216:219], v[88:91], v[104:107], v[216:219]
    v_exp_f32 v132, v132
    v_mfma_f32_16x16x32_bf16 v[28:31], v[224:227], v[104:107], v[28:31]
    v_mfma_f32_16x16x32_bf16 v[212:215], v[92:95], v[96:99], v[212:215]
    ds_read_b128 v[88:91], v4 offset:13312
    v_exp_f32 v133, v133
    v_mfma_f32_16x16x32_bf16 v[220:223], v[92:95], v[104:107], v[220:223]
    v_cvt_pk_bf16_f32 v129, v130, v131
    s_add_u32 s63, s62, 2
    s_lshl_b32 s96, s63, 1
    s_sub_u32 s96, s96, s61
    s_lshr_b32 s19, s9, 1
    s_cmp_ge_u32 s63, s61
    s_cselect_b32 s96, s96, s63
    s_cselect_b32 s19, s9, s19
    s_cselect_b32 s32, 4, 2
    s_cselect_b32 s12, s45, 0
    s_lshl_b32 s96, s96, 14
    s_add_u32 s18, s96, s19
    s_add_u32 s18, s18, s99
    s_cmp_gt_u32 s63, 16
    s_cselect_b32 s32, 0, s32
    s_waitcnt lgkmcnt(5)
    v_mfma_f32_16x16x32_bf16 v[160:163], v[64:67], v[112:115], v[160:163]
    ds_read_b128 v[92:95], v4 offset:15360
    v_exp_f32 v134, v134
    v_mfma_f32_16x16x32_bf16 v[168:171], v[64:67], v[120:123], v[168:171]
    v_exp_f32 v135, v135
    v_mfma_f32_16x16x32_bf16 v[164:167], v[68:71], v[112:115], v[164:167]
    v_cvt_pk_bf16_f32 v130, v132, v133
    v_mfma_f32_16x16x32_bf16 v[172:175], v[68:71], v[120:123], v[172:175]
    v_exp_f32 v136, v136
    s_waitcnt lgkmcnt(4)
    v_mfma_f32_16x16x32_bf16 v[176:179], v[72:75], v[112:115], v[176:179]
    v_exp_f32 v137, v137
    v_mfma_f32_16x16x32_bf16 v[184:187], v[72:75], v[120:123], v[184:187]
    s_waitcnt vmcnt(2) lgkmcnt(0)
    s_cmp_eq_u32 s56, 0
    s_cbranch_scc0 A_fcret_89
    v_cmp_ne_u32 vcc, s3, v253
    s_nop 1
    s_cbranch_vccnz A_fc_88
A_fcret_89:
    s_barrier
    s_setprio 3
    s_add_u32 s52, s14, 0x3000000
    s_addc_u32 s53, s15, 0
    s_mov_b32 s54, 0x380000
    s_mov_b32 s55, 0x00020000
    buffer_load_dwordx4 v[228:231], v248, s[52:55], s16 offen sc1
    buffer_load_dwordx4 v[232:235], v249, s[52:55], s16 offen sc1
    ds_read_b128 v[64:67], v3 offset:0
    ds_read_b128 v[68:71], v3 offset:1024
    v_cvt_pk_bf16_f32 v131, v134, v135
    v_mfma_f32_16x16x32_bf16 v[180:183], v[76:79], v[112:115], v[180:183]
    ds_read_b128 v[72:75], v3 offset:2048
    v_exp_f32 v138, v138
    v_mfma_f32_16x16x32_bf16 v[188:191], v[76:79], v[120:123], v[188:191]
    v_exp_f32 v139, v139
    s_add_u32 m0, s19, 98304
    s_cmp_le_u32 s32, 0
    s_cbranch_scc1 A_d_189
    buffer_load_dwordx4 v2, s[20:23], s18 offen offset:0 sc1 lds
A_d_189:
    v_mfma_f32_16x16x32_bf16 v[192:195], v[80:83], v[112:115], v[192:195]
    ds_read_b128 v[76:79], v3 offset:3072
    v_cvt_pk_bf16_f32 v136, v136, v137
    v_mfma_f32_16x16x32_bf16 v[200:203], v[80:83], v[120:123], v[200:203]
    v_exp_f32 v140, v140
    v_mfma_f32_16x16x32_bf16 v[24:27], v[224:227], v[112:115], v[24:27]
    v_mfma_f32_16x16x32_bf16 v[196:199], v[84:87], v[112:115], v[196:199]
    ds_read_b128 v[80:83], v3 offset:4096
    v_exp_f32 v141, v141
    v_mfma_f32_16x16x32_bf16 v[204:207], v[84:87], v[120:123], v[204:207]
    v_cvt_pk_bf16_f32 v137, v138, v139
    s_add_u32 m0, s19, 98304
    s_cmp_le_u32 s32, 1
    s_cbranch_scc1 A_d_190
    buffer_load_dwordx4 v2, s[20:23], s18 offen offset:1024 sc1 lds
A_d_190:
    v_mfma_f32_16x16x32_bf16 v[208:211], v[88:91], v[112:115], v[208:211]
    ds_read_b128 v[84:87], v3 offset:5120
    v_exp_f32 v142, v142
    v_mfma_f32_16x16x32_bf16 v[216:219], v[88:91], v[120:123], v[216:219]
    v_exp_f32 v143, v143
    v_mfma_f32_16x16x32_bf16 v[28:31], v[224:227], v[120:123], v[28:31]
    v_mfma_f32_16x16x32_bf16 v[212:215], v[92:95], v[112:115], v[212:215]
    ds_read_b128 v[88:91], v3 offset:6144
    v_cvt_pk_bf16_f32 v138, v140, v141
    v_mfma_f32_16x16x32_bf16 v[220:223], v[92:95], v[120:123], v[220:223]
    s_nop 0
    v_cvt_pk_bf16_f32 v139, v142, v143
    s_add_u32 m0, s19, 98304
    s_cmp_le_u32 s32, 2
    s_cbranch_scc1 A_d_191
    buffer_load_dwordx4 v2, s[20:23], s18 offen offset:2048 sc1 lds
A_d_191:
    s_cmp_lg_u32 s98, 0
    s_cbranch_scc1 A_resc_192
A_rescret_193:
    s_add_u32 s63, s8, 32768
    v_add_u32 v4, s63, v2
    s_waitcnt lgkmcnt(5)
    v_mfma_f32_16x16x32_bf16 v[96:99], v[64:67], v[32:35], v[16:19]
    ds_read_b128 v[92:95], v3 offset:7168
    v_exp_f32 v144, v144
    v_mfma_f32_16x16x32_bf16 v[104:107], v[64:67], v[36:39], v[20:23]
    v_exp_f32 v145, v145
    v_lshlrev_b32 v250, 16, v240
    v_lshlrev_b32 v251, 16, v244
    v_mul_f32 v255, v250, v251
    v_mfma_f32_16x16x32_bf16 v[96:99], v[68:71], v[40:43], v[96:99]
    ds_read_b128 v[64:67], v3 offset:8192
    v_exp_f32 v146, v146
    v_mfma_f32_16x16x32_bf16 v[104:107], v[68:71], v[44:47], v[104:107]
    v_exp_f32 v147, v147
    v_and_b32 v252, 0xffff0000, v240
    v_and_b32 v253, 0xffff0000, v244
    v_fmac_f32 v255, v252, v253
    s_add_u32 m0, s19, 98304
    s_cmp_le_u32 s32, 3
    s_cbranch_scc1 A_d_195
    buffer_load_dwordx4 v2, s[20:23], s18 offen offset:3072 sc1 lds
A_d_195:
    s_waitcnt lgkmcnt(5)
    v_mfma_f32_16x16x32_bf16 v[96:99], v[72:75], v[48:51], v[96:99]
    ds_read_b128 v[68:71], v3 offset:9216
    v_cvt_pk_bf16_f32 v144, v144, v145
    v_mfma_f32_16x16x32_bf16 v[104:107], v[72:75], v[52:55], v[104:107]
    v_lshlrev_b32 v250, 16, v241
    v_lshlrev_b32 v251, 16, v245
    v_fmac_f32 v255, v250, v251
    v_mfma_f32_16x16x32_bf16 v[96:99], v[76:79], v[56:59], v[96:99]
    s_setprio 2
    ds_read_b128 v[72:75], v3 offset:10240
    v_exp_f32 v148, v148
    v_mfma_f32_16x16x32_bf16 v[104:107], v[76:79], v[60:63], v[104:107]
    v_exp_f32 v149, v149
    v_and_b32 v252, 0xffff0000, v241
    v_and_b32 v253, 0xffff0000, v245
    v_fmac_f32 v255, v252, v253
    s_add_u32 m0, s34, 0
    s_cmp_le_u32 s35, 0
    s_cbranch_scc1 A_d_196
    buffer_load_dwordx4 v2, s[24:27], s33 offen offset:0 sc1 lds
A_d_196:
    s_waitcnt lgkmcnt(5)
    v_mfma_f32_16x16x32_bf16 v[100:103], v[80:83], v[32:35], v[16:19]
    ds_read_b128 v[76:79], v3 offset:11264
    v_cvt_pk_bf16_f32 v145, v146, v147
    v_mfma_f32_16x16x32_bf16 v[108:111], v[80:83], v[36:39], v[20:23]
    v_lshlrev_b32 v250, 16, v242
    v_lshlrev_b32 v251, 16, v246
    v_fmac_f32 v255, v250, v251
    v_mfma_f32_16x16x32_bf16 v[100:103], v[84:87], v[40:43], v[100:103]
    ds_read_b128 v[80:83], v3 offset:12288
    v_exp_f32 v150, v150
    v_mfma_f32_16x16x32_bf16 v[108:111], v[84:87], v[44:47], v[108:111]
    v_exp_f32 v151, v151
    v_and_b32 v252, 0xffff0000, v242
    v_and_b32 v253, 0xffff0000, v246
    v_fmac_f32 v255, v252, v253
    s_add_u32 m0, s34, 0
    s_cmp_le_u32 s35, 1
    s_cbranch_scc1 A_d_197
    buffer_load_dwordx4 v2, s[24:27], s33 offen offset:1024 sc1 lds
A_d_197:
    s_waitcnt lgkmcnt(5)
    v_mfma_f32_16x16x32_bf16 v[100:103], v[88:91], v[48:51], v[100:103]
    ds_read_b128 v[84:87], v3 offset:13312
    v_cvt_pk_bf16_f32 v146, v148, v149
    v_mfma_f32_16x16x32_bf16 v[108:111], v[88:91], v[52:55], v[108:111]
    v_lshlrev_b32 v250, 16, v243
    v_lshlrev_b32 v251, 16, v247
    v_fmac_f32 v255, v250, v251
    v_mfma_f32_16x16x32_bf16 v[100:103], v[92:95], v[56:59], v[100:103]
    ds_read_b128 v[88:91], v3 offset:14336
    v_exp_f32 v152, v152
    v_mfma_f32_16x16x32_bf16 v[108:111], v[92:95], v[60:63], v[108:111]
    v_exp_f32 v153, v153
    s_add_u32 m0, s34, 0
    s_cmp_le_u32 s35, 2
    s_cbranch_scc1 A_d_198
    buffer_load_dwordx4 v2, s[24:27], s33 offen offset:2048 sc1 lds
A_d_198:
    s_waitcnt lgkmcnt(5)
    v_mfma_f32_16x16x32_bf16 v[112:115], v[64:67], v[32:35], v[16:19]
    ds_read_b128 v[92:95], v3 offset:15360
    v_cvt_pk_bf16_f32 v147, v150, v151
    v_mfma_f32_16x16x32_bf16 v[120:123], v[64:67], v[36:39], v[20:23]
    v_exp_f32 v154, v154
    v_and_b32 v252, 0xffff0000, v243
    v_and_b32 v253, 0xffff0000, v247
    v_fmac_f32 v255, v252, v253
    v_mfma_f32_16x16x32_bf16 v[112:115], v[68:71], v[40:43], v[112:115]
    ds_read_b128 v[64:67], v4 offset:0
    v_exp_f32 v155, v155
    v_mfma_f32_16x16x32_bf16 v[120:123], v[68:71], v[44:47], v[120:123]
    s_nop 1
    v_add_f32_dpp v255, v255, v255 quad_perm:[1,0,3,2] row_mask:0xf bank_mask:0xf
    s_add_u32 m0, s34, 0
    s_cmp_le_u32 s35, 3
    s_cbranch_scc1 A_d_199
    buffer_load_dwordx4 v2, s[24:27], s33 offen offset:3072 sc1 lds
A_d_199:
    s_waitcnt lgkmcnt(5)
    v_mfma_f32_16x16x32_bf16 v[112:115], v[72:75], v[48:51], v[112:115]
    ds_read_b128 v[68:71], v4 offset:2048
    v_cvt_pk_bf16_f32 v152, v152, v153
    v_mfma_f32_16x16x32_bf16 v[120:123], v[72:75], v[52:55], v[120:123]
    v_exp_f32 v156, v156
    s_nop 1
    v_add_f32_dpp v255, v255, v255 quad_perm:[2,3,0,1] row_mask:0xf bank_mask:0xf
    v_mfma_f32_16x16x32_bf16 v[112:115], v[76:79], v[56:59], v[112:115]
    s_setprio 1
    ds_read_b128 v[72:75], v4 offset:4096
    v_exp_f32 v157, v157
    v_mfma_f32_16x16x32_bf16 v[120:123], v[76:79], v[60:63], v[120:123]
    s_nop 1
    v_add_f32_dpp v255, v255, v255 row_half_mirror row_mask:0xf bank_mask:0xf
    s_waitcnt lgkmcnt(5)
    v_mfma_f32_16x16x32_bf16 v[116:119], v[80:83], v[32:35], v[16:19]
    ds_read_b128 v[76:79], v4 offset:6144
    v_cvt_pk_bf16_f32 v153, v154, v155
    v_mfma_f32_16x16x32_bf16 v[124:127], v[80:83], v[36:39], v[20:23]
    v_exp_f32 v158, v158
    s_nop 1
    v_add_f32_dpp v255, v255, v255 row_mirror row_mask:0xf bank_mask:0xf
    v_mfma_f32_16x16x32_bf16 v[116:119], v[84:87], v[40:43], v[116:119]
    ds_read_b128 v[80:83], v4 offset:8192
    v_exp_f32 v159, v159
    v_mfma_f32_16x16x32_bf16 v[124:127], v[84:87], v[44:47], v[124:127]
    s_nop 1
    v_add_f32_dpp v255, v255, v255 row_bcast:15 row_mask:0xa bank_mask:0xf
    s_waitcnt lgkmcnt(5)
    v_mfma_f32_16x16x32_bf16 v[116:119], v[88:91], v[48:51], v[116:119]
    ds_read_b128 v[84:87], v4 offset:10240
    v_cvt_pk_bf16_f32 v154, v156, v157
    v_mfma_f32_16x16x32_bf16 v[124:127], v[88:91], v[52:55], v[124:127]
    s_nop 0
    s_nop 1
    v_add_f32_dpp v255, v255, v255 row_bcast:31 row_mask:0xc bank_mask:0xf
    v_mfma_f32_16x16x32_bf16 v[116:119], v[92:95], v[56:59], v[116:119]
    ds_read_b128 v[88:91], v4 offset:12288
    v_cvt_pk_bf16_f32 v155, v158, v159
    v_mfma_f32_16x16x32_bf16 v[124:127], v[92:95], v[60:63], v[124:127]
    s_bitcmp1_b32 s44, s62
    s_cbranch_scc1 A_evb_200
A_evbret_201:
    s_waitcnt lgkmcnt(5)
    v_mfma_f32_16x16x32_bf16 v[160:163], v[64:67], v[128:131], v[160:163]
    ds_read_b128 v[92:95], v4 offset:14336
    v_max3_f32 v8, v96, v97, v98
    v_max3_f32 v8, v8, v99, v100
    v_mfma_f32_16x16x32_bf16 v[168:171], v[64:67], v[136:139], v[168:171]
    v_max3_f32 v8, v8, v101, v102
    v_max3_f32 v8, v8, v103, v104
    v_mul_f32 v255, 0xbfb8aa3b, v255
    v_mfma_f32_16x16x32_bf16 v[164:167], v[68:71], v[128:131], v[164:167]
    ds_read_b128 v[64:67], v4 offset:1024
    v_max3_f32 v8, v8, v105, v106
    v_mfma_f32_16x16x32_bf16 v[172:175], v[68:71], v[136:139], v[172:175]
    v_max3_f32 v8, v8, v107, v108
    v_max3_f32 v8, v8, v109, v110
    s_waitcnt lgkmcnt(5)
    v_mfma_f32_16x16x32_bf16 v[176:179], v[72:75], v[128:131], v[176:179]
    ds_read_b128 v[68:71], v4 offset:3072
    v_max3_f32 v14, v111, v112, v113
    v_max3_f32 v14, v14, v114, v115
    v_mfma_f32_16x16x32_bf16 v[184:187], v[72:75], v[136:139], v[184:187]
    v_max3_f32 v14, v14, v116, v117
    v_max3_f32 v14, v14, v118, v119
    v_max3_f32 v14, v14, v120, v121
    v_exp_f32 v255, v255
    v_mfma_f32_16x16x32_bf16 v[180:183], v[76:79], v[128:131], v[180:183]
    ds_read_b128 v[72:75], v4 offset:5120
    v_max3_f32 v14, v14, v122, v123
    v_max3_f32 v14, v14, v124, v125
    v_mfma_f32_16x16x32_bf16 v[188:191], v[76:79], v[136:139], v[188:191]
    s_setprio 0
    v_max3_f32 v14, v14, v126, v127
    v_max_f32 v8, v8, v14
    v_cmp_lt_f32 vcc, 0x41000000, v8
    s_cmp_eq_u32 s101, 1
    s_cbranch_scc1 A_slow_203
    s_cbranch_vccnz A_slow_203
A_slowret_204:
    s_waitcnt lgkmcnt(5)
    v_mfma_f32_16x16x32_bf16 v[192:195], v[80:83], v[128:131], v[192:195]
    ds_read_b128 v[76:79], v4 offset:7168
    v_exp_f32 v96, v96
    v_mfma_f32_16x16x32_bf16 v[200:203], v[80:83], v[136:139], v[200:203]
    v_exp_f32 v97, v97
    s_add_u32 s63, s12, 98304
    v_add_u32 v3, s63, v2
    s_add_u32 s62, s62, 1
    s_mov_b32 s33, s18
    s_mov_b32 s34, s19
    s_mov_b32 s35, s32
    s_mov_b32 s8, s13
    s_mov_b32 s13, s12
    v_mfma_f32_16x16x32_bf16 v[196:199], v[84:87], v[128:131], v[196:199]
    ds_read_b128 v[80:83], v4 offset:9216
    v_exp_f32 v98, v98
    v_mfma_f32_16x16x32_bf16 v[204:207], v[84:87], v[136:139], v[204:207]
    v_exp_f32 v99, v99
    v_mfma_f32_16x16x32_bf16 v[24:27], v[224:227], v[128:131], v[24:27]
    s_nop 0
    v_add_f32 v255, 1.0, v255
    s_waitcnt lgkmcnt(5)
    v_mfma_f32_16x16x32_bf16 v[208:211], v[88:91], v[128:131], v[208:211]
    ds_read_b128 v[84:87], v4 offset:11264
    v_cvt_pk_bf16_f32 v96, v96, v97
    v_mfma_f32_16x16x32_bf16 v[216:219], v[88:91], v[136:139], v[216:219]
    v_exp_f32 v100, v100
    v_mfma_f32_16x16x32_bf16 v[28:31], v[224:227], v[136:139], v[28:31]
    v_mfma_f32_16x16x32_bf16 v[212:215], v[92:95], v[128:131], v[212:215]
    ds_read_b128 v[88:91], v4 offset:13312
    v_exp_f32 v101, v101
    v_mfma_f32_16x16x32_bf16 v[220:223], v[92:95], v[136:139], v[220:223]
    v_cvt_pk_bf16_f32 v97, v98, v99
    v_rcp_f32 v255, v255
    v_mov_b32 v253, 0
    s_add_u32 s63, s62, 2
    s_lshl_b32 s96, s63, 1
    s_sub_u32 s96, s96, s61
    s_lshr_b32 s19, s9, 1
    s_cmp_ge_u32 s63, s61
    s_cselect_b32 s96, s96, s63
    s_cselect_b32 s19, s9, s19
    s_cselect_b32 s32, 4, 2
    s_cselect_b32 s12, s45, 0
    s_lshl_b32 s96, s96, 14
    s_add_u32 s18, s96, s19
    s_add_u32 s18, s18, s99
    s_cmp_gt_u32 s63, 16
    s_cselect_b32 s32, 0, s32
    s_waitcnt lgkmcnt(5)
    v_mfma_f32_16x16x32_bf16 v[160:163], v[64:67], v[144:147], v[160:163]
    ds_read_b128 v[92:95], v4 offset:15360
    v_exp_f32 v102, v102
    v_mfma_f32_16x16x32_bf16 v[168:171], v[64:67], v[152:155], v[168:171]
    v_exp_f32 v103, v103
    v_mfma_f32_16x16x32_bf16 v[164:167], v[68:71], v[144:147], v[164:167]
    v_cvt_pk_bf16_f32 v98, v100, v101
    v_mfma_f32_16x16x32_bf16 v[172:175], v[68:71], v[152:155], v[172:175]
    v_exp_f32 v104, v104
    s_waitcnt lgkmcnt(4)
    v_mfma_f32_16x16x32_bf16 v[176:179], v[72:75], v[144:147], v[176:179]
    v_exp_f32 v105, v105
    v_mfma_f32_16x16x32_bf16 v[184:187], v[72:75], v[152:155], v[184:187]
    s_waitcnt vmcnt(0) lgkmcnt(0)
    s_barrier
    s_setprio 3
    s_add_u32 s52, s14, 0x3c00000
    s_addc_u32 s53, s15, 0
    s_mov_b32 s54, 0x2000
    s_mov_b32 s55, 0x00020000
    s_lshr_b32 s96, s48, 8
    s_mov_b32 exec_lo, 0
    s_mov_b32 exec_hi, 0x80000000
    buffer_store_dword v255, v253, s[52:55], s96 offen sc1
    s_mov_b64 exec, -1
    ds_read_b128 v[64:67], v3 offset:0
    ds_read_b128 v[68:71], v3 offset:1024
    v_cvt_pk_bf16_f32 v99, v102, v103
    v_mfma_f32_16x16x32_bf16 v[180:183], v[76:79], v[144:147], v[180:183]
    ds_read_b128 v[72:75], v3 offset:2048
    v_exp_f32 v106, v106
    v_mfma_f32_16x16x32_bf16 v[188:191], v[76:79], v[152:155], v[188:191]
    v_exp_f32 v107, v107
    s_add_u32 m0, s19, 131072
    s_cmp_le_u32 s32, 0
    s_cbranch_scc1 A_d_207
    buffer_load_dwordx4 v2, s[20:23], s18 offen offset:0 sc1 lds
A_d_207:
    v_mfma_f32_16x16x32_bf16 v[192:195], v[80:83], v[144:147], v[192:195]
    ds_read_b128 v[76:79], v3 offset:3072
    v_cvt_pk_bf16_f32 v104, v104, v105
    v_mfma_f32_16x16x32_bf16 v[200:203], v[80:83], v[152:155], v[200:203]
    v_exp_f32 v108, v108
    v_mfma_f32_16x16x32_bf16 v[24:27], v[224:227], v[144:147], v[24:27]
    v_mfma_f32_16x16x32_bf16 v[196:199], v[84:87], v[144:147], v[196:199]
    ds_read_b128 v[80:83], v3 offset:4096
    v_exp_f32 v109, v109
    v_mfma_f32_16x16x32_bf16 v[204:207], v[84:87], v[152:155], v[204:207]
    v_cvt_pk_bf16_f32 v105, v106, v107
    s_add_u32 m0, s19, 131072
    s_cmp_le_u32 s32, 1
    s_cbranch_scc1 A_d_208
    buffer_load_dwordx4 v2, s[20:23], s18 offen offset:1024 sc1 lds
A_d_208:
    v_mfma_f32_16x16x32_bf16 v[208:211], v[88:91], v[144:147], v[208:211]
    ds_read_b128 v[84:87], v3 offset:5120
    v_exp_f32 v110, v110
    v_mfma_f32_16x16x32_bf16 v[216:219], v[88:91], v[152:155], v[216:219]
    v_exp_f32 v111, v111
    v_mfma_f32_16x16x32_bf16 v[28:31], v[224:227], v[152:155], v[28:31]
    v_mfma_f32_16x16x32_bf16 v[212:215], v[92:95], v[144:147], v[212:215]
    ds_read_b128 v[88:91], v3 offset:6144
    v_cvt_pk_bf16_f32 v106, v108, v109
    v_mfma_f32_16x16x32_bf16 v[220:223], v[92:95], v[152:155], v[220:223]
    s_nop 0
    v_cvt_pk_bf16_f32 v107, v110, v111
    s_add_u32 m0, s19, 131072
    s_cmp_le_u32 s32, 2
    s_cbranch_scc1 A_d_209
    buffer_load_dwordx4 v2, s[20:23], s18 offen offset:2048 sc1 lds
A_d_209:
    s_cmp_lg_u32 s98, 0
    s_cbranch_scc1 A_resc_210
A_rescret_211:
    s_add_u32 s63, s8, 0
    v_add_u32 v4, s63, v2
    s_waitcnt lgkmcnt(5)
    v_mfma_f32_16x16x32_bf16 v[128:131], v[64:67], v[32:35], v[16:19]
    ds_read_b128 v[92:95], v3 offset:7168
    v_exp_f32 v112, v112
    v_mfma_f32_16x16x32_bf16 v[136:139], v[64:67], v[36:39], v[20:23]
    v_exp_f32 v113, v113
    v_lshlrev_b32 v252, 16, v228
    v_lshlrev_b32 v253, 16, v232
    v_add_f32 v236, v252, v253
    v_mul_f32 v237, v252, v252
    v_fmac_f32 v237, v253, v253
    v_mfma_f32_16x16x32_bf16 v[128:131], v[68:71], v[40:43], v[128:131]
    ds_read_b128 v[64:67], v3 offset:8192
    v_exp_f32 v114, v114
    v_mfma_f32_16x16x32_bf16 v[136:139], v[68:71], v[44:47], v[136:139]
    v_exp_f32 v115, v115
    v_and_b32 v252, 0xffff0000, v228
    v_and_b32 v253, 0xffff0000, v232
    v_add_f32 v238, v252, v253
    v_mul_f32 v239, v252, v252
    v_fmac_f32 v239, v253, v253
    s_add_u32 m0, s19, 131072
    s_cmp_le_u32 s32, 3
    s_cbranch_scc1 A_d_213
    buffer_load_dwordx4 v2, s[20:23], s18 offen offset:3072 sc1 lds
A_d_213:
    s_waitcnt lgkmcnt(5)
    v_mfma_f32_16x16x32_bf16 v[128:131], v[72:75], v[48:51], v[128:131]
    ds_read_b128 v[68:71], v3 offset:9216
    v_cvt_pk_bf16_f32 v112, v112, v113
    v_mfma_f32_16x16x32_bf16 v[136:139], v[72:75], v[52:55], v[136:139]
    v_lshlrev_b32 v252, 16, v229
    v_lshlrev_b32 v253, 16, v233
    v_add_f32 v240, v252, v253
    v_mul_f32 v241, v252, v252
    v_fmac_f32 v241, v253, v253
    v_mfma_f32_16x16x32_bf16 v[128:131], v[76:79], v[56:59], v[128:131]
    s_setprio 2
    ds_read_b128 v[72:75], v3 offset:10240
    v_exp_f32 v116, v116
    v_mfma_f32_16x16x32_bf16 v[136:139], v[76:79], v[60:63], v[136:139]
    v_exp_f32 v117, v117
    v_and_b32 v252, 0xffff0000, v229
    v_and_b32 v253, 0xffff0000, v233
    v_add_f32 v242, v252, v253
    v_mul_f32 v243, v252, v252
    v_fmac_f32 v243, v253, v253
    s_add_u32 m0, s34, 32768
    s_cmp_le_u32 s35, 0
    s_cbranch_scc1 A_d_214
    buffer_load_dwordx4 v2, s[24:27], s33 offen offset:0 sc1 lds
A_d_214:
    s_waitcnt lgkmcnt(5)
    v_mfma_f32_16x16x32_bf16 v[132:135], v[80:83], v[32:35], v[16:19]
    ds_read_b128 v[76:79], v3 offset:11264
    v_cvt_pk_bf16_f32 v113, v114, v115
    v_mfma_f32_16x16x32_bf16 v[140:143], v[80:83], v[36:39], v[20:23]
    v_lshlrev_b32 v252, 16, v230
    v_lshlrev_b32 v253, 16, v234
    v_add_f32 v244, v252, v253
    v_mul_f32 v245, v252, v252
    v_fmac_f32 v245, v253, v253
    v_mfma_f32_16x16x32_bf16 v[132:135], v[84:87], v[40:43], v[132:135]
    ds_read_b128 v[80:83], v3 offset:12288
    v_exp_f32 v118, v118
    v_mfma_f32_16x16x32_bf16 v[140:143], v[84:87], v[44:47], v[140:143]
    v_exp_f32 v119, v119
    v_and_b32 v252, 0xffff0000, v230
    v_and_b32 v253, 0xffff0000, v234
    v_add_f32 v246, v252, v253
    v_mul_f32 v247, v252, v252
    v_fmac_f32 v247, v253, v253
    s_add_u32 m0, s34, 32768
    s_cmp_le_u32 s35, 1
    s_cbranch_scc1 A_d_215
    buffer_load_dwordx4 v2, s[24:27], s33 offen offset:1024 sc1 lds
A_d_215:
    s_waitcnt lgkmcnt(5)
    v_mfma_f32_16x16x32_bf16 v[132:135], v[88:91], v[48:51], v[132:135]
    ds_read_b128 v[84:87], v3 offset:13312
    v_cvt_pk_bf16_f32 v114, v116, v117
    v_mfma_f32_16x16x32_bf16 v[140:143], v[88:91], v[52:55], v[140:143]
    v_lshlrev_b32 v252, 16, v231
    v_lshlrev_b32 v253, 16, v235
    v_add_f32 v248, v252, v253
    v_mul_f32 v249, v252, v252
    v_fmac_f32 v249, v253, v253
    v_mfma_f32_16x16x32_bf16 v[132:135], v[92:95], v[56:59], v[132:135]
    ds_read_b128 v[88:91], v3 offset:14336
    v_exp_f32 v120, v120
    v_mfma_f32_16x16x32_bf16 v[140:143], v[92:95], v[60:63], v[140:143]
    v_exp_f32 v121, v121
    v_and_b32 v252, 0xffff0000, v231
    v_and_b32 v253, 0xffff0000, v235
    v_add_f32 v250, v252, v253
    v_mul_f32 v251, v252, v252
    v_fmac_f32 v251, v253, v253
    s_add_u32 m0, s34, 32768
    s_cmp_le_u32 s35, 2
    s_cbranch_scc1 A_d_216
    buffer_load_dwordx4 v2, s[24:27], s33 offen offset:2048 sc1 lds
A_d_216:
    s_waitcnt lgkmcnt(5)
    v_mfma_f32_16x16x32_bf16 v[144:147], v[64:67], v[32:35], v[16:19]
    ds_read_b128 v[92:95], v3 offset:15360
    v_cvt_pk_bf16_f32 v115, v118, v119
    v_mfma_f32_16x16x32_bf16 v[152:155], v[64:67], v[36:39], v[20:23]
    v_exp_f32 v122, v122
    s_nop 1
    v_permlane32_swap_b32 v236, v244
    v_permlane32_swap_b32 v237, v245
    v_permlane32_swap_b32 v238, v246
    v_permlane32_swap_b32 v239, v247
    v_mfma_f32_16x16x32_bf16 v[144:147], v[68:71], v[40:43], v[144:147]
    ds_read_b128 v[64:67], v4 offset:0
    v_exp_f32 v123, v123
    v_mfma_f32_16x16x32_bf16 v[152:155], v[68:71], v[44:47], v[152:155]
    s_nop 1
    v_permlane32_swap_b32 v240, v248
    v_permlane32_swap_b32 v241, v249
    v_permlane32_swap_b32 v242, v250
    v_permlane32_swap_b32 v243, v251
    s_add_u32 m0, s34, 32768
    s_cmp_le_u32 s35, 3
    s_cbranch_scc1 A_d_217
    buffer_load_dwordx4 v2, s[24:27], s33 offen offset:3072 sc1 lds
A_d_217:
    s_waitcnt lgkmcnt(5)
    v_mfma_f32_16x16x32_bf16 v[144:147], v[72:75], v[48:51], v[144:147]
    ds_read_b128 v[68:71], v4 offset:2048
    v_cvt_pk_bf16_f32 v120, v120, v121
    v_mfma_f32_16x16x32_bf16 v[152:155], v[72:75], v[52:55], v[152:155]
    v_exp_f32 v124, v124
    v_add_f32 v236, v236, v244
    v_add_f32 v237, v237, v245
    v_add_f32 v238, v238, v246
    v_add_f32 v239, v239, v247
    v_mfma_f32_16x16x32_bf16 v[144:147], v[76:79], v[56:59], v[144:147]
    s_setprio 1
    ds_read_b128 v[72:75], v4 offset:4096
    v_exp_f32 v125, v125
    v_mfma_f32_16x16x32_bf16 v[152:155], v[76:79], v[60:63], v[152:155]
    v_add_f32 v240, v240, v248
    v_add_f32 v241, v241, v249
    v_add_f32 v242, v242, v250
    v_add_f32 v243, v243, v251
    s_waitcnt lgkmcnt(5)
    v_mfma_f32_16x16x32_bf16 v[148:151], v[80:83], v[32:35], v[16:19]
    ds_read_b128 v[76:79], v4 offset:6144
    v_cvt_pk_bf16_f32 v121, v122, v123
    v_mfma_f32_16x16x32_bf16 v[156:159], v[80:83], v[36:39], v[20:23]
    v_exp_f32 v126, v126
    s_nop 1
    v_permlane16_swap_b32 v236, v240
    v_permlane16_swap_b32 v237, v241
    v_permlane16_swap_b32 v238, v242
    v_permlane16_swap_b32 v239, v243
    v_mfma_f32_16x16x32_bf16 v[148:151], v[84:87], v[40:43], v[148:151]
    ds_read_b128 v[80:83], v4 offset:8192
    v_exp_f32 v127, v127
    v_mfma_f32_16x16x32_bf16 v[156:159], v[84:87], v[44:47], v[156:159]
    v_add_f32 v236, v236, v240
    v_add_f32 v237, v237, v241
    v_add_f32 v238, v238, v242
    v_add_f32 v239, v239, v243
    s_waitcnt lgkmcnt(5)
    v_mfma_f32_16x16x32_bf16 v[148:151], v[88:91], v[48:51], v[148:151]
    ds_read_b128 v[84:87], v4 offset:10240
    v_cvt_pk_bf16_f32 v122, v124, v125
    v_mfma_f32_16x16x32_bf16 v[156:159], v[88:91], v[52:55], v[156:159]
    s_nop 0
    s_lshl_b32 s96, s56, 6
    s_add_u32 s96, s96, s50
    v_add_u32 v252, s96, v1
    v_mfma_f32_16x16x32_bf16 v[148:151], v[92:95], v[56:59], v[148:151]
    ds_read_b128 v[88:91], v4 offset:12288
    v_cvt_pk_bf16_f32 v123, v126, v127
    v_mfma_f32_16x16x32_bf16 v[156:159], v[92:95], v[60:63], v[156:159]
    s_bitcmp1_b32 s44, s62
    s_cbranch_scc1 A_evb_218
A_evbret_219:
    s_waitcnt lgkmcnt(5)
    v_mfma_f32_16x16x32_bf16 v[160:163], v[64:67], v[96:99], v[160:163]
    ds_read_b128 v[92:95], v4 offset:14336
    v_max3_f32 v8, v128, v129, v130
    v_max3_f32 v8, v8, v131, v132
    v_mfma_f32_16x16x32_bf16 v[168:171], v[64:67], v[104:107], v[168:171]
    v_max3_f32 v8, v8, v133, v134
    v_max3_f32 v8, v8, v135, v136
    v_add_f32_dpp v236, v236, v236 quad_perm:[1,0,3,2] row_mask:0xf bank_mask:0xf
    v_add_f32_dpp v237, v237, v237 quad_perm:[1,0,3,2] row_mask:0xf bank_mask:0xf
    v_add_f32_dpp v238, v238, v238 quad_perm:[1,0,3,2] row_mask:0xf bank_mask:0xf
    v_add_f32_dpp v239, v239, v239 quad_perm:[1,0,3,2] row_mask:0xf bank_mask:0xf
    v_mfma_f32_16x16x32_bf16 v[164:167], v[68:71], v[96:99], v[164:167]
    ds_read_b128 v[64:67], v4 offset:1024
    v_max3_f32 v8, v8, v137, v138
    v_mfma_f32_16x16x32_bf16 v[172:175], v[68:71], v[104:107], v[172:175]
    v_max3_f32 v8, v8, v139, v140
    v_max3_f32 v8, v8, v141, v142
    v_add_f32_dpp v236, v236, v236 quad_perm:[2,3,0,1] row_mask:0xf bank_mask:0xf
    v_add_f32_dpp v237, v237, v237 quad_perm:[2,3,0,1] row_mask:0xf bank_mask:0xf
    v_add_f32_dpp v238, v238, v238 quad_perm:[2,3,0,1] row_mask:0xf bank_mask:0xf
    v_add_f32_dpp v239, v239, v239 quad_perm:[2,3,0,1] row_mask:0xf bank_mask:0xf
    s_waitcnt lgkmcnt(5)
    v_mfma_f32_16x16x32_bf16 v[176:179], v[72:75], v[96:99], v[176:179]
    ds_read_b128 v[68:71], v4 offset:3072
    v_max3_f32 v14, v143, v144, v145
    v_max3_f32 v14, v14, v146, v147
    v_mfma_f32_16x16x32_bf16 v[184:187], v[72:75], v[104:107], v[184:187]
    v_max3_f32 v14, v14, v148, v149
    v_max3_f32 v14, v14, v150, v151
    v_max3_f32 v14, v14, v152, v153
    v_mfma_f32_16x16x32_bf16 v[180:183], v[76:79], v[96:99], v[180:183]
    ds_read_b128 v[72:75], v4 offset:5120
    v_max3_f32 v14, v14, v154, v155
    v_max3_f32 v14, v14, v156, v157
    v_mfma_f32_16x16x32_bf16 v[188:191], v[76:79], v[104:107], v[188:191]
    s_setprio 0
    v_max3_f32 v14, v14, v158, v159
    v_max_f32 v8, v8, v14
    v_cmp_lt_f32 vcc, 0x41000000, v8
    s_cmp_eq_u32 s101, 1
    s_cbranch_scc1 A_slow_221
    s_cbranch_vccnz A_slow_221
A_slowret_222:
    v_add_f32_dpp v236, v236, v236 row_half_mirror row_mask:0xf bank_mask:0xf
    v_add_f32_dpp v237, v237, v237 row_half_mirror row_mask:0xf bank_mask:0xf
    v_add_f32_dpp v238, v238, v238 row_half_mirror row_mask:0xf bank_mask:0xf
    v_add_f32_dpp v239, v239, v239 row_half_mirror row_mask:0xf bank_mask:0xf
    s_waitcnt lgkmcnt(5)
    v_mfma_f32_16x16x32_bf16 v[192:195], v[80:83], v[96:99], v[192:195]
    ds_read_b128 v[76:79], v4 offset:7168
    v_exp_f32 v128, v128
    v_mfma_f32_16x16x32_bf16 v[200:203], v[80:83], v[104:107], v[200:203]
    v_exp_f32 v129, v129
    s_add_u32 s63, s12, 131072
    v_add_u32 v3, s63, v2
    s_add_u32 s62, s62, 1
    s_mov_b32 s33, s18
    s_mov_b32 s34, s19
    s_mov_b32 s35, s32
    s_mov_b32 s8, s13
    s_mov_b32 s13, s12
    v_mfma_f32_16x16x32_bf16 v[196:199], v[84:87], v[96:99], v[196:199]
    ds_read_b128 v[80:83], v4 offset:9216
    v_exp_f32 v130, v130
    v_mfma_f32_16x16x32_bf16 v[204:207], v[84:87], v[104:107], v[204:207]
    v_exp_f32 v131, v131
    v_mfma_f32_16x16x32_bf16 v[24:27], v[224:227], v[96:99], v[24:27]
    v_add_f32_dpp v236, v236, v236 row_mirror row_mask:0xf bank_mask:0xf
    v_add_f32_dpp v237, v237, v237 row_mirror row_mask:0xf bank_mask:0xf
    v_add_f32_dpp v238, v238, v238 row_mirror row_mask:0xf bank_mask:0xf
    v_add_f32_dpp v239, v239, v239 row_mirror row_mask:0xf bank_mask:0xf
    s_waitcnt lgkmcnt(5)
    v_mfma_f32_16x16x32_bf16 v[208:211], v[88:91], v[96:99], v[208:211]
    ds_read_b128 v[84:87], v4 offset:11264
    v_cvt_pk_bf16_f32 v128, v128, v129
    v_mfma_f32_16x16x32_bf16 v[216:219], v[88:91], v[104:107], v[216:219]
    v_exp_f32 v132, v132
    v_mfma_f32_16x16x32_bf16 v[28:31], v[224:227], v[104:107], v[28:31]
    s_mov_b32 exec_lo, 0x00010001
    s_mov_b32 exec_hi, 0x00010001
    ds_write_b128 v252, v[236:239]
    s_mov_b64 exec, -1
    v_mfma_f32_16x16x32_bf16 v[212:215], v[92:95], v[96:99], v[212:215]
    ds_read_b128 v[88:91], v4 offset:13312
    v_exp_f32 v133, v133
    v_mfma_f32_16x16x32_bf16 v[220:223], v[92:95], v[104:107], v[220:223]
    v_cvt_pk_bf16_f32 v129, v130, v131
    s_add_u32 s63, s62, 2
    s_lshl_b32 s96, s63, 1
    s_sub_u32 s96, s96, s61
    s_lshr_b32 s19, s9, 1
    s_cmp_ge_u32 s63, s61
    s_cselect_b32 s96, s96, s63
    s_cselect_b32 s19, s9, s19
    s_cselect_b32 s32, 4, 2
    s_cselect_b32 s12, s45, 0
    s_lshl_b32 s96, s96, 14
    s_add_u32 s18, s96, s19
    s_add_u32 s18, s18, s99
    s_cmp_gt_u32 s63, 16
    s_cselect_b32 s32, 0, s32
    s_waitcnt lgkmcnt(5)
    v_mfma_f32_16x16x32_bf16 v[160:163], v[64:67], v[112:115], v[160:163]
    ds_read_b128 v[92:95], v4 offset:15360
    v_exp_f32 v134, v134
    v_mfma_f32_16x16x32_bf16 v[168:171], v[64:67], v[120:123], v[168:171]
    v_exp_f32 v135, v135
    v_lshlrev_b32 v252, 3, v1
    v_add_u32 v252, s50, v252
    v_mfma_f32_16x16x32_bf16 v[164:167], v[68:71], v[112:115], v[164:167]
    v_cvt_pk_bf16_f32 v130, v132, v133
    v_mfma_f32_16x16x32_bf16 v[172:175], v[68:71], v[120:123], v[172:175]
    v_exp_f32 v136, v136
    s_waitcnt lgkmcnt(4)
    v_mfma_f32_16x16x32_bf16 v[176:179], v[72:75], v[112:115], v[176:179]
    v_exp_f32 v137, v137
    v_mfma_f32_16x16x32_bf16 v[184:187], v[72:75], v[120:123], v[184:187]
    s_waitcnt vmcnt(0) lgkmcnt(0)
    s_barrier
    s_setprio 3
    ds_read_b64 v[250:251], v252
    ds_read_b128 v[64:67], v3 offset:0
    ds_read_b128 v[68:71], v3 offset:1024
    v_cvt_pk_bf16_f32 v131, v134, v135
    v_mfma_f32_16x16x32_bf16 v[180:183], v[76:79], v[112:115], v[180:183]
    ds_read_b128 v[72:75], v3 offset:2048
    v_exp_f32 v138, v138
    v_mfma_f32_16x16x32_bf16 v[188:191], v[76:79], v[120:123], v[188:191]
    v_exp_f32 v139, v139
    s_add_u32 m0, s19, 98304
    s_cmp_le_u32 s32, 0
    s_cbranch_scc1 A_d_225
    buffer_load_dwordx4 v2, s[20:23], s18 offen offset:0 sc1 lds
A_d_225:
    v_mfma_f32_16x16x32_bf16 v[192:195], v[80:83], v[112:115], v[192:195]
    ds_read_b128 v[76:79], v3 offset:3072
    v_cvt_pk_bf16_f32 v136, v136, v137
    v_mfma_f32_16x16x32_bf16 v[200:203], v[80:83], v[120:123], v[200:203]
    v_exp_f32 v140, v140
    v_mfma_f32_16x16x32_bf16 v[24:27], v[224:227], v[112:115], v[24:27]
    v_mfma_f32_16x16x32_bf16 v[196:199], v[84:87], v[112:115], v[196:199]
    ds_read_b128 v[80:83], v3 offset:4096
    v_exp_f32 v141, v141
    v_mfma_f32_16x16x32_bf16 v[204:207], v[84:87], v[120:123], v[204:207]
    v_cvt_pk_bf16_f32 v137, v138, v139
    s_add_u32 m0, s19, 98304
    s_cmp_le_u32 s32, 1
    s_cbranch_scc1 A_d_226
    buffer_load_dwordx4 v2, s[20:23], s18 offen offset:1024 sc1 lds
A_d_226:
    v_mfma_f32_16x16x32_bf16 v[208:211], v[88:91], v[112:115], v[208:211]
    ds_read_b128 v[84:87], v3 offset:5120
    v_exp_f32 v142, v142
    v_mfma_f32_16x16x32_bf16 v[216:219], v[88:91], v[120:123], v[216:219]
    v_exp_f32 v143, v143
    v_mfma_f32_16x16x32_bf16 v[28:31], v[224:227], v[120:123], v[28:31]
    v_mfma_f32_16x16x32_bf16 v[212:215], v[92:95], v[112:115], v[212:215]
    ds_read_b128 v[88:91], v3 offset:6144
    v_cvt_pk_bf16_f32 v138, v140, v141
    v_mfma_f32_16x16x32_bf16 v[220:223], v[92:95], v[120:123], v[220:223]
    s_nop 0
    v_cvt_pk_bf16_f32 v139, v142, v143
    s_add_u32 m0, s19, 98304
    s_cmp_le_u32 s32, 2
    s_cbranch_scc1 A_d_227
    buffer_load_dwordx4 v2, s[20:23], s18 offen offset:2048 sc1 lds
A_d_227:
    s_cmp_lg_u32 s98, 0
    s_cbranch_scc1 A_resc_228
A_rescret_229:
    s_add_u32 s63, s8, 32768
    v_add_u32 v4, s63, v2
    s_waitcnt lgkmcnt(5)
    v_mfma_f32_16x16x32_bf16 v[96:99], v[64:67], v[32:35], v[16:19]
    ds_read_b128 v[92:95], v3 offset:7168
    v_exp_f32 v144, v144
    v_mfma_f32_16x16x32_bf16 v[104:107], v[64:67], v[36:39], v[20:23]
    v_exp_f32 v145, v145
    v_mfma_f32_16x16x32_bf16 v[96:99], v[68:71], v[40:43], v[96:99]
    ds_read_b128 v[64:67], v3 offset:8192
    v_exp_f32 v146, v146
    v_mfma_f32_16x16x32_bf16 v[104:107], v[68:71], v[44:47], v[104:107]
    v_exp_f32 v147, v147
    v_lshrrev_b32 v248, 5, v1
    s_lshl_b32 s63, s56, 1
    v_add_u32 v248, s63, v248
    v_lshlrev_b32 v248, 17, v248
    s_add_u32 m0, s19, 98304
    s_cmp_le_u32 s32, 3
    s_cbranch_scc1 A_d_231
    buffer_load_dwordx4 v2, s[20:23], s18 offen offset:3072 sc1 lds
A_d_231:
    s_waitcnt lgkmcnt(5)
    v_mfma_f32_16x16x32_bf16 v[96:99], v[72:75], v[48:51], v[96:99]
    ds_read_b128 v[68:71], v3 offset:9216
    v_cvt_pk_bf16_f32 v144, v144, v145
    v_mfma_f32_16x16x32_bf16 v[104:107], v[72:75], v[52:55], v[104:107]
    v_and_b32 v249, 31, v1
    v_lshlrev_b32 v249, 4, v249
    v_add_u32 v248, v248, v249
    v_add_u32 v249, 2097152, v248
    v_mfma_f32_16x16x32_bf16 v[96:99], v[76:79], v[56:59], v[96:99]
    s_setprio 2
    ds_read_b128 v[72:75], v3 offset:10240
    v_exp_f32 v148, v148
    v_mfma_f32_16x16x32_bf16 v[104:107], v[76:79], v[60:63], v[104:107]
    v_exp_f32 v149, v149
    v_add_f32_dpp v250, v250, v250 row_ror:8 row_mask:0xf bank_mask:0xf
    v_add_f32_dpp v251, v251, v251 row_ror:8 row_mask:0xf bank_mask:0xf
    s_add_u32 m0, s34, 0
    s_cmp_le_u32 s35, 0
    s_cbranch_scc1 A_d_232
    buffer_load_dwordx4 v2, s[24:27], s33 offen offset:0 sc1 lds
A_d_232:
    s_waitcnt lgkmcnt(5)
    v_mfma_f32_16x16x32_bf16 v[100:103], v[80:83], v[32:35], v[16:19]
    ds_read_b128 v[76:79], v3 offset:11264
    v_cvt_pk_bf16_f32 v145, v146, v147
    v_mfma_f32_16x16x32_bf16 v[108:111], v[80:83], v[36:39], v[20:23]
    v_mov_b32 v252, v250
    v_mov_b32 v253, v251
    s_nop 1
    v_permlane16_swap_b32 v250, v252
    v_permlane16_swap_b32 v251, v253
    v_mfma_f32_16x16x32_bf16 v[100:103], v[84:87], v[40:43], v[100:103]
    ds_read_b128 v[80:83], v3 offset:12288
    v_exp_f32 v150, v150
    v_mfma_f32_16x16x32_bf16 v[108:111], v[84:87], v[44:47], v[108:111]
    v_exp_f32 v151, v151
    s_nop 1
    v_add_f32 v250, v250, v252
    v_add_f32 v251, v251, v253
    s_add_u32 m0, s34, 0
    s_cmp_le_u32 s35, 1
    s_cbranch_scc1 A_d_233
    buffer_load_dwordx4 v2, s[24:27], s33 offen offset:1024 sc1 lds
A_d_233:
    s_waitcnt lgkmcnt(5)
    v_mfma_f32_16x16x32_bf16 v[100:103], v[88:91], v[48:51], v[100:103]
    ds_read_b128 v[84:87], v3 offset:13312
    v_cvt_pk_bf16_f32 v146, v148, v149
    v_mfma_f32_16x16x32_bf16 v[108:111], v[88:91], v[52:55], v[108:111]
    v_mov_b32 v252, v250
    v_mov_b32 v253, v251
    s_nop 1
    v_permlane32_swap_b32 v250, v252
    v_permlane32_swap_b32 v251, v253
    v_mfma_f32_16x16x32_bf16 v[100:103], v[92:95], v[56:59], v[100:103]
    ds_read_b128 v[88:91], v3 offset:14336
    v_exp_f32 v152, v152
    v_mfma_f32_16x16x32_bf16 v[108:111], v[92:95], v[60:63], v[108:111]
    v_exp_f32 v153, v153
    s_nop 1
    v_add_f32 v250, v250, v252
    v_add_f32 v251, v251, v253
    s_add_u32 m0, s34, 0
    s_cmp_le_u32 s35, 2
    s_cbranch_scc1 A_d_234
    buffer_load_dwordx4 v2, s[24:27], s33 offen offset:2048 sc1 lds
A_d_234:
    s_waitcnt lgkmcnt(5)
    v_mfma_f32_16x16x32_bf16 v[112:115], v[64:67], v[32:35], v[16:19]
    ds_read_b128 v[92:95], v3 offset:15360
    v_cvt_pk_bf16_f32 v147, v150, v151
    v_mfma_f32_16x16x32_bf16 v[120:123], v[64:67], v[36:39], v[20:23]
    v_exp_f32 v154, v154
    v_mul_f32 v250, 0x3a924925, v250
    v_mul_f32 v251, 0x3a924925, v251
    v_fma_f32 v251, -v250, v250, v251
    v_mfma_f32_16x16x32_bf16 v[112:115], v[68:71], v[40:43], v[112:115]
    ds_read_b128 v[64:67], v4 offset:0
    v_exp_f32 v155, v155
    v_mfma_f32_16x16x32_bf16 v[120:123], v[68:71], v[44:47], v[120:123]
    v_max_f32 v251, 0, v251
    v_add_f32 v251, 0x3727c5ac, v251
    v_rsq_f32 v251, v251
    s_add_u32 m0, s34, 0
    s_cmp_le_u32 s35, 3
    s_cbranch_scc1 A_d_235
    buffer_load_dwordx4 v2, s[24:27], s33 offen offset:3072 sc1 lds
A_d_235:
    s_waitcnt lgkmcnt(5)
    v_mfma_f32_16x16x32_bf16 v[112:115], v[72:75], v[48:51], v[112:115]
    ds_read_b128 v[68:71], v4 offset:2048
    v_cvt_pk_bf16_f32 v152, v152, v153
    v_mfma_f32_16x16x32_bf16 v[120:123], v[72:75], v[52:55], v[120:123]
    v_exp_f32 v156, v156
    v_lshlrev_b32 v236, 16, v228
    v_lshlrev_b32 v240, 16, v232
    v_and_b32 v237, 0xffff0000, v228
    v_and_b32 v241, 0xffff0000, v232
    v_lshlrev_b32 v238, 16, v229
    v_lshlrev_b32 v242, 16, v233
    v_and_b32 v239, 0xffff0000, v229
    v_and_b32 v243, 0xffff0000, v233
    v_mfma_f32_16x16x32_bf16 v[112:115], v[76:79], v[56:59], v[112:115]
    s_setprio 1
    ds_read_b128 v[72:75], v4 offset:4096
    v_exp_f32 v157, v157
    v_mfma_f32_16x16x32_bf16 v[120:123], v[76:79], v[60:63], v[120:123]
    v_subrev_f32_dpp v236, v250, v236 row_newbcast:0 row_mask:0xf bank_mask:0xf
    v_subrev_f32_dpp v240, v250, v240 row_newbcast:0 row_mask:0xf bank_mask:0xf
    v_mul_f32_dpp v236, v251, v236 row_newbcast:0 row_mask:0xf bank_mask:0xf
    v_mul_f32_dpp v240, v251, v240 row_newbcast:0 row_mask:0xf bank_mask:0xf
    s_waitcnt lgkmcnt(5)
    v_mfma_f32_16x16x32_bf16 v[116:119], v[80:83], v[32:35], v[16:19]
    ds_read_b128 v[76:79], v4 offset:6144
    v_cvt_pk_bf16_f32 v153, v154, v155
    v_mfma_f32_16x16x32_bf16 v[124:127], v[80:83], v[36:39], v[20:23]
    v_exp_f32 v158, v158
    v_subrev_f32_dpp v237, v250, v237 row_newbcast:1 row_mask:0xf bank_mask:0xf
    v_subrev_f32_dpp v241, v250, v241 row_newbcast:1 row_mask:0xf bank_mask:0xf
    v_mul_f32_dpp v237, v251, v237 row_newbcast:1 row_mask:0xf bank_mask:0xf
    v_mul_f32_dpp v241, v251, v241 row_newbcast:1 row_mask:0xf bank_mask:0xf
    v_mfma_f32_16x16x32_bf16 v[116:119], v[84:87], v[40:43], v[116:119]
    ds_read_b128 v[80:83], v4 offset:8192
    v_exp_f32 v159, v159
    v_mfma_f32_16x16x32_bf16 v[124:127], v[84:87], v[44:47], v[124:127]
    v_subrev_f32_dpp v238, v250, v238 row_newbcast:2 row_mask:0xf bank_mask:0xf
    v_subrev_f32_dpp v242, v250, v242 row_newbcast:2 row_mask:0xf bank_mask:0xf
    v_mul_f32_dpp v238, v251, v238 row_newbcast:2 row_mask:0xf bank_mask:0xf
    v_mul_f32_dpp v242, v251, v242 row_newbcast:2 row_mask:0xf bank_mask:0xf
    s_waitcnt lgkmcnt(5)
    v_mfma_f32_16x16x32_bf16 v[116:119], v[88:91], v[48:51], v[116:119]
    ds_read_b128 v[84:87], v4 offset:10240
    v_cvt_pk_bf16_f32 v154, v156, v157
    v_mfma_f32_16x16x32_bf16 v[124:127], v[88:91], v[52:55], v[124:127]
    s_nop 0
    v_subrev_f32_dpp v239, v250, v239 row_newbcast:3 row_mask:0xf bank_mask:0xf
    v_subrev_f32_dpp v243, v250, v243 row_newbcast:3 row_mask:0xf bank_mask:0xf
    v_mul_f32_dpp v239, v251, v239 row_newbcast:3 row_mask:0xf bank_mask:0xf
    v_mul_f32_dpp v243, v251, v243 row_newbcast:3 row_mask:0xf bank_mask:0xf
    v_mfma_f32_16x16x32_bf16 v[116:119], v[92:95], v[56:59], v[116:119]
    ds_read_b128 v[88:91], v4 offset:12288
    v_cvt_pk_bf16_f32 v155, v158, v159
    v_mfma_f32_16x16x32_bf16 v[124:127], v[92:95], v[60:63], v[124:127]
    v_cvt_pk_bf16_f32 v228, v236, v237
    v_cvt_pk_bf16_f32 v232, v240, v241
    v_cvt_pk_bf16_f32 v229, v238, v239
    v_cvt_pk_bf16_f32 v233, v242, v243
    s_bitcmp1_b32 s44, s62
    s_cbranch_scc1 A_evb_236
A_evbret_237:
    s_waitcnt lgkmcnt(5)
    v_mfma_f32_16x16x32_bf16 v[160:163], v[64:67], v[128:131], v[160:163]
    ds_read_b128 v[92:95], v4 offset:14336
    v_max3_f32 v8, v96, v97, v98
    v_max3_f32 v8, v8, v99, v100
    v_mfma_f32_16x16x32_bf16 v[168:171], v[64:67], v[136:139], v[168:171]
    v_max3_f32 v8, v8, v101, v102
    v_max3_f32 v8, v8, v103, v104
    v_lshlrev_b32 v236, 16, v230
    v_lshlrev_b32 v240, 16, v234
    v_and_b32 v237, 0xffff0000, v230
    v_and_b32 v241, 0xffff0000, v234
    v_lshlrev_b32 v238, 16, v231
    v_lshlrev_b32 v242, 16, v235
    v_and_b32 v239, 0xffff0000, v231
    v_and_b32 v243, 0xffff0000, v235
    v_mfma_f32_16x16x32_bf16 v[164:167], v[68:71], v[128:131], v[164:167]
    ds_read_b128 v[64:67], v4 offset:1024
    v_max3_f32 v8, v8, v105, v106
    v_mfma_f32_16x16x32_bf16 v[172:175], v[68:71], v[136:139], v[172:175]
    v_max3_f32 v8, v8, v107, v108
    v_max3_f32 v8, v8, v109, v110
    v_subrev_f32_dpp v236, v250, v236 row_newbcast:4 row_mask:0xf bank_mask:0xf
    v_subrev_f32_dpp v240, v250, v240 row_newbcast:4 row_mask:0xf bank_mask:0xf
    v_mul_f32_dpp v236, v251, v236 row_newbcast:4 row_mask:0xf bank_mask:0xf
    v_mul_f32_dpp v240, v251, v240 row_newbcast:4 row_mask:0xf bank_mask:0xf
    s_waitcnt lgkmcnt(5)
    v_mfma_f32_16x16x32_bf16 v[176:179], v[72:75], v[128:131], v[176:179]
    ds_read_b128 v[68:71], v4 offset:3072
    v_max3_f32 v14, v111, v112, v113
    v_max3_f32 v14, v14, v114, v115
    v_mfma_f32_16x16x32_bf16 v[184:187], v[72:75], v[136:139], v[184:187]
    v_max3_f32 v14, v14, v116, v117
    v_max3_f32 v14, v14, v118, v119
    v_max3_f32 v14, v14, v120, v121
    v_mfma_f32_16x16x32_bf16 v[180:183], v[76:79], v[128:131], v[180:183]
    ds_read_b128 v[72:75], v4 offset:5120
    v_max3_f32 v14, v14, v122, v123
    v_max3_f32 v14, v14, v124, v125
    v_mfma_f32_16x16x32_bf16 v[188:191], v[76:79], v[136:139], v[188:191]
    s_setprio 0
    v_max3_f32 v14, v14, v126, v127
    v_max_f32 v8, v8, v14
    v_cmp_lt_f32 vcc, 0x41000000, v8
    s_cmp_eq_u32 s101, 1
    s_cbranch_scc1 A_slow_239
    s_cbranch_vccnz A_slow_239
A_slowret_240:
    v_subrev_f32_dpp v237, v250, v237 row_newbcast:5 row_mask:0xf bank_mask:0xf
    v_subrev_f32_dpp v241, v250, v241 row_newbcast:5 row_mask:0xf bank_mask:0xf
    v_mul_f32_dpp v237, v251, v237 row_newbcast:5 row_mask:0xf bank_mask:0xf
    v_mul_f32_dpp v241, v251, v241 row_newbcast:5 row_mask:0xf bank_mask:0xf
    s_waitcnt lgkmcnt(5)
    v_mfma_f32_16x16x32_bf16 v[192:195], v[80:83], v[128:131], v[192:195]
    ds_read_b128 v[76:79], v4 offset:7168
    v_exp_f32 v96, v96
    v_mfma_f32_16x16x32_bf16 v[200:203], v[80:83], v[136:139], v[200:203]
    v_exp_f32 v97, v97
    s_add_u32 s63, s12, 98304
    v_add_u32 v3, s63, v2
    s_add_u32 s62, s62, 1
    s_mov_b32 s33, s18
    s_mov_b32 s34, s19
    s_mov_b32 s35, s32
    s_mov_b32 s8, s13
    s_mov_b32 s13, s12
    v_mfma_f32_16x16x32_bf16 v[196:199], v[84:87], v[128:131], v[196:199]
    ds_read_b128 v[80:83], v4 offset:9216
    v_exp_f32 v98, v98
    v_mfma_f32_16x16x32_bf16 v[204:207], v[84:87], v[136:139], v[204:207]
    v_exp_f32 v99, v99
    v_mfma_f32_16x16x32_bf16 v[24:27], v[224:227], v[128:131], v[24:27]
    v_subrev_f32_dpp v238, v250, v238 row_newbcast:6 row_mask:0xf bank_mask:0xf
    v_subrev_f32_dpp v242, v250, v242 row_newbcast:6 row_mask:0xf bank_mask:0xf
    v_mul_f32_dpp v238, v251, v238 row_newbcast:6 row_mask:0xf bank_mask:0xf
    v_mul_f32_dpp v242, v251, v242 row_newbcast:6 row_mask:0xf bank_mask:0xf
    s_waitcnt lgkmcnt(5)
    v_mfma_f32_16x16x32_bf16 v[208:211], v[88:91], v[128:131], v[208:211]
    ds_read_b128 v[84:87], v4 offset:11264
    v_cvt_pk_bf16_f32 v96, v96, v97
    v_mfma_f32_16x16x32_bf16 v[216:219], v[88:91], v[136:139], v[216:219]
    v_exp_f32 v100, v100
    v_mfma_f32_16x16x32_bf16 v[28:31], v[224:227], v[136:139], v[28:31]
    v_subrev_f32_dpp v239, v250, v239 row_newbcast:7 row_mask:0xf bank_mask:0xf
    v_subrev_f32_dpp v243, v250, v243 row_newbcast:7 row_mask:0xf bank_mask:0xf
    v_mul_f32_dpp v239, v251, v239 row_newbcast:7 row_mask:0xf bank_mask:0xf
    v_mul_f32_dpp v243, v251, v243 row_newbcast:7 row_mask:0xf bank_mask:0xf
    v_mfma_f32_16x16x32_bf16 v[212:215], v[92:95], v[128:131], v[212:215]
    ds_read_b128 v[88:91], v4 offset:13312
    v_exp_f32 v101, v101
    v_mfma_f32_16x16x32_bf16 v[220:223], v[92:95], v[136:139], v[220:223]
    v_cvt_pk_bf16_f32 v97, v98, v99
    s_add_u32 s63, s62, 2
    s_lshl_b32 s96, s63, 1
    s_sub_u32 s96, s96, s61
    s_lshr_b32 s19, s9, 1
    s_cmp_ge_u32 s63, s61
    s_cselect_b32 s96, s96, s63
    s_cselect_b32 s19, s9, s19
    s_cselect_b32 s32, 4, 2
    s_cselect_b32 s12, s45, 0
    s_lshl_b32 s96, s96, 14
    s_add_u32 s18, s96, s19
    s_add_u32 s18, s18, s99
    s_cmp_gt_u32 s63, 16
    s_cselect_b32 s32, 0, s32
    s_waitcnt lgkmcnt(5)
    v_mfma_f32_16x16x32_bf16 v[160:163], v[64:67], v[144:147], v[160:163]
    ds_read_b128 v[92:95], v4 offset:15360
    v_exp_f32 v102, v102
    v_mfma_f32_16x16x32_bf16 v[168:171], v[64:67], v[152:155], v[168:171]
    v_exp_f32 v103, v103
    v_cvt_pk_bf16_f32 v230, v236, v237
    v_cvt_pk_bf16_f32 v234, v240, v241
    v_cvt_pk_bf16_f32 v231, v238, v239
    v_cvt_pk_bf16_f32 v235, v242, v243
    v_mfma_f32_16x16x32_bf16 v[164:167], v[68:71], v[144:147], v[164:167]
    v_cvt_pk_bf16_f32 v98, v100, v101
    v_mfma_f32_16x16x32_bf16 v[172:175], v[68:71], v[152:155], v[172:175]
    v_exp_f32 v104, v104
    s_waitcnt lgkmcnt(4)
    v_mfma_f32_16x16x32_bf16 v[176:179], v[72:75], v[144:147], v[176:179]
    v_exp_f32 v105, v105
    v_mfma_f32_16x16x32_bf16 v[184:187], v[72:75], v[152:155], v[184:187]
    s_waitcnt vmcnt(0) lgkmcnt(0)
    s_barrier
    s_setprio 3
    s_add_u32 s52, s14, 0x3400000
    s_addc_u32 s53, s15, 0
    s_mov_b32 s54, 0x380000
    s_mov_b32 s55, 0x00020000
    buffer_store_dwordx4 v[228:231], v248, s[52:55], s16 offen sc1
    buffer_store_dwordx4 v[232:235], v249, s[52:55], s16 offen sc1
    ds_read_b128 v[64:67], v3 offset:0
    ds_read_b128 v[68:71], v3 offset:1024
    v_cvt_pk_bf16_f32 v99, v102, v103
    v_mfma_f32_16x16x32_bf16 v[180:183], v[76:79], v[144:147], v[180:183]
    ds_read_b128 v[72:75], v3 offset:2048
    v_exp_f32 v106, v106
    v_mfma_f32_16x16x32_bf16 v[188:191], v[76:79], v[152:155], v[188:191]
    v_exp_f32 v107, v107
    s_add_u32 m0, s19, 131072
    s_cmp_le_u32 s32, 0
    s_cbranch_scc1 A_d_243
    buffer_load_dwordx4 v2, s[20:23], s18 offen offset:0 sc1 lds
A_d_243:
    v_mfma_f32_16x16x32_bf16 v[192:195], v[80:83], v[144:147], v[192:195]
    ds_read_b128 v[76:79], v3 offset:3072
    v_cvt_pk_bf16_f32 v104, v104, v105
    v_mfma_f32_16x16x32_bf16 v[200:203], v[80:83], v[152:155], v[200:203]
    v_exp_f32 v108, v108
    v_mfma_f32_16x16x32_bf16 v[24:27], v[224:227], v[144:147], v[24:27]
    v_mfma_f32_16x16x32_bf16 v[196:199], v[84:87], v[144:147], v[196:199]
    ds_read_b128 v[80:83], v3 offset:4096
    v_exp_f32 v109, v109
    v_mfma_f32_16x16x32_bf16 v[204:207], v[84:87], v[152:155], v[204:207]
    v_cvt_pk_bf16_f32 v105, v106, v107
    s_add_u32 m0, s19, 131072
    s_cmp_le_u32 s32, 1
    s_cbranch_scc1 A_d_244
    buffer_load_dwordx4 v2, s[20:23], s18 offen offset:1024 sc1 lds
A_d_244:
    v_mfma_f32_16x16x32_bf16 v[208:211], v[88:91], v[144:147], v[208:211]
    ds_read_b128 v[84:87], v3 offset:5120
    v_exp_f32 v110, v110
    v_mfma_f32_16x16x32_bf16 v[216:219], v[88:91], v[152:155], v[216:219]
    v_exp_f32 v111, v111
    v_mfma_f32_16x16x32_bf16 v[28:31], v[224:227], v[152:155], v[28:31]
    v_mfma_f32_16x16x32_bf16 v[212:215], v[92:95], v[144:147], v[212:215]
    ds_read_b128 v[88:91], v3 offset:6144
    v_cvt_pk_bf16_f32 v106, v108, v109
    v_mfma_f32_16x16x32_bf16 v[220:223], v[92:95], v[152:155], v[220:223]
    s_nop 0
    v_cvt_pk_bf16_f32 v107, v110, v111
    s_add_u32 m0, s19, 131072
    s_cmp_le_u32 s32, 2
    s_cbranch_scc1 A_d_245
    buffer_load_dwordx4 v2, s[20:23], s18 offen offset:2048 sc1 lds
A_d_245:
    s_cmp_lg_u32 s98, 0
    s_cbranch_scc1 A_resc_246
A_rescret_247:
    s_add_u32 s63, s8, 0
    v_add_u32 v4, s63, v2
    s_waitcnt lgkmcnt(5)
    v_mfma_f32_16x16x32_bf16 v[128:131], v[64:67], v[32:35], v[16:19]
    ds_read_b128 v[92:95], v3 offset:7168
    v_exp_f32 v112, v112
    v_mfma_f32_16x16x32_bf16 v[136:139], v[64:67], v[36:39], v[20:23]
    v_exp_f32 v113, v113
    v_mfma_f32_16x16x32_bf16 v[128:131], v[68:71], v[40:43], v[128:131]
    ds_read_b128 v[64:67], v3 offset:8192
    v_exp_f32 v114, v114
    v_mfma_f32_16x16x32_bf16 v[136:139], v[68:71], v[44:47], v[136:139]
    v_exp_f32 v115, v115
    s_add_u32 m0, s19, 131072
    s_cmp_le_u32 s32, 3
    s_cbranch_scc1 A_d_249
    buffer_load_dwordx4 v2, s[20:23], s18 offen offset:3072 sc1 lds
A_d_249:
    s_waitcnt lgkmcnt(5)
    v_mfma_f32_16x16x32_bf16 v[128:131], v[72:75], v[48:51], v[128:131]
    ds_read_b128 v[68:71], v3 offset:9216
    v_cvt_pk_bf16_f32 v112, v112, v113
    v_mfma_f32_16x16x32_bf16 v[136:139], v[72:75], v[52:55], v[136:139]
    v_mfma_f32_16x16x32_bf16 v[128:131], v[76:79], v[56:59], v[128:131]
    s_setprio 2
    ds_read_b128 v[72:75], v3 offset:10240
    v_exp_f32 v116, v116
    v_mfma_f32_16x16x32_bf16 v[136:139], v[76:79], v[60:63], v[136:139]
    v_exp_f32 v117, v117
    s_add_u32 m0, s34, 32768
    s_cmp_le_u32 s35, 0
    s_cbranch_scc1 A_d_250
    buffer_load_dwordx4 v2, s[24:27], s33 offen offset:0 sc1 lds
A_d_250:
    s_waitcnt lgkmcnt(5)
    v_mfma_f32_16x16x32_bf16 v[132:135], v[80:83], v[32:35], v[16:19]
    ds_read_b128 v[76:79], v3 offset:11264
    v_cvt_pk_bf16_f32 v113, v114, v115
    v_mfma_f32_16x16x32_bf16 v[140:143], v[80:83], v[36:39], v[20:23]
    v_mfma_f32_16x16x32_bf16 v[132:135], v[84:87], v[40:43], v[132:135]
    ds_read_b128 v[80:83], v3 offset:12288
    v_exp_f32 v118, v118
    v_mfma_f32_16x16x32_bf16 v[140:143], v[84:87], v[44:47], v[140:143]
    v_exp_f32 v119, v119
    s_add_u32 m0, s34, 32768
    s_cmp_le_u32 s35, 1
    s_cbranch_scc1 A_d_251
    buffer_load_dwordx4 v2, s[24:27], s33 offen offset:1024 sc1 lds
A_d_251:
    s_waitcnt lgkmcnt(5)
    v_mfma_f32_16x16x32_bf16 v[132:135], v[88:91], v[48:51], v[132:135]
    ds_read_b128 v[84:87], v3 offset:13312
    v_cvt_pk_bf16_f32 v114, v116, v117
    v_mfma_f32_16x16x32_bf16 v[140:143], v[88:91], v[52:55], v[140:143]
    v_mfma_f32_16x16x32_bf16 v[132:135], v[92:95], v[56:59], v[132:135]
    ds_read_b128 v[88:91], v3 offset:14336
    v_exp_f32 v120, v120
    v_mfma_f32_16x16x32_bf16 v[140:143], v[92:95], v[60:63], v[140:143]
    v_exp_f32 v121, v121
    s_add_u32 m0, s34, 32768
    s_cmp_le_u32 s35, 2
    s_cbranch_scc1 A_d_252
    buffer_load_dwordx4 v2, s[24:27], s33 offen offset:2048 sc1 lds
A_d_252:
    s_waitcnt lgkmcnt(5)
    v_mfma_f32_16x16x32_bf16 v[144:147], v[64:67], v[32:35], v[16:19]
    ds_read_b128 v[92:95], v3 offset:15360
    v_cvt_pk_bf16_f32 v115, v118, v119
    v_mfma_f32_16x16x32_bf16 v[152:155], v[64:67], v[36:39], v[20:23]
    v_exp_f32 v122, v122
    v_mfma_f32_16x16x32_bf16 v[144:147], v[68:71], v[40:43], v[144:147]
    ds_read_b128 v[64:67], v4 offset:0
    v_exp_f32 v123, v123
    v_mfma_f32_16x16x32_bf16 v[152:155], v[68:71], v[44:47], v[152:155]
    s_add_u32 m0, s34, 32768
    s_cmp_le_u32 s35, 3
    s_cbranch_scc1 A_d_253
    buffer_load_dwordx4 v2, s[24:27], s33 offen offset:3072 sc1 lds
A_d_253:
    s_waitcnt lgkmcnt(5)
    v_mfma_f32_16x16x32_bf16 v[144:147], v[72:75], v[48:51], v[144:147]
    ds_read_b128 v[68:71], v4 offset:2048
    v_cvt_pk_bf16_f32 v120, v120, v121
    v_mfma_f32_16x16x32_bf16 v[152:155], v[72:75], v[52:55], v[152:155]
    v_exp_f32 v124, v124
    v_mfma_f32_16x16x32_bf16 v[144:147], v[76:79], v[56:59], v[144:147]
    s_setprio 1
    ds_read_b128 v[72:75], v4 offset:4096
    v_exp_f32 v125, v125
    v_mfma_f32_16x16x32_bf16 v[152:155], v[76:79], v[60:63], v[152:155]
    s_waitcnt lgkmcnt(5)
    v_mfma_f32_16x16x32_bf16 v[148:151], v[80:83], v[32:35], v[16:19]
    ds_read_b128 v[76:79], v4 offset:6144
    v_cvt_pk_bf16_f32 v121, v122, v123
    v_mfma_f32_16x16x32_bf16 v[156:159], v[80:83], v[36:39], v[20:23]
    v_exp_f32 v126, v126
    v_mfma_f32_16x16x32_bf16 v[148:151], v[84:87], v[40:43], v[148:151]
    ds_read_b128 v[80:83], v4 offset:8192
    v_exp_f32 v127, v127
    v_mfma_f32_16x16x32_bf16 v[156:159], v[84:87], v[44:47], v[156:159]
    s_waitcnt lgkmcnt(5)
    v_mfma_f32_16x16x32_bf16 v[148:151], v[88:91], v[48:51], v[148:151]
    ds_read_b128 v[84:87], v4 offset:10240
    v_cvt_pk_bf16_f32 v122, v124, v125
    v_mfma_f32_16x16x32_bf16 v[156:159], v[88:91], v[52:55], v[156:159]
    s_nop 0
    v_mfma_f32_16x16x32_bf16 v[148:151], v[92:95], v[56:59], v[148:151]
    ds_read_b128 v[88:91], v4 offset:12288
    v_cvt_pk_bf16_f32 v123, v126, v127
    v_mfma_f32_16x16x32_bf16 v[156:159], v[92:95], v[60:63], v[156:159]
    s_bitcmp1_b32 s44, s62
    s_cbranch_scc1 A_evb_254
A_evbret_255:
    s_waitcnt lgkmcnt(5)
    v_mfma_f32_16x16x32_bf16 v[160:163], v[64:67], v[96:99], v[160:163]
    ds_read_b128 v[92:95], v4 offset:14336
    v_max3_f32 v8, v128, v129, v130
    v_max3_f32 v8, v8, v131, v132
    v_mfma_f32_16x16x32_bf16 v[168:171], v[64:67], v[104:107], v[168:171]
    v_max3_f32 v8, v8, v133, v134
    v_max3_f32 v8, v8, v135, v136
    v_mfma_f32_16x16x32_bf16 v[164:167], v[68:71], v[96:99], v[164:167]
    ds_read_b128 v[64:67], v4 offset:1024
    v_max3_f32 v8, v8, v137, v138
    v_mfma_f32_16x16x32_bf16 v[172:175], v[68:71], v[104:107], v[172:175]
    v_max3_f32 v8, v8, v139, v140
    v_max3_f32 v8, v8, v141, v142
    s_waitcnt lgkmcnt(5)
    v_mfma_f32_16x16x32_bf16 v[176:179], v[72:75], v[96:99], v[176:179]
    ds_read_b128 v[68:71], v4 offset:3072
    v_max3_f32 v14, v143, v144, v145
    v_max3_f32 v14, v14, v146, v147
    v_mfma_f32_16x16x32_bf16 v[184:187], v[72:75], v[104:107], v[184:187]
    v_max3_f32 v14, v14, v148, v149
    v_max3_f32 v14, v14, v150, v151
    v_max3_f32 v14, v14, v152, v153
    v_mfma_f32_16x16x32_bf16 v[180:183], v[76:79], v[96:99], v[180:183]
    ds_read_b128 v[72:75], v4 offset:5120
    v_max3_f32 v14, v14, v154, v155
    v_max3_f32 v14, v14, v156, v157
    v_mfma_f32_16x16x32_bf16 v[188:191], v[76:79], v[104:107], v[188:191]
    s_setprio 0
    v_max3_f32 v14, v14, v158, v159
    v_max_f32 v8, v8, v14
    v_cmp_lt_f32 vcc, 0x41000000, v8
    s_cmp_eq_u32 s101, 1
    s_cbranch_scc1 A_slow_257
    s_cbranch_vccnz A_slow_257
A_slowret_258:
    s_waitcnt lgkmcnt(5)
    v_mfma_f32_16x16x32_bf16 v[192:195], v[80:83], v[96:99], v[192:195]
    ds_read_b128 v[76:79], v4 offset:7168
    v_exp_f32 v128, v128
    v_mfma_f32_16x16x32_bf16 v[200:203], v[80:83], v[104:107], v[200:203]
    v_exp_f32 v129, v129
    s_add_u32 s63, s12, 131072
    v_add_u32 v3, s63, v2
    s_add_u32 s62, s62, 1
    s_mov_b32 s33, s18
    s_mov_b32 s34, s19
    s_mov_b32 s35, s32
    s_mov_b32 s8, s13
    s_mov_b32 s13, s12
    v_mfma_f32_16x16x32_bf16 v[196:199], v[84:87], v[96:99], v[196:199]
    ds_read_b128 v[80:83], v4 offset:9216
    v_exp_f32 v130, v130
    v_mfma_f32_16x16x32_bf16 v[204:207], v[84:87], v[104:107], v[204:207]
    v_exp_f32 v131, v131
    v_mfma_f32_16x16x32_bf16 v[24:27], v[224:227], v[96:99], v[24:27]
    s_waitcnt lgkmcnt(5)
    v_mfma_f32_16x16x32_bf16 v[208:211], v[88:91], v[96:99], v[208:211]
    ds_read_b128 v[84:87], v4 offset:11264
    v_cvt_pk_bf16_f32 v128, v128, v129
    v_mfma_f32_16x16x32_bf16 v[216:219], v[88:91], v[104:107], v[216:219]
    v_exp_f32 v132, v132
    v_mfma_f32_16x16x32_bf16 v[28:31], v[224:227], v[104:107], v[28:31]
    v_mfma_f32_16x16x32_bf16 v[212:215], v[92:95], v[96:99], v[212:215]
    ds_read_b128 v[88:91], v4 offset:13312
    v_exp_f32 v133, v133
    v_mfma_f32_16x16x32_bf16 v[220:223], v[92:95], v[104:107], v[220:223]
    v_cvt_pk_bf16_f32 v129, v130, v131
    s_add_u32 s63, s62, 2
    s_lshl_b32 s96, s63, 1
    s_sub_u32 s96, s96, s61
    s_lshr_b32 s19, s9, 1
    s_cmp_ge_u32 s63, s61
    s_cselect_b32 s96, s96, s63
    s_cselect_b32 s19, s9, s19
    s_cselect_b32 s32, 4, 2
    s_cselect_b32 s12, s45, 0
    s_lshl_b32 s96, s96, 14
    s_add_u32 s18, s96, s19
    s_add_u32 s18, s18, s99
    s_cmp_gt_u32 s63, 16
    s_cselect_b32 s32, 0, s32
    s_waitcnt lgkmcnt(5)
    v_mfma_f32_16x16x32_bf16 v[160:163], v[64:67], v[112:115], v[160:163]
    ds_read_b128 v[92:95], v4 offset:15360
    v_exp_f32 v134, v134
    v_mfma_f32_16x16x32_bf16 v[168:171], v[64:67], v[120:123], v[168:171]
    v_exp_f32 v135, v135
    v_mfma_f32_16x16x32_bf16 v[164:167], v[68:71], v[112:115], v[164:167]
    v_cvt_pk_bf16_f32 v130, v132, v133
    v_mfma_f32_16x16x32_bf16 v[172:175], v[68:71], v[120:123], v[172:175]
    v_exp_f32 v136, v136
    s_waitcnt lgkmcnt(4)
    v_mfma_f32_16x16x32_bf16 v[176:179], v[72:75], v[112:115], v[176:179]
    v_exp_f32 v137, v137
    v_mfma_f32_16x16x32_bf16 v[184:187], v[72:75], v[120:123], v[184:187]
    s_waitcnt vmcnt(0) lgkmcnt(0)
    s_barrier
    s_setprio 3
    s_lshl_b32 s51, s2, 2
    s_add_u32 s51, s51, 8192
    s_cmp_eq_u32 s56, 0
    s_cbranch_scc0 M_sig_93
    s_add_u32 s52, s14, 0x6400000
    s_addc_u32 s53, s15, 0
    s_mov_b32 s54, 0x4000
    s_mov_b32 s55, 0x00020000
    v_mov_b32 v9, s3
    v_mov_b32 v10, 0
    s_mov_b64 exec, 1
    buffer_store_dword v9, v10, s[52:55], s51 offen sc1
    s_mov_b64 exec, -1
M_sig_93:
    ds_read_b128 v[64:67], v3 offset:0
    ds_read_b128 v[68:71], v3 offset:1024
    v_cvt_pk_bf16_f32 v131, v134, v135
    v_mfma_f32_16x16x32_bf16 v[180:183], v[76:79], v[112:115], v[180:183]
    ds_read_b128 v[72:75], v3 offset:2048
    v_exp_f32 v138, v138
    v_mfma_f32_16x16x32_bf16 v[188:191], v[76:79], v[120:123], v[188:191]
    v_exp_f32 v139, v139
    s_add_u32 m0, s19, 98304
    s_cmp_le_u32 s32, 0
    s_cbranch_scc1 A_d_261
    buffer_load_dwordx4 v2, s[20:23], s18 offen offset:0 sc1 lds
A_d_261:
    v_mfma_f32_16x16x32_bf16 v[192:195], v[80:83], v[112:115], v[192:195]
    ds_read_b128 v[76:79], v3 offset:3072
    v_cvt_pk_bf16_f32 v136, v136, v137
    v_mfma_f32_16x16x32_bf16 v[200:203], v[80:83], v[120:123], v[200:203]
    v_exp_f32 v140, v140
    v_mfma_f32_16x16x32_bf16 v[24:27], v[224:227], v[112:115], v[24:27]
    v_mfma_f32_16x16x32_bf16 v[196:199], v[84:87], v[112:115], v[196:199]
    ds_read_b128 v[80:83], v3 offset:4096
    v_exp_f32 v141, v141
    v_mfma_f32_16x16x32_bf16 v[204:207], v[84:87], v[120:123], v[204:207]
    v_cvt_pk_bf16_f32 v137, v138, v139
    s_add_u32 m0, s19, 98304
    s_cmp_le_u32 s32, 1
    s_cbranch_scc1 A_d_262
    buffer_load_dwordx4 v2, s[20:23], s18 offen offset:1024 sc1 lds
A_d_262:
    v_mfma_f32_16x16x32_bf16 v[208:211], v[88:91], v[112:115], v[208:211]
    ds_read_b128 v[84:87], v3 offset:5120
    v_exp_f32 v142, v142
    v_mfma_f32_16x16x32_bf16 v[216:219], v[88:91], v[120:123], v[216:219]
    v_exp_f32 v143, v143
    v_mfma_f32_16x16x32_bf16 v[28:31], v[224:227], v[120:123], v[28:31]
    v_mfma_f32_16x16x32_bf16 v[212:215], v[92:95], v[112:115], v[212:215]
    ds_read_b128 v[88:91], v3 offset:6144
    v_cvt_pk_bf16_f32 v138, v140, v141
    v_mfma_f32_16x16x32_bf16 v[220:223], v[92:95], v[120:123], v[220:223]
    s_nop 0
    v_cvt_pk_bf16_f32 v139, v142, v143
    s_add_u32 m0, s19, 98304
    s_cmp_le_u32 s32, 2
    s_cbranch_scc1 A_d_263
    buffer_load_dwordx4 v2, s[20:23], s18 offen offset:2048 sc1 lds
A_d_263:
    s_cmp_lg_u32 s98, 0
    s_cbranch_scc1 A_resc_264
A_rescret_265:
    s_add_u32 s63, s8, 32768
    v_add_u32 v4, s63, v2
    s_waitcnt lgkmcnt(5)
    v_mfma_f32_16x16x32_bf16 v[96:99], v[64:67], v[32:35], v[16:19]
    ds_read_b128 v[92:95], v3 offset:7168
    v_exp_f32 v144, v144
    v_mfma_f32_16x16x32_bf16 v[104:107], v[64:67], v[36:39], v[20:23]
    v_exp_f32 v145, v145
    v_mfma_f32_16x16x32_bf16 v[96:99], v[68:71], v[40:43], v[96:99]
    ds_read_b128 v[64:67], v3 offset:8192
    v_exp_f32 v146, v146
    v_mfma_f32_16x16x32_bf16 v[104:107], v[68:71], v[44:47], v[104:107]
    v_exp_f32 v147, v147
    s_add_u32 m0, s19, 98304
    s_cmp_le_u32 s32, 3
    s_cbranch_scc1 A_d_267
    buffer_load_dwordx4 v2, s[20:23], s18 offen offset:3072 sc1 lds
A_d_267:
    s_waitcnt lgkmcnt(5)
    v_mfma_f32_16x16x32_bf16 v[96:99], v[72:75], v[48:51], v[96:99]
    ds_read_b128 v[68:71], v3 offset:9216
    v_cvt_pk_bf16_f32 v144, v144, v145
    v_mfma_f32_16x16x32_bf16 v[104:107], v[72:75], v[52:55], v[104:107]
    v_mfma_f32_16x16x32_bf16 v[96:99], v[76:79], v[56:59], v[96:99]
    s_setprio 2
    ds_read_b128 v[72:75], v3 offset:10240
    v_exp_f32 v148, v148
    v_mfma_f32_16x16x32_bf16 v[104:107], v[76:79], v[60:63], v[104:107]
    v_exp_f32 v149, v149
    s_add_u32 m0, s34, 0
    s_cmp_le_u32 s35, 0
    s_cbranch_scc1 A_d_268
    buffer_load_dwordx4 v2, s[24:27], s33 offen offset:0 sc1 lds
A_d_268:
    s_waitcnt lgkmcnt(5)
    v_mfma_f32_16x16x32_bf16 v[100:103], v[80:83], v[32:35], v[16:19]
    ds_read_b128 v[76:79], v3 offset:11264
    v_cvt_pk_bf16_f32 v145, v146, v147
    v_mfma_f32_16x16x32_bf16 v[108:111], v[80:83], v[36:39], v[20:23]
    v_mfma_f32_16x16x32_bf16 v[100:103], v[84:87], v[40:43], v[100:103]
    ds_read_b128 v[80:83], v3 offset:12288
    v_exp_f32 v150, v150
    v_mfma_f32_16x16x32_bf16 v[108:111], v[84:87], v[44:47], v[108:111]
    v_exp_f32 v151, v151
    s_add_u32 m0, s34, 0
    s_cmp_le_u32 s35, 1
    s_cbranch_scc1 A_d_269
    buffer_load_dwordx4 v2, s[24:27], s33 offen offset:1024 sc1 lds
A_d_269:
    s_waitcnt lgkmcnt(5)
    v_mfma_f32_16x16x32_bf16 v[100:103], v[88:91], v[48:51], v[100:103]
    ds_read_b128 v[84:87], v3 offset:13312
    v_cvt_pk_bf16_f32 v146, v148, v149
    v_mfma_f32_16x16x32_bf16 v[108:111], v[88:91], v[52:55], v[108:111]
    v_mfma_f32_16x16x32_bf16 v[100:103], v[92:95], v[56:59], v[100:103]
    ds_read_b128 v[88:91], v3 offset:14336
    v_exp_f32 v152, v152
    v_mfma_f32_16x16x32_bf16 v[108:111], v[92:95], v[60:63], v[108:111]
    v_exp_f32 v153, v153
    s_add_u32 m0, s34, 0
    s_cmp_le_u32 s35, 2
    s_cbranch_scc1 A_d_270
    buffer_load_dwordx4 v2, s[24:27], s33 offen offset:2048 sc1 lds
A_d_270:
    s_waitcnt lgkmcnt(5)
    v_mfma_f32_16x16x32_bf16 v[112:115], v[64:67], v[32:35], v[16:19]
    ds_read_b128 v[92:95], v3 offset:15360
    v_cvt_pk_bf16_f32 v147, v150, v151
    v_mfma_f32_16x16x32_bf16 v[120:123], v[64:67], v[36:39], v[20:23]
    v_exp_f32 v154, v154
    v_mfma_f32_16x16x32_bf16 v[112:115], v[68:71], v[40:43], v[112:115]
    ds_read_b128 v[64:67], v4 offset:0
    v_exp_f32 v155, v155
    v_mfma_f32_16x16x32_bf16 v[120:123], v[68:71], v[44:47], v[120:123]
    s_add_u32 m0, s34, 0
    s_cmp_le_u32 s35, 3
    s_cbranch_scc1 A_d_271
    buffer_load_dwordx4 v2, s[24:27], s33 offen offset:3072 sc1 lds
A_d_271:
    s_waitcnt lgkmcnt(5)
    v_mfma_f32_16x16x32_bf16 v[112:115], v[72:75], v[48:51], v[112:115]
    ds_read_b128 v[68:71], v4 offset:2048
    v_cvt_pk_bf16_f32 v152, v152, v153
    v_mfma_f32_16x16x32_bf16 v[120:123], v[72:75], v[52:55], v[120:123]
    v_exp_f32 v156, v156
    v_mfma_f32_16x16x32_bf16 v[112:115], v[76:79], v[56:59], v[112:115]
    s_setprio 1
    ds_read_b128 v[72:75], v4 offset:4096
    v_exp_f32 v157, v157
    v_mfma_f32_16x16x32_bf16 v[120:123], v[76:79], v[60:63], v[120:123]
    s_waitcnt lgkmcnt(5)
    v_mfma_f32_16x16x32_bf16 v[116:119], v[80:83], v[32:35], v[16:19]
    ds_read_b128 v[76:79], v4 offset:6144
    v_cvt_pk_bf16_f32 v153, v154, v155
    v_mfma_f32_16x16x32_bf16 v[124:127], v[80:83], v[36:39], v[20:23]
    v_exp_f32 v158, v158
    v_mfma_f32_16x16x32_bf16 v[116:119], v[84:87], v[40:43], v[116:119]
    ds_read_b128 v[80:83], v4 offset:8192
    v_exp_f32 v159, v159
    v_mfma_f32_16x16x32_bf16 v[124:127], v[84:87], v[44:47], v[124:127]
    s_waitcnt lgkmcnt(5)
    v_mfma_f32_16x16x32_bf16 v[116:119], v[88:91], v[48:51], v[116:119]
    ds_read_b128 v[84:87], v4 offset:10240
    v_cvt_pk_bf16_f32 v154, v156, v157
    v_mfma_f32_16x16x32_bf16 v[124:127], v[88:91], v[52:55], v[124:127]
    s_nop 0
    v_mfma_f32_16x16x32_bf16 v[116:119], v[92:95], v[56:59], v[116:119]
    ds_read_b128 v[88:91], v4 offset:12288
    v_cvt_pk_bf16_f32 v155, v158, v159
    v_mfma_f32_16x16x32_bf16 v[124:127], v[92:95], v[60:63], v[124:127]
    s_bitcmp1_b32 s44, s62
    s_cbranch_scc1 A_evb_272
A_evbret_273:
    s_waitcnt lgkmcnt(5)
    v_mfma_f32_16x16x32_bf16 v[160:163], v[64:67], v[128:131], v[160:163]
    ds_read_b128 v[92:95], v4 offset:14336
    v_max3_f32 v8, v96, v97, v98
    v_max3_f32 v8, v8, v99, v100
    v_mfma_f32_16x16x32_bf16 v[168:171], v[64:67], v[136:139], v[168:171]
    v_max3_f32 v8, v8, v101, v102
    v_max3_f32 v8, v8, v103, v104
    v_mfma_f32_16x16x32_bf16 v[164:167], v[68:71], v[128:131], v[164:167]
    ds_read_b128 v[64:67], v4 offset:1024
    v_max3_f32 v8, v8, v105, v106
    v_mfma_f32_16x16x32_bf16 v[172:175], v[68:71], v[136:139], v[172:175]
    v_max3_f32 v8, v8, v107, v108
    v_max3_f32 v8, v8, v109, v110
    s_waitcnt lgkmcnt(5)
    v_mfma_f32_16x16x32_bf16 v[176:179], v[72:75], v[128:131], v[176:179]
    ds_read_b128 v[68:71], v4 offset:3072
    v_max3_f32 v14, v111, v112, v113
    v_max3_f32 v14, v14, v114, v115
    v_mfma_f32_16x16x32_bf16 v[184:187], v[72:75], v[136:139], v[184:187]
    v_max3_f32 v14, v14, v116, v117
    v_max3_f32 v14, v14, v118, v119
    v_max3_f32 v14, v14, v120, v121
    v_mfma_f32_16x16x32_bf16 v[180:183], v[76:79], v[128:131], v[180:183]
    ds_read_b128 v[72:75], v4 offset:5120
    v_max3_f32 v14, v14, v122, v123
    v_max3_f32 v14, v14, v124, v125
    v_mfma_f32_16x16x32_bf16 v[188:191], v[76:79], v[136:139], v[188:191]
    s_setprio 0
    v_max3_f32 v14, v14, v126, v127
    v_max_f32 v8, v8, v14
    v_cmp_lt_f32 vcc, 0x41000000, v8
    s_cmp_eq_u32 s101, 1
    s_cbranch_scc1 A_slow_275
    s_cbranch_vccnz A_slow_275
A_slowret_276:
    s_waitcnt lgkmcnt(5)
    v_mfma_f32_16x16x32_bf16 v[192:195], v[80:83], v[128:131], v[192:195]
    ds_read_b128 v[76:79], v4 offset:7168
    v_exp_f32 v96, v96
    v_mfma_f32_16x16x32_bf16 v[200:203], v[80:83], v[136:139], v[200:203]
    v_exp_f32 v97, v97
    s_add_u32 s63, s12, 98304
    v_add_u32 v3, s63, v2
    s_add_u32 s62, s62, 1
    s_mov_b32 s33, s18
    s_mov_b32 s34, s19
    s_mov_b32 s35, s32
    s_mov_b32 s8, s13
    s_mov_b32 s13, s12
    v_mfma_f32_16x16x32_bf16 v[196:199], v[84:87], v[128:131], v[196:199]
    ds_read_b128 v[80:83], v4 offset:9216
    v_exp_f32 v98, v98
    v_mfma_f32_16x16x32_bf16 v[204:207], v[84:87], v[136:139], v[204:207]
    v_exp_f32 v99, v99
    v_mfma_f32_16x16x32_bf16 v[24:27], v[224:227], v[128:131], v[24:27]
    s_waitcnt lgkmcnt(5)
    v_mfma_f32_16x16x32_bf16 v[208:211], v[88:91], v[128:131], v[208:211]
    ds_read_b128 v[84:87], v4 offset:11264
    v_cvt_pk_bf16_f32 v96, v96, v97
    v_mfma_f32_16x16x32_bf16 v[216:219], v[88:91], v[136:139], v[216:219]
    v_exp_f32 v100, v100
    v_mfma_f32_16x16x32_bf16 v[28:31], v[224:227], v[136:139], v[28:31]
    v_mfma_f32_16x16x32_bf16 v[212:215], v[92:95], v[128:131], v[212:215]
    ds_read_b128 v[88:91], v4 offset:13312
    v_exp_f32 v101, v101
    v_mfma_f32_16x16x32_bf16 v[220:223], v[92:95], v[136:139], v[220:223]
    v_cvt_pk_bf16_f32 v97, v98, v99
    s_add_u32 s63, s62, 2
    s_lshl_b32 s96, s63, 1
    s_sub_u32 s96, s96, s61
    s_lshr_b32 s19, s9, 1
    s_cmp_ge_u32 s63, s61
    s_cselect_b32 s96, s96, s63
    s_cselect_b32 s19, s9, s19
    s_cselect_b32 s32, 4, 2
    s_cselect_b32 s12, s45, 0
    s_lshl_b32 s96, s96, 14
    s_add_u32 s18, s96, s19
    s_add_u32 s18, s18, s99
    s_cmp_gt_u32 s63, 16
    s_cselect_b32 s32, 0, s32
    s_waitcnt lgkmcnt(5)
    v_mfma_f32_16x16x32_bf16 v[160:163], v[64:67], v[144:147], v[160:163]
    ds_read_b128 v[92:95], v4 offset:15360
    v_exp_f32 v102, v102
    v_mfma_f32_16x16x32_bf16 v[168:171], v[64:67], v[152:155], v[168:171]
    v_exp_f32 v103, v103
    v_mfma_f32_16x16x32_bf16 v[164:167], v[68:71], v[144:147], v[164:167]
    v_cvt_pk_bf16_f32 v98, v100, v101
    v_mfma_f32_16x16x32_bf16 v[172:175], v[68:71], v[152:155], v[172:175]
    v_exp_f32 v104, v104
    s_waitcnt lgkmcnt(4)
    v_mfma_f32_16x16x32_bf16 v[176:179], v[72:75], v[144:147], v[176:179]
    v_exp_f32 v105, v105
    v_mfma_f32_16x16x32_bf16 v[184:187], v[72:75], v[152:155], v[184:187]
    s_waitcnt vmcnt(0) lgkmcnt(0)
    s_barrier
    s_setprio 3
    ds_read_b128 v[64:67], v3 offset:0
    ds_read_b128 v[68:71], v3 offset:1024
    v_cvt_pk_bf16_f32 v99, v102, v103
    v_mfma_f32_16x16x32_bf16 v[180:183], v[76:79], v[144:147], v[180:183]
    ds_read_b128 v[72:75], v3 offset:2048
    v_exp_f32 v106, v106
    v_mfma_f32_16x16x32_bf16 v[188:191], v[76:79], v[152:155], v[188:191]
    v_exp_f32 v107, v107
    s_add_u32 m0, s19, 131072
    s_cmp_le_u32 s32, 0
    s_cbranch_scc1 A_d_279
    buffer_load_dwordx4 v2, s[20:23], s18 offen offset:0 sc1 lds
A_d_279:
    v_mfma_f32_16x16x32_bf16 v[192:195], v[80:83], v[144:147], v[192:195]
    ds_read_b128 v[76:79], v3 offset:3072
    v_cvt_pk_bf16_f32 v104, v104, v105
    v_mfma_f32_16x16x32_bf16 v[200:203], v[80:83], v[152:155], v[200:203]
    v_exp_f32 v108, v108
    v_mfma_f32_16x16x32_bf16 v[24:27], v[224:227], v[144:147], v[24:27]
    v_mfma_f32_16x16x32_bf16 v[196:199], v[84:87], v[144:147], v[196:199]
    ds_read_b128 v[80:83], v3 offset:4096
    v_exp_f32 v109, v109
    v_mfma_f32_16x16x32_bf16 v[204:207], v[84:87], v[152:155], v[204:207]
    v_cvt_pk_bf16_f32 v105, v106, v107
    s_add_u32 m0, s19, 131072
    s_cmp_le_u32 s32, 1
    s_cbranch_scc1 A_d_280
    buffer_load_dwordx4 v2, s[20:23], s18 offen offset:1024 sc1 lds
A_d_280:
    v_mfma_f32_16x16x32_bf16 v[208:211], v[88:91], v[144:147], v[208:211]
    ds_read_b128 v[84:87], v3 offset:5120
    v_exp_f32 v110, v110
    v_mfma_f32_16x16x32_bf16 v[216:219], v[88:91], v[152:155], v[216:219]
    v_exp_f32 v111, v111
    v_mfma_f32_16x16x32_bf16 v[28:31], v[224:227], v[152:155], v[28:31]
    v_mfma_f32_16x16x32_bf16 v[212:215], v[92:95], v[144:147], v[212:215]
    ds_read_b128 v[88:91], v3 offset:6144
    v_cvt_pk_bf16_f32 v106, v108, v109
    v_mfma_f32_16x16x32_bf16 v[220:223], v[92:95], v[152:155], v[220:223]
    s_nop 0
    v_cvt_pk_bf16_f32 v107, v110, v111
    s_add_u32 m0, s19, 131072
    s_cmp_le_u32 s32, 2
    s_cbranch_scc1 A_d_281
    buffer_load_dwordx4 v2, s[20:23], s18 offen offset:2048 sc1 lds
A_d_281:
A_loop:
    s_cmp_lg_u32 s98, 0
    s_cbranch_scc1 A_resc_282
A_rescret_283:
    s_add_u32 s63, s8, 0
    v_add_u32 v4, s63, v2
    s_waitcnt lgkmcnt(5)
    v_mfma_f32_16x16x32_bf16 v[128:131], v[64:67], v[32:35], v[16:19]
    ds_read_b128 v[92:95], v3 offset:7168
    v_exp_f32 v112, v112
    v_mfma_f32_16x16x32_bf16 v[136:139], v[64:67], v[36:39], v[20:23]
    v_exp_f32 v113, v113
    v_mfma_f32_16x16x32_bf16 v[128:131], v[68:71], v[40:43], v[128:131]
    ds_read_b128 v[64:67], v3 offset:8192
    v_exp_f32 v114, v114
    v_mfma_f32_16x16x32_bf16 v[136:139], v[68:71], v[44:47], v[136:139]
    v_exp_f32 v115, v115
    s_add_u32 m0, s19, 131072
    s_cmp_le_u32 s32, 3
    s_cbranch_scc1 A_d_285
    buffer_load_dwordx4 v2, s[20:23], s18 offen offset:3072 sc1 lds
A_d_285:
    s_waitcnt lgkmcnt(5)
    v_mfma_f32_16x16x32_bf16 v[128:131], v[72:75], v[48:51], v[128:131]
    ds_read_b128 v[68:71], v3 offset:9216
    v_cvt_pk_bf16_f32 v112, v112, v113
    v_mfma_f32_16x16x32_bf16 v[136:139], v[72:75], v[52:55], v[136:139]
    v_mfma_f32_16x16x32_bf16 v[128:131], v[76:79], v[56:59], v[128:131]
    s_setprio 2
    ds_read_b128 v[72:75], v3 offset:10240
    v_exp_f32 v116, v116
    v_mfma_f32_16x16x32_bf16 v[136:139], v[76:79], v[60:63], v[136:139]
    v_exp_f32 v117, v117
    s_add_u32 m0, s34, 32768
    s_cmp_le_u32 s35, 0
    s_cbranch_scc1 A_d_286
    buffer_load_dwordx4 v2, s[24:27], s33 offen offset:0 sc1 lds
A_d_286:
    s_waitcnt lgkmcnt(5)
    v_mfma_f32_16x16x32_bf16 v[132:135], v[80:83], v[32:35], v[16:19]
    ds_read_b128 v[76:79], v3 offset:11264
    v_cvt_pk_bf16_f32 v113, v114, v115
    v_mfma_f32_16x16x32_bf16 v[140:143], v[80:83], v[36:39], v[20:23]
    v_mfma_f32_16x16x32_bf16 v[132:135], v[84:87], v[40:43], v[132:135]
    ds_read_b128 v[80:83], v3 offset:12288
    v_exp_f32 v118, v118
    v_mfma_f32_16x16x32_bf16 v[140:143], v[84:87], v[44:47], v[140:143]
    v_exp_f32 v119, v119
    s_add_u32 m0, s34, 32768
    s_cmp_le_u32 s35, 1
    s_cbranch_scc1 A_d_287
    buffer_load_dwordx4 v2, s[24:27], s33 offen offset:1024 sc1 lds
A_d_287:
    s_waitcnt lgkmcnt(5)
    v_mfma_f32_16x16x32_bf16 v[132:135], v[88:91], v[48:51], v[132:135]
    ds_read_b128 v[84:87], v3 offset:13312
    v_cvt_pk_bf16_f32 v114, v116, v117
    v_mfma_f32_16x16x32_bf16 v[140:143], v[88:91], v[52:55], v[140:143]
    v_mfma_f32_16x16x32_bf16 v[132:135], v[92:95], v[56:59], v[132:135]
    ds_read_b128 v[88:91], v3 offset:14336
    v_exp_f32 v120, v120
    v_mfma_f32_16x16x32_bf16 v[140:143], v[92:95], v[60:63], v[140:143]
    v_exp_f32 v121, v121
    s_add_u32 m0, s34, 32768
    s_cmp_le_u32 s35, 2
    s_cbranch_scc1 A_d_288
    buffer_load_dwordx4 v2, s[24:27], s33 offen offset:2048 sc1 lds
A_d_288:
    s_waitcnt lgkmcnt(5)
    v_mfma_f32_16x16x32_bf16 v[144:147], v[64:67], v[32:35], v[16:19]
    ds_read_b128 v[92:95], v3 offset:15360
    v_cvt_pk_bf16_f32 v115, v118, v119
    v_mfma_f32_16x16x32_bf16 v[152:155], v[64:67], v[36:39], v[20:23]
    v_exp_f32 v122, v122
    v_mfma_f32_16x16x32_bf16 v[144:147], v[68:71], v[40:43], v[144:147]
    ds_read_b128 v[64:67], v4 offset:0
    v_exp_f32 v123, v123
    v_mfma_f32_16x16x32_bf16 v[152:155], v[68:71], v[44:47], v[152:155]
    s_add_u32 m0, s34, 32768
    s_cmp_le_u32 s35, 3
    s_cbranch_scc1 A_d_289
    buffer_load_dwordx4 v2, s[24:27], s33 offen offset:3072 sc1 lds
A_d_289:
    s_waitcnt lgkmcnt(5)
    v_mfma_f32_16x16x32_bf16 v[144:147], v[72:75], v[48:51], v[144:147]
    ds_read_b128 v[68:71], v4 offset:2048
    v_cvt_pk_bf16_f32 v120, v120, v121
    v_mfma_f32_16x16x32_bf16 v[152:155], v[72:75], v[52:55], v[152:155]
    v_exp_f32 v124, v124
    v_mfma_f32_16x16x32_bf16 v[144:147], v[76:79], v[56:59], v[144:147]
    s_setprio 1
    ds_read_b128 v[72:75], v4 offset:4096
    v_exp_f32 v125, v125
    v_mfma_f32_16x16x32_bf16 v[152:155], v[76:79], v[60:63], v[152:155]
    s_waitcnt lgkmcnt(5)
    v_mfma_f32_16x16x32_bf16 v[148:151], v[80:83], v[32:35], v[16:19]
    ds_read_b128 v[76:79], v4 offset:6144
    v_cvt_pk_bf16_f32 v121, v122, v123
    v_mfma_f32_16x16x32_bf16 v[156:159], v[80:83], v[36:39], v[20:23]
    v_exp_f32 v126, v126
    v_mfma_f32_16x16x32_bf16 v[148:151], v[84:87], v[40:43], v[148:151]
    ds_read_b128 v[80:83], v4 offset:8192
    v_exp_f32 v127, v127
    v_mfma_f32_16x16x32_bf16 v[156:159], v[84:87], v[44:47], v[156:159]
    s_waitcnt lgkmcnt(5)
    v_mfma_f32_16x16x32_bf16 v[148:151], v[88:91], v[48:51], v[148:151]
    ds_read_b128 v[84:87], v4 offset:10240
    v_cvt_pk_bf16_f32 v122, v124, v125
    v_mfma_f32_16x16x32_bf16 v[156:159], v[88:91], v[52:55], v[156:159]
    s_nop 0
    v_mfma_f32_16x16x32_bf16 v[148:151], v[92:95], v[56:59], v[148:151]
    ds_read_b128 v[88:91], v4 offset:12288
    v_cvt_pk_bf16_f32 v123, v126, v127
    v_mfma_f32_16x16x32_bf16 v[156:159], v[92:95], v[60:63], v[156:159]
    s_bitcmp1_b32 s44, s62
    s_cbranch_scc1 A_evb_290
A_evbret_291:
    s_waitcnt lgkmcnt(5)
    v_mfma_f32_16x16x32_bf16 v[160:163], v[64:67], v[96:99], v[160:163]
    ds_read_b128 v[92:95], v4 offset:14336
    v_max3_f32 v8, v128, v129, v130
    v_max3_f32 v8, v8, v131, v132
    v_mfma_f32_16x16x32_bf16 v[168:171], v[64:67], v[104:107], v[168:171]
    v_max3_f32 v8, v8, v133, v134
    v_max3_f32 v8, v8, v135, v136
    v_mfma_f32_16x16x32_bf16 v[164:167], v[68:71], v[96:99], v[164:167]
    ds_read_b128 v[64:67], v4 offset:1024
    v_max3_f32 v8, v8, v137, v138
    v_mfma_f32_16x16x32_bf16 v[172:175], v[68:71], v[104:107], v[172:175]
    v_max3_f32 v8, v8, v139, v140
    v_max3_f32 v8, v8, v141, v142
    s_waitcnt lgkmcnt(5)
    v_mfma_f32_16x16x32_bf16 v[176:179], v[72:75], v[96:99], v[176:179]
    ds_read_b128 v[68:71], v4 offset:3072
    v_max3_f32 v14, v143, v144, v145
    v_max3_f32 v14, v14, v146, v147
    v_mfma_f32_16x16x32_bf16 v[184:187], v[72:75], v[104:107], v[184:187]
    v_max3_f32 v14, v14, v148, v149
    v_max3_f32 v14, v14, v150, v151
    v_max3_f32 v14, v14, v152, v153
    v_mfma_f32_16x16x32_bf16 v[180:183], v[76:79], v[96:99], v[180:183]
    ds_read_b128 v[72:75], v4 offset:5120
    v_max3_f32 v14, v14, v154, v155
    v_max3_f32 v14, v14, v156, v157
    v_mfma_f32_16x16x32_bf16 v[188:191], v[76:79], v[104:107], v[188:191]
    s_setprio 0
    v_max3_f32 v14, v14, v158, v159
    v_max_f32 v8, v8, v14
    v_cmp_lt_f32 vcc, 0x41000000, v8
    s_cmp_eq_u32 s101, 1
    s_cbranch_scc1 A_slow_293
    s_cbranch_vccnz A_slow_293
A_slowret_294:
    s_waitcnt lgkmcnt(5)
    v_mfma_f32_16x16x32_bf16 v[192:195], v[80:83], v[96:99], v[192:195]
    ds_read_b128 v[76:79], v4 offset:7168
    v_exp_f32 v128, v128
    v_mfma_f32_16x16x32_bf16 v[200:203], v[80:83], v[104:107], v[200:203]
    v_exp_f32 v129, v129
    s_add_u32 s63, s12, 131072
    v_add_u32 v3, s63, v2
    s_add_u32 s62, s62, 1
    s_mov_b32 s33, s18
    s_mov_b32 s34, s19
    s_mov_b32 s35, s32
    s_mov_b32 s8, s13
    s_mov_b32 s13, s12
    v_mfma_f32_16x16x32_bf16 v[196:199], v[84:87], v[96:99], v[196:199]
    ds_read_b128 v[80:83], v4 offset:9216
    v_exp_f32 v130, v130
    v_mfma_f32_16x16x32_bf16 v[204:207], v[84:87], v[104:107], v[204:207]
    v_exp_f32 v131, v131
    v_mfma_f32_16x16x32_bf16 v[24:27], v[224:227], v[96:99], v[24:27]
    s_waitcnt lgkmcnt(5)
    v_mfma_f32_16x16x32_bf16 v[208:211], v[88:91], v[96:99], v[208:211]
    ds_read_b128 v[84:87], v4 offset:11264
    v_cvt_pk_bf16_f32 v128, v128, v129
    v_mfma_f32_16x16x32_bf16 v[216:219], v[88:91], v[104:107], v[216:219]
    v_exp_f32 v132, v132
    v_mfma_f32_16x16x32_bf16 v[28:31], v[224:227], v[104:107], v[28:31]
    v_mfma_f32_16x16x32_bf16 v[212:215], v[92:95], v[96:99], v[212:215]
    ds_read_b128 v[88:91], v4 offset:13312
    v_exp_f32 v133, v133
    v_mfma_f32_16x16x32_bf16 v[220:223], v[92:95], v[104:107], v[220:223]
    v_cvt_pk_bf16_f32 v129, v130, v131
    s_add_u32 s63, s62, 2
    s_lshl_b32 s96, s63, 1
    s_sub_u32 s96, s96, s61
    s_lshr_b32 s19, s9, 1
    s_cmp_ge_u32 s63, s61
    s_cselect_b32 s96, s96, s63
    s_cselect_b32 s19, s9, s19
    s_cselect_b32 s32, 4, 2
    s_cselect_b32 s12, s45, 0
    s_lshl_b32 s96, s96, 14
    s_add_u32 s18, s96, s19
    s_add_u32 s18, s18, s99
    s_cmp_gt_u32 s63, 16
    s_cselect_b32 s32, 0, s32
    s_waitcnt lgkmcnt(5)
    v_mfma_f32_16x16x32_bf16 v[160:163], v[64:67], v[112:115], v[160:163]
    ds_read_b128 v[92:95], v4 offset:15360
    v_exp_f32 v134, v134
    v_mfma_f32_16x16x32_bf16 v[168:171], v[64:67], v[120:123], v[168:171]
    v_exp_f32 v135, v135
    v_mfma_f32_16x16x32_bf16 v[164:167], v[68:71], v[112:115], v[164:167]
    v_cvt_pk_bf16_f32 v130, v132, v133
    v_mfma_f32_16x16x32_bf16 v[172:175], v[68:71], v[120:123], v[172:175]
    v_exp_f32 v136, v136
    s_waitcnt lgkmcnt(4)
    v_mfma_f32_16x16x32_bf16 v[176:179], v[72:75], v[112:115], v[176:179]
    v_exp_f32 v137, v137
    v_mfma_f32_16x16x32_bf16 v[184:187], v[72:75], v[120:123], v[184:187]
    s_waitcnt vmcnt(0) lgkmcnt(0)
    s_barrier
    s_setprio 3
    ds_read_b128 v[64:67], v3 offset:0
    ds_read_b128 v[68:71], v3 offset:1024
    v_cvt_pk_bf16_f32 v131, v134, v135
    v_mfma_f32_16x16x32_bf16 v[180:183], v[76:79], v[112:115], v[180:183]
    ds_read_b128 v[72:75], v3 offset:2048
    v_exp_f32 v138, v138
    v_mfma_f32_16x16x32_bf16 v[188:191], v[76:79], v[120:123], v[188:191]
    v_exp_f32 v139, v139
    s_add_u32 m0, s19, 98304
    s_cmp_le_u32 s32, 0
    s_cbranch_scc1 A_d_297
    buffer_load_dwordx4 v2, s[20:23], s18 offen offset:0 sc1 lds
A_d_297:
    v_mfma_f32_16x16x32_bf16 v[192:195], v[80:83], v[112:115], v[192:195]
    ds_read_b128 v[76:79], v3 offset:3072
    v_cvt_pk_bf16_f32 v136, v136, v137
    v_mfma_f32_16x16x32_bf16 v[200:203], v[80:83], v[120:123], v[200:203]
    v_exp_f32 v140, v140
    v_mfma_f32_16x16x32_bf16 v[24:27], v[224:227], v[112:115], v[24:27]
    v_mfma_f32_16x16x32_bf16 v[196:199], v[84:87], v[112:115], v[196:199]
    ds_read_b128 v[80:83], v3 offset:4096
    v_exp_f32 v141, v141
    v_mfma_f32_16x16x32_bf16 v[204:207], v[84:87], v[120:123], v[204:207]
    v_cvt_pk_bf16_f32 v137, v138, v139
    s_add_u32 m0, s19, 98304
    s_cmp_le_u32 s32, 1
    s_cbranch_scc1 A_d_298
    buffer_load_dwordx4 v2, s[20:23], s18 offen offset:1024 sc1 lds
A_d_298:
    v_mfma_f32_16x16x32_bf16 v[208:211], v[88:91], v[112:115], v[208:211]
    ds_read_b128 v[84:87], v3 offset:5120
    v_exp_f32 v142, v142
    v_mfma_f32_16x16x32_bf16 v[216:219], v[88:91], v[120:123], v[216:219]
    v_exp_f32 v143, v143
    v_mfma_f32_16x16x32_bf16 v[28:31], v[224:227], v[120:123], v[28:31]
    v_mfma_f32_16x16x32_bf16 v[212:215], v[92:95], v[112:115], v[212:215]
    ds_read_b128 v[88:91], v3 offset:6144
    v_cvt_pk_bf16_f32 v138, v140, v141
    v_mfma_f32_16x16x32_bf16 v[220:223], v[92:95], v[120:123], v[220:223]
    s_nop 0
    v_cvt_pk_bf16_f32 v139, v142, v143
    s_add_u32 m0, s19, 98304
    s_cmp_le_u32 s32, 2
    s_cbranch_scc1 A_d_299
    buffer_load_dwordx4 v2, s[20:23], s18 offen offset:2048 sc1 lds
A_d_299:
    s_cmp_lg_u32 s98, 0
    s_cbranch_scc1 A_resc_300
A_rescret_301:
    s_add_u32 s63, s8, 32768
    v_add_u32 v4, s63, v2
    s_waitcnt lgkmcnt(5)
    v_mfma_f32_16x16x32_bf16 v[96:99], v[64:67], v[32:35], v[16:19]
    ds_read_b128 v[92:95], v3 offset:7168
    v_exp_f32 v144, v144
    v_mfma_f32_16x16x32_bf16 v[104:107], v[64:67], v[36:39], v[20:23]
    v_exp_f32 v145, v145
    v_mfma_f32_16x16x32_bf16 v[96:99], v[68:71], v[40:43], v[96:99]
    ds_read_b128 v[64:67], v3 offset:8192
    v_exp_f32 v146, v146
    v_mfma_f32_16x16x32_bf16 v[104:107], v[68:71], v[44:47], v[104:107]
    v_exp_f32 v147, v147
    s_add_u32 m0, s19, 98304
    s_cmp_le_u32 s32, 3
    s_cbranch_scc1 A_d_303
    buffer_load_dwordx4 v2, s[20:23], s18 offen offset:3072 sc1 lds
A_d_303:
    s_waitcnt lgkmcnt(5)
    v_mfma_f32_16x16x32_bf16 v[96:99], v[72:75], v[48:51], v[96:99]
    ds_read_b128 v[68:71], v3 offset:9216
    v_cvt_pk_bf16_f32 v144, v144, v145
    v_mfma_f32_16x16x32_bf16 v[104:107], v[72:75], v[52:55], v[104:107]
    v_mfma_f32_16x16x32_bf16 v[96:99], v[76:79], v[56:59], v[96:99]
    s_setprio 2
    ds_read_b128 v[72:75], v3 offset:10240
    v_exp_f32 v148, v148
    v_mfma_f32_16x16x32_bf16 v[104:107], v[76:79], v[60:63], v[104:107]
    v_exp_f32 v149, v149
    s_add_u32 m0, s34, 0
    s_cmp_le_u32 s35, 0
    s_cbranch_scc1 A_d_304
    buffer_load_dwordx4 v2, s[24:27], s33 offen offset:0 sc1 lds
A_d_304:
    s_waitcnt lgkmcnt(5)
    v_mfma_f32_16x16x32_bf16 v[100:103], v[80:83], v[32:35], v[16:19]
    ds_read_b128 v[76:79], v3 offset:11264
    v_cvt_pk_bf16_f32 v145, v146, v147
    v_mfma_f32_16x16x32_bf16 v[108:111], v[80:83], v[36:39], v[20:23]
    v_mfma_f32_16x16x32_bf16 v[100:103], v[84:87], v[40:43], v[100:103]
    ds_read_b128 v[80:83], v3 offset:12288
    v_exp_f32 v150, v150
    v_mfma_f32_16x16x32_bf16 v[108:111], v[84:87], v[44:47], v[108:111]
    v_exp_f32 v151, v151
    s_add_u32 m0, s34, 0
    s_cmp_le_u32 s35, 1
    s_cbranch_scc1 A_d_305
    buffer_load_dwordx4 v2, s[24:27], s33 offen offset:1024 sc1 lds
A_d_305:
    s_waitcnt lgkmcnt(5)
    v_mfma_f32_16x16x32_bf16 v[100:103], v[88:91], v[48:51], v[100:103]
    ds_read_b128 v[84:87], v3 offset:13312
    v_cvt_pk_bf16_f32 v146, v148, v149
    v_mfma_f32_16x16x32_bf16 v[108:111], v[88:91], v[52:55], v[108:111]
    v_mfma_f32_16x16x32_bf16 v[100:103], v[92:95], v[56:59], v[100:103]
    ds_read_b128 v[88:91], v3 offset:14336
    v_exp_f32 v152, v152
    v_mfma_f32_16x16x32_bf16 v[108:111], v[92:95], v[60:63], v[108:111]
    v_exp_f32 v153, v153
    s_add_u32 m0, s34, 0
    s_cmp_le_u32 s35, 2
    s_cbranch_scc1 A_d_306
    buffer_load_dwordx4 v2, s[24:27], s33 offen offset:2048 sc1 lds
A_d_306:
    s_waitcnt lgkmcnt(5)
    v_mfma_f32_16x16x32_bf16 v[112:115], v[64:67], v[32:35], v[16:19]
    ds_read_b128 v[92:95], v3 offset:15360
    v_cvt_pk_bf16_f32 v147, v150, v151
    v_mfma_f32_16x16x32_bf16 v[120:123], v[64:67], v[36:39], v[20:23]
    v_exp_f32 v154, v154
    v_mfma_f32_16x16x32_bf16 v[112:115], v[68:71], v[40:43], v[112:115]
    ds_read_b128 v[64:67], v4 offset:0
    v_exp_f32 v155, v155
    v_mfma_f32_16x16x32_bf16 v[120:123], v[68:71], v[44:47], v[120:123]
    s_add_u32 m0, s34, 0
    s_cmp_le_u32 s35, 3
    s_cbranch_scc1 A_d_307
    buffer_load_dwordx4 v2, s[24:27], s33 offen offset:3072 sc1 lds
A_d_307:
    s_waitcnt lgkmcnt(5)
    v_mfma_f32_16x16x32_bf16 v[112:115], v[72:75], v[48:51], v[112:115]
    ds_read_b128 v[68:71], v4 offset:2048
    v_cvt_pk_bf16_f32 v152, v152, v153
    v_mfma_f32_16x16x32_bf16 v[120:123], v[72:75], v[52:55], v[120:123]
    v_exp_f32 v156, v156
    v_mfma_f32_16x16x32_bf16 v[112:115], v[76:79], v[56:59], v[112:115]
    s_setprio 1
    ds_read_b128 v[72:75], v4 offset:4096
    v_exp_f32 v157, v157
    v_mfma_f32_16x16x32_bf16 v[120:123], v[76:79], v[60:63], v[120:123]
    s_waitcnt lgkmcnt(5)
    v_mfma_f32_16x16x32_bf16 v[116:119], v[80:83], v[32:35], v[16:19]
    ds_read_b128 v[76:79], v4 offset:6144
    v_cvt_pk_bf16_f32 v153, v154, v155
    v_mfma_f32_16x16x32_bf16 v[124:127], v[80:83], v[36:39], v[20:23]
    v_exp_f32 v158, v158
    v_mfma_f32_16x16x32_bf16 v[116:119], v[84:87], v[40:43], v[116:119]
    ds_read_b128 v[80:83], v4 offset:8192
    v_exp_f32 v159, v159
    v_mfma_f32_16x16x32_bf16 v[124:127], v[84:87], v[44:47], v[124:127]
    s_waitcnt lgkmcnt(5)
    v_mfma_f32_16x16x32_bf16 v[116:119], v[88:91], v[48:51], v[116:119]
    ds_read_b128 v[84:87], v4 offset:10240
    v_cvt_pk_bf16_f32 v154, v156, v157
    v_mfma_f32_16x16x32_bf16 v[124:127], v[88:91], v[52:55], v[124:127]
    s_nop 0
    v_mfma_f32_16x16x32_bf16 v[116:119], v[92:95], v[56:59], v[116:119]
    ds_read_b128 v[88:91], v4 offset:12288
    v_cvt_pk_bf16_f32 v155, v158, v159
    v_mfma_f32_16x16x32_bf16 v[124:127], v[92:95], v[60:63], v[124:127]
    s_bitcmp1_b32 s44, s62
    s_cbranch_scc1 A_evb_308
A_evbret_309:
    s_waitcnt lgkmcnt(5)
    v_mfma_f32_16x16x32_bf16 v[160:163], v[64:67], v[128:131], v[160:163]
    ds_read_b128 v[92:95], v4 offset:14336
    v_max3_f32 v8, v96, v97, v98
    v_max3_f32 v8, v8, v99, v100
    v_mfma_f32_16x16x32_bf16 v[168:171], v[64:67], v[136:139], v[168:171]
    v_max3_f32 v8, v8, v101, v102
    v_max3_f32 v8, v8, v103, v104
    v_mfma_f32_16x16x32_bf16 v[164:167], v[68:71], v[128:131], v[164:167]
    ds_read_b128 v[64:67], v4 offset:1024
    v_max3_f32 v8, v8, v105, v106
    v_mfma_f32_16x16x32_bf16 v[172:175], v[68:71], v[136:139], v[172:175]
    v_max3_f32 v8, v8, v107, v108
    v_max3_f32 v8, v8, v109, v110
    s_waitcnt lgkmcnt(5)
    v_mfma_f32_16x16x32_bf16 v[176:179], v[72:75], v[128:131], v[176:179]
    ds_read_b128 v[68:71], v4 offset:3072
    v_max3_f32 v14, v111, v112, v113
    v_max3_f32 v14, v14, v114, v115
    v_mfma_f32_16x16x32_bf16 v[184:187], v[72:75], v[136:139], v[184:187]
    v_max3_f32 v14, v14, v116, v117
    v_max3_f32 v14, v14, v118, v119
    v_max3_f32 v14, v14, v120, v121
    v_mfma_f32_16x16x32_bf16 v[180:183], v[76:79], v[128:131], v[180:183]
    ds_read_b128 v[72:75], v4 offset:5120
    v_max3_f32 v14, v14, v122, v123
    v_max3_f32 v14, v14, v124, v125
    v_mfma_f32_16x16x32_bf16 v[188:191], v[76:79], v[136:139], v[188:191]
    s_setprio 0
    v_max3_f32 v14, v14, v126, v127
    v_max_f32 v8, v8, v14
    v_cmp_lt_f32 vcc, 0x41000000, v8
    s_cmp_eq_u32 s101, 1
    s_cbranch_scc1 A_slow_311
    s_cbranch_vccnz A_slow_311
A_slowret_312:
    s_waitcnt lgkmcnt(5)
    v_mfma_f32_16x16x32_bf16 v[192:195], v[80:83], v[128:131], v[192:195]
    ds_read_b128 v[76:79], v4 offset:7168
    v_exp_f32 v96, v96
    v_mfma_f32_16x16x32_bf16 v[200:203], v[80:83], v[136:139], v[200:203]
    v_exp_f32 v97, v97
    s_add_u32 s63, s12, 98304
    v_add_u32 v3, s63, v2
    s_add_u32 s62, s62, 1
    s_mov_b32 s33, s18
    s_mov_b32 s34, s19
    s_mov_b32 s35, s32
    s_mov_b32 s8, s13
    s_mov_b32 s13, s12
    v_mfma_f32_16x16x32_bf16 v[196:199], v[84:87], v[128:131], v[196:199]
    ds_read_b128 v[80:83], v4 offset:9216
    v_exp_f32 v98, v98
    v_mfma_f32_16x16x32_bf16 v[204:207], v[84:87], v[136:139], v[204:207]
    v_exp_f32 v99, v99
    v_mfma_f32_16x16x32_bf16 v[24:27], v[224:227], v[128:131], v[24:27]
    s_waitcnt lgkmcnt(5)
    v_mfma_f32_16x16x32_bf16 v[208:211], v[88:91], v[128:131], v[208:211]
    ds_read_b128 v[84:87], v4 offset:11264
    v_cvt_pk_bf16_f32 v96, v96, v97
    v_mfma_f32_16x16x32_bf16 v[216:219], v[88:91], v[136:139], v[216:219]
    v_exp_f32 v100, v100
    v_mfma_f32_16x16x32_bf16 v[28:31], v[224:227], v[136:139], v[28:31]
    v_mfma_f32_16x16x32_bf16 v[212:215], v[92:95], v[128:131], v[212:215]
    ds_read_b128 v[88:91], v4 offset:13312
    v_exp_f32 v101, v101
    v_mfma_f32_16x16x32_bf16 v[220:223], v[92:95], v[136:139], v[220:223]
    v_cvt_pk_bf16_f32 v97, v98, v99
    s_add_u32 s63, s62, 2
    s_lshl_b32 s96, s63, 1
    s_sub_u32 s96, s96, s61
    s_lshr_b32 s19, s9, 1
    s_cmp_ge_u32 s63, s61
    s_cselect_b32 s96, s96, s63
    s_cselect_b32 s19, s9, s19
    s_cselect_b32 s32, 4, 2
    s_cselect_b32 s12, s45, 0
    s_lshl_b32 s96, s96, 14
    s_add_u32 s18, s96, s19
    s_add_u32 s18, s18, s99
    s_cmp_gt_u32 s63, 16
    s_cselect_b32 s32, 0, s32
    s_waitcnt lgkmcnt(5)
    v_mfma_f32_16x16x32_bf16 v[160:163], v[64:67], v[144:147], v[160:163]
    ds_read_b128 v[92:95], v4 offset:15360
    v_exp_f32 v102, v102
    v_mfma_f32_16x16x32_bf16 v[168:171], v[64:67], v[152:155], v[168:171]
    v_exp_f32 v103, v103
    v_mfma_f32_16x16x32_bf16 v[164:167], v[68:71], v[144:147], v[164:167]
    v_cvt_pk_bf16_f32 v98, v100, v101
    v_mfma_f32_16x16x32_bf16 v[172:175], v[68:71], v[152:155], v[172:175]
    v_exp_f32 v104, v104
    s_waitcnt lgkmcnt(4)
    v_mfma_f32_16x16x32_bf16 v[176:179], v[72:75], v[144:147], v[176:179]
    v_exp_f32 v105, v105
    v_mfma_f32_16x16x32_bf16 v[184:187], v[72:75], v[152:155], v[184:187]
    s_waitcnt vmcnt(0) lgkmcnt(0)
    s_barrier
    s_setprio 3
    ds_read_b128 v[64:67], v3 offset:0
    ds_read_b128 v[68:71], v3 offset:1024
    v_cvt_pk_bf16_f32 v99, v102, v103
    v_mfma_f32_16x16x32_bf16 v[180:183], v[76:79], v[144:147], v[180:183]
    ds_read_b128 v[72:75], v3 offset:2048
    v_exp_f32 v106, v106
    v_mfma_f32_16x16x32_bf16 v[188:191], v[76:79], v[152:155], v[188:191]
    v_exp_f32 v107, v107
    s_add_u32 m0, s19, 131072
    s_cmp_le_u32 s32, 0
    s_cbranch_scc1 A_d_315
    buffer_load_dwordx4 v2, s[20:23], s18 offen offset:0 sc1 lds
A_d_315:
    v_mfma_f32_16x16x32_bf16 v[192:195], v[80:83], v[144:147], v[192:195]
    ds_read_b128 v[76:79], v3 offset:3072
    v_cvt_pk_bf16_f32 v104, v104, v105
    v_mfma_f32_16x16x32_bf16 v[200:203], v[80:83], v[152:155], v[200:203]
    v_exp_f32 v108, v108
    v_mfma_f32_16x16x32_bf16 v[24:27], v[224:227], v[144:147], v[24:27]
    v_mfma_f32_16x16x32_bf16 v[196:199], v[84:87], v[144:147], v[196:199]
    ds_read_b128 v[80:83], v3 offset:4096
    v_exp_f32 v109, v109
    v_mfma_f32_16x16x32_bf16 v[204:207], v[84:87], v[152:155], v[204:207]
    v_cvt_pk_bf16_f32 v105, v106, v107
    s_add_u32 m0, s19, 131072
    s_cmp_le_u32 s32, 1
    s_cbranch_scc1 A_d_316
    buffer_load_dwordx4 v2, s[20:23], s18 offen offset:1024 sc1 lds
A_d_316:
    v_mfma_f32_16x16x32_bf16 v[208:211], v[88:91], v[144:147], v[208:211]
    ds_read_b128 v[84:87], v3 offset:5120
    v_exp_f32 v110, v110
    v_mfma_f32_16x16x32_bf16 v[216:219], v[88:91], v[152:155], v[216:219]
    v_exp_f32 v111, v111
    v_mfma_f32_16x16x32_bf16 v[28:31], v[224:227], v[152:155], v[28:31]
    v_mfma_f32_16x16x32_bf16 v[212:215], v[92:95], v[144:147], v[212:215]
    ds_read_b128 v[88:91], v3 offset:6144
    v_cvt_pk_bf16_f32 v106, v108, v109
    v_mfma_f32_16x16x32_bf16 v[220:223], v[92:95], v[152:155], v[220:223]
    s_nop 0
    v_cvt_pk_bf16_f32 v107, v110, v111
    s_add_u32 m0, s19, 131072
    s_cmp_le_u32 s32, 2
    s_cbranch_scc1 A_d_317
    buffer_load_dwordx4 v2, s[20:23], s18 offen offset:2048 sc1 lds
A_d_317:
    s_cmp_lt_u32 s62, 16
    s_cbranch_scc1 A_loop
    s_waitcnt lgkmcnt(0)
    s_setprio 0
    s_and_b32 s64, s2, 7
    s_lshl_b32 s67, s56, 10
    s_mov_b32 s16, s46
    s_mov_b32 s17, s47
    s_mov_b32 s18, 0x800000
    s_mov_b32 s19, 0x00020000
    s_add_u32 s36, s14, 0x3400000
    s_addc_u32 s37, s15, 0
    s_mov_b32 s38, 0x380000
    s_mov_b32 s39, 0x00020000
    s_cmp_ge_u32 s2, 240
    s_cbranch_scc1 PE_done
    s_cmp_ge_u32 s2, 112
    s_cbranch_scc1 PE_wo
    s_lshr_b32 s69, s2, 3
    s_and_b32 s65, s69, 1
    s_lshl_b32 s70, s64, 1
    s_add_u32 s65, s65, s70
    s_lshr_b32 s66, s69, 1
    v_lshrrev_b32 v33, 3, v1
    v_and_b32 v34, 7, v1
    v_lshrrev_b32 v35, 1, v33
    s_and_b32 s69, s56, 1
    s_lshl_b32 s69, s69, 2
    v_add_u32 v35, s69, v35
    v_xor_b32 v34, v34, v35
    v_lshlrev_b32 v34, 4, v34
    s_lshl_b32 s69, s56, 3
    v_add_u32 v33, s69, v33
    v_lshlrev_b32 v33, 12, v33
    v_add_u32 v3, v33, v34
    s_lshl_b32 s73, s65, 19
    s_lshl_b32 s70, s66, 2
    s_add_u32 s70, s70, s58
    s_lshl_b32 s74, s70, 17
    s_lshl_b32 s69, s57, 11
    s_add_u32 s74, s74, s69
    s_cmp_eq_u32 s56, 0
    s_cbranch_scc0 PE_nf
    s_add_u32 s52, s14, 0x6400000
    s_addc_u32 s53, s15, 0
    s_mov_b32 s54, 0x4000
    s_mov_b32 s55, 0x00020000
    s_mov_b32 s51, 8192
    buffer_load_dwordx4 v[36:39], v2, s[52:55], s51 offen sc1
PE_nf:
    s_add_u32 m0, s67, 98304
    s_add_u32 s63, s73, 0
    buffer_load_dwordx4 v3, s[16:19], s63 offen lds
    s_add_u32 m0, s67, 106496
    s_add_u32 s63, s73, 262144
    buffer_load_dwordx4 v3, s[16:19], s63 offen lds
    s_add_u32 m0, s67, 114688
    s_add_u32 s63, s73, 128
    buffer_load_dwordx4 v3, s[16:19], s63 offen lds
    s_add_u32 m0, s67, 122880
    s_add_u32 s63, s73, 262272
    buffer_load_dwordx4 v3, s[16:19], s63 offen lds
    s_add_u32 m0, s67, 131072
    s_add_u32 s63, s73, 256
    buffer_load_dwordx4 v3, s[16:19], s63 offen lds
    s_add_u32 m0, s67, 139264
    s_add_u32 s63, s73, 262400
    buffer_load_dwordx4 v3, s[16:19], s63 offen lds
    s_add_u32 m0, s67, 147456
    s_add_u32 s63, s73, 384
    buffer_load_dwordx4 v3, s[16:19], s63 offen lds
    s_add_u32 m0, s67, 155648
    s_add_u32 s63, s73, 262528
    buffer_load_dwordx4 v3, s[16:19], s63 offen lds
    s_branch PE_done
PE_wo:
    s_sub_u32 s69, s2, 112
    s_lshr_b32 s69, s69, 3
    s_and_b32 s66, s69, 3
    s_lshr_b32 s65, s69, 2
    s_and_b32 s70, s64, 1
    s_lshl_b32 s70, s70, 2
    s_add_u32 s65, s65, s70
    s_lshr_b32 s78, s64, 1
    v_lshrrev_b32 v33, 4, v1
    v_and_b32 v34, 15, v1
    v_lshrrev_b32 v35, 1, v34
    v_and_b32 v34, 1, v34
    s_and_b32 s69, s56, 1
    s_lshl_b32 s69, s69, 2
    v_add_u32 v36, s69, v33
    v_xor_b32 v35, v35, v36
    v_lshlrev_b32 v35, 5, v35
    v_lshlrev_b32 v34, 4, v34
    v_add_u32 v35, v35, v34
    s_lshl_b32 s69, s56, 2
    v_add_u32 v33, s69, v33
    v_lshlrev_b32 v33, 10, v33
    v_add_u32 v3, v33, v35
    s_mov_b32 s16, s40
    s_mov_b32 s17, s41
    s_mov_b32 s18, 0x400000
    s_mov_b32 s19, 0x00020000
    s_lshl_b32 s74, s78, 20
    s_lshl_b32 s69, s66, 8
    s_add_u32 s74, s74, s69
    s_add_u32 m0, s67, 98304
    s_add_u32 s63, s74, 0
    buffer_load_dwordx4 v3, s[16:19], s63 offen lds
    s_add_u32 m0, s67, 106496
    s_add_u32 s63, s74, 32768
    buffer_load_dwordx4 v3, s[16:19], s63 offen lds
    s_add_u32 m0, s67, 114688
    s_add_u32 s63, s74, 65536
    buffer_load_dwordx4 v3, s[16:19], s63 offen lds
    s_add_u32 m0, s67, 122880
    s_add_u32 s63, s74, 98304
    buffer_load_dwordx4 v3, s[16:19], s63 offen lds
    s_add_u32 m0, s67, 131072
    s_add_u32 s63, s74, 131072
    buffer_load_dwordx4 v3, s[16:19], s63 offen lds
    s_add_u32 m0, s67, 139264
    s_add_u32 s63, s74, 163840
    buffer_load_dwordx4 v3, s[16:19], s63 offen lds
    s_add_u32 m0, s67, 147456
    s_add_u32 s63, s74, 196608
    buffer_load_dwordx4 v3, s[16:19], s63 offen lds
    s_add_u32 m0, s67, 155648
    s_add_u32 s63, s74, 229376
    buffer_load_dwordx4 v3, s[16:19], s63 offen lds
PE_done:
    s_cmp_lg_u32 s98, 0
    s_cbranch_scc1 A_resc_318
A_rescret_319:
    s_add_u32 s63, s8, 0
    v_add_u32 v4, s63, v2
    ds_read_b128 v[64:67], v4 offset:0
    ds_read_b128 v[68:71], v4 offset:2048
    ds_read_b128 v[72:75], v4 offset:4096
    ds_read_b128 v[76:79], v4 offset:6144
    ds_read_b128 v[80:83], v4 offset:8192
    ds_read_b128 v[84:87], v4 offset:10240
    ds_read_b128 v[88:91], v4 offset:12288
    v_exp_f32 v112, v112
    v_exp_f32 v113, v113
    v_exp_f32 v114, v114
    v_exp_f32 v115, v115
    v_cvt_pk_bf16_f32 v112, v112, v113
    v_exp_f32 v116, v116
    v_exp_f32 v117, v117
    v_cvt_pk_bf16_f32 v113, v114, v115
    v_exp_f32 v118, v118
    v_exp_f32 v119, v119
    v_cvt_pk_bf16_f32 v114, v116, v117
    v_exp_f32 v120, v120
    v_exp_f32 v121, v121
    v_cvt_pk_bf16_f32 v115, v118, v119
    v_exp_f32 v122, v122
    v_exp_f32 v123, v123
    v_cvt_pk_bf16_f32 v120, v120, v121
    v_exp_f32 v124, v124
    v_exp_f32 v125, v125
    v_cvt_pk_bf16_f32 v121, v122, v123
    v_exp_f32 v126, v126
    v_exp_f32 v127, v127
    v_cvt_pk_bf16_f32 v122, v124, v125
    s_nop 0
    v_cvt_pk_bf16_f32 v123, v126, v127
    s_waitcnt lgkmcnt(6)
    v_mfma_f32_16x16x32_bf16 v[160:163], v[64:67], v[96:99], v[160:163]
    ds_read_b128 v[92:95], v4 offset:14336
    v_mfma_f32_16x16x32_bf16 v[168:171], v[64:67], v[104:107], v[168:171]
    s_waitcnt lgkmcnt(6)
    v_mfma_f32_16x16x32_bf16 v[164:167], v[68:71], v[96:99], v[164:167]
    ds_read_b128 v[64:67], v4 offset:1024
    v_mfma_f32_16x16x32_bf16 v[172:175], v[68:71], v[104:107], v[172:175]
    v_mfma_f32_16x16x32_bf16 v[24:27], v[224:227], v[96:99], v[24:27]
    v_mfma_f32_16x16x32_bf16 v[28:31], v[224:227], v[104:107], v[28:31]
    s_waitcnt lgkmcnt(6)
    v_mfma_f32_16x16x32_bf16 v[176:179], v[72:75], v[96:99], v[176:179]
    ds_read_b128 v[68:71], v4 offset:3072
    v_mfma_f32_16x16x32_bf16 v[184:187], v[72:75], v[104:107], v[184:187]
    s_waitcnt lgkmcnt(6)
    v_mfma_f32_16x16x32_bf16 v[180:183], v[76:79], v[96:99], v[180:183]
    ds_read_b128 v[72:75], v4 offset:5120
    v_mfma_f32_16x16x32_bf16 v[188:191], v[76:79], v[104:107], v[188:191]
    s_waitcnt lgkmcnt(6)
    v_mfma_f32_16x16x32_bf16 v[192:195], v[80:83], v[96:99], v[192:195]
    ds_read_b128 v[76:79], v4 offset:7168
    v_mfma_f32_16x16x32_bf16 v[200:203], v[80:83], v[104:107], v[200:203]
    s_waitcnt lgkmcnt(6)
    v_mfma_f32_16x16x32_bf16 v[196:199], v[84:87], v[96:99], v[196:199]
    ds_read_b128 v[80:83], v4 offset:9216
    v_mfma_f32_16x16x32_bf16 v[204:207], v[84:87], v[104:107], v[204:207]
    s_waitcnt lgkmcnt(6)
    v_mfma_f32_16x16x32_bf16 v[208:211], v[88:91], v[96:99], v[208:211]
    ds_read_b128 v[84:87], v4 offset:11264
    v_mfma_f32_16x16x32_bf16 v[216:219], v[88:91], v[104:107], v[216:219]
    s_waitcnt lgkmcnt(6)
    v_mfma_f32_16x16x32_bf16 v[212:215], v[92:95], v[96:99], v[212:215]
    ds_read_b128 v[88:91], v4 offset:13312
    v_mfma_f32_16x16x32_bf16 v[220:223], v[92:95], v[104:107], v[220:223]
    s_waitcnt lgkmcnt(6)
    v_mfma_f32_16x16x32_bf16 v[160:163], v[64:67], v[112:115], v[160:163]
    ds_read_b128 v[92:95], v4 offset:15360
    v_mfma_f32_16x16x32_bf16 v[168:171], v[64:67], v[120:123], v[168:171]
    s_waitcnt lgkmcnt(6)
    v_mfma_f32_16x16x32_bf16 v[164:167], v[68:71], v[112:115], v[164:167]
    v_mfma_f32_16x16x32_bf16 v[172:175], v[68:71], v[120:123], v[172:175]
    v_mfma_f32_16x16x32_bf16 v[24:27], v[224:227], v[112:115], v[24:27]
    v_mfma_f32_16x16x32_bf16 v[28:31], v[224:227], v[120:123], v[28:31]
    s_waitcnt lgkmcnt(5)
    v_mfma_f32_16x16x32_bf16 v[176:179], v[72:75], v[112:115], v[176:179]
    v_mfma_f32_16x16x32_bf16 v[184:187], v[72:75], v[120:123], v[184:187]
    s_waitcnt lgkmcnt(4)
    v_mfma_f32_16x16x32_bf16 v[180:183], v[76:79], v[112:115], v[180:183]
    v_mfma_f32_16x16x32_bf16 v[188:191], v[76:79], v[120:123], v[188:191]
    s_waitcnt lgkmcnt(3)
    v_mfma_f32_16x16x32_bf16 v[192:195], v[80:83], v[112:115], v[192:195]
    v_mfma_f32_16x16x32_bf16 v[200:203], v[80:83], v[120:123], v[200:203]
    s_waitcnt lgkmcnt(2)
    v_mfma_f32_16x16x32_bf16 v[196:199], v[84:87], v[112:115], v[196:199]
    v_mfma_f32_16x16x32_bf16 v[204:207], v[84:87], v[120:123], v[204:207]
    s_waitcnt lgkmcnt(1)
    v_mfma_f32_16x16x32_bf16 v[208:211], v[88:91], v[112:115], v[208:211]
    v_mfma_f32_16x16x32_bf16 v[216:219], v[88:91], v[120:123], v[216:219]
    s_waitcnt lgkmcnt(0)
    v_mfma_f32_16x16x32_bf16 v[212:215], v[92:95], v[112:115], v[212:215]
    v_mfma_f32_16x16x32_bf16 v[220:223], v[92:95], v[120:123], v[220:223]
    v_mov_b32 v16, v5
    v_mov_b32 v17, v24
    v_mov_b32 v18, v6
    v_mov_b32 v19, v28
    s_lshl_b32 s63, s56, 10
    s_add_u32 s63, s63, 65536
    v_add_u32 v9, s63, v2
    s_xor_b32 s63, s63, 4096
    v_add_u32 v13, s63, v2
    ds_write_b128 v9, v[16:19]
    s_cmp_ge_u32 s2, 112
    s_cbranch_scc1 PC_done
    s_cmp_eq_u32 s56, 0
    s_cbranch_scc0 PC_done
    s_waitcnt vmcnt(8)
    v_xor_b32 v36, s3, v36
    v_xor_b32 v37, s3, v37
    v_xor_b32 v38, s3, v38
    v_xor_b32 v39, s3, v39
    v_or_b32 v36, v36, v37
    v_or3_b32 v36, v36, v38, v39
    v_cmp_ne_u32 vcc, 0, v36
    s_nop 1
    s_cbranch_vccnz PC_slow
PC_done:
    s_waitcnt lgkmcnt(0)
    s_barrier
    s_cmp_ge_u32 s2, 112
    s_cbranch_scc1 PM_done
    s_add_u32 s63, s74, 0
    buffer_load_dwordx4 v[224:227], v12, s[36:39], s63 offen sc1
    buffer_load_dwordx4 v[228:231], v12, s[36:39], s63 offen offset:256 sc1
    s_add_u32 s63, s74, 4096
    buffer_load_dwordx4 v[232:235], v12, s[36:39], s63 offen sc1
    buffer_load_dwordx4 v[236:239], v12, s[36:39], s63 offen offset:256 sc1
    s_add_u32 s63, s74, 8192
    buffer_load_dwordx4 v[240:243], v12, s[36:39], s63 offen sc1
    buffer_load_dwordx4 v[244:247], v12, s[36:39], s63 offen offset:256 sc1
    s_add_u32 s63, s74, 12288
    buffer_load_dwordx4 v[248:251], v12, s[36:39], s63 offen sc1
    buffer_load_dwordx4 v[252:255], v12, s[36:39], s63 offen offset:256 sc1
PM_done:
    ds_read_b128 v[20:23], v13
    s_lshl_b32 s63, s56, 13
    v_add_u32 v9, s63, v2
    s_xor_b32 s63, s63, 32768
    v_add_u32 v13, s63, v2
    s_sub_u32 s97, 15, s60
    s_lshl_b32 s97, s97, 2
    s_add_u32 s97, s97, s58
    s_lshl_b32 s97, s97, 18
    s_lshl_b32 s96, s59, 13
    s_add_u32 s97, s97, s96
    s_waitcnt lgkmcnt(0)
    v_max_f32 v8, v16, v20
    v_sub_f32 v16, v16, v8
    v_sub_f32 v20, v20, v8
    v_exp_f32 v16, v16
    v_exp_f32 v20, v20
    s_nop 0
    v_mul_f32 v17, v17, v16
    v_fmac_f32 v17, v21, v20
    v_rcp_f32 v17, v17
    s_nop 0
    v_mul_f32 v11, v16, v17
    v_max_f32 v8, v18, v22
    v_sub_f32 v18, v18, v8
    v_sub_f32 v22, v22, v8
    v_exp_f32 v18, v18
    v_exp_f32 v22, v22
    s_nop 0
    v_mul_f32 v19, v19, v18
    v_fmac_f32 v19, v23, v22
    v_rcp_f32 v19, v19
    s_nop 0
    v_mul_f32 v7, v18, v19
    s_cmp_eq_u32 s57, 0
    s_cbranch_scc0 A_mg1
    v_mul_f32 v192, v192, v11
    v_mul_f32 v193, v193, v11
    v_mul_f32 v194, v194, v11
    v_mul_f32 v195, v195, v11
    v_mul_f32 v196, v196, v11
    v_mul_f32 v197, v197, v11
    v_mul_f32 v198, v198, v11
    v_mul_f32 v199, v199, v11
    v_mul_f32 v200, v200, v7
    v_mul_f32 v201, v201, v7
    v_mul_f32 v202, v202, v7
    v_mul_f32 v203, v203, v7
    v_mul_f32 v204, v204, v7
    v_mul_f32 v205, v205, v7
    v_mul_f32 v206, v206, v7
    v_mul_f32 v207, v207, v7
    v_mul_f32 v208, v208, v11
    v_mul_f32 v209, v209, v11
    v_mul_f32 v210, v210, v11
    v_mul_f32 v211, v211, v11
    v_mul_f32 v212, v212, v11
    v_mul_f32 v213, v213, v11
    v_mul_f32 v214, v214, v11
    v_mul_f32 v215, v215, v11
    v_mul_f32 v216, v216, v7
    v_mul_f32 v217, v217, v7
    v_mul_f32 v218, v218, v7
    v_mul_f32 v219, v219, v7
    v_mul_f32 v220, v220, v7
    v_mul_f32 v221, v221, v7
    v_mul_f32 v222, v222, v7
    v_mul_f32 v223, v223, v7
    ds_write_b128 v9, v[192:195] offset:0
    ds_write_b128 v9, v[196:199] offset:1024
    ds_write_b128 v9, v[200:203] offset:2048
    ds_write_b128 v9, v[204:207] offset:3072
    ds_write_b128 v9, v[208:211] offset:4096
    ds_write_b128 v9, v[212:215] offset:5120
    ds_write_b128 v9, v[216:219] offset:6144
    ds_write_b128 v9, v[220:223] offset:7168
    s_waitcnt lgkmcnt(0)
    s_barrier
    ds_read_b128 v[96:99], v13 offset:0
    ds_read_b128 v[100:103], v13 offset:1024
    ds_read_b128 v[104:107], v13 offset:2048
    ds_read_b128 v[108:111], v13 offset:3072
    ds_read_b128 v[112:115], v13 offset:4096
    ds_read_b128 v[116:119], v13 offset:5120
    ds_read_b128 v[120:123], v13 offset:6144
    ds_read_b128 v[124:127], v13 offset:7168
    s_waitcnt lgkmcnt(7)
    v_fma_f32 v160, v160, v11, v96
    v_fma_f32 v161, v161, v11, v97
    v_fma_f32 v162, v162, v11, v98
    v_fma_f32 v163, v163, v11, v99
    s_waitcnt lgkmcnt(6)
    v_fma_f32 v164, v164, v11, v100
    v_fma_f32 v165, v165, v11, v101
    v_fma_f32 v166, v166, v11, v102
    v_fma_f32 v167, v167, v11, v103
    s_waitcnt lgkmcnt(5)
    v_fma_f32 v168, v168, v7, v104
    v_fma_f32 v169, v169, v7, v105
    v_fma_f32 v170, v170, v7, v106
    v_fma_f32 v171, v171, v7, v107
    s_waitcnt lgkmcnt(4)
    v_fma_f32 v172, v172, v7, v108
    v_fma_f32 v173, v173, v7, v109
    v_fma_f32 v174, v174, v7, v110
    v_fma_f32 v175, v175, v7, v111
    s_waitcnt lgkmcnt(3)
    v_fma_f32 v176, v176, v11, v112
    v_fma_f32 v177, v177, v11, v113
    v_fma_f32 v178, v178, v11, v114
    v_fma_f32 v179, v179, v11, v115
    s_waitcnt lgkmcnt(2)
    v_fma_f32 v180, v180, v11, v116
    v_fma_f32 v181, v181, v11, v117
    v_fma_f32 v182, v182, v11, v118
    v_fma_f32 v183, v183, v11, v119
    s_waitcnt lgkmcnt(1)
    v_fma_f32 v184, v184, v7, v120
    v_fma_f32 v185, v185, v7, v121
    v_fma_f32 v186, v186, v7, v122
    v_fma_f32 v187, v187, v7, v123
    s_waitcnt lgkmcnt(0)
    v_fma_f32 v188, v188, v7, v124
    v_fma_f32 v189, v189, v7, v125
    v_fma_f32 v190, v190, v7, v126
    v_fma_f32 v191, v191, v7, v127
    s_add_u32 s96, s97, 0
    v_cvt_pk_bf16_f32 v160, v160, v161
    v_cvt_pk_bf16_f32 v161, v162, v163
    v_cvt_pk_bf16_f32 v162, v164, v165
    v_cvt_pk_bf16_f32 v163, v166, v167
    buffer_store_dwordx4 v[160:163], v12, s[28:31], s96 offen offset:0 sc1
    v_cvt_pk_bf16_f32 v168, v168, v169
    v_cvt_pk_bf16_f32 v169, v170, v171
    v_cvt_pk_bf16_f32 v170, v172, v173
    v_cvt_pk_bf16_f32 v171, v174, v175
    buffer_store_dwordx4 v[168:171], v12, s[28:31], s96 offen offset:256 sc1
    s_add_u32 s96, s97, 2048
    v_cvt_pk_bf16_f32 v176, v176, v177
    v_cvt_pk_bf16_f32 v177, v178, v179
    v_cvt_pk_bf16_f32 v178, v180, v181
    v_cvt_pk_bf16_f32 v179, v182, v183
    buffer_store_dwordx4 v[176:179], v12, s[28:31], s96 offen offset:0 sc1
    v_cvt_pk_bf16_f32 v184, v184, v185
    v_cvt_pk_bf16_f32 v185, v186, v187
    v_cvt_pk_bf16_f32 v186, v188, v189
    v_cvt_pk_bf16_f32 v187, v190, v191
    buffer_store_dwordx4 v[184:187], v12, s[28:31], s96 offen offset:256 sc1
    s_branch A_done
A_mg1:
    v_mul_f32 v160, v160, v11
    v_mul_f32 v161, v161, v11
    v_mul_f32 v162, v162, v11
    v_mul_f32 v163, v163, v11
    v_mul_f32 v164, v164, v11
    v_mul_f32 v165, v165, v11
    v_mul_f32 v166, v166, v11
    v_mul_f32 v167, v167, v11
    v_mul_f32 v168, v168, v7
    v_mul_f32 v169, v169, v7
    v_mul_f32 v170, v170, v7
    v_mul_f32 v171, v171, v7
    v_mul_f32 v172, v172, v7
    v_mul_f32 v173, v173, v7
    v_mul_f32 v174, v174, v7
    v_mul_f32 v175, v175, v7
    v_mul_f32 v176, v176, v11
    v_mul_f32 v177, v177, v11
    v_mul_f32 v178, v178, v11
    v_mul_f32 v179, v179, v11
    v_mul_f32 v180, v180, v11
    v_mul_f32 v181, v181, v11
    v_mul_f32 v182, v182, v11
    v_mul_f32 v183, v183, v11
    v_mul_f32 v184, v184, v7
    v_mul_f32 v185, v185, v7
    v_mul_f32 v186, v186, v7
    v_mul_f32 v187, v187, v7
    v_mul_f32 v188, v188, v7
    v_mul_f32 v189, v189, v7
    v_mul_f32 v190, v190, v7
    v_mul_f32 v191, v191, v7
    ds_write_b128 v9, v[160:163] offset:0
    ds_write_b128 v9, v[164:167] offset:1024
    ds_write_b128 v9, v[168:171] offset:2048
    ds_write_b128 v9, v[172:175] offset:3072
    ds_write_b128 v9, v[176:179] offset:4096
    ds_write_b128 v9, v[180:183] offset:5120
    ds_write_b128 v9, v[184:187] offset:6144
    ds_write_b128 v9, v[188:191] offset:7168
    s_waitcnt lgkmcnt(0)
    s_barrier
    ds_read_b128 v[96:99], v13 offset:0
    ds_read_b128 v[100:103], v13 offset:1024
    ds_read_b128 v[104:107], v13 offset:2048
    ds_read_b128 v[108:111], v13 offset:3072
    ds_read_b128 v[112:115], v13 offset:4096
    ds_read_b128 v[116:119], v13 offset:5120
    ds_read_b128 v[120:123], v13 offset:6144
    ds_read_b128 v[124:127], v13 offset:7168
    s_waitcnt lgkmcnt(7)
    v_fma_f32 v192, v192, v11, v96
    v_fma_f32 v193, v193, v11, v97
    v_fma_f32 v194, v194, v11, v98
    v_fma_f32 v195, v195, v11, v99
    s_waitcnt lgkmcnt(6)
    v_fma_f32 v196, v196, v11, v100
    v_fma_f32 v197, v197, v11, v101
    v_fma_f32 v198, v198, v11, v102
    v_fma_f32 v199, v199, v11, v103
    s_waitcnt lgkmcnt(5)
    v_fma_f32 v200, v200, v7, v104
    v_fma_f32 v201, v201, v7, v105
    v_fma_f32 v202, v202, v7, v106
    v_fma_f32 v203, v203, v7, v107
    s_waitcnt lgkmcnt(4)
    v_fma_f32 v204, v204, v7, v108
    v_fma_f32 v205, v205, v7, v109
    v_fma_f32 v206, v206, v7, v110
    v_fma_f32 v207, v207, v7, v111
    s_waitcnt lgkmcnt(3)
    v_fma_f32 v208, v208, v11, v112
    v_fma_f32 v209, v209, v11, v113
    v_fma_f32 v210, v210, v11, v114
    v_fma_f32 v211, v211, v11, v115
    s_waitcnt lgkmcnt(2)
    v_fma_f32 v212, v212, v11, v116
    v_fma_f32 v213, v213, v11, v117
    v_fma_f32 v214, v214, v11, v118
    v_fma_f32 v215, v215, v11, v119
    s_waitcnt lgkmcnt(1)
    v_fma_f32 v216, v216, v7, v120
    v_fma_f32 v217, v217, v7, v121
    v_fma_f32 v218, v218, v7, v122
    v_fma_f32 v219, v219, v7, v123
    s_waitcnt lgkmcnt(0)
    v_fma_f32 v220, v220, v7, v124
    v_fma_f32 v221, v221, v7, v125
    v_fma_f32 v222, v222, v7, v126
    v_fma_f32 v223, v223, v7, v127
    s_add_u32 s96, s97, 4096
    v_cvt_pk_bf16_f32 v192, v192, v193
    v_cvt_pk_bf16_f32 v193, v194, v195
    v_cvt_pk_bf16_f32 v194, v196, v197
    v_cvt_pk_bf16_f32 v195, v198, v199
    buffer_store_dwordx4 v[192:195], v12, s[28:31], s96 offen offset:0 sc1
    v_cvt_pk_bf16_f32 v200, v200, v201
    v_cvt_pk_bf16_f32 v201, v202, v203
    v_cvt_pk_bf16_f32 v202, v204, v205
    v_cvt_pk_bf16_f32 v203, v206, v207
    buffer_store_dwordx4 v[200:203], v12, s[28:31], s96 offen offset:256 sc1
    s_add_u32 s96, s97, 6144
    v_cvt_pk_bf16_f32 v208, v208, v209
    v_cvt_pk_bf16_f32 v209, v210, v211
    v_cvt_pk_bf16_f32 v210, v212, v213
    v_cvt_pk_bf16_f32 v211, v214, v215
    buffer_store_dwordx4 v[208:211], v12, s[28:31], s96 offen offset:0 sc1
    v_cvt_pk_bf16_f32 v216, v216, v217
    v_cvt_pk_bf16_f32 v217, v218, v219
    v_cvt_pk_bf16_f32 v218, v220, v221
    v_cvt_pk_bf16_f32 v219, v222, v223
    buffer_store_dwordx4 v[216:219], v12, s[28:31], s96 offen offset:256 sc1
A_done:
    s_load_dwordx2 s[12:13], s[0:1], 72
    s_lshr_b32 s69, s59, 3
    s_lshl_b32 s69, s69, 2
    s_lshr_b32 s71, s60, 1
    s_add_u32 s69, s69, s71
    s_lshl_b32 s69, s69, 7
    s_and_b32 s71, s59, 7
    s_lshl_b32 s71, s71, 1
    s_and_b32 s72, s60, 1
    s_add_u32 s71, s71, s72
    s_lshl_b32 s71, s71, 2
    s_add_u32 s69, s69, s71
    s_add_u32 s79, s69, 12288
    v_and_b32 v4, 15, v1
    v_lshrrev_b32 v5, 4, v1
    s_cmp_ge_u32 s2, 112
    s_cbranch_scc1 P_notsp
    v_lshrrev_b32 v6, 1, v4
    v_xor_b32 v6, v6, v5
    v_lshlrev_b32 v6, 4, v6
    v_lshlrev_b32 v7, 7, v4
    v_add_u32 v6, v6, v7
    s_lshl_b32 s69, s57, 6
    v_xor_b32 v16, s69, v6
    v_add_u32 v17, 65536, v16
    v_add_u32 v18, 131072, v16
    s_add_u32 s24, s14, 0x6000000
    s_addc_u32 s25, s15, 0
    s_mov_b32 s26, 0x380000
    s_mov_b32 s27, 0x00020000
    s_add_u32 s28, s14, 0x3800000
    s_addc_u32 s29, s15, 0
    s_mov_b32 s30, 0x380000
    s_mov_b32 s31, 0x00020000
    s_lshl_b32 s76, s65, 2
    s_lshl_b32 s69, s57, 1
    s_add_u32 s76, s76, s69
    s_lshl_b32 s77, s76, 6
    s_mul_i32 s76, s76, 57344
    s_lshl_b32 s69, s70, 11
    s_add_u32 s76, s76, s69
    s_add_u32 s78, s76, 57344
    v_lshlrev_b32 v7, 1, v4
    s_waitcnt vmcnt(0) lgkmcnt(0)
    s_barrier
    s_cmp_eq_u32 s56, 0
    s_cbranch_scc0 M_sig_324
    s_add_u32 s52, s14, 0x6400000
    s_addc_u32 s53, s15, 0
    s_mov_b32 s54, 0x4000
    s_mov_b32 s55, 0x00020000
    v_mov_b32 v9, s3
    v_mov_b32 v10, 0
    s_mov_b64 exec, 1
    buffer_store_dword v9, v10, s[52:55], s79 offen sc1
    s_mov_b64 exec, -1
M_sig_324:
    s_mov_b32 s32, s12
    s_mov_b32 s33, s13
    s_mov_b32 s34, 0x1000
    s_mov_b32 s35, 0x00020000
    ds_read_b128 v[64:67], v17 offset:32768
    ds_read_b128 v[68:71], v17 offset:34816
    ds_read_b128 v[72:75], v17 offset:36864
    ds_read_b128 v[76:79], v17 offset:38912
    ds_read_b128 v[80:83], v17 offset:40960
    ds_read_b128 v[84:87], v17 offset:43008
    s_waitcnt lgkmcnt(5)
    v_mfma_f32_16x16x32_bf16 v[160:163], v[224:227], v[64:67], 0
    ds_read_b128 v[88:91], v17 offset:45056
    v_mfma_f32_16x16x32_bf16 v[164:167], v[228:231], v[64:67], 0
    s_add_u32 m0, s67, 0
    s_add_u32 s63, s73, 512
    buffer_load_dwordx4 v3, s[16:19], s63 offen lds
    s_waitcnt lgkmcnt(5)
    v_mfma_f32_16x16x32_bf16 v[168:171], v[224:227], v[68:71], 0
    ds_read_b128 v[92:95], v17 offset:47104
    v_mfma_f32_16x16x32_bf16 v[172:175], v[228:231], v[68:71], 0
    s_add_u32 m0, s67, 8192
    s_add_u32 s63, s73, 262656
    buffer_load_dwordx4 v3, s[16:19], s63 offen lds
    s_waitcnt lgkmcnt(5)
    v_mfma_f32_16x16x32_bf16 v[176:179], v[224:227], v[72:75], 0
    ds_read_b128 v[64:67], v17 offset:49152
    v_mfma_f32_16x16x32_bf16 v[180:183], v[228:231], v[72:75], 0
    s_setprio 0
    s_add_u32 m0, s67, 16384
    s_add_u32 s63, s73, 640
    buffer_load_dwordx4 v3, s[16:19], s63 offen lds
    s_waitcnt lgkmcnt(5)
    v_mfma_f32_16x16x32_bf16 v[184:187], v[224:227], v[76:79], 0
    ds_read_b128 v[68:71], v17 offset:51200
    v_mfma_f32_16x16x32_bf16 v[188:191], v[228:231], v[76:79], 0
    s_add_u32 m0, s67, 24576
    s_add_u32 s63, s73, 262784
    buffer_load_dwordx4 v3, s[16:19], s63 offen lds
    s_waitcnt lgkmcnt(5)
    v_mfma_f32_16x16x32_bf16 v[192:195], v[224:227], v[80:83], 0
    ds_read_b128 v[72:75], v17 offset:53248
    v_mfma_f32_16x16x32_bf16 v[196:199], v[228:231], v[80:83], 0
    s_add_u32 s63, s74, 16384
    buffer_load_dwordx4 v[128:131], v12, s[36:39], s63 offen sc1
    buffer_load_dwordx4 v[132:135], v12, s[36:39], s63 offen offset:256 sc1
    s_waitcnt lgkmcnt(5)
    v_mfma_f32_16x16x32_bf16 v[200:203], v[224:227], v[84:87], 0
    ds_read_b128 v[76:79], v17 offset:55296
    v_mfma_f32_16x16x32_bf16 v[204:207], v[228:231], v[84:87], 0
    s_add_u32 s63, s74, 20480
    buffer_load_dwordx4 v[136:139], v12, s[36:39], s63 offen sc1
    buffer_load_dwordx4 v[140:143], v12, s[36:39], s63 offen offset:256 sc1
    s_waitcnt lgkmcnt(5)
    v_mfma_f32_16x16x32_bf16 v[208:211], v[224:227], v[88:91], 0
    ds_read_b128 v[80:83], v17 offset:57344
    v_mfma_f32_16x16x32_bf16 v[212:215], v[228:231], v[88:91], 0
    s_add_u32 m0, s67, 32768
    s_add_u32 s63, s73, 768
    buffer_load_dwordx4 v3, s[16:19], s63 offen lds
    s_waitcnt lgkmcnt(5)
    v_mfma_f32_16x16x32_bf16 v[216:219], v[224:227], v[92:95], 0
    ds_read_b128 v[84:87], v17 offset:59392
    v_mfma_f32_16x16x32_bf16 v[220:223], v[228:231], v[92:95], 0
    s_add_u32 m0, s67, 40960
    s_add_u32 s63, s73, 262912
    buffer_load_dwordx4 v3, s[16:19], s63 offen lds
    s_waitcnt lgkmcnt(5)
    v_mfma_f32_16x16x32_bf16 v[160:163], v[232:235], v[64:67], v[160:163]
    ds_read_b128 v[88:91], v17 offset:61440
    v_mfma_f32_16x16x32_bf16 v[164:167], v[236:239], v[64:67], v[164:167]
    s_add_u32 m0, s67, 49152
    s_add_u32 s63, s73, 896
    buffer_load_dwordx4 v3, s[16:19], s63 offen lds
    s_waitcnt lgkmcnt(5)
    v_mfma_f32_16x16x32_bf16 v[168:171], v[232:235], v[68:71], v[168:171]
    ds_read_b128 v[92:95], v17 offset:63488
    v_mfma_f32_16x16x32_bf16 v[172:175], v[236:239], v[68:71], v[172:175]
    s_add_u32 m0, s67, 57344
    s_add_u32 s63, s73, 263040
    buffer_load_dwordx4 v3, s[16:19], s63 offen lds
    s_waitcnt lgkmcnt(5)
    v_mfma_f32_16x16x32_bf16 v[176:179], v[232:235], v[72:75], v[176:179]
    s_waitcnt lgkmcnt(0)
    s_barrier
    s_setprio 1
    ds_read_b128 v[64:67], v18 offset:0
    v_mfma_f32_16x16x32_bf16 v[180:183], v[236:239], v[72:75], v[180:183]
    s_add_u32 s63, s74, 24576
    buffer_load_dwordx4 v[144:147], v12, s[36:39], s63 offen sc1
    buffer_load_dwordx4 v[148:151], v12, s[36:39], s63 offen offset:256 sc1
    v_mfma_f32_16x16x32_bf16 v[184:187], v[232:235], v[76:79], v[184:187]
    ds_read_b128 v[68:71], v18 offset:2048
    v_mfma_f32_16x16x32_bf16 v[188:191], v[236:239], v[76:79], v[188:191]
    s_add_u32 s63, s74, 28672
    buffer_load_dwordx4 v[152:155], v12, s[36:39], s63 offen sc1
    buffer_load_dwordx4 v[156:159], v12, s[36:39], s63 offen offset:256 sc1
    v_mfma_f32_16x16x32_bf16 v[192:195], v[232:235], v[80:83], v[192:195]
    ds_read_b128 v[72:75], v18 offset:4096
    v_mfma_f32_16x16x32_bf16 v[196:199], v[236:239], v[80:83], v[196:199]
    s_add_u32 m0, s67, 65536
    s_add_u32 s63, s73, 1024
    buffer_load_dwordx4 v3, s[16:19], s63 offen lds
    v_mfma_f32_16x16x32_bf16 v[200:203], v[232:235], v[84:87], v[200:203]
    ds_read_b128 v[76:79], v18 offset:6144
    v_mfma_f32_16x16x32_bf16 v[204:207], v[236:239], v[84:87], v[204:207]
    s_add_u32 m0, s67, 73728
    s_add_u32 s63, s73, 263168
    buffer_load_dwordx4 v3, s[16:19], s63 offen lds
    v_mfma_f32_16x16x32_bf16 v[208:211], v[232:235], v[88:91], v[208:211]
    ds_read_b128 v[80:83], v18 offset:8192
    v_mfma_f32_16x16x32_bf16 v[212:215], v[236:239], v[88:91], v[212:215]
    s_add_u32 m0, s67, 81920
    s_add_u32 s63, s73, 1152
    buffer_load_dwordx4 v3, s[16:19], s63 offen lds
    v_mfma_f32_16x16x32_bf16 v[216:219], v[232:235], v[92:95], v[216:219]
    ds_read_b128 v[84:87], v18 offset:10240
    v_mfma_f32_16x16x32_bf16 v[220:223], v[236:239], v[92:95], v[220:223]
    s_add_u32 m0, s67, 90112
    s_add_u32 s63, s73, 263296
    buffer_load_dwordx4 v3, s[16:19], s63 offen lds
    s_waitcnt lgkmcnt(5)
    v_mfma_f32_16x16x32_bf16 v[160:163], v[240:243], v[64:67], v[160:163]
    ds_read_b128 v[88:91], v18 offset:12288
    v_mfma_f32_16x16x32_bf16 v[164:167], v[244:247], v[64:67], v[164:167]
    s_add_u32 s63, s74, 32768
    buffer_load_dwordx4 v[48:51], v12, s[36:39], s63 offen sc1
    buffer_load_dwordx4 v[52:55], v12, s[36:39], s63 offen offset:256 sc1
    s_waitcnt lgkmcnt(5)
    v_mfma_f32_16x16x32_bf16 v[168:171], v[240:243], v[68:71], v[168:171]
    ds_read_b128 v[92:95], v18 offset:14336
    v_mfma_f32_16x16x32_bf16 v[172:175], v[244:247], v[68:71], v[172:175]
    s_add_u32 s63, s74, 36864
    buffer_load_dwordx4 v[56:59], v12, s[36:39], s63 offen sc1
    buffer_load_dwordx4 v[60:63], v12, s[36:39], s63 offen offset:256 sc1
    s_waitcnt lgkmcnt(5)
    v_mfma_f32_16x16x32_bf16 v[176:179], v[240:243], v[72:75], v[176:179]
    ds_read_b128 v[64:67], v18 offset:16384
    v_mfma_f32_16x16x32_bf16 v[180:183], v[244:247], v[72:75], v[180:183]
    s_setprio 0
    s_waitcnt lgkmcnt(5)
    v_mfma_f32_16x16x32_bf16 v[184:187], v[240:243], v[76:79], v[184:187]
    ds_read_b128 v[68:71], v18 offset:18432
    v_mfma_f32_16x16x32_bf16 v[188:191], v[244:247], v[76:79], v[188:191]
    s_add_u32 m0, s67, 98304
    s_add_u32 s63, s73, 1280
    buffer_load_dwordx4 v3, s[16:19], s63 offen lds
    s_waitcnt lgkmcnt(5)
    v_mfma_f32_16x16x32_bf16 v[192:195], v[240:243], v[80:83], v[192:195]
    ds_read_b128 v[72:75], v18 offset:20480
    v_mfma_f32_16x16x32_bf16 v[196:199], v[244:247], v[80:83], v[196:199]
    s_waitcnt lgkmcnt(5)
    v_mfma_f32_16x16x32_bf16 v[200:203], v[240:243], v[84:87], v[200:203]
    ds_read_b128 v[76:79], v18 offset:22528
    v_mfma_f32_16x16x32_bf16 v[204:207], v[244:247], v[84:87], v[204:207]
    s_add_u32 m0, s67, 106496
    s_add_u32 s63, s73, 263424
    buffer_load_dwordx4 v3, s[16:19], s63 offen lds
    s_waitcnt lgkmcnt(5)
    v_mfma_f32_16x16x32_bf16 v[208:211], v[240:243], v[88:91], v[208:211]
    ds_read_b128 v[80:83], v18 offset:24576
    v_mfma_f32_16x16x32_bf16 v[212:215], v[244:247], v[88:91], v[212:215]
    s_waitcnt lgkmcnt(5)
    v_mfma_f32_16x16x32_bf16 v[216:219], v[240:243], v[92:95], v[216:219]
    ds_read_b128 v[84:87], v18 offset:26624
    v_mfma_f32_16x16x32_bf16 v[220:223], v[244:247], v[92:95], v[220:223]
    s_add_u32 m0, s67, 114688
    s_add_u32 s63, s73, 1408
    buffer_load_dwordx4 v3, s[16:19], s63 offen lds
    s_waitcnt lgkmcnt(5)
    v_mfma_f32_16x16x32_bf16 v[160:163], v[248:251], v[64:67], v[160:163]
    ds_read_b128 v[88:91], v18 offset:28672
    v_mfma_f32_16x16x32_bf16 v[164:167], v[252:255], v[64:67], v[164:167]
    s_waitcnt lgkmcnt(5)
    v_mfma_f32_16x16x32_bf16 v[168:171], v[248:251], v[68:71], v[168:171]
    ds_read_b128 v[92:95], v18 offset:30720
    v_mfma_f32_16x16x32_bf16 v[172:175], v[252:255], v[68:71], v[172:175]
    s_add_u32 m0, s67, 122880
    s_add_u32 s63, s73, 263552
    buffer_load_dwordx4 v3, s[16:19], s63 offen lds
    s_waitcnt lgkmcnt(5)
    v_mfma_f32_16x16x32_bf16 v[176:179], v[248:251], v[72:75], v[176:179]
    s_waitcnt lgkmcnt(0)
    s_waitcnt vmcnt(20)
    s_barrier
    s_setprio 1
    ds_read_b128 v[64:67], v16 offset:0
    v_mfma_f32_16x16x32_bf16 v[180:183], v[252:255], v[72:75], v[180:183]
    s_add_u32 s63, s74, 40960
    buffer_load_dwordx4 v[224:227], v12, s[36:39], s63 offen sc1
    buffer_load_dwordx4 v[228:231], v12, s[36:39], s63 offen offset:256 sc1
    v_mfma_f32_16x16x32_bf16 v[184:187], v[248:251], v[76:79], v[184:187]
    ds_read_b128 v[68:71], v16 offset:2048
    v_mfma_f32_16x16x32_bf16 v[188:191], v[252:255], v[76:79], v[188:191]
    s_add_u32 s63, s74, 45056
    buffer_load_dwordx4 v[232:235], v12, s[36:39], s63 offen sc1
    buffer_load_dwordx4 v[236:239], v12, s[36:39], s63 offen offset:256 sc1
    v_mfma_f32_16x16x32_bf16 v[192:195], v[248:251], v[80:83], v[192:195]
    ds_read_b128 v[72:75], v16 offset:4096
    v_mfma_f32_16x16x32_bf16 v[196:199], v[252:255], v[80:83], v[196:199]
    v_mfma_f32_16x16x32_bf16 v[200:203], v[248:251], v[84:87], v[200:203]
    ds_read_b128 v[76:79], v16 offset:6144
    v_mfma_f32_16x16x32_bf16 v[204:207], v[252:255], v[84:87], v[204:207]
    s_add_u32 m0, s67, 131072
    s_add_u32 s63, s73, 1536
    buffer_load_dwordx4 v3, s[16:19], s63 offen lds
    v_mfma_f32_16x16x32_bf16 v[208:211], v[248:251], v[88:91], v[208:211]
    ds_read_b128 v[80:83], v16 offset:8192
    v_mfma_f32_16x16x32_bf16 v[212:215], v[252:255], v[88:91], v[212:215]
    v_mfma_f32_16x16x32_bf16 v[216:219], v[248:251], v[92:95], v[216:219]
    ds_read_b128 v[84:87], v16 offset:10240
    v_mfma_f32_16x16x32_bf16 v[220:223], v[252:255], v[92:95], v[220:223]
    s_add_u32 m0, s67, 139264
    s_add_u32 s63, s73, 263680
    buffer_load_dwordx4 v3, s[16:19], s63 offen lds
    s_waitcnt lgkmcnt(5)
    v_mfma_f32_16x16x32_bf16 v[160:163], v[128:131], v[64:67], v[160:163]
    ds_read_b128 v[88:91], v16 offset:12288
    v_mfma_f32_16x16x32_bf16 v[164:167], v[132:135], v[64:67], v[164:167]
    s_waitcnt lgkmcnt(5)
    v_mfma_f32_16x16x32_bf16 v[168:171], v[128:131], v[68:71], v[168:171]
    ds_read_b128 v[92:95], v16 offset:14336
    v_mfma_f32_16x16x32_bf16 v[172:175], v[132:135], v[68:71], v[172:175]
    s_add_u32 m0, s67, 147456
    s_add_u32 s63, s73, 1664
    buffer_load_dwordx4 v3, s[16:19], s63 offen lds
    s_waitcnt lgkmcnt(5)
    v_mfma_f32_16x16x32_bf16 v[176:179], v[128:131], v[72:75], v[176:179]
    ds_read_b128 v[64:67], v16 offset:16384
    v_mfma_f32_16x16x32_bf16 v[180:183], v[132:135], v[72:75], v[180:183]
    s_setprio 0
    s_waitcnt lgkmcnt(5)
    v_mfma_f32_16x16x32_bf16 v[184:187], v[128:131], v[76:79], v[184:187]
    ds_read_b128 v[68:71], v16 offset:18432
    v_mfma_f32_16x16x32_bf16 v[188:191], v[132:135], v[76:79], v[188:191]
    s_add_u32 m0, s67, 155648
    s_add_u32 s63, s73, 263808
    buffer_load_dwordx4 v3, s[16:19], s63 offen lds
    s_waitcnt lgkmcnt(5)
    v_mfma_f32_16x16x32_bf16 v[192:195], v[128:131], v[80:83], v[192:195]
    ds_read_b128 v[72:75], v16 offset:20480
    v_mfma_f32_16x16x32_bf16 v[196:199], v[132:135], v[80:83], v[196:199]
    s_waitcnt lgkmcnt(5)
    v_mfma_f32_16x16x32_bf16 v[200:203], v[128:131], v[84:87], v[200:203]
    ds_read_b128 v[76:79], v16 offset:22528
    v_mfma_f32_16x16x32_bf16 v[204:207], v[132:135], v[84:87], v[204:207]
    s_add_u32 s63, s74, 49152
    buffer_load_dwordx4 v[240:243], v12, s[36:39], s63 offen sc1
    buffer_load_dwordx4 v[244:247], v12, s[36:39], s63 offen offset:256 sc1
    s_waitcnt lgkmcnt(5)
    v_mfma_f32_16x16x32_bf16 v[208:211], v[128:131], v[88:91], v[208:211]
    ds_read_b128 v[80:83], v16 offset:24576
    v_mfma_f32_16x16x32_bf16 v[212:215], v[132:135], v[88:91], v[212:215]
    s_waitcnt lgkmcnt(5)
    v_mfma_f32_16x16x32_bf16 v[216:219], v[128:131], v[92:95], v[216:219]
    ds_read_b128 v[84:87], v16 offset:26624
    v_mfma_f32_16x16x32_bf16 v[220:223], v[132:135], v[92:95], v[220:223]
    s_add_u32 s63, s74, 53248
    buffer_load_dwordx4 v[248:251], v12, s[36:39], s63 offen sc1
    buffer_load_dwordx4 v[252:255], v12, s[36:39], s63 offen offset:256 sc1
    s_waitcnt lgkmcnt(5)
    v_mfma_f32_16x16x32_bf16 v[160:163], v[136:139], v[64:67], v[160:163]
    ds_read_b128 v[88:91], v16 offset:28672
    v_mfma_f32_16x16x32_bf16 v[164:167], v[140:143], v[64:67], v[164:167]
    s_waitcnt lgkmcnt(5)
    v_mfma_f32_16x16x32_bf16 v[168:171], v[136:139], v[68:71], v[168:171]
    ds_read_b128 v[92:95], v16 offset:30720
    v_mfma_f32_16x16x32_bf16 v[172:175], v[140:143], v[68:71], v[172:175]
    s_waitcnt lgkmcnt(5)
    v_mfma_f32_16x16x32_bf16 v[176:179], v[136:139], v[72:75], v[176:179]
    s_waitcnt lgkmcnt(0)
    s_waitcnt vmcnt(24)
    s_barrier
    s_setprio 1
    ds_read_b128 v[64:67], v16 offset:32768
    v_mfma_f32_16x16x32_bf16 v[180:183], v[140:143], v[72:75], v[180:183]
    v_mfma_f32_16x16x32_bf16 v[184:187], v[136:139], v[76:79], v[184:187]
    ds_read_b128 v[68:71], v16 offset:34816
    v_mfma_f32_16x16x32_bf16 v[188:191], v[140:143], v[76:79], v[188:191]
    s_add_u32 m0, s67, 0
    s_add_u32 s63, s73, 1792
    buffer_load_dwordx4 v3, s[16:19], s63 offen lds
    v_mfma_f32_16x16x32_bf16 v[192:195], v[136:139], v[80:83], v[192:195]
    ds_read_b128 v[72:75], v16 offset:36864
    v_mfma_f32_16x16x32_bf16 v[196:199], v[140:143], v[80:83], v[196:199]
    v_mfma_f32_16x16x32_bf16 v[200:203], v[136:139], v[84:87], v[200:203]
    ds_read_b128 v[76:79], v16 offset:38912
    v_mfma_f32_16x16x32_bf16 v[204:207], v[140:143], v[84:87], v[204:207]
    s_add_u32 m0, s67, 8192
    s_add_u32 s63, s73, 263936
    buffer_load_dwordx4 v3, s[16:19], s63 offen lds
    v_mfma_f32_16x16x32_bf16 v[208:211], v[136:139], v[88:91], v[208:211]
    ds_read_b128 v[80:83], v16 offset:40960
    v_mfma_f32_16x16x32_bf16 v[212:215], v[140:143], v[88:91], v[212:215]
    v_mfma_f32_16x16x32_bf16 v[216:219], v[136:139], v[92:95], v[216:219]
    ds_read_b128 v[84:87], v16 offset:43008
    v_mfma_f32_16x16x32_bf16 v[220:223], v[140:143], v[92:95], v[220:223]
    s_add_u32 m0, s67, 16384
    s_add_u32 s63, s73, 1920
    buffer_load_dwordx4 v3, s[16:19], s63 offen lds
    s_waitcnt lgkmcnt(5)
    v_mfma_f32_16x16x32_bf16 v[160:163], v[144:147], v[64:67], v[160:163]
    ds_read_b128 v[88:91], v16 offset:45056
    v_mfma_f32_16x16x32_bf16 v[164:167], v[148:151], v[64:67], v[164:167]
    s_waitcnt lgkmcnt(5)
    v_mfma_f32_16x16x32_bf16 v[168:171], v[144:147], v[68:71], v[168:171]
    ds_read_b128 v[92:95], v16 offset:47104
    v_mfma_f32_16x16x32_bf16 v[172:175], v[148:151], v[68:71], v[172:175]
    s_add_u32 m0, s67, 24576
    s_add_u32 s63, s73, 264064
    buffer_load_dwordx4 v3, s[16:19], s63 offen lds
    s_waitcnt lgkmcnt(5)
    v_mfma_f32_16x16x32_bf16 v[176:179], v[144:147], v[72:75], v[176:179]
    ds_read_b128 v[64:67], v16 offset:49152
    v_mfma_f32_16x16x32_bf16 v[180:183], v[148:151], v[72:75], v[180:183]
    s_setprio 0
    s_waitcnt lgkmcnt(5)
    v_mfma_f32_16x16x32_bf16 v[184:187], v[144:147], v[76:79], v[184:187]
    ds_read_b128 v[68:71], v16 offset:51200
    v_mfma_f32_16x16x32_bf16 v[188:191], v[148:151], v[76:79], v[188:191]
    s_add_u32 s63, s74, 57344
    buffer_load_dwordx4 v[128:131], v12, s[36:39], s63 offen sc1
    buffer_load_dwordx4 v[132:135], v12, s[36:39], s63 offen offset:256 sc1
    s_waitcnt lgkmcnt(5)
    v_mfma_f32_16x16x32_bf16 v[192:195], v[144:147], v[80:83], v[192:195]
    ds_read_b128 v[72:75], v16 offset:53248
    v_mfma_f32_16x16x32_bf16 v[196:199], v[148:151], v[80:83], v[196:199]
    s_waitcnt lgkmcnt(5)
    v_mfma_f32_16x16x32_bf16 v[200:203], v[144:147], v[84:87], v[200:203]
    ds_read_b128 v[76:79], v16 offset:55296
    v_mfma_f32_16x16x32_bf16 v[204:207], v[148:151], v[84:87], v[204:207]
    s_add_u32 s63, s74, 61440
    buffer_load_dwordx4 v[136:139], v12, s[36:39], s63 offen sc1
    buffer_load_dwordx4 v[140:143], v12, s[36:39], s63 offen offset:256 sc1
    s_waitcnt lgkmcnt(5)
    v_mfma_f32_16x16x32_bf16 v[208:211], v[144:147], v[88:91], v[208:211]
    ds_read_b128 v[80:83], v16 offset:57344
    v_mfma_f32_16x16x32_bf16 v[212:215], v[148:151], v[88:91], v[212:215]
    s_waitcnt lgkmcnt(5)
    v_mfma_f32_16x16x32_bf16 v[216:219], v[144:147], v[92:95], v[216:219]
    ds_read_b128 v[84:87], v16 offset:59392
    v_mfma_f32_16x16x32_bf16 v[220:223], v[148:151], v[92:95], v[220:223]
    s_waitcnt lgkmcnt(5)
    v_mfma_f32_16x16x32_bf16 v[160:163], v[152:155], v[64:67], v[160:163]
    ds_read_b128 v[88:91], v16 offset:61440
    v_mfma_f32_16x16x32_bf16 v[164:167], v[156:159], v[64:67], v[164:167]
    s_waitcnt lgkmcnt(5)
    v_mfma_f32_16x16x32_bf16 v[168:171], v[152:155], v[68:71], v[168:171]
    ds_read_b128 v[92:95], v16 offset:63488
    v_mfma_f32_16x16x32_bf16 v[172:175], v[156:159], v[68:71], v[172:175]
    s_waitcnt lgkmcnt(5)
    v_mfma_f32_16x16x32_bf16 v[176:179], v[152:155], v[72:75], v[176:179]
    s_waitcnt lgkmcnt(0)
    s_waitcnt vmcnt(24)
    s_barrier
    s_setprio 1
    ds_read_b128 v[64:67], v17 offset:0
    v_mfma_f32_16x16x32_bf16 v[180:183], v[156:159], v[72:75], v[180:183]
    v_mfma_f32_16x16x32_bf16 v[184:187], v[152:155], v[76:79], v[184:187]
    ds_read_b128 v[68:71], v17 offset:2048
    v_mfma_f32_16x16x32_bf16 v[188:191], v[156:159], v[76:79], v[188:191]
    s_add_u32 m0, s67, 32768
    s_add_u32 s63, s73, 2048
    buffer_load_dwordx4 v3, s[16:19], s63 offen lds
    v_mfma_f32_16x16x32_bf16 v[192:195], v[152:155], v[80:83], v[192:195]
    ds_read_b128 v[72:75], v17 offset:4096
    v_mfma_f32_16x16x32_bf16 v[196:199], v[156:159], v[80:83], v[196:199]
    v_mfma_f32_16x16x32_bf16 v[200:203], v[152:155], v[84:87], v[200:203]
    ds_read_b128 v[76:79], v17 offset:6144
    v_mfma_f32_16x16x32_bf16 v[204:207], v[156:159], v[84:87], v[204:207]
    s_add_u32 m0, s67, 40960
    s_add_u32 s63, s73, 264192
    buffer_load_dwordx4 v3, s[16:19], s63 offen lds
    v_mfma_f32_16x16x32_bf16 v[208:211], v[152:155], v[88:91], v[208:211]
    ds_read_b128 v[80:83], v17 offset:8192
    v_mfma_f32_16x16x32_bf16 v[212:215], v[156:159], v[88:91], v[212:215]
    v_mfma_f32_16x16x32_bf16 v[216:219], v[152:155], v[92:95], v[216:219]
    ds_read_b128 v[84:87], v17 offset:10240
    v_mfma_f32_16x16x32_bf16 v[220:223], v[156:159], v[92:95], v[220:223]
    s_add_u32 m0, s67, 49152
    s_add_u32 s63, s73, 2176
    buffer_load_dwordx4 v3, s[16:19], s63 offen lds
    s_waitcnt lgkmcnt(5)
    v_mfma_f32_16x16x32_bf16 v[160:163], v[48:51], v[64:67], v[160:163]
    ds_read_b128 v[88:91], v17 offset:12288
    v_mfma_f32_16x16x32_bf16 v[164:167], v[52:55], v[64:67], v[164:167]
    s_waitcnt lgkmcnt(5)
    v_mfma_f32_16x16x32_bf16 v[168:171], v[48:51], v[68:71], v[168:171]
    ds_read_b128 v[92:95], v17 offset:14336
    v_mfma_f32_16x16x32_bf16 v[172:175], v[52:55], v[68:71], v[172:175]
    s_add_u32 m0, s67, 57344
    s_add_u32 s63, s73, 264320
    buffer_load_dwordx4 v3, s[16:19], s63 offen lds
    s_waitcnt lgkmcnt(5)
    v_mfma_f32_16x16x32_bf16 v[176:179], v[48:51], v[72:75], v[176:179]
    ds_read_b128 v[64:67], v17 offset:16384
    v_mfma_f32_16x16x32_bf16 v[180:183], v[52:55], v[72:75], v[180:183]
    s_setprio 0
    s_waitcnt lgkmcnt(5)
    v_mfma_f32_16x16x32_bf16 v[184:187], v[48:51], v[76:79], v[184:187]
    ds_read_b128 v[68:71], v17 offset:18432
    v_mfma_f32_16x16x32_bf16 v[188:191], v[52:55], v[76:79], v[188:191]
    s_add_u32 s63, s74, 65536
    buffer_load_dwordx4 v[144:147], v12, s[36:39], s63 offen sc1
    buffer_load_dwordx4 v[148:151], v12, s[36:39], s63 offen offset:256 sc1
    s_waitcnt lgkmcnt(5)
    v_mfma_f32_16x16x32_bf16 v[192:195], v[48:51], v[80:83], v[192:195]
    ds_read_b128 v[72:75], v17 offset:20480
    v_mfma_f32_16x16x32_bf16 v[196:199], v[52:55], v[80:83], v[196:199]
    s_waitcnt lgkmcnt(5)
    v_mfma_f32_16x16x32_bf16 v[200:203], v[48:51], v[84:87], v[200:203]
    ds_read_b128 v[76:79], v17 offset:22528
    v_mfma_f32_16x16x32_bf16 v[204:207], v[52:55], v[84:87], v[204:207]
    s_add_u32 s63, s74, 69632
    buffer_load_dwordx4 v[152:155], v12, s[36:39], s63 offen sc1
    buffer_load_dwordx4 v[156:159], v12, s[36:39], s63 offen offset:256 sc1
    s_waitcnt lgkmcnt(5)
    v_mfma_f32_16x16x32_bf16 v[208:211], v[48:51], v[88:91], v[208:211]
    ds_read_b128 v[80:83], v17 offset:24576
    v_mfma_f32_16x16x32_bf16 v[212:215], v[52:55], v[88:91], v[212:215]
    s_waitcnt lgkmcnt(5)
    v_mfma_f32_16x16x32_bf16 v[216:219], v[48:51], v[92:95], v[216:219]
    ds_read_b128 v[84:87], v17 offset:26624
    v_mfma_f32_16x16x32_bf16 v[220:223], v[52:55], v[92:95], v[220:223]
    s_waitcnt lgkmcnt(5)
    v_mfma_f32_16x16x32_bf16 v[160:163], v[56:59], v[64:67], v[160:163]
    ds_read_b128 v[88:91], v17 offset:28672
    v_mfma_f32_16x16x32_bf16 v[164:167], v[60:63], v[64:67], v[164:167]
    s_waitcnt lgkmcnt(5)
    v_mfma_f32_16x16x32_bf16 v[168:171], v[56:59], v[68:71], v[168:171]
    ds_read_b128 v[92:95], v17 offset:30720
    v_mfma_f32_16x16x32_bf16 v[172:175], v[60:63], v[68:71], v[172:175]
    s_waitcnt lgkmcnt(5)
    v_mfma_f32_16x16x32_bf16 v[176:179], v[56:59], v[72:75], v[176:179]
    s_waitcnt lgkmcnt(0)
    s_waitcnt vmcnt(24)
    s_barrier
    s_setprio 1
    ds_read_b128 v[64:67], v17 offset:32768
    v_mfma_f32_16x16x32_bf16 v[180:183], v[60:63], v[72:75], v[180:183]
    v_mfma_f32_16x16x32_bf16 v[184:187], v[56:59], v[76:79], v[184:187]
    ds_read_b128 v[68:71], v17 offset:34816
    v_mfma_f32_16x16x32_bf16 v[188:191], v[60:63], v[76:79], v[188:191]
    s_add_u32 m0, s67, 65536
    s_add_u32 s63, s73, 2304
    buffer_load_dwordx4 v3, s[16:19], s63 offen lds
    v_mfma_f32_16x16x32_bf16 v[192:195], v[56:59], v[80:83], v[192:195]
    ds_read_b128 v[72:75], v17 offset:36864
    v_mfma_f32_16x16x32_bf16 v[196:199], v[60:63], v[80:83], v[196:199]
    v_mfma_f32_16x16x32_bf16 v[200:203], v[56:59], v[84:87], v[200:203]
    ds_read_b128 v[76:79], v17 offset:38912
    v_mfma_f32_16x16x32_bf16 v[204:207], v[60:63], v[84:87], v[204:207]
    s_add_u32 m0, s67, 73728
    s_add_u32 s63, s73, 264448
    buffer_load_dwordx4 v3, s[16:19], s63 offen lds
    v_mfma_f32_16x16x32_bf16 v[208:211], v[56:59], v[88:91], v[208:211]
    ds_read_b128 v[80:83], v17 offset:40960
    v_mfma_f32_16x16x32_bf16 v[212:215], v[60:63], v[88:91], v[212:215]
    v_mfma_f32_16x16x32_bf16 v[216:219], v[56:59], v[92:95], v[216:219]
    ds_read_b128 v[84:87], v17 offset:43008
    v_mfma_f32_16x16x32_bf16 v[220:223], v[60:63], v[92:95], v[220:223]
    s_add_u32 m0, s67, 81920
    s_add_u32 s63, s73, 2432
    buffer_load_dwordx4 v3, s[16:19], s63 offen lds
    s_waitcnt lgkmcnt(5)
    v_mfma_f32_16x16x32_bf16 v[160:163], v[224:227], v[64:67], v[160:163]
    ds_read_b128 v[88:91], v17 offset:45056
    v_mfma_f32_16x16x32_bf16 v[164:167], v[228:231], v[64:67], v[164:167]
    s_waitcnt lgkmcnt(5)
    v_mfma_f32_16x16x32_bf16 v[168:171], v[224:227], v[68:71], v[168:171]
    ds_read_b128 v[92:95], v17 offset:47104
    v_mfma_f32_16x16x32_bf16 v[172:175], v[228:231], v[68:71], v[172:175]
    s_add_u32 m0, s67, 90112
    s_add_u32 s63, s73, 264576
    buffer_load_dwordx4 v3, s[16:19], s63 offen lds
    s_waitcnt lgkmcnt(5)
    v_mfma_f32_16x16x32_bf16 v[176:179], v[224:227], v[72:75], v[176:179]
    ds_read_b128 v[64:67], v17 offset:49152
    v_mfma_f32_16x16x32_bf16 v[180:183], v[228:231], v[72:75], v[180:183]
    s_setprio 0
    s_waitcnt lgkmcnt(5)
    v_mfma_f32_16x16x32_bf16 v[184:187], v[224:227], v[76:79], v[184:187]
    ds_read_b128 v[68:71], v17 offset:51200
    v_mfma_f32_16x16x32_bf16 v[188:191], v[228:231], v[76:79], v[188:191]
    s_add_u32 s63, s74, 73728
    buffer_load_dwordx4 v[48:51], v12, s[36:39], s63 offen sc1
    buffer_load_dwordx4 v[52:55], v12, s[36:39], s63 offen offset:256 sc1
    s_waitcnt lgkmcnt(5)
    v_mfma_f32_16x16x32_bf16 v[192:195], v[224:227], v[80:83], v[192:195]
    ds_read_b128 v[72:75], v17 offset:53248
    v_mfma_f32_16x16x32_bf16 v[196:199], v[228:231], v[80:83], v[196:199]
    s_waitcnt lgkmcnt(5)
    v_mfma_f32_16x16x32_bf16 v[200:203], v[224:227], v[84:87], v[200:203]
    ds_read_b128 v[76:79], v17 offset:55296
    v_mfma_f32_16x16x32_bf16 v[204:207], v[228:231], v[84:87], v[204:207]
    s_add_u32 s63, s74, 77824
    buffer_load_dwordx4 v[56:59], v12, s[36:39], s63 offen sc1
    buffer_load_dwordx4 v[60:63], v12, s[36:39], s63 offen offset:256 sc1
    s_waitcnt lgkmcnt(5)
    v_mfma_f32_16x16x32_bf16 v[208:211], v[224:227], v[88:91], v[208:211]
    ds_read_b128 v[80:83], v17 offset:57344
    v_mfma_f32_16x16x32_bf16 v[212:215], v[228:231], v[88:91], v[212:215]
    s_waitcnt lgkmcnt(5)
    v_mfma_f32_16x16x32_bf16 v[216:219], v[224:227], v[92:95], v[216:219]
    ds_read_b128 v[84:87], v17 offset:59392
    v_mfma_f32_16x16x32_bf16 v[220:223], v[228:231], v[92:95], v[220:223]
    s_waitcnt lgkmcnt(5)
    v_mfma_f32_16x16x32_bf16 v[160:163], v[232:235], v[64:67], v[160:163]
    ds_read_b128 v[88:91], v17 offset:61440
    v_mfma_f32_16x16x32_bf16 v[164:167], v[236:239], v[64:67], v[164:167]
    s_waitcnt lgkmcnt(5)
    v_mfma_f32_16x16x32_bf16 v[168:171], v[232:235], v[68:71], v[168:171]
    ds_read_b128 v[92:95], v17 offset:63488
    v_mfma_f32_16x16x32_bf16 v[172:175], v[236:239], v[68:71], v[172:175]
    s_waitcnt lgkmcnt(5)
    v_mfma_f32_16x16x32_bf16 v[176:179], v[232:235], v[72:75], v[176:179]
    s_waitcnt lgkmcnt(0)
    s_waitcnt vmcnt(24)
    s_barrier
    s_setprio 1
    ds_read_b128 v[64:67], v18 offset:0
    v_mfma_f32_16x16x32_bf16 v[180:183], v[236:239], v[72:75], v[180:183]
    v_mfma_f32_16x16x32_bf16 v[184:187], v[232:235], v[76:79], v[184:187]
    ds_read_b128 v[68:71], v18 offset:2048
    v_mfma_f32_16x16x32_bf16 v[188:191], v[236:239], v[76:79], v[188:191]
    s_add_u32 m0, s67, 98304
    s_add_u32 s63, s73, 2560
    buffer_load_dwordx4 v3, s[16:19], s63 offen lds
    v_mfma_f32_16x16x32_bf16 v[192:195], v[232:235], v[80:83], v[192:195]
    ds_read_b128 v[72:75], v18 offset:4096
    v_mfma_f32_16x16x32_bf16 v[196:199], v[236:239], v[80:83], v[196:199]
    v_mfma_f32_16x16x32_bf16 v[200:203], v[232:235], v[84:87], v[200:203]
    ds_read_b128 v[76:79], v18 offset:6144
    v_mfma_f32_16x16x32_bf16 v[204:207], v[236:239], v[84:87], v[204:207]
    s_add_u32 m0, s67, 106496
    s_add_u32 s63, s73, 264704
    buffer_load_dwordx4 v3, s[16:19], s63 offen lds
    v_mfma_f32_16x16x32_bf16 v[208:211], v[232:235], v[88:91], v[208:211]
    ds_read_b128 v[80:83], v18 offset:8192
    v_mfma_f32_16x16x32_bf16 v[212:215], v[236:239], v[88:91], v[212:215]
    v_mfma_f32_16x16x32_bf16 v[216:219], v[232:235], v[92:95], v[216:219]
    ds_read_b128 v[84:87], v18 offset:10240
    v_mfma_f32_16x16x32_bf16 v[220:223], v[236:239], v[92:95], v[220:223]
    s_add_u32 m0, s67, 114688
    s_add_u32 s63, s73, 2688
    buffer_load_dwordx4 v3, s[16:19], s63 offen lds
    s_waitcnt lgkmcnt(5)
    v_mfma_f32_16x16x32_bf16 v[160:163], v[240:243], v[64:67], v[160:163]
    ds_read_b128 v[88:91], v18 offset:12288
    v_mfma_f32_16x16x32_bf16 v[164:167], v[244:247], v[64:67], v[164:167]
    s_waitcnt lgkmcnt(5)
    v_mfma_f32_16x16x32_bf16 v[168:171], v[240:243], v[68:71], v[168:171]
    ds_read_b128 v[92:95], v18 offset:14336
    v_mfma_f32_16x16x32_bf16 v[172:175], v[244:247], v[68:71], v[172:175]
    s_add_u32 m0, s67, 122880
    s_add_u32 s63, s73, 264832
    buffer_load_dwordx4 v3, s[16:19], s63 offen lds
    s_waitcnt lgkmcnt(5)
    v_mfma_f32_16x16x32_bf16 v[176:179], v[240:243], v[72:75], v[176:179]
    ds_read_b128 v[64:67], v18 offset:16384
    v_mfma_f32_16x16x32_bf16 v[180:183], v[244:247], v[72:75], v[180:183]
    s_setprio 0
    s_waitcnt lgkmcnt(5)
    v_mfma_f32_16x16x32_bf16 v[184:187], v[240:243], v[76:79], v[184:187]
    ds_read_b128 v[68:71], v18 offset:18432
    v_mfma_f32_16x16x32_bf16 v[188:191], v[244:247], v[76:79], v[188:191]
    s_add_u32 s63, s74, 81920
    buffer_load_dwordx4 v[224:227], v12, s[36:39], s63 offen sc1
    buffer_load_dwordx4 v[228:231], v12, s[36:39], s63 offen offset:256 sc1
    s_waitcnt lgkmcnt(5)
    v_mfma_f32_16x16x32_bf16 v[192:195], v[240:243], v[80:83], v[192:195]
    ds_read_b128 v[72:75], v18 offset:20480
    v_mfma_f32_16x16x32_bf16 v[196:199], v[244:247], v[80:83], v[196:199]
    s_waitcnt lgkmcnt(5)
    v_mfma_f32_16x16x32_bf16 v[200:203], v[240:243], v[84:87], v[200:203]
    ds_read_b128 v[76:79], v18 offset:22528
    v_mfma_f32_16x16x32_bf16 v[204:207], v[244:247], v[84:87], v[204:207]
    s_add_u32 s63, s74, 86016
    buffer_load_dwordx4 v[232:235], v12, s[36:39], s63 offen sc1
    buffer_load_dwordx4 v[236:239], v12, s[36:39], s63 offen offset:256 sc1
    s_waitcnt lgkmcnt(5)
    v_mfma_f32_16x16x32_bf16 v[208:211], v[240:243], v[88:91], v[208:211]
    ds_read_b128 v[80:83], v18 offset:24576
    v_mfma_f32_16x16x32_bf16 v[212:215], v[244:247], v[88:91], v[212:215]
    s_waitcnt lgkmcnt(5)
    v_mfma_f32_16x16x32_bf16 v[216:219], v[240:243], v[92:95], v[216:219]
    ds_read_b128 v[84:87], v18 offset:26624
    v_mfma_f32_16x16x32_bf16 v[220:223], v[244:247], v[92:95], v[220:223]
    s_waitcnt lgkmcnt(5)
    v_mfma_f32_16x16x32_bf16 v[160:163], v[248:251], v[64:67], v[160:163]
    ds_read_b128 v[88:91], v18 offset:28672
    v_mfma_f32_16x16x32_bf16 v[164:167], v[252:255], v[64:67], v[164:167]
    s_waitcnt lgkmcnt(5)
    v_mfma_f32_16x16x32_bf16 v[168:171], v[248:251], v[68:71], v[168:171]
    ds_read_b128 v[92:95], v18 offset:30720
    v_mfma_f32_16x16x32_bf16 v[172:175], v[252:255], v[68:71], v[172:175]
    s_waitcnt lgkmcnt(5)
    v_mfma_f32_16x16x32_bf16 v[176:179], v[248:251], v[72:75], v[176:179]
    s_waitcnt lgkmcnt(0)
    s_waitcnt vmcnt(24)
    s_barrier
    s_setprio 1
    ds_read_b128 v[64:67], v16 offset:0
    v_mfma_f32_16x16x32_bf16 v[180:183], v[252:255], v[72:75], v[180:183]
    v_mfma_f32_16x16x32_bf16 v[184:187], v[248:251], v[76:79], v[184:187]
    ds_read_b128 v[68:71], v16 offset:2048
    v_mfma_f32_16x16x32_bf16 v[188:191], v[252:255], v[76:79], v[188:191]
    s_add_u32 m0, s67, 131072
    s_add_u32 s63, s73, 2816
    buffer_load_dwordx4 v3, s[16:19], s63 offen lds
    v_mfma_f32_16x16x32_bf16 v[192:195], v[248:251], v[80:83], v[192:195]
    ds_read_b128 v[72:75], v16 offset:4096
    v_mfma_f32_16x16x32_bf16 v[196:199], v[252:255], v[80:83], v[196:199]
    v_mfma_f32_16x16x32_bf16 v[200:203], v[248:251], v[84:87], v[200:203]
    ds_read_b128 v[76:79], v16 offset:6144
    v_mfma_f32_16x16x32_bf16 v[204:207], v[252:255], v[84:87], v[204:207]
    s_add_u32 m0, s67, 139264
    s_add_u32 s63, s73, 264960
    buffer_load_dwordx4 v3, s[16:19], s63 offen lds
    v_mfma_f32_16x16x32_bf16 v[208:211], v[248:251], v[88:91], v[208:211]
    ds_read_b128 v[80:83], v16 offset:8192
    v_mfma_f32_16x16x32_bf16 v[212:215], v[252:255], v[88:91], v[212:215]
    v_mfma_f32_16x16x32_bf16 v[216:219], v[248:251], v[92:95], v[216:219]
    ds_read_b128 v[84:87], v16 offset:10240
    v_mfma_f32_16x16x32_bf16 v[220:223], v[252:255], v[92:95], v[220:223]
    s_add_u32 m0, s67, 147456
    s_add_u32 s63, s73, 2944
    buffer_load_dwordx4 v3, s[16:19], s63 offen lds
    s_waitcnt lgkmcnt(5)
    v_mfma_f32_16x16x32_bf16 v[160:163], v[128:131], v[64:67], v[160:163]
    ds_read_b128 v[88:91], v16 offset:12288
    v_mfma_f32_16x16x32_bf16 v[164:167], v[132:135], v[64:67], v[164:167]
    s_waitcnt lgkmcnt(5)
    v_mfma_f32_16x16x32_bf16 v[168:171], v[128:131], v[68:71], v[168:171]
    ds_read_b128 v[92:95], v16 offset:14336
    v_mfma_f32_16x16x32_bf16 v[172:175], v[132:135], v[68:71], v[172:175]
    s_add_u32 m0, s67, 155648
    s_add_u32 s63, s73, 265088
    buffer_load_dwordx4 v3, s[16:19], s63 offen lds
    s_waitcnt lgkmcnt(5)
    v_mfma_f32_16x16x32_bf16 v[176:179], v[128:131], v[72:75], v[176:179]
    ds_read_b128 v[64:67], v16 offset:16384
    v_mfma_f32_16x16x32_bf16 v[180:183], v[132:135], v[72:75], v[180:183]
    s_setprio 0
    s_waitcnt lgkmcnt(5)
    v_mfma_f32_16x16x32_bf16 v[184:187], v[128:131], v[76:79], v[184:187]
    ds_read_b128 v[68:71], v16 offset:18432
    v_mfma_f32_16x16x32_bf16 v[188:191], v[132:135], v[76:79], v[188:191]
    s_add_u32 s63, s74, 90112
    buffer_load_dwordx4 v[240:243], v12, s[36:39], s63 offen sc1
    buffer_load_dwordx4 v[244:247], v12, s[36:39], s63 offen offset:256 sc1
    s_waitcnt lgkmcnt(5)
    v_mfma_f32_16x16x32_bf16 v[192:195], v[128:131], v[80:83], v[192:195]
    ds_read_b128 v[72:75], v16 offset:20480
    v_mfma_f32_16x16x32_bf16 v[196:199], v[132:135], v[80:83], v[196:199]
    s_waitcnt lgkmcnt(5)
    v_mfma_f32_16x16x32_bf16 v[200:203], v[128:131], v[84:87], v[200:203]
    ds_read_b128 v[76:79], v16 offset:22528
    v_mfma_f32_16x16x32_bf16 v[204:207], v[132:135], v[84:87], v[204:207]
    s_add_u32 s63, s74, 94208
    buffer_load_dwordx4 v[248:251], v12, s[36:39], s63 offen sc1
    buffer_load_dwordx4 v[252:255], v12, s[36:39], s63 offen offset:256 sc1
    s_waitcnt lgkmcnt(5)
    v_mfma_f32_16x16x32_bf16 v[208:211], v[128:131], v[88:91], v[208:211]
    ds_read_b128 v[80:83], v16 offset:24576
    v_mfma_f32_16x16x32_bf16 v[212:215], v[132:135], v[88:91], v[212:215]
    s_waitcnt lgkmcnt(5)
    v_mfma_f32_16x16x32_bf16 v[216:219], v[128:131], v[92:95], v[216:219]
    ds_read_b128 v[84:87], v16 offset:26624
    v_mfma_f32_16x16x32_bf16 v[220:223], v[132:135], v[92:95], v[220:223]
    s_waitcnt lgkmcnt(5)
    v_mfma_f32_16x16x32_bf16 v[160:163], v[136:139], v[64:67], v[160:163]
    ds_read_b128 v[88:91], v16 offset:28672
    v_mfma_f32_16x16x32_bf16 v[164:167], v[140:143], v[64:67], v[164:167]
    s_waitcnt lgkmcnt(5)
    v_mfma_f32_16x16x32_bf16 v[168:171], v[136:139], v[68:71], v[168:171]
    ds_read_b128 v[92:95], v16 offset:30720
    v_mfma_f32_16x16x32_bf16 v[172:175], v[140:143], v[68:71], v[172:175]
    s_waitcnt lgkmcnt(5)
    v_mfma_f32_16x16x32_bf16 v[176:179], v[136:139], v[72:75], v[176:179]
    s_waitcnt lgkmcnt(0)
    s_waitcnt vmcnt(24)
    s_barrier
    s_setprio 1
    ds_read_b128 v[64:67], v16 offset:32768
    v_mfma_f32_16x16x32_bf16 v[180:183], v[140:143], v[72:75], v[180:183]
    v_mfma_f32_16x16x32_bf16 v[184:187], v[136:139], v[76:79], v[184:187]
    ds_read_b128 v[68:71], v16 offset:34816
    v_mfma_f32_16x16x32_bf16 v[188:191], v[140:143], v[76:79], v[188:191]
    s_add_u32 m0, s67, 0
    s_add_u32 s63, s73, 3072
    buffer_load_dwordx4 v3, s[16:19], s63 offen lds
    v_mfma_f32_16x16x32_bf16 v[192:195], v[136:139], v[80:83], v[192:195]
    ds_read_b128 v[72:75], v16 offset:36864
    v_mfma_f32_16x16x32_bf16 v[196:199], v[140:143], v[80:83], v[196:199]
    v_mfma_f32_16x16x32_bf16 v[200:203], v[136:139], v[84:87], v[200:203]
    ds_read_b128 v[76:79], v16 offset:38912
    v_mfma_f32_16x16x32_bf16 v[204:207], v[140:143], v[84:87], v[204:207]
    s_add_u32 m0, s67, 8192
    s_add_u32 s63, s73, 265216
    buffer_load_dwordx4 v3, s[16:19], s63 offen lds
    v_mfma_f32_16x16x32_bf16 v[208:211], v[136:139], v[88:91], v[208:211]
    ds_read_b128 v[80:83], v16 offset:40960
    v_mfma_f32_16x16x32_bf16 v[212:215], v[140:143], v[88:91], v[212:215]
    v_mfma_f32_16x16x32_bf16 v[216:219], v[136:139], v[92:95], v[216:219]
    ds_read_b128 v[84:87], v16 offset:43008
    v_mfma_f32_16x16x32_bf16 v[220:223], v[140:143], v[92:95], v[220:223]
    s_add_u32 m0, s67, 16384
    s_add_u32 s63, s73, 3200
    buffer_load_dwordx4 v3, s[16:19], s63 offen lds
    s_waitcnt lgkmcnt(5)
    v_mfma_f32_16x16x32_bf16 v[160:163], v[144:147], v[64:67], v[160:163]
    ds_read_b128 v[88:91], v16 offset:45056
    v_mfma_f32_16x16x32_bf16 v[164:167], v[148:151], v[64:67], v[164:167]
    s_waitcnt lgkmcnt(5)
    v_mfma_f32_16x16x32_bf16 v[168:171], v[144:147], v[68:71], v[168:171]
    ds_read_b128 v[92:95], v16 offset:47104
    v_mfma_f32_16x16x32_bf16 v[172:175], v[148:151], v[68:71], v[172:175]
    s_add_u32 m0, s67, 24576
    s_add_u32 s63, s73, 265344
    buffer_load_dwordx4 v3, s[16:19], s63 offen lds
    s_waitcnt lgkmcnt(5)
    v_mfma_f32_16x16x32_bf16 v[176:179], v[144:147], v[72:75], v[176:179]
    ds_read_b128 v[64:67], v16 offset:49152
    v_mfma_f32_16x16x32_bf16 v[180:183], v[148:151], v[72:75], v[180:183]
    s_setprio 0
    s_waitcnt lgkmcnt(5)
    v_mfma_f32_16x16x32_bf16 v[184:187], v[144:147], v[76:79], v[184:187]
    ds_read_b128 v[68:71], v16 offset:51200
    v_mfma_f32_16x16x32_bf16 v[188:191], v[148:151], v[76:79], v[188:191]
    s_add_u32 s63, s74, 98304
    buffer_load_dwordx4 v[128:131], v12, s[36:39], s63 offen sc1
    buffer_load_dwordx4 v[132:135], v12, s[36:39], s63 offen offset:256 sc1
    s_waitcnt lgkmcnt(5)
    v_mfma_f32_16x16x32_bf16 v[192:195], v[144:147], v[80:83], v[192:195]
    ds_read_b128 v[72:75], v16 offset:53248
    v_mfma_f32_16x16x32_bf16 v[196:199], v[148:151], v[80:83], v[196:199]
    s_waitcnt lgkmcnt(5)
    v_mfma_f32_16x16x32_bf16 v[200:203], v[144:147], v[84:87], v[200:203]
    ds_read_b128 v[76:79], v16 offset:55296
    v_mfma_f32_16x16x32_bf16 v[204:207], v[148:151], v[84:87], v[204:207]
    s_add_u32 s63, s74, 102400
    buffer_load_dwordx4 v[136:139], v12, s[36:39], s63 offen sc1
    buffer_load_dwordx4 v[140:143], v12, s[36:39], s63 offen offset:256 sc1
    s_waitcnt lgkmcnt(5)
    v_mfma_f32_16x16x32_bf16 v[208:211], v[144:147], v[88:91], v[208:211]
    ds_read_b128 v[80:83], v16 offset:57344
    v_mfma_f32_16x16x32_bf16 v[212:215], v[148:151], v[88:91], v[212:215]
    s_waitcnt lgkmcnt(5)
    v_mfma_f32_16x16x32_bf16 v[216:219], v[144:147], v[92:95], v[216:219]
    ds_read_b128 v[84:87], v16 offset:59392
    v_mfma_f32_16x16x32_bf16 v[220:223], v[148:151], v[92:95], v[220:223]
    s_waitcnt lgkmcnt(5)
    v_mfma_f32_16x16x32_bf16 v[160:163], v[152:155], v[64:67], v[160:163]
    ds_read_b128 v[88:91], v16 offset:61440
    v_mfma_f32_16x16x32_bf16 v[164:167], v[156:159], v[64:67], v[164:167]
    s_waitcnt lgkmcnt(5)
    v_mfma_f32_16x16x32_bf16 v[168:171], v[152:155], v[68:71], v[168:171]
    ds_read_b128 v[92:95], v16 offset:63488
    v_mfma_f32_16x16x32_bf16 v[172:175], v[156:159], v[68:71], v[172:175]
    s_waitcnt lgkmcnt(5)
    v_mfma_f32_16x16x32_bf16 v[176:179], v[152:155], v[72:75], v[176:179]
    s_waitcnt lgkmcnt(0)
    s_waitcnt vmcnt(24)
    s_barrier
    s_setprio 1
    ds_read_b128 v[64:67], v17 offset:0
    v_mfma_f32_16x16x32_bf16 v[180:183], v[156:159], v[72:75], v[180:183]
    v_mfma_f32_16x16x32_bf16 v[184:187], v[152:155], v[76:79], v[184:187]
    ds_read_b128 v[68:71], v17 offset:2048
    v_mfma_f32_16x16x32_bf16 v[188:191], v[156:159], v[76:79], v[188:191]
    s_add_u32 m0, s67, 32768
    s_add_u32 s63, s73, 3328
    buffer_load_dwordx4 v3, s[16:19], s63 offen lds
    v_mfma_f32_16x16x32_bf16 v[192:195], v[152:155], v[80:83], v[192:195]
    ds_read_b128 v[72:75], v17 offset:4096
    v_mfma_f32_16x16x32_bf16 v[196:199], v[156:159], v[80:83], v[196:199]
    v_mfma_f32_16x16x32_bf16 v[200:203], v[152:155], v[84:87], v[200:203]
    ds_read_b128 v[76:79], v17 offset:6144
    v_mfma_f32_16x16x32_bf16 v[204:207], v[156:159], v[84:87], v[204:207]
    s_add_u32 m0, s67, 40960
    s_add_u32 s63, s73, 265472
    buffer_load_dwordx4 v3, s[16:19], s63 offen lds
    v_mfma_f32_16x16x32_bf16 v[208:211], v[152:155], v[88:91], v[208:211]
    ds_read_b128 v[80:83], v17 offset:8192
    v_mfma_f32_16x16x32_bf16 v[212:215], v[156:159], v[88:91], v[212:215]
    v_mfma_f32_16x16x32_bf16 v[216:219], v[152:155], v[92:95], v[216:219]
    ds_read_b128 v[84:87], v17 offset:10240
    v_mfma_f32_16x16x32_bf16 v[220:223], v[156:159], v[92:95], v[220:223]
    s_add_u32 m0, s67, 49152
    s_add_u32 s63, s73, 3456
    buffer_load_dwordx4 v3, s[16:19], s63 offen lds
    s_waitcnt lgkmcnt(5)
    v_mfma_f32_16x16x32_bf16 v[160:163], v[48:51], v[64:67], v[160:163]
    ds_read_b128 v[88:91], v17 offset:12288
    v_mfma_f32_16x16x32_bf16 v[164:167], v[52:55], v[64:67], v[164:167]
    s_waitcnt lgkmcnt(5)
    v_mfma_f32_16x16x32_bf16 v[168:171], v[48:51], v[68:71], v[168:171]
    ds_read_b128 v[92:95], v17 offset:14336
    v_mfma_f32_16x16x32_bf16 v[172:175], v[52:55], v[68:71], v[172:175]
    s_add_u32 m0, s67, 57344
    s_add_u32 s63, s73, 265600
    buffer_load_dwordx4 v3, s[16:19], s63 offen lds
    s_waitcnt lgkmcnt(5)
    v_mfma_f32_16x16x32_bf16 v[176:179], v[48:51], v[72:75], v[176:179]
    ds_read_b128 v[64:67], v17 offset:16384
    v_mfma_f32_16x16x32_bf16 v[180:183], v[52:55], v[72:75], v[180:183]
    s_setprio 0
    s_waitcnt lgkmcnt(5)
    v_mfma_f32_16x16x32_bf16 v[184:187], v[48:51], v[76:79], v[184:187]
    ds_read_b128 v[68:71], v17 offset:18432
    v_mfma_f32_16x16x32_bf16 v[188:191], v[52:55], v[76:79], v[188:191]
    s_add_u32 s63, s74, 106496
    buffer_load_dwordx4 v[144:147], v12, s[36:39], s63 offen sc1
    buffer_load_dwordx4 v[148:151], v12, s[36:39], s63 offen offset:256 sc1
    s_waitcnt lgkmcnt(5)
    v_mfma_f32_16x16x32_bf16 v[192:195], v[48:51], v[80:83], v[192:195]
    ds_read_b128 v[72:75], v17 offset:20480
    v_mfma_f32_16x16x32_bf16 v[196:199], v[52:55], v[80:83], v[196:199]
    s_waitcnt lgkmcnt(5)
    v_mfma_f32_16x16x32_bf16 v[200:203], v[48:51], v[84:87], v[200:203]
    ds_read_b128 v[76:79], v17 offset:22528
    v_mfma_f32_16x16x32_bf16 v[204:207], v[52:55], v[84:87], v[204:207]
    s_add_u32 s63, s74, 110592
    buffer_load_dwordx4 v[152:155], v12, s[36:39], s63 offen sc1
    buffer_load_dwordx4 v[156:159], v12, s[36:39], s63 offen offset:256 sc1
    s_waitcnt lgkmcnt(5)
    v_mfma_f32_16x16x32_bf16 v[208:211], v[48:51], v[88:91], v[208:211]
    ds_read_b128 v[80:83], v17 offset:24576
    v_mfma_f32_16x16x32_bf16 v[212:215], v[52:55], v[88:91], v[212:215]
    s_waitcnt lgkmcnt(5)
    v_mfma_f32_16x16x32_bf16 v[216:219], v[48:51], v[92:95], v[216:219]
    ds_read_b128 v[84:87], v17 offset:26624
    v_mfma_f32_16x16x32_bf16 v[220:223], v[52:55], v[92:95], v[220:223]
    s_waitcnt lgkmcnt(5)
    v_mfma_f32_16x16x32_bf16 v[160:163], v[56:59], v[64:67], v[160:163]
    ds_read_b128 v[88:91], v17 offset:28672
    v_mfma_f32_16x16x32_bf16 v[164:167], v[60:63], v[64:67], v[164:167]
    s_waitcnt lgkmcnt(5)
    v_mfma_f32_16x16x32_bf16 v[168:171], v[56:59], v[68:71], v[168:171]
    ds_read_b128 v[92:95], v17 offset:30720
    v_mfma_f32_16x16x32_bf16 v[172:175], v[60:63], v[68:71], v[172:175]
    s_waitcnt lgkmcnt(5)
    v_mfma_f32_16x16x32_bf16 v[176:179], v[56:59], v[72:75], v[176:179]
    s_waitcnt lgkmcnt(0)
    s_waitcnt vmcnt(24)
    s_barrier
    s_setprio 1
    ds_read_b128 v[64:67], v17 offset:32768
    v_mfma_f32_16x16x32_bf16 v[180:183], v[60:63], v[72:75], v[180:183]
    v_mfma_f32_16x16x32_bf16 v[184:187], v[56:59], v[76:79], v[184:187]
    ds_read_b128 v[68:71], v17 offset:34816
    v_mfma_f32_16x16x32_bf16 v[188:191], v[60:63], v[76:79], v[188:191]
    s_add_u32 m0, s67, 65536
    s_add_u32 s63, s73, 3584
    buffer_load_dwordx4 v3, s[16:19], s63 offen lds
    v_mfma_f32_16x16x32_bf16 v[192:195], v[56:59], v[80:83], v[192:195]
    ds_read_b128 v[72:75], v17 offset:36864
    v_mfma_f32_16x16x32_bf16 v[196:199], v[60:63], v[80:83], v[196:199]
    v_mfma_f32_16x16x32_bf16 v[200:203], v[56:59], v[84:87], v[200:203]
    ds_read_b128 v[76:79], v17 offset:38912
    v_mfma_f32_16x16x32_bf16 v[204:207], v[60:63], v[84:87], v[204:207]
    s_add_u32 m0, s67, 73728
    s_add_u32 s63, s73, 265728
    buffer_load_dwordx4 v3, s[16:19], s63 offen lds
    v_mfma_f32_16x16x32_bf16 v[208:211], v[56:59], v[88:91], v[208:211]
    ds_read_b128 v[80:83], v17 offset:40960
    v_mfma_f32_16x16x32_bf16 v[212:215], v[60:63], v[88:91], v[212:215]
    v_mfma_f32_16x16x32_bf16 v[216:219], v[56:59], v[92:95], v[216:219]
    ds_read_b128 v[84:87], v17 offset:43008
    v_mfma_f32_16x16x32_bf16 v[220:223], v[60:63], v[92:95], v[220:223]
    s_add_u32 m0, s67, 81920
    s_add_u32 s63, s73, 3712
    buffer_load_dwordx4 v3, s[16:19], s63 offen lds
    s_waitcnt lgkmcnt(5)
    v_mfma_f32_16x16x32_bf16 v[160:163], v[224:227], v[64:67], v[160:163]
    ds_read_b128 v[88:91], v17 offset:45056
    v_mfma_f32_16x16x32_bf16 v[164:167], v[228:231], v[64:67], v[164:167]
    s_waitcnt lgkmcnt(5)
    v_mfma_f32_16x16x32_bf16 v[168:171], v[224:227], v[68:71], v[168:171]
    ds_read_b128 v[92:95], v17 offset:47104
    v_mfma_f32_16x16x32_bf16 v[172:175], v[228:231], v[68:71], v[172:175]
    s_add_u32 m0, s67, 90112
    s_add_u32 s63, s73, 265856
    buffer_load_dwordx4 v3, s[16:19], s63 offen lds
    s_waitcnt lgkmcnt(5)
    v_mfma_f32_16x16x32_bf16 v[176:179], v[224:227], v[72:75], v[176:179]
    ds_read_b128 v[64:67], v17 offset:49152
    v_mfma_f32_16x16x32_bf16 v[180:183], v[228:231], v[72:75], v[180:183]
    s_setprio 0
    s_waitcnt lgkmcnt(5)
    v_mfma_f32_16x16x32_bf16 v[184:187], v[224:227], v[76:79], v[184:187]
    ds_read_b128 v[68:71], v17 offset:51200
    v_mfma_f32_16x16x32_bf16 v[188:191], v[228:231], v[76:79], v[188:191]
    s_add_u32 s63, s74, 114688
    buffer_load_dwordx4 v[48:51], v12, s[36:39], s63 offen sc1
    buffer_load_dwordx4 v[52:55], v12, s[36:39], s63 offen offset:256 sc1
    s_waitcnt lgkmcnt(5)
    v_mfma_f32_16x16x32_bf16 v[192:195], v[224:227], v[80:83], v[192:195]
    ds_read_b128 v[72:75], v17 offset:53248
    v_mfma_f32_16x16x32_bf16 v[196:199], v[228:231], v[80:83], v[196:199]
    s_waitcnt lgkmcnt(5)
    v_mfma_f32_16x16x32_bf16 v[200:203], v[224:227], v[84:87], v[200:203]
    ds_read_b128 v[76:79], v17 offset:55296
    v_mfma_f32_16x16x32_bf16 v[204:207], v[228:231], v[84:87], v[204:207]
    s_add_u32 s63, s74, 118784
    buffer_load_dwordx4 v[56:59], v12, s[36:39], s63 offen sc1
    buffer_load_dwordx4 v[60:63], v12, s[36:39], s63 offen offset:256 sc1
    s_waitcnt lgkmcnt(5)
    v_mfma_f32_16x16x32_bf16 v[208:211], v[224:227], v[88:91], v[208:211]
    ds_read_b128 v[80:83], v17 offset:57344
    v_mfma_f32_16x16x32_bf16 v[212:215], v[228:231], v[88:91], v[212:215]
    s_waitcnt lgkmcnt(5)
    v_mfma_f32_16x16x32_bf16 v[216:219], v[224:227], v[92:95], v[216:219]
    ds_read_b128 v[84:87], v17 offset:59392
    v_mfma_f32_16x16x32_bf16 v[220:223], v[228:231], v[92:95], v[220:223]
    s_waitcnt lgkmcnt(5)
    v_mfma_f32_16x16x32_bf16 v[160:163], v[232:235], v[64:67], v[160:163]
    ds_read_b128 v[88:91], v17 offset:61440
    v_mfma_f32_16x16x32_bf16 v[164:167], v[236:239], v[64:67], v[164:167]
    s_waitcnt lgkmcnt(5)
    v_mfma_f32_16x16x32_bf16 v[168:171], v[232:235], v[68:71], v[168:171]
    ds_read_b128 v[92:95], v17 offset:63488
    v_mfma_f32_16x16x32_bf16 v[172:175], v[236:239], v[68:71], v[172:175]
    s_waitcnt lgkmcnt(5)
    v_mfma_f32_16x16x32_bf16 v[176:179], v[232:235], v[72:75], v[176:179]
    s_waitcnt lgkmcnt(0)
    s_waitcnt vmcnt(24)
    s_barrier
    s_setprio 1
    ds_read_b128 v[64:67], v18 offset:0
    v_mfma_f32_16x16x32_bf16 v[180:183], v[236:239], v[72:75], v[180:183]
    v_mfma_f32_16x16x32_bf16 v[184:187], v[232:235], v[76:79], v[184:187]
    ds_read_b128 v[68:71], v18 offset:2048
    v_mfma_f32_16x16x32_bf16 v[188:191], v[236:239], v[76:79], v[188:191]
    s_add_u32 m0, s67, 98304
    s_add_u32 s63, s73, 3840
    buffer_load_dwordx4 v3, s[16:19], s63 offen lds
    v_mfma_f32_16x16x32_bf16 v[192:195], v[232:235], v[80:83], v[192:195]
    ds_read_b128 v[72:75], v18 offset:4096
    v_mfma_f32_16x16x32_bf16 v[196:199], v[236:239], v[80:83], v[196:199]
    v_mfma_f32_16x16x32_bf16 v[200:203], v[232:235], v[84:87], v[200:203]
    ds_read_b128 v[76:79], v18 offset:6144
    v_mfma_f32_16x16x32_bf16 v[204:207], v[236:239], v[84:87], v[204:207]
    s_add_u32 m0, s67, 106496
    s_add_u32 s63, s73, 265984
    buffer_load_dwordx4 v3, s[16:19], s63 offen lds
    v_mfma_f32_16x16x32_bf16 v[208:211], v[232:235], v[88:91], v[208:211]
    ds_read_b128 v[80:83], v18 offset:8192
    v_mfma_f32_16x16x32_bf16 v[212:215], v[236:239], v[88:91], v[212:215]
    v_mfma_f32_16x16x32_bf16 v[216:219], v[232:235], v[92:95], v[216:219]
    ds_read_b128 v[84:87], v18 offset:10240
    v_mfma_f32_16x16x32_bf16 v[220:223], v[236:239], v[92:95], v[220:223]
    s_add_u32 m0, s67, 114688
    s_add_u32 s63, s73, 3968
    buffer_load_dwordx4 v3, s[16:19], s63 offen lds
    s_waitcnt lgkmcnt(5)
    v_mfma_f32_16x16x32_bf16 v[160:163], v[240:243], v[64:67], v[160:163]
    ds_read_b128 v[88:91], v18 offset:12288
    v_mfma_f32_16x16x32_bf16 v[164:167], v[244:247], v[64:67], v[164:167]
    s_waitcnt lgkmcnt(5)
    v_mfma_f32_16x16x32_bf16 v[168:171], v[240:243], v[68:71], v[168:171]
    ds_read_b128 v[92:95], v18 offset:14336
    v_mfma_f32_16x16x32_bf16 v[172:175], v[244:247], v[68:71], v[172:175]
    s_add_u32 m0, s67, 122880
    s_add_u32 s63, s73, 266112
    buffer_load_dwordx4 v3, s[16:19], s63 offen lds
    s_waitcnt lgkmcnt(5)
    v_mfma_f32_16x16x32_bf16 v[176:179], v[240:243], v[72:75], v[176:179]
    ds_read_b128 v[64:67], v18 offset:16384
    v_mfma_f32_16x16x32_bf16 v[180:183], v[244:247], v[72:75], v[180:183]
    s_setprio 0
    s_waitcnt lgkmcnt(5)
    v_mfma_f32_16x16x32_bf16 v[184:187], v[240:243], v[76:79], v[184:187]
    ds_read_b128 v[68:71], v18 offset:18432
    v_mfma_f32_16x16x32_bf16 v[188:191], v[244:247], v[76:79], v[188:191]
    s_add_u32 s63, s74, 122880
    buffer_load_dwordx4 v[224:227], v12, s[36:39], s63 offen sc1
    buffer_load_dwordx4 v[228:231], v12, s[36:39], s63 offen offset:256 sc1
    s_waitcnt lgkmcnt(5)
    v_mfma_f32_16x16x32_bf16 v[192:195], v[240:243], v[80:83], v[192:195]
    ds_read_b128 v[72:75], v18 offset:20480
    v_mfma_f32_16x16x32_bf16 v[196:199], v[244:247], v[80:83], v[196:199]
    s_waitcnt lgkmcnt(5)
    v_mfma_f32_16x16x32_bf16 v[200:203], v[240:243], v[84:87], v[200:203]
    ds_read_b128 v[76:79], v18 offset:22528
    v_mfma_f32_16x16x32_bf16 v[204:207], v[244:247], v[84:87], v[204:207]
    s_add_u32 s63, s74, 126976
    buffer_load_dwordx4 v[232:235], v12, s[36:39], s63 offen sc1
    buffer_load_dwordx4 v[236:239], v12, s[36:39], s63 offen offset:256 sc1
    s_waitcnt lgkmcnt(5)
    v_mfma_f32_16x16x32_bf16 v[208:211], v[240:243], v[88:91], v[208:211]
    ds_read_b128 v[80:83], v18 offset:24576
    v_mfma_f32_16x16x32_bf16 v[212:215], v[244:247], v[88:91], v[212:215]
    s_waitcnt lgkmcnt(5)
    v_mfma_f32_16x16x32_bf16 v[216:219], v[240:243], v[92:95], v[216:219]
    ds_read_b128 v[84:87], v18 offset:26624
    v_mfma_f32_16x16x32_bf16 v[220:223], v[244:247], v[92:95], v[220:223]
    s_waitcnt lgkmcnt(5)
    v_mfma_f32_16x16x32_bf16 v[160:163], v[248:251], v[64:67], v[160:163]
    ds_read_b128 v[88:91], v18 offset:28672
    v_mfma_f32_16x16x32_bf16 v[164:167], v[252:255], v[64:67], v[164:167]
    s_waitcnt lgkmcnt(5)
    v_mfma_f32_16x16x32_bf16 v[168:171], v[248:251], v[68:71], v[168:171]
    ds_read_b128 v[92:95], v18 offset:30720
    v_mfma_f32_16x16x32_bf16 v[172:175], v[252:255], v[68:71], v[172:175]
    s_waitcnt lgkmcnt(5)
    v_mfma_f32_16x16x32_bf16 v[176:179], v[248:251], v[72:75], v[176:179]
    s_waitcnt lgkmcnt(0)
    s_waitcnt vmcnt(24)
    s_barrier
    s_setprio 1
    ds_read_b128 v[64:67], v16 offset:0
    v_mfma_f32_16x16x32_bf16 v[180:183], v[252:255], v[72:75], v[180:183]
    v_mfma_f32_16x16x32_bf16 v[184:187], v[248:251], v[76:79], v[184:187]
    ds_read_b128 v[68:71], v16 offset:2048
    v_mfma_f32_16x16x32_bf16 v[188:191], v[252:255], v[76:79], v[188:191]
    buffer_load_ushort v20, v7, s[32:35], s77 offen offset:0
    buffer_load_ushort v21, v7, s[32:35], s77 offen offset:32
    v_mfma_f32_16x16x32_bf16 v[192:195], v[248:251], v[80:83], v[192:195]
    ds_read_b128 v[72:75], v16 offset:4096
    v_mfma_f32_16x16x32_bf16 v[196:199], v[252:255], v[80:83], v[196:199]
    v_mfma_f32_16x16x32_bf16 v[200:203], v[248:251], v[84:87], v[200:203]
    ds_read_b128 v[76:79], v16 offset:6144
    v_mfma_f32_16x16x32_bf16 v[204:207], v[252:255], v[84:87], v[204:207]
    buffer_load_ushort v22, v7, s[32:35], s77 offen offset:64
    buffer_load_ushort v23, v7, s[32:35], s77 offen offset:96
    v_mfma_f32_16x16x32_bf16 v[208:211], v[248:251], v[88:91], v[208:211]
    ds_read_b128 v[80:83], v16 offset:8192
    v_mfma_f32_16x16x32_bf16 v[212:215], v[252:255], v[88:91], v[212:215]
    v_mfma_f32_16x16x32_bf16 v[216:219], v[248:251], v[92:95], v[216:219]
    ds_read_b128 v[84:87], v16 offset:10240
    v_mfma_f32_16x16x32_bf16 v[220:223], v[252:255], v[92:95], v[220:223]
    buffer_load_dwordx4 v[96:99], v12, s[24:27], s76 offen offset:0 sc1
    buffer_load_dwordx4 v[100:103], v12, s[24:27], s76 offen offset:256 sc1
    s_waitcnt lgkmcnt(5)
    v_mfma_f32_16x16x32_bf16 v[160:163], v[128:131], v[64:67], v[160:163]
    ds_read_b128 v[88:91], v16 offset:12288
    v_mfma_f32_16x16x32_bf16 v[164:167], v[132:135], v[64:67], v[164:167]
    s_waitcnt lgkmcnt(5)
    v_mfma_f32_16x16x32_bf16 v[168:171], v[128:131], v[68:71], v[168:171]
    ds_read_b128 v[92:95], v16 offset:14336
    v_mfma_f32_16x16x32_bf16 v[172:175], v[132:135], v[68:71], v[172:175]
    buffer_load_dwordx4 v[104:107], v12, s[24:27], s78 offen offset:0 sc1
    buffer_load_dwordx4 v[108:111], v12, s[24:27], s78 offen offset:256 sc1
    s_waitcnt lgkmcnt(5)
    v_mfma_f32_16x16x32_bf16 v[176:179], v[128:131], v[72:75], v[176:179]
    ds_read_b128 v[64:67], v16 offset:16384
    v_mfma_f32_16x16x32_bf16 v[180:183], v[132:135], v[72:75], v[180:183]
    s_setprio 0
    s_waitcnt lgkmcnt(5)
    v_mfma_f32_16x16x32_bf16 v[184:187], v[128:131], v[76:79], v[184:187]
    ds_read_b128 v[68:71], v16 offset:18432
    v_mfma_f32_16x16x32_bf16 v[188:191], v[132:135], v[76:79], v[188:191]
    s_waitcnt lgkmcnt(5)
    v_mfma_f32_16x16x32_bf16 v[192:195], v[128:131], v[80:83], v[192:195]
    ds_read_b128 v[72:75], v16 offset:20480
    v_mfma_f32_16x16x32_bf16 v[196:199], v[132:135], v[80:83], v[196:199]
    s_waitcnt lgkmcnt(5)
    v_mfma_f32_16x16x32_bf16 v[200:203], v[128:131], v[84:87], v[200:203]
    ds_read_b128 v[76:79], v16 offset:22528
    v_mfma_f32_16x16x32_bf16 v[204:207], v[132:135], v[84:87], v[204:207]
    s_waitcnt lgkmcnt(5)
    v_mfma_f32_16x16x32_bf16 v[208:211], v[128:131], v[88:91], v[208:211]
    ds_read_b128 v[80:83], v16 offset:24576
    v_mfma_f32_16x16x32_bf16 v[212:215], v[132:135], v[88:91], v[212:215]
    s_waitcnt lgkmcnt(5)
    v_mfma_f32_16x16x32_bf16 v[216:219], v[128:131], v[92:95], v[216:219]
    ds_read_b128 v[84:87], v16 offset:26624
    v_mfma_f32_16x16x32_bf16 v[220:223], v[132:135], v[92:95], v[220:223]
    s_waitcnt lgkmcnt(5)
    v_mfma_f32_16x16x32_bf16 v[160:163], v[136:139], v[64:67], v[160:163]
    ds_read_b128 v[88:91], v16 offset:28672
    v_mfma_f32_16x16x32_bf16 v[164:167], v[140:143], v[64:67], v[164:167]
    s_waitcnt lgkmcnt(5)
    v_mfma_f32_16x16x32_bf16 v[168:171], v[136:139], v[68:71], v[168:171]
    ds_read_b128 v[92:95], v16 offset:30720
    v_mfma_f32_16x16x32_bf16 v[172:175], v[140:143], v[68:71], v[172:175]
    s_waitcnt lgkmcnt(5)
    v_mfma_f32_16x16x32_bf16 v[176:179], v[136:139], v[72:75], v[176:179]
    s_waitcnt lgkmcnt(0)
    s_waitcnt vmcnt(24)
    s_barrier
    s_setprio 1
    ds_read_b128 v[64:67], v16 offset:32768
    v_mfma_f32_16x16x32_bf16 v[180:183], v[140:143], v[72:75], v[180:183]
    v_mfma_f32_16x16x32_bf16 v[184:187], v[136:139], v[76:79], v[184:187]
    ds_read_b128 v[68:71], v16 offset:34816
    v_mfma_f32_16x16x32_bf16 v[188:191], v[140:143], v[76:79], v[188:191]
    v_mfma_f32_16x16x32_bf16 v[192:195], v[136:139], v[80:83], v[192:195]
    ds_read_b128 v[72:75], v16 offset:36864
    v_mfma_f32_16x16x32_bf16 v[196:199], v[140:143], v[80:83], v[196:199]
    v_mfma_f32_16x16x32_bf16 v[200:203], v[136:139], v[84:87], v[200:203]
    ds_read_b128 v[76:79], v16 offset:38912
    v_mfma_f32_16x16x32_bf16 v[204:207], v[140:143], v[84:87], v[204:207]
    v_mfma_f32_16x16x32_bf16 v[208:211], v[136:139], v[88:91], v[208:211]
    ds_read_b128 v[80:83], v16 offset:40960
    v_mfma_f32_16x16x32_bf16 v[212:215], v[140:143], v[88:91], v[212:215]
    v_mfma_f32_16x16x32_bf16 v[216:219], v[136:139], v[92:95], v[216:219]
    ds_read_b128 v[84:87], v16 offset:43008
    v_mfma_f32_16x16x32_bf16 v[220:223], v[140:143], v[92:95], v[220:223]
    s_waitcnt lgkmcnt(5)
    v_mfma_f32_16x16x32_bf16 v[160:163], v[144:147], v[64:67], v[160:163]
    ds_read_b128 v[88:91], v16 offset:45056
    v_mfma_f32_16x16x32_bf16 v[164:167], v[148:151], v[64:67], v[164:167]
    s_waitcnt lgkmcnt(5)
    v_mfma_f32_16x16x32_bf16 v[168:171], v[144:147], v[68:71], v[168:171]
    ds_read_b128 v[92:95], v16 offset:47104
    v_mfma_f32_16x16x32_bf16 v[172:175], v[148:151], v[68:71], v[172:175]
    s_waitcnt lgkmcnt(5)
    v_mfma_f32_16x16x32_bf16 v[176:179], v[144:147], v[72:75], v[176:179]
    ds_read_b128 v[64:67], v16 offset:49152
    v_mfma_f32_16x16x32_bf16 v[180:183], v[148:151], v[72:75], v[180:183]
    s_setprio 0
    s_waitcnt lgkmcnt(5)
    v_mfma_f32_16x16x32_bf16 v[184:187], v[144:147], v[76:79], v[184:187]
    ds_read_b128 v[68:71], v16 offset:51200
    v_mfma_f32_16x16x32_bf16 v[188:191], v[148:151], v[76:79], v[188:191]
    s_waitcnt lgkmcnt(5)
    v_mfma_f32_16x16x32_bf16 v[192:195], v[144:147], v[80:83], v[192:195]
    ds_read_b128 v[72:75], v16 offset:53248
    v_mfma_f32_16x16x32_bf16 v[196:199], v[148:151], v[80:83], v[196:199]
    s_waitcnt lgkmcnt(5)
    v_mfma_f32_16x16x32_bf16 v[200:203], v[144:147], v[84:87], v[200:203]
    ds_read_b128 v[76:79], v16 offset:55296
    v_mfma_f32_16x16x32_bf16 v[204:207], v[148:151], v[84:87], v[204:207]
    s_waitcnt lgkmcnt(5)
    v_mfma_f32_16x16x32_bf16 v[208:211], v[144:147], v[88:91], v[208:211]
    ds_read_b128 v[80:83], v16 offset:57344
    v_mfma_f32_16x16x32_bf16 v[212:215], v[148:151], v[88:91], v[212:215]
    s_waitcnt lgkmcnt(5)
    v_mfma_f32_16x16x32_bf16 v[216:219], v[144:147], v[92:95], v[216:219]
    ds_read_b128 v[84:87], v16 offset:59392
    v_mfma_f32_16x16x32_bf16 v[220:223], v[148:151], v[92:95], v[220:223]
    s_waitcnt lgkmcnt(5)
    v_mfma_f32_16x16x32_bf16 v[160:163], v[152:155], v[64:67], v[160:163]
    ds_read_b128 v[88:91], v16 offset:61440
    v_mfma_f32_16x16x32_bf16 v[164:167], v[156:159], v[64:67], v[164:167]
    s_waitcnt lgkmcnt(5)
    v_mfma_f32_16x16x32_bf16 v[168:171], v[152:155], v[68:71], v[168:171]
    ds_read_b128 v[92:95], v16 offset:63488
    v_mfma_f32_16x16x32_bf16 v[172:175], v[156:159], v[68:71], v[172:175]
    s_waitcnt lgkmcnt(5)
    v_mfma_f32_16x16x32_bf16 v[176:179], v[152:155], v[72:75], v[176:179]
    s_waitcnt lgkmcnt(0)
    s_waitcnt vmcnt(16)
    s_barrier
    s_setprio 1
    ds_read_b128 v[64:67], v17 offset:0
    v_mfma_f32_16x16x32_bf16 v[180:183], v[156:159], v[72:75], v[180:183]
    v_mfma_f32_16x16x32_bf16 v[184:187], v[152:155], v[76:79], v[184:187]
    ds_read_b128 v[68:71], v17 offset:2048
    v_mfma_f32_16x16x32_bf16 v[188:191], v[156:159], v[76:79], v[188:191]
    v_mfma_f32_16x16x32_bf16 v[192:195], v[152:155], v[80:83], v[192:195]
    ds_read_b128 v[72:75], v17 offset:4096
    v_mfma_f32_16x16x32_bf16 v[196:199], v[156:159], v[80:83], v[196:199]
    v_mfma_f32_16x16x32_bf16 v[200:203], v[152:155], v[84:87], v[200:203]
    ds_read_b128 v[76:79], v17 offset:6144
    v_mfma_f32_16x16x32_bf16 v[204:207], v[156:159], v[84:87], v[204:207]
    v_mfma_f32_16x16x32_bf16 v[208:211], v[152:155], v[88:91], v[208:211]
    ds_read_b128 v[80:83], v17 offset:8192
    v_mfma_f32_16x16x32_bf16 v[212:215], v[156:159], v[88:91], v[212:215]
    v_mfma_f32_16x16x32_bf16 v[216:219], v[152:155], v[92:95], v[216:219]
    ds_read_b128 v[84:87], v17 offset:10240
    v_mfma_f32_16x16x32_bf16 v[220:223], v[156:159], v[92:95], v[220:223]
    s_waitcnt lgkmcnt(5)
    v_mfma_f32_16x16x32_bf16 v[160:163], v[48:51], v[64:67], v[160:163]
    ds_read_b128 v[88:91], v17 offset:12288
    v_mfma_f32_16x16x32_bf16 v[164:167], v[52:55], v[64:67], v[164:167]
    s_waitcnt lgkmcnt(5)
    v_mfma_f32_16x16x32_bf16 v[168:171], v[48:51], v[68:71], v[168:171]
    ds_read_b128 v[92:95], v17 offset:14336
    v_mfma_f32_16x16x32_bf16 v[172:175], v[52:55], v[68:71], v[172:175]
    s_waitcnt lgkmcnt(5)
    v_mfma_f32_16x16x32_bf16 v[176:179], v[48:51], v[72:75], v[176:179]
    ds_read_b128 v[64:67], v17 offset:16384
    v_mfma_f32_16x16x32_bf16 v[180:183], v[52:55], v[72:75], v[180:183]
    s_setprio 0
    s_waitcnt lgkmcnt(5)
    v_mfma_f32_16x16x32_bf16 v[184:187], v[48:51], v[76:79], v[184:187]
    ds_read_b128 v[68:71], v17 offset:18432
    v_mfma_f32_16x16x32_bf16 v[188:191], v[52:55], v[76:79], v[188:191]
    s_waitcnt lgkmcnt(5)
    v_mfma_f32_16x16x32_bf16 v[192:195], v[48:51], v[80:83], v[192:195]
    ds_read_b128 v[72:75], v17 offset:20480
    v_mfma_f32_16x16x32_bf16 v[196:199], v[52:55], v[80:83], v[196:199]
    s_waitcnt lgkmcnt(5)
    v_mfma_f32_16x16x32_bf16 v[200:203], v[48:51], v[84:87], v[200:203]
    ds_read_b128 v[76:79], v17 offset:22528
    v_mfma_f32_16x16x32_bf16 v[204:207], v[52:55], v[84:87], v[204:207]
    s_waitcnt lgkmcnt(5)
    v_mfma_f32_16x16x32_bf16 v[208:211], v[48:51], v[88:91], v[208:211]
    ds_read_b128 v[80:83], v17 offset:24576
    v_mfma_f32_16x16x32_bf16 v[212:215], v[52:55], v[88:91], v[212:215]
    s_waitcnt lgkmcnt(5)
    v_mfma_f32_16x16x32_bf16 v[216:219], v[48:51], v[92:95], v[216:219]
    ds_read_b128 v[84:87], v17 offset:26624
    v_mfma_f32_16x16x32_bf16 v[220:223], v[52:55], v[92:95], v[220:223]
    s_waitcnt lgkmcnt(5)
    v_mfma_f32_16x16x32_bf16 v[160:163], v[56:59], v[64:67], v[160:163]
    ds_read_b128 v[88:91], v17 offset:28672
    v_mfma_f32_16x16x32_bf16 v[164:167], v[60:63], v[64:67], v[164:167]
    s_waitcnt lgkmcnt(5)
    v_mfma_f32_16x16x32_bf16 v[168:171], v[56:59], v[68:71], v[168:171]
    ds_read_b128 v[92:95], v17 offset:30720
    v_mfma_f32_16x16x32_bf16 v[172:175], v[60:63], v[68:71], v[172:175]
    s_waitcnt lgkmcnt(5)
    v_mfma_f32_16x16x32_bf16 v[176:179], v[56:59], v[72:75], v[176:179]
    s_waitcnt lgkmcnt(0)
    s_waitcnt vmcnt(8)
    s_barrier
    s_setprio 1
    ds_read_b128 v[64:67], v17 offset:32768
    v_mfma_f32_16x16x32_bf16 v[180:183], v[60:63], v[72:75], v[180:183]
    v_mfma_f32_16x16x32_bf16 v[184:187], v[56:59], v[76:79], v[184:187]
    ds_read_b128 v[68:71], v17 offset:34816
    v_mfma_f32_16x16x32_bf16 v[188:191], v[60:63], v[76:79], v[188:191]
    v_mfma_f32_16x16x32_bf16 v[192:195], v[56:59], v[80:83], v[192:195]
    ds_read_b128 v[72:75], v17 offset:36864
    v_mfma_f32_16x16x32_bf16 v[196:199], v[60:63], v[80:83], v[196:199]
    v_mfma_f32_16x16x32_bf16 v[200:203], v[56:59], v[84:87], v[200:203]
    ds_read_b128 v[76:79], v17 offset:38912
    v_mfma_f32_16x16x32_bf16 v[204:207], v[60:63], v[84:87], v[204:207]
    v_mfma_f32_16x16x32_bf16 v[208:211], v[56:59], v[88:91], v[208:211]
    ds_read_b128 v[80:83], v17 offset:40960
    v_mfma_f32_16x16x32_bf16 v[212:215], v[60:63], v[88:91], v[212:215]
    v_mfma_f32_16x16x32_bf16 v[216:219], v[56:59], v[92:95], v[216:219]
    ds_read_b128 v[84:87], v17 offset:43008
    v_mfma_f32_16x16x32_bf16 v[220:223], v[60:63], v[92:95], v[220:223]
    s_waitcnt lgkmcnt(5)
    v_mfma_f32_16x16x32_bf16 v[160:163], v[224:227], v[64:67], v[160:163]
    ds_read_b128 v[88:91], v17 offset:45056
    v_mfma_f32_16x16x32_bf16 v[164:167], v[228:231], v[64:67], v[164:167]
    s_waitcnt lgkmcnt(5)
    v_mfma_f32_16x16x32_bf16 v[168:171], v[224:227], v[68:71], v[168:171]
    ds_read_b128 v[92:95], v17 offset:47104
    v_mfma_f32_16x16x32_bf16 v[172:175], v[228:231], v[68:71], v[172:175]
    s_waitcnt lgkmcnt(5)
    v_mfma_f32_16x16x32_bf16 v[176:179], v[224:227], v[72:75], v[176:179]
    ds_read_b128 v[64:67], v17 offset:49152
    v_mfma_f32_16x16x32_bf16 v[180:183], v[228:231], v[72:75], v[180:183]
    s_setprio 0
    s_waitcnt lgkmcnt(5)
    v_mfma_f32_16x16x32_bf16 v[184:187], v[224:227], v[76:79], v[184:187]
    ds_read_b128 v[68:71], v17 offset:51200
    v_mfma_f32_16x16x32_bf16 v[188:191], v[228:231], v[76:79], v[188:191]
    s_waitcnt lgkmcnt(5)
    v_mfma_f32_16x16x32_bf16 v[192:195], v[224:227], v[80:83], v[192:195]
    ds_read_b128 v[72:75], v17 offset:53248
    v_mfma_f32_16x16x32_bf16 v[196:199], v[228:231], v[80:83], v[196:199]
    s_waitcnt lgkmcnt(5)
    v_mfma_f32_16x16x32_bf16 v[200:203], v[224:227], v[84:87], v[200:203]
    ds_read_b128 v[76:79], v17 offset:55296
    v_mfma_f32_16x16x32_bf16 v[204:207], v[228:231], v[84:87], v[204:207]
    s_waitcnt lgkmcnt(5)
    v_mfma_f32_16x16x32_bf16 v[208:211], v[224:227], v[88:91], v[208:211]
    ds_read_b128 v[80:83], v17 offset:57344
    v_mfma_f32_16x16x32_bf16 v[212:215], v[228:231], v[88:91], v[212:215]
    s_waitcnt lgkmcnt(5)
    v_mfma_f32_16x16x32_bf16 v[216:219], v[224:227], v[92:95], v[216:219]
    ds_read_b128 v[84:87], v17 offset:59392
    v_mfma_f32_16x16x32_bf16 v[220:223], v[228:231], v[92:95], v[220:223]
    s_waitcnt lgkmcnt(5)
    v_mfma_f32_16x16x32_bf16 v[160:163], v[232:235], v[64:67], v[160:163]
    ds_read_b128 v[88:91], v17 offset:61440
    v_mfma_f32_16x16x32_bf16 v[164:167], v[236:239], v[64:67], v[164:167]
    s_waitcnt lgkmcnt(5)
    v_mfma_f32_16x16x32_bf16 v[168:171], v[232:235], v[68:71], v[168:171]
    ds_read_b128 v[92:95], v17 offset:63488
    v_mfma_f32_16x16x32_bf16 v[172:175], v[236:239], v[68:71], v[172:175]
    s_waitcnt lgkmcnt(5)
    v_mfma_f32_16x16x32_bf16 v[176:179], v[232:235], v[72:75], v[176:179]
    v_mfma_f32_16x16x32_bf16 v[180:183], v[236:239], v[72:75], v[180:183]
    s_waitcnt lgkmcnt(4)
    v_mfma_f32_16x16x32_bf16 v[184:187], v[232:235], v[76:79], v[184:187]
    v_mfma_f32_16x16x32_bf16 v[188:191], v[236:239], v[76:79], v[188:191]
    s_waitcnt lgkmcnt(3)
    v_mfma_f32_16x16x32_bf16 v[192:195], v[232:235], v[80:83], v[192:195]
    v_mfma_f32_16x16x32_bf16 v[196:199], v[236:239], v[80:83], v[196:199]
    s_waitcnt lgkmcnt(2)
    v_mfma_f32_16x16x32_bf16 v[200:203], v[232:235], v[84:87], v[200:203]
    v_mfma_f32_16x16x32_bf16 v[204:207], v[236:239], v[84:87], v[204:207]
    s_waitcnt lgkmcnt(1)
    v_mfma_f32_16x16x32_bf16 v[208:211], v[232:235], v[88:91], v[208:211]
    v_mfma_f32_16x16x32_bf16 v[212:215], v[236:239], v[88:91], v[212:215]
    s_waitcnt lgkmcnt(0)
    v_mfma_f32_16x16x32_bf16 v[216:219], v[232:235], v[92:95], v[216:219]
    v_mfma_f32_16x16x32_bf16 v[220:223], v[236:239], v[92:95], v[220:223]
    s_waitcnt vmcnt(0)
    s_lshl_b32 s69, s56, 13
    v_add_u32 v6, s69, v2
    s_xor_b32 s69, s69, 32768
    v_add_u32 v7, s69, v2
    v_lshlrev_b32 v20, 16, v20
    v_lshlrev_b32 v21, 16, v21
    v_lshlrev_b32 v22, 16, v22
    v_lshlrev_b32 v23, 16, v23
    s_lshl_b32 s51, s65, 7
    s_lshl_b32 s69, s66, 2
    s_add_u32 s51, s51, s69
    s_add_u32 s51, s51, 6144
    s_cmp_eq_u32 s57, 0
    s_cbranch_scc0 P_sg1
    ds_write_b128 v6, v[192:195] offset:0
    ds_write_b128 v6, v[196:199] offset:1024
    ds_write_b128 v6, v[200:203] offset:2048
    ds_write_b128 v6, v[204:207] offset:3072
    ds_write_b128 v6, v[208:211] offset:4096
    ds_write_b128 v6, v[212:215] offset:5120
    ds_write_b128 v6, v[216:219] offset:6144
    ds_write_b128 v6, v[220:223] offset:7168
    v_add_f32 v160, v160, v20
    v_add_f32 v161, v161, v20
    v_add_f32 v162, v162, v20
    v_add_f32 v163, v163, v20
    v_add_f32 v164, v164, v20
    v_add_f32 v165, v165, v20
    v_add_f32 v166, v166, v20
    v_add_f32 v167, v167, v20
    v_add_f32 v168, v168, v21
    v_add_f32 v169, v169, v21
    v_add_f32 v170, v170, v21
    v_add_f32 v171, v171, v21
    v_add_f32 v172, v172, v21
    v_add_f32 v173, v173, v21
    v_add_f32 v174, v174, v21
    v_add_f32 v175, v175, v21
    v_add_f32 v176, v176, v22
    v_add_f32 v177, v177, v22
    v_add_f32 v178, v178, v22
    v_add_f32 v179, v179, v22
    v_add_f32 v180, v180, v22
    v_add_f32 v181, v181, v22
    v_add_f32 v182, v182, v22
    v_add_f32 v183, v183, v22
    v_add_f32 v184, v184, v23
    v_add_f32 v185, v185, v23
    v_add_f32 v186, v186, v23
    v_add_f32 v187, v187, v23
    v_add_f32 v188, v188, v23
    v_add_f32 v189, v189, v23
    v_add_f32 v190, v190, v23
    v_add_f32 v191, v191, v23
    v_lshlrev_b32 v128, 16, v96
    v_and_b32 v129, 0xffff0000, v96
    v_lshlrev_b32 v130, 16, v97
    v_and_b32 v131, 0xffff0000, v97
    v_lshlrev_b32 v132, 16, v98
    v_and_b32 v133, 0xffff0000, v98
    v_lshlrev_b32 v134, 16, v99
    v_and_b32 v135, 0xffff0000, v99
    v_lshlrev_b32 v136, 16, v100
    v_and_b32 v137, 0xffff0000, v100
    v_lshlrev_b32 v138, 16, v101
    v_and_b32 v139, 0xffff0000, v101
    v_lshlrev_b32 v140, 16, v102
    v_and_b32 v141, 0xffff0000, v102
    v_lshlrev_b32 v142, 16, v103
    v_and_b32 v143, 0xffff0000, v103
    v_lshlrev_b32 v144, 16, v104
    v_and_b32 v145, 0xffff0000, v104
    v_lshlrev_b32 v146, 16, v105
    v_and_b32 v147, 0xffff0000, v105
    v_lshlrev_b32 v148, 16, v106
    v_and_b32 v149, 0xffff0000, v106
    v_lshlrev_b32 v150, 16, v107
    v_and_b32 v151, 0xffff0000, v107
    v_lshlrev_b32 v152, 16, v108
    v_and_b32 v153, 0xffff0000, v108
    v_lshlrev_b32 v154, 16, v109
    v_and_b32 v155, 0xffff0000, v109
    v_lshlrev_b32 v156, 16, v110
    v_and_b32 v157, 0xffff0000, v110
    v_lshlrev_b32 v158, 16, v111
    v_and_b32 v159, 0xffff0000, v111
    s_waitcnt lgkmcnt(0)
    s_barrier
    ds_read_b128 v[224:227], v7 offset:0
    ds_read_b128 v[228:231], v7 offset:1024
    ds_read_b128 v[232:235], v7 offset:2048
    ds_read_b128 v[236:239], v7 offset:3072
    ds_read_b128 v[240:243], v7 offset:4096
    ds_read_b128 v[244:247], v7 offset:5120
    ds_read_b128 v[248:251], v7 offset:6144
    ds_read_b128 v[252:255], v7 offset:7168
    s_waitcnt lgkmcnt(6)
    v_add_f32 v160, v160, v224
    v_add_f32 v161, v161, v225
    v_add_f32 v162, v162, v226
    v_add_f32 v163, v163, v227
    v_add_f32 v164, v164, v228
    v_add_f32 v165, v165, v229
    v_add_f32 v166, v166, v230
    v_add_f32 v167, v167, v231
    v_mul_f32 v160, v160, v128
    v_mul_f32 v161, v161, v129
    v_mul_f32 v162, v162, v130
    v_mul_f32 v163, v163, v131
    v_mul_f32 v164, v164, v132
    v_mul_f32 v165, v165, v133
    v_mul_f32 v166, v166, v134
    v_mul_f32 v167, v167, v135
    v_cvt_pk_bf16_f32 v160, v160, v161
    v_cvt_pk_bf16_f32 v161, v162, v163
    v_cvt_pk_bf16_f32 v162, v164, v165
    v_cvt_pk_bf16_f32 v163, v166, v167
    buffer_store_dwordx4 v[160:163], v12, s[28:31], s76 offen offset:0 sc1
    s_waitcnt lgkmcnt(4)
    v_add_f32 v168, v168, v232
    v_add_f32 v169, v169, v233
    v_add_f32 v170, v170, v234
    v_add_f32 v171, v171, v235
    v_add_f32 v172, v172, v236
    v_add_f32 v173, v173, v237
    v_add_f32 v174, v174, v238
    v_add_f32 v175, v175, v239
    v_mul_f32 v168, v168, v136
    v_mul_f32 v169, v169, v137
    v_mul_f32 v170, v170, v138
    v_mul_f32 v171, v171, v139
    v_mul_f32 v172, v172, v140
    v_mul_f32 v173, v173, v141
    v_mul_f32 v174, v174, v142
    v_mul_f32 v175, v175, v143
    v_cvt_pk_bf16_f32 v168, v168, v169
    v_cvt_pk_bf16_f32 v169, v170, v171
    v_cvt_pk_bf16_f32 v170, v172, v173
    v_cvt_pk_bf16_f32 v171, v174, v175
    buffer_store_dwordx4 v[168:171], v12, s[28:31], s76 offen offset:256 sc1
    s_waitcnt lgkmcnt(2)
    v_add_f32 v176, v176, v240
    v_add_f32 v177, v177, v241
    v_add_f32 v178, v178, v242
    v_add_f32 v179, v179, v243
    v_add_f32 v180, v180, v244
    v_add_f32 v181, v181, v245
    v_add_f32 v182, v182, v246
    v_add_f32 v183, v183, v247
    v_mul_f32 v176, v176, v144
    v_mul_f32 v177, v177, v145
    v_mul_f32 v178, v178, v146
    v_mul_f32 v179, v179, v147
    v_mul_f32 v180, v180, v148
    v_mul_f32 v181, v181, v149
    v_mul_f32 v182, v182, v150
    v_mul_f32 v183, v183, v151
    v_cvt_pk_bf16_f32 v176, v176, v177
    v_cvt_pk_bf16_f32 v177, v178, v179
    v_cvt_pk_bf16_f32 v178, v180, v181
    v_cvt_pk_bf16_f32 v179, v182, v183
    buffer_store_dwordx4 v[176:179], v12, s[28:31], s78 offen offset:0 sc1
    s_waitcnt lgkmcnt(0)
    v_add_f32 v184, v184, v248
    v_add_f32 v185, v185, v249
    v_add_f32 v186, v186, v250
    v_add_f32 v187, v187, v251
    v_add_f32 v188, v188, v252
    v_add_f32 v189, v189, v253
    v_add_f32 v190, v190, v254
    v_add_f32 v191, v191, v255
    v_mul_f32 v184, v184, v152
    v_mul_f32 v185, v185, v153
    v_mul_f32 v186, v186, v154
    v_mul_f32 v187, v187, v155
    v_mul_f32 v188, v188, v156
    v_mul_f32 v189, v189, v157
    v_mul_f32 v190, v190, v158
    v_mul_f32 v191, v191, v159
    v_cvt_pk_bf16_f32 v184, v184, v185
    v_cvt_pk_bf16_f32 v185, v186, v187
    v_cvt_pk_bf16_f32 v186, v188, v189
    v_cvt_pk_bf16_f32 v187, v190, v191
    buffer_store_dwordx4 v[184:187], v12, s[28:31], s78 offen offset:256 sc1
    s_branch P4
P_sg1:
    ds_write_b128 v6, v[160:163] offset:0
    ds_write_b128 v6, v[164:167] offset:1024
    ds_write_b128 v6, v[168:171] offset:2048
    ds_write_b128 v6, v[172:175] offset:3072
    ds_write_b128 v6, v[176:179] offset:4096
    ds_write_b128 v6, v[180:183] offset:5120
    ds_write_b128 v6, v[184:187] offset:6144
    ds_write_b128 v6, v[188:191] offset:7168
    v_add_f32 v192, v192, v20
    v_add_f32 v193, v193, v20
    v_add_f32 v194, v194, v20
    v_add_f32 v195, v195, v20
    v_add_f32 v196, v196, v20
    v_add_f32 v197, v197, v20
    v_add_f32 v198, v198, v20
    v_add_f32 v199, v199, v20
    v_add_f32 v200, v200, v21
    v_add_f32 v201, v201, v21
    v_add_f32 v202, v202, v21
    v_add_f32 v203, v203, v21
    v_add_f32 v204, v204, v21
    v_add_f32 v205, v205, v21
    v_add_f32 v206, v206, v21
    v_add_f32 v207, v207, v21
    v_add_f32 v208, v208, v22
    v_add_f32 v209, v209, v22
    v_add_f32 v210, v210, v22
    v_add_f32 v211, v211, v22
    v_add_f32 v212, v212, v22
    v_add_f32 v213, v213, v22
    v_add_f32 v214, v214, v22
    v_add_f32 v215, v215, v22
    v_add_f32 v216, v216, v23
    v_add_f32 v217, v217, v23
    v_add_f32 v218, v218, v23
    v_add_f32 v219, v219, v23
    v_add_f32 v220, v220, v23
    v_add_f32 v221, v221, v23
    v_add_f32 v222, v222, v23
    v_add_f32 v223, v223, v23
    v_lshlrev_b32 v128, 16, v96
    v_and_b32 v129, 0xffff0000, v96
    v_lshlrev_b32 v130, 16, v97
    v_and_b32 v131, 0xffff0000, v97
    v_lshlrev_b32 v132, 16, v98
    v_and_b32 v133, 0xffff0000, v98
    v_lshlrev_b32 v134, 16, v99
    v_and_b32 v135, 0xffff0000, v99
    v_lshlrev_b32 v136, 16, v100
    v_and_b32 v137, 0xffff0000, v100
    v_lshlrev_b32 v138, 16, v101
    v_and_b32 v139, 0xffff0000, v101
    v_lshlrev_b32 v140, 16, v102
    v_and_b32 v141, 0xffff0000, v102
    v_lshlrev_b32 v142, 16, v103
    v_and_b32 v143, 0xffff0000, v103
    v_lshlrev_b32 v144, 16, v104
    v_and_b32 v145, 0xffff0000, v104
    v_lshlrev_b32 v146, 16, v105
    v_and_b32 v147, 0xffff0000, v105
    v_lshlrev_b32 v148, 16, v106
    v_and_b32 v149, 0xffff0000, v106
    v_lshlrev_b32 v150, 16, v107
    v_and_b32 v151, 0xffff0000, v107
    v_lshlrev_b32 v152, 16, v108
    v_and_b32 v153, 0xffff0000, v108
    v_lshlrev_b32 v154, 16, v109
    v_and_b32 v155, 0xffff0000, v109
    v_lshlrev_b32 v156, 16, v110
    v_and_b32 v157, 0xffff0000, v110
    v_lshlrev_b32 v158, 16, v111
    v_and_b32 v159, 0xffff0000, v111
    s_waitcnt lgkmcnt(0)
    s_barrier
    ds_read_b128 v[224:227], v7 offset:0
    ds_read_b128 v[228:231], v7 offset:1024
    ds_read_b128 v[232:235], v7 offset:2048
    ds_read_b128 v[236:239], v7 offset:3072
    ds_read_b128 v[240:243], v7 offset:4096
    ds_read_b128 v[244:247], v7 offset:5120
    ds_read_b128 v[248:251], v7 offset:6144
    ds_read_b128 v[252:255], v7 offset:7168
    s_waitcnt lgkmcnt(6)
    v_add_f32 v192, v192, v224
    v_add_f32 v193, v193, v225
    v_add_f32 v194, v194, v226
    v_add_f32 v195, v195, v227
    v_add_f32 v196, v196, v228
    v_add_f32 v197, v197, v229
    v_add_f32 v198, v198, v230
    v_add_f32 v199, v199, v231
    v_mul_f32 v192, v192, v128
    v_mul_f32 v193, v193, v129
    v_mul_f32 v194, v194, v130
    v_mul_f32 v195, v195, v131
    v_mul_f32 v196, v196, v132
    v_mul_f32 v197, v197, v133
    v_mul_f32 v198, v198, v134
    v_mul_f32 v199, v199, v135
    v_cvt_pk_bf16_f32 v192, v192, v193
    v_cvt_pk_bf16_f32 v193, v194, v195
    v_cvt_pk_bf16_f32 v194, v196, v197
    v_cvt_pk_bf16_f32 v195, v198, v199
    buffer_store_dwordx4 v[192:195], v12, s[28:31], s76 offen offset:0 sc1
    s_waitcnt lgkmcnt(4)
    v_add_f32 v200, v200, v232
    v_add_f32 v201, v201, v233
    v_add_f32 v202, v202, v234
    v_add_f32 v203, v203, v235
    v_add_f32 v204, v204, v236
    v_add_f32 v205, v205, v237
    v_add_f32 v206, v206, v238
    v_add_f32 v207, v207, v239
    v_mul_f32 v200, v200, v136
    v_mul_f32 v201, v201, v137
    v_mul_f32 v202, v202, v138
    v_mul_f32 v203, v203, v139
    v_mul_f32 v204, v204, v140
    v_mul_f32 v205, v205, v141
    v_mul_f32 v206, v206, v142
    v_mul_f32 v207, v207, v143
    v_cvt_pk_bf16_f32 v200, v200, v201
    v_cvt_pk_bf16_f32 v201, v202, v203
    v_cvt_pk_bf16_f32 v202, v204, v205
    v_cvt_pk_bf16_f32 v203, v206, v207
    buffer_store_dwordx4 v[200:203], v12, s[28:31], s76 offen offset:256 sc1
    s_waitcnt lgkmcnt(2)
    v_add_f32 v208, v208, v240
    v_add_f32 v209, v209, v241
    v_add_f32 v210, v210, v242
    v_add_f32 v211, v211, v243
    v_add_f32 v212, v212, v244
    v_add_f32 v213, v213, v245
    v_add_f32 v214, v214, v246
    v_add_f32 v215, v215, v247
    v_mul_f32 v208, v208, v144
    v_mul_f32 v209, v209, v145
    v_mul_f32 v210, v210, v146
    v_mul_f32 v211, v211, v147
    v_mul_f32 v212, v212, v148
    v_mul_f32 v213, v213, v149
    v_mul_f32 v214, v214, v150
    v_mul_f32 v215, v215, v151
    v_cvt_pk_bf16_f32 v208, v208, v209
    v_cvt_pk_bf16_f32 v209, v210, v211
    v_cvt_pk_bf16_f32 v210, v212, v213
    v_cvt_pk_bf16_f32 v211, v214, v215
    buffer_store_dwordx4 v[208:211], v12, s[28:31], s78 offen offset:0 sc1
    s_waitcnt lgkmcnt(0)
    v_add_f32 v216, v216, v248
    v_add_f32 v217, v217, v249
    v_add_f32 v218, v218, v250
    v_add_f32 v219, v219, v251
    v_add_f32 v220, v220, v252
    v_add_f32 v221, v221, v253
    v_add_f32 v222, v222, v254
    v_add_f32 v223, v223, v255
    v_mul_f32 v216, v216, v152
    v_mul_f32 v217, v217, v153
    v_mul_f32 v218, v218, v154
    v_mul_f32 v219, v219, v155
    v_mul_f32 v220, v220, v156
    v_mul_f32 v221, v221, v157
    v_mul_f32 v222, v222, v158
    v_mul_f32 v223, v223, v159
    v_cvt_pk_bf16_f32 v216, v216, v217
    v_cvt_pk_bf16_f32 v217, v218, v219
    v_cvt_pk_bf16_f32 v218, v220, v221
    v_cvt_pk_bf16_f32 v219, v222, v223
    buffer_store_dwordx4 v[216:219], v12, s[28:31], s78 offen offset:256 sc1
    s_branch P4
P_notsp:
    v_lshrrev_b32 v6, 2, v4
    v_lshlrev_b32 v7, 2, v5
    v_add_u32 v6, v6, v7
    v_and_b32 v7, 7, v6
    v_lshlrev_b32 v7, 5, v7
    v_lshlrev_b32 v6, 8, v6
    v_add_u32 v6, v6, v7
    v_and_b32 v7, 3, v1
    v_lshlrev_b32 v7, 3, v7
    v_add_u32 v8, v6, v7
    v_xor_b32 v13, 32, v8
    v_xor_b32 v14, 64, v8
    v_xor_b32 v15, 96, v8
    v_xor_b32 v16, 128, v8
    v_xor_b32 v17, 160, v8
    v_xor_b32 v18, 192, v8
    v_xor_b32 v19, 224, v8
    s_waitcnt vmcnt(0) lgkmcnt(0)
    s_barrier
    s_cmp_eq_u32 s56, 0
    s_cbranch_scc0 M_sig_325
    s_add_u32 s52, s14, 0x6400000
    s_addc_u32 s53, s15, 0
    s_mov_b32 s54, 0x4000
    s_mov_b32 s55, 0x00020000
    v_mov_b32 v9, s3
    v_mov_b32 v10, 0
    s_mov_b64 exec, 1
    buffer_store_dword v9, v10, s[52:55], s79 offen sc1
    s_mov_b64 exec, -1
M_sig_325:
    s_mov_b32 s51, -1
    s_cmp_ge_u32 s2, 240
    s_cbranch_scc1 P4
    s_add_u32 m0, s67, 0
    s_add_u32 s63, s74, 262144
    buffer_load_dwordx4 v3, s[16:19], s63 offen lds
    s_add_u32 m0, s67, 8192
    s_add_u32 s63, s74, 294912
    buffer_load_dwordx4 v3, s[16:19], s63 offen lds
    s_add_u32 m0, s67, 16384
    s_add_u32 s63, s74, 327680
    buffer_load_dwordx4 v3, s[16:19], s63 offen lds
    s_add_u32 m0, s67, 24576
    s_add_u32 s63, s74, 360448
    buffer_load_dwordx4 v3, s[16:19], s63 offen lds
    s_add_u32 m0, s67, 32768
    s_add_u32 s63, s74, 393216
    buffer_load_dwordx4 v3, s[16:19], s63 offen lds
    s_add_u32 m0, s67, 40960
    s_add_u32 s63, s74, 425984
    buffer_load_dwordx4 v3, s[16:19], s63 offen lds
    s_add_u32 m0, s67, 49152
    s_add_u32 s63, s74, 458752
    buffer_load_dwordx4 v3, s[16:19], s63 offen lds
    s_add_u32 m0, s67, 57344
    s_add_u32 s63, s74, 491520
    buffer_load_dwordx4 v3, s[16:19], s63 offen lds
    s_add_u32 m0, s67, 65536
    s_add_u32 s63, s74, 524288
    buffer_load_dwordx4 v3, s[16:19], s63 offen lds
    s_add_u32 m0, s67, 73728
    s_add_u32 s63, s74, 557056
    buffer_load_dwordx4 v3, s[16:19], s63 offen lds
    s_add_u32 m0, s67, 81920
    s_add_u32 s63, s74, 589824
    buffer_load_dwordx4 v3, s[16:19], s63 offen lds
    s_add_u32 m0, s67, 90112
    s_add_u32 s63, s74, 622592
    buffer_load_dwordx4 v3, s[16:19], s63 offen lds
    s_add_u32 s20, s14, 0x2000000
    s_addc_u32 s21, s15, 0
    s_mov_b32 s22, 0x1000000
    s_mov_b32 s23, 0x00020000
    s_add_u32 s24, s14, 0x4000000
    s_addc_u32 s25, s15, 0
    s_mov_b32 s26, 0x1000000
    s_mov_b32 s27, 0x00020000
    s_lshl_b32 s71, s65, 3
    s_add_u32 s71, s71, s56
    s_lshl_b32 s73, s71, 18
    s_lshl_b32 s69, s78, 16
    s_add_u32 s73, s73, s69
    s_sub_u32 s69, 7, s65
    s_min_u32 s69, s69, s65
    s_lshl_b32 s70, s78, 2
    s_add_u32 s69, s69, s70
    s_lshl_b32 s69, s69, 7
    s_add_u32 s51, s69, 12288
    v_add_u32 v20, 98304, v8
    v_add_u32 v21, 98304, v13
    v_add_u32 v22, 98304, v14
    v_add_u32 v23, 98304, v15
    v_add_u32 v24, 98304, v16
    v_add_u32 v25, 98304, v17
    v_add_u32 v26, 98304, v18
    v_add_u32 v27, 98304, v19
    s_cmp_eq_u32 s56, 0
    s_cbranch_scc0 M_poll_326
    s_add_u32 s52, s14, 0x6400000
    s_addc_u32 s53, s15, 0
    s_mov_b32 s54, 0x4000
    s_mov_b32 s55, 0x00020000
    s_mov_b32 s97, 0
    v_and_b32 v10, 15, v1
    v_lshlrev_b32 v10, 2, v10
M_pl_327:
    buffer_load_dword v9, v10, s[52:55], s51 offen sc1
    s_waitcnt vmcnt(0)
    v_cmp_ne_u32 vcc, s3, v9
    s_add_u32 s97, s97, 1
    s_cbranch_vccz M_pd_328
    s_cmp_ge_u32 s97, 0x40000
    s_cbranch_scc1 M_pd_328
    s_sleep 4
    s_branch M_pl_327
M_pd_328:
M_poll_326:
    s_barrier
    s_add_u32 s63, s73, 0
    buffer_load_dwordx4 v[224:227], v12, s[20:23], s63 offen sc1
    buffer_load_dwordx4 v[228:231], v12, s[20:23], s63 offen offset:256 sc1
    s_add_u32 s63, s73, 2048
    buffer_load_dwordx4 v[232:235], v12, s[20:23], s63 offen sc1
    buffer_load_dwordx4 v[236:239], v12, s[20:23], s63 offen offset:256 sc1
    s_add_u32 s63, s73, 4096
    buffer_load_dwordx4 v[240:243], v12, s[20:23], s63 offen sc1
    buffer_load_dwordx4 v[244:247], v12, s[20:23], s63 offen offset:256 sc1
    s_add_u32 s63, s73, 6144
    buffer_load_dwordx4 v[248:251], v12, s[20:23], s63 offen sc1
    buffer_load_dwordx4 v[252:255], v12, s[20:23], s63 offen offset:256 sc1
    s_add_u32 s63, s73, 8192
    buffer_load_dwordx4 v[128:131], v12, s[20:23], s63 offen sc1
    buffer_load_dwordx4 v[132:135], v12, s[20:23], s63 offen offset:256 sc1
    s_add_u32 s63, s73, 10240
    buffer_load_dwordx4 v[136:139], v12, s[20:23], s63 offen sc1
    buffer_load_dwordx4 v[140:143], v12, s[20:23], s63 offen offset:256 sc1
    s_add_u32 s63, s73, 12288
    buffer_load_dwordx4 v[144:147], v12, s[20:23], s63 offen sc1
    buffer_load_dwordx4 v[148:151], v12, s[20:23], s63 offen offset:256 sc1
    s_add_u32 s63, s73, 14336
    buffer_load_dwordx4 v[152:155], v12, s[20:23], s63 offen sc1
    buffer_load_dwordx4 v[156:159], v12, s[20:23], s63 offen offset:256 sc1
    ds_read_b64_tr_b16 v[32:33], v20 offset:0
    ds_read_b64_tr_b16 v[34:35], v20 offset:4096
    ds_read_b64_tr_b16 v[36:37], v21 offset:0
    ds_read_b64_tr_b16 v[38:39], v21 offset:4096
    ds_read_b64_tr_b16 v[40:41], v22 offset:0
    ds_read_b64_tr_b16 v[42:43], v22 offset:4096
    ds_read_b64_tr_b16 v[44:45], v23 offset:0
    ds_read_b64_tr_b16 v[46:47], v23 offset:4096
    ds_read_b64_tr_b16 v[48:49], v24 offset:0
    ds_read_b64_tr_b16 v[50:51], v24 offset:4096
    ds_read_b64_tr_b16 v[52:53], v25 offset:0
    ds_read_b64_tr_b16 v[54:55], v25 offset:4096
    s_waitcnt lgkmcnt(10)
    s_waitcnt vmcnt(8)
    v_mfma_f32_16x16x32_bf16 v[160:163], v[32:35], v[224:227], 0
    ds_read_b64_tr_b16 v[56:57], v26 offset:0
    ds_read_b64_tr_b16 v[58:59], v26 offset:4096
    v_mfma_f32_16x16x32_bf16 v[168:171], v[32:35], v[228:231], 0
    s_waitcnt lgkmcnt(10)
    v_mfma_f32_16x16x32_bf16 v[164:167], v[36:39], v[224:227], 0
    ds_read_b64_tr_b16 v[60:61], v27 offset:0
    ds_read_b64_tr_b16 v[62:63], v27 offset:4096
    v_mfma_f32_16x16x32_bf16 v[172:175], v[36:39], v[228:231], 0
    s_add_u32 s63, s73, 16384
    buffer_load_dwordx4 v[96:99], v12, s[20:23], s63 offen sc1
    buffer_load_dwordx4 v[100:103], v12, s[20:23], s63 offen offset:256 sc1
    s_waitcnt lgkmcnt(10)
    v_mfma_f32_16x16x32_bf16 v[176:179], v[40:43], v[224:227], 0
    ds_read_b64_tr_b16 v[32:33], v20 offset:8192
    ds_read_b64_tr_b16 v[34:35], v20 offset:12288
    v_mfma_f32_16x16x32_bf16 v[184:187], v[40:43], v[228:231], 0
    s_waitcnt lgkmcnt(10)
    v_mfma_f32_16x16x32_bf16 v[180:183], v[44:47], v[224:227], 0
    ds_read_b64_tr_b16 v[36:37], v21 offset:8192
    ds_read_b64_tr_b16 v[38:39], v21 offset:12288
    v_mfma_f32_16x16x32_bf16 v[188:191], v[44:47], v[228:231], 0
    s_add_u32 s63, s73, 18432
    buffer_load_dwordx4 v[104:107], v12, s[20:23], s63 offen sc1
    buffer_load_dwordx4 v[108:111], v12, s[20:23], s63 offen offset:256 sc1
    s_waitcnt lgkmcnt(10)
    v_mfma_f32_16x16x32_bf16 v[192:195], v[48:51], v[224:227], 0
    ds_read_b64_tr_b16 v[40:41], v22 offset:8192
    ds_read_b64_tr_b16 v[42:43], v22 offset:12288
    v_mfma_f32_16x16x32_bf16 v[200:203], v[48:51], v[228:231], 0
    s_waitcnt lgkmcnt(10)
    v_mfma_f32_16x16x32_bf16 v[196:199], v[52:55], v[224:227], 0
    ds_read_b64_tr_b16 v[44:45], v23 offset:8192
    ds_read_b64_tr_b16 v[46:47], v23 offset:12288
    v_mfma_f32_16x16x32_bf16 v[204:207], v[52:55], v[228:231], 0
    s_setprio 1
    s_add_u32 s63, s73, 20480
    buffer_load_dwordx4 v[112:115], v12, s[20:23], s63 offen sc1
    buffer_load_dwordx4 v[116:119], v12, s[20:23], s63 offen offset:256 sc1
    s_waitcnt lgkmcnt(10)
    v_mfma_f32_16x16x32_bf16 v[208:211], v[56:59], v[224:227], 0
    ds_read_b64_tr_b16 v[48:49], v24 offset:8192
    ds_read_b64_tr_b16 v[50:51], v24 offset:12288
    v_mfma_f32_16x16x32_bf16 v[216:219], v[56:59], v[228:231], 0
    s_waitcnt lgkmcnt(10)
    v_mfma_f32_16x16x32_bf16 v[212:215], v[60:63], v[224:227], 0
    ds_read_b64_tr_b16 v[52:53], v25 offset:8192
    ds_read_b64_tr_b16 v[54:55], v25 offset:12288
    v_mfma_f32_16x16x32_bf16 v[220:223], v[60:63], v[228:231], 0
    s_add_u32 s63, s73, 22528
    buffer_load_dwordx4 v[120:123], v12, s[20:23], s63 offen sc1
    buffer_load_dwordx4 v[124:127], v12, s[20:23], s63 offen offset:256 sc1
    s_waitcnt lgkmcnt(10)
    v_mfma_f32_16x16x32_bf16 v[160:163], v[32:35], v[232:235], v[160:163]
    ds_read_b64_tr_b16 v[56:57], v26 offset:8192
    ds_read_b64_tr_b16 v[58:59], v26 offset:12288
    v_mfma_f32_16x16x32_bf16 v[168:171], v[32:35], v[236:239], v[168:171]
    s_waitcnt lgkmcnt(10)
    v_mfma_f32_16x16x32_bf16 v[164:167], v[36:39], v[232:235], v[164:167]
    ds_read_b64_tr_b16 v[60:61], v27 offset:8192
    ds_read_b64_tr_b16 v[62:63], v27 offset:12288
    v_mfma_f32_16x16x32_bf16 v[172:175], v[36:39], v[236:239], v[172:175]
    s_add_u32 s63, s73, 24576
    buffer_load_dwordx4 v[64:67], v12, s[20:23], s63 offen sc1
    buffer_load_dwordx4 v[68:71], v12, s[20:23], s63 offen offset:256 sc1
    s_waitcnt lgkmcnt(10)
    v_mfma_f32_16x16x32_bf16 v[176:179], v[40:43], v[232:235], v[176:179]
    ds_read_b64_tr_b16 v[32:33], v20 offset:16384
    ds_read_b64_tr_b16 v[34:35], v20 offset:20480
    v_mfma_f32_16x16x32_bf16 v[184:187], v[40:43], v[236:239], v[184:187]
    s_waitcnt lgkmcnt(10)
    v_mfma_f32_16x16x32_bf16 v[180:183], v[44:47], v[232:235], v[180:183]
    ds_read_b64_tr_b16 v[36:37], v21 offset:16384
    ds_read_b64_tr_b16 v[38:39], v21 offset:20480
    v_mfma_f32_16x16x32_bf16 v[188:191], v[44:47], v[236:239], v[188:191]
    s_add_u32 s63, s73, 26624
    buffer_load_dwordx4 v[72:75], v12, s[20:23], s63 offen sc1
    buffer_load_dwordx4 v[76:79], v12, s[20:23], s63 offen offset:256 sc1
    s_waitcnt lgkmcnt(10)
    v_mfma_f32_16x16x32_bf16 v[192:195], v[48:51], v[232:235], v[192:195]
    ds_read_b64_tr_b16 v[40:41], v22 offset:16384
    ds_read_b64_tr_b16 v[42:43], v22 offset:20480
    v_mfma_f32_16x16x32_bf16 v[200:203], v[48:51], v[236:239], v[200:203]
    s_waitcnt lgkmcnt(10)
    v_mfma_f32_16x16x32_bf16 v[196:199], v[52:55], v[232:235], v[196:199]
    ds_read_b64_tr_b16 v[44:45], v23 offset:16384
    ds_read_b64_tr_b16 v[46:47], v23 offset:20480
    v_mfma_f32_16x16x32_bf16 v[204:207], v[52:55], v[236:239], v[204:207]
    s_add_u32 s63, s73, 28672
    buffer_load_dwordx4 v[80:83], v12, s[20:23], s63 offen sc1
    buffer_load_dwordx4 v[84:87], v12, s[20:23], s63 offen offset:256 sc1
    s_waitcnt lgkmcnt(10)
    v_mfma_f32_16x16x32_bf16 v[208:211], v[56:59], v[232:235], v[208:211]
    ds_read_b64_tr_b16 v[48:49], v24 offset:16384
    ds_read_b64_tr_b16 v[50:51], v24 offset:20480
    v_mfma_f32_16x16x32_bf16 v[216:219], v[56:59], v[236:239], v[216:219]
    s_waitcnt lgkmcnt(10)
    v_mfma_f32_16x16x32_bf16 v[212:215], v[60:63], v[232:235], v[212:215]
    ds_read_b64_tr_b16 v[52:53], v25 offset:16384
    ds_read_b64_tr_b16 v[54:55], v25 offset:20480
    v_mfma_f32_16x16x32_bf16 v[220:223], v[60:63], v[236:239], v[220:223]
    s_setprio 0
    s_add_u32 s63, s73, 30720
    buffer_load_dwordx4 v[88:91], v12, s[20:23], s63 offen sc1
    buffer_load_dwordx4 v[92:95], v12, s[20:23], s63 offen offset:256 sc1
    s_waitcnt lgkmcnt(10)
    v_mfma_f32_16x16x32_bf16 v[160:163], v[32:35], v[240:243], v[160:163]
    ds_read_b64_tr_b16 v[56:57], v26 offset:16384
    ds_read_b64_tr_b16 v[58:59], v26 offset:20480
    v_mfma_f32_16x16x32_bf16 v[168:171], v[32:35], v[244:247], v[168:171]
    s_waitcnt lgkmcnt(10)
    v_mfma_f32_16x16x32_bf16 v[164:167], v[36:39], v[240:243], v[164:167]
    ds_read_b64_tr_b16 v[60:61], v27 offset:16384
    ds_read_b64_tr_b16 v[62:63], v27 offset:20480
    v_mfma_f32_16x16x32_bf16 v[172:175], v[36:39], v[244:247], v[172:175]
    s_waitcnt lgkmcnt(10)
    v_mfma_f32_16x16x32_bf16 v[176:179], v[40:43], v[240:243], v[176:179]
    ds_read_b64_tr_b16 v[32:33], v20 offset:24576
    ds_read_b64_tr_b16 v[34:35], v20 offset:28672
    v_mfma_f32_16x16x32_bf16 v[184:187], v[40:43], v[244:247], v[184:187]
    s_waitcnt lgkmcnt(10)
    v_mfma_f32_16x16x32_bf16 v[180:183], v[44:47], v[240:243], v[180:183]
    ds_read_b64_tr_b16 v[36:37], v21 offset:24576
    ds_read_b64_tr_b16 v[38:39], v21 offset:28672
    v_mfma_f32_16x16x32_bf16 v[188:191], v[44:47], v[244:247], v[188:191]
    s_waitcnt lgkmcnt(10)
    v_mfma_f32_16x16x32_bf16 v[192:195], v[48:51], v[240:243], v[192:195]
    ds_read_b64_tr_b16 v[40:41], v22 offset:24576
    ds_read_b64_tr_b16 v[42:43], v22 offset:28672
    v_mfma_f32_16x16x32_bf16 v[200:203], v[48:51], v[244:247], v[200:203]
    s_waitcnt lgkmcnt(10)
    v_mfma_f32_16x16x32_bf16 v[196:199], v[52:55], v[240:243], v[196:199]
    ds_read_b64_tr_b16 v[44:45], v23 offset:24576
    ds_read_b64_tr_b16 v[46:47], v23 offset:28672
    v_mfma_f32_16x16x32_bf16 v[204:207], v[52:55], v[244:247], v[204:207]
    s_waitcnt lgkmcnt(10)
    v_mfma_f32_16x16x32_bf16 v[208:211], v[56:59], v[240:243], v[208:211]
    ds_read_b64_tr_b16 v[48:49], v24 offset:24576
    ds_read_b64_tr_b16 v[50:51], v24 offset:28672
    v_mfma_f32_16x16x32_bf16 v[216:219], v[56:59], v[244:247], v[216:219]
    s_waitcnt lgkmcnt(10)
    v_mfma_f32_16x16x32_bf16 v[212:215], v[60:63], v[240:243], v[212:215]
    ds_read_b64_tr_b16 v[52:53], v25 offset:24576
    ds_read_b64_tr_b16 v[54:55], v25 offset:28672
    v_mfma_f32_16x16x32_bf16 v[220:223], v[60:63], v[244:247], v[220:223]
    s_waitcnt lgkmcnt(10)
    v_mfma_f32_16x16x32_bf16 v[160:163], v[32:35], v[248:251], v[160:163]
    ds_read_b64_tr_b16 v[56:57], v26 offset:24576
    ds_read_b64_tr_b16 v[58:59], v26 offset:28672
    v_mfma_f32_16x16x32_bf16 v[168:171], v[32:35], v[252:255], v[168:171]
    s_waitcnt lgkmcnt(10)
    v_mfma_f32_16x16x32_bf16 v[164:167], v[36:39], v[248:251], v[164:167]
    ds_read_b64_tr_b16 v[60:61], v27 offset:24576
    ds_read_b64_tr_b16 v[62:63], v27 offset:28672
    v_mfma_f32_16x16x32_bf16 v[172:175], v[36:39], v[252:255], v[172:175]
    s_waitcnt lgkmcnt(10)
    v_mfma_f32_16x16x32_bf16 v[176:179], v[40:43], v[248:251], v[176:179]
    s_waitcnt lgkmcnt(0)
    s_waitcnt vmcnt(44)
    s_barrier
    s_setprio 2
    v_add_u32 v20, 131072, v8
    ds_read_b64_tr_b16 v[32:33], v20 offset:0
    ds_read_b64_tr_b16 v[34:35], v20 offset:4096
    v_mfma_f32_16x16x32_bf16 v[184:187], v[40:43], v[252:255], v[184:187]
    v_mfma_f32_16x16x32_bf16 v[180:183], v[44:47], v[248:251], v[180:183]
    v_add_u32 v21, 131072, v13
    ds_read_b64_tr_b16 v[36:37], v21 offset:0
    ds_read_b64_tr_b16 v[38:39], v21 offset:4096
    v_mfma_f32_16x16x32_bf16 v[188:191], v[44:47], v[252:255], v[188:191]
    s_add_u32 m0, s67, 98304
    s_add_u32 s63, s74, 655360
    buffer_load_dwordx4 v3, s[16:19], s63 offen lds
    v_mfma_f32_16x16x32_bf16 v[192:195], v[48:51], v[248:251], v[192:195]
    v_add_u32 v22, 131072, v14
    ds_read_b64_tr_b16 v[40:41], v22 offset:0
    ds_read_b64_tr_b16 v[42:43], v22 offset:4096
    v_mfma_f32_16x16x32_bf16 v[200:203], v[48:51], v[252:255], v[200:203]
    v_mfma_f32_16x16x32_bf16 v[196:199], v[52:55], v[248:251], v[196:199]
    v_add_u32 v23, 131072, v15
    ds_read_b64_tr_b16 v[44:45], v23 offset:0
    ds_read_b64_tr_b16 v[46:47], v23 offset:4096
    v_mfma_f32_16x16x32_bf16 v[204:207], v[52:55], v[252:255], v[204:207]
    s_add_u32 m0, s67, 106496
    s_add_u32 s63, s74, 688128
    buffer_load_dwordx4 v3, s[16:19], s63 offen lds
    v_mfma_f32_16x16x32_bf16 v[208:211], v[56:59], v[248:251], v[208:211]
    v_add_u32 v24, 131072, v16
    ds_read_b64_tr_b16 v[48:49], v24 offset:0
    ds_read_b64_tr_b16 v[50:51], v24 offset:4096
    v_mfma_f32_16x16x32_bf16 v[216:219], v[56:59], v[252:255], v[216:219]
    v_mfma_f32_16x16x32_bf16 v[212:215], v[60:63], v[248:251], v[212:215]
    v_add_u32 v25, 131072, v17
    ds_read_b64_tr_b16 v[52:53], v25 offset:0
    ds_read_b64_tr_b16 v[54:55], v25 offset:4096
    v_mfma_f32_16x16x32_bf16 v[220:223], v[60:63], v[252:255], v[220:223]
    s_add_u32 m0, s67, 114688
    s_add_u32 s63, s74, 720896
    buffer_load_dwordx4 v3, s[16:19], s63 offen lds
    s_waitcnt lgkmcnt(10)
    s_waitcnt vmcnt(19)
    v_mfma_f32_16x16x32_bf16 v[160:163], v[32:35], v[128:131], v[160:163]
    v_add_u32 v26, 131072, v18
    ds_read_b64_tr_b16 v[56:57], v26 offset:0
    ds_read_b64_tr_b16 v[58:59], v26 offset:4096
    v_mfma_f32_16x16x32_bf16 v[168:171], v[32:35], v[132:135], v[168:171]
    s_waitcnt lgkmcnt(10)
    v_mfma_f32_16x16x32_bf16 v[164:167], v[36:39], v[128:131], v[164:167]
    v_add_u32 v27, 131072, v19
    ds_read_b64_tr_b16 v[60:61], v27 offset:0
    ds_read_b64_tr_b16 v[62:63], v27 offset:4096
    v_mfma_f32_16x16x32_bf16 v[172:175], v[36:39], v[132:135], v[172:175]
    s_add_u32 m0, s67, 122880
    s_add_u32 s63, s74, 753664
    buffer_load_dwordx4 v3, s[16:19], s63 offen lds
    s_waitcnt lgkmcnt(10)
    v_mfma_f32_16x16x32_bf16 v[176:179], v[40:43], v[128:131], v[176:179]
    ds_read_b64_tr_b16 v[32:33], v20 offset:8192
    ds_read_b64_tr_b16 v[34:35], v20 offset:12288
    v_mfma_f32_16x16x32_bf16 v[184:187], v[40:43], v[132:135], v[184:187]
    s_waitcnt lgkmcnt(10)
    v_mfma_f32_16x16x32_bf16 v[180:183], v[44:47], v[128:131], v[180:183]
    ds_read_b64_tr_b16 v[36:37], v21 offset:8192
    ds_read_b64_tr_b16 v[38:39], v21 offset:12288
    v_mfma_f32_16x16x32_bf16 v[188:191], v[44:47], v[132:135], v[188:191]
    s_add_u32 s63, s73, 32768
    buffer_load_dwordx4 v[224:227], v12, s[20:23], s63 offen sc1
    buffer_load_dwordx4 v[228:231], v12, s[20:23], s63 offen offset:256 sc1
    s_waitcnt lgkmcnt(10)
    v_mfma_f32_16x16x32_bf16 v[192:195], v[48:51], v[128:131], v[192:195]
    ds_read_b64_tr_b16 v[40:41], v22 offset:8192
    ds_read_b64_tr_b16 v[42:43], v22 offset:12288
    v_mfma_f32_16x16x32_bf16 v[200:203], v[48:51], v[132:135], v[200:203]
    s_waitcnt lgkmcnt(10)
    v_mfma_f32_16x16x32_bf16 v[196:199], v[52:55], v[128:131], v[196:199]
    ds_read_b64_tr_b16 v[44:45], v23 offset:8192
    ds_read_b64_tr_b16 v[46:47], v23 offset:12288
    v_mfma_f32_16x16x32_bf16 v[204:207], v[52:55], v[132:135], v[204:207]
    s_setprio 1
    s_add_u32 s63, s73, 34816
    buffer_load_dwordx4 v[232:235], v12, s[20:23], s63 offen sc1
    buffer_load_dwordx4 v[236:239], v12, s[20:23], s63 offen offset:256 sc1
    s_waitcnt lgkmcnt(10)
    v_mfma_f32_16x16x32_bf16 v[208:211], v[56:59], v[128:131], v[208:211]
    ds_read_b64_tr_b16 v[48:49], v24 offset:8192
    ds_read_b64_tr_b16 v[50:51], v24 offset:12288
    v_mfma_f32_16x16x32_bf16 v[216:219], v[56:59], v[132:135], v[216:219]
    s_waitcnt lgkmcnt(10)
    v_mfma_f32_16x16x32_bf16 v[212:215], v[60:63], v[128:131], v[212:215]
    ds_read_b64_tr_b16 v[52:53], v25 offset:8192
    ds_read_b64_tr_b16 v[54:55], v25 offset:12288
    v_mfma_f32_16x16x32_bf16 v[220:223], v[60:63], v[132:135], v[220:223]
    s_add_u32 s63, s73, 36864
    buffer_load_dwordx4 v[240:243], v12, s[20:23], s63 offen sc1
    buffer_load_dwordx4 v[244:247], v12, s[20:23], s63 offen offset:256 sc1
    s_waitcnt lgkmcnt(10)
    v_mfma_f32_16x16x32_bf16 v[160:163], v[32:35], v[136:139], v[160:163]
    ds_read_b64_tr_b16 v[56:57], v26 offset:8192
    ds_read_b64_tr_b16 v[58:59], v26 offset:12288
    v_mfma_f32_16x16x32_bf16 v[168:171], v[32:35], v[140:143], v[168:171]
    s_waitcnt lgkmcnt(10)
    v_mfma_f32_16x16x32_bf16 v[164:167], v[36:39], v[136:139], v[164:167]
    ds_read_b64_tr_b16 v[60:61], v27 offset:8192
    ds_read_b64_tr_b16 v[62:63], v27 offset:12288
    v_mfma_f32_16x16x32_bf16 v[172:175], v[36:39], v[140:143], v[172:175]
    s_add_u32 s63, s73, 38912
    buffer_load_dwordx4 v[248:251], v12, s[20:23], s63 offen sc1
    buffer_load_dwordx4 v[252:255], v12, s[20:23], s63 offen offset:256 sc1
    s_waitcnt lgkmcnt(10)
    v_mfma_f32_16x16x32_bf16 v[176:179], v[40:43], v[136:139], v[176:179]
    ds_read_b64_tr_b16 v[32:33], v20 offset:16384
    ds_read_b64_tr_b16 v[34:35], v20 offset:20480
    v_mfma_f32_16x16x32_bf16 v[184:187], v[40:43], v[140:143], v[184:187]
    s_waitcnt lgkmcnt(10)
    v_mfma_f32_16x16x32_bf16 v[180:183], v[44:47], v[136:139], v[180:183]
    ds_read_b64_tr_b16 v[36:37], v21 offset:16384
    ds_read_b64_tr_b16 v[38:39], v21 offset:20480
    v_mfma_f32_16x16x32_bf16 v[188:191], v[44:47], v[140:143], v[188:191]
    s_waitcnt lgkmcnt(10)
    v_mfma_f32_16x16x32_bf16 v[192:195], v[48:51], v[136:139], v[192:195]
    ds_read_b64_tr_b16 v[40:41], v22 offset:16384
    ds_read_b64_tr_b16 v[42:43], v22 offset:20480
    v_mfma_f32_16x16x32_bf16 v[200:203], v[48:51], v[140:143], v[200:203]
    s_waitcnt lgkmcnt(10)
    v_mfma_f32_16x16x32_bf16 v[196:199], v[52:55], v[136:139], v[196:199]
    ds_read_b64_tr_b16 v[44:45], v23 offset:16384
    ds_read_b64_tr_b16 v[46:47], v23 offset:20480
    v_mfma_f32_16x16x32_bf16 v[204:207], v[52:55], v[140:143], v[204:207]
    s_waitcnt lgkmcnt(10)
    v_mfma_f32_16x16x32_bf16 v[208:211], v[56:59], v[136:139], v[208:211]
    ds_read_b64_tr_b16 v[48:49], v24 offset:16384
    ds_read_b64_tr_b16 v[50:51], v24 offset:20480
    v_mfma_f32_16x16x32_bf16 v[216:219], v[56:59], v[140:143], v[216:219]
    s_waitcnt lgkmcnt(10)
    v_mfma_f32_16x16x32_bf16 v[212:215], v[60:63], v[136:139], v[212:215]
    ds_read_b64_tr_b16 v[52:53], v25 offset:16384
    ds_read_b64_tr_b16 v[54:55], v25 offset:20480
    v_mfma_f32_16x16x32_bf16 v[220:223], v[60:63], v[140:143], v[220:223]
    s_setprio 0
    s_waitcnt lgkmcnt(10)
    v_mfma_f32_16x16x32_bf16 v[160:163], v[32:35], v[144:147], v[160:163]
    ds_read_b64_tr_b16 v[56:57], v26 offset:16384
    ds_read_b64_tr_b16 v[58:59], v26 offset:20480
    v_mfma_f32_16x16x32_bf16 v[168:171], v[32:35], v[148:151], v[168:171]
    s_waitcnt lgkmcnt(10)
    v_mfma_f32_16x16x32_bf16 v[164:167], v[36:39], v[144:147], v[164:167]
    ds_read_b64_tr_b16 v[60:61], v27 offset:16384
    ds_read_b64_tr_b16 v[62:63], v27 offset:20480
    v_mfma_f32_16x16x32_bf16 v[172:175], v[36:39], v[148:151], v[172:175]
    s_waitcnt lgkmcnt(10)
    v_mfma_f32_16x16x32_bf16 v[176:179], v[40:43], v[144:147], v[176:179]
    ds_read_b64_tr_b16 v[32:33], v20 offset:24576
    ds_read_b64_tr_b16 v[34:35], v20 offset:28672
    v_mfma_f32_16x16x32_bf16 v[184:187], v[40:43], v[148:151], v[184:187]
    s_waitcnt lgkmcnt(10)
    v_mfma_f32_16x16x32_bf16 v[180:183], v[44:47], v[144:147], v[180:183]
    ds_read_b64_tr_b16 v[36:37], v21 offset:24576
    ds_read_b64_tr_b16 v[38:39], v21 offset:28672
    v_mfma_f32_16x16x32_bf16 v[188:191], v[44:47], v[148:151], v[188:191]
    s_waitcnt lgkmcnt(10)
    v_mfma_f32_16x16x32_bf16 v[192:195], v[48:51], v[144:147], v[192:195]
    ds_read_b64_tr_b16 v[40:41], v22 offset:24576
    ds_read_b64_tr_b16 v[42:43], v22 offset:28672
    v_mfma_f32_16x16x32_bf16 v[200:203], v[48:51], v[148:151], v[200:203]
    s_waitcnt lgkmcnt(10)
    v_mfma_f32_16x16x32_bf16 v[196:199], v[52:55], v[144:147], v[196:199]
    ds_read_b64_tr_b16 v[44:45], v23 offset:24576
    ds_read_b64_tr_b16 v[46:47], v23 offset:28672
    v_mfma_f32_16x16x32_bf16 v[204:207], v[52:55], v[148:151], v[204:207]
    s_waitcnt lgkmcnt(10)
    v_mfma_f32_16x16x32_bf16 v[208:211], v[56:59], v[144:147], v[208:211]
    ds_read_b64_tr_b16 v[48:49], v24 offset:24576
    ds_read_b64_tr_b16 v[50:51], v24 offset:28672
    v_mfma_f32_16x16x32_bf16 v[216:219], v[56:59], v[148:151], v[216:219]
    s_waitcnt lgkmcnt(10)
    v_mfma_f32_16x16x32_bf16 v[212:215], v[60:63], v[144:147], v[212:215]
    ds_read_b64_tr_b16 v[52:53], v25 offset:24576
    ds_read_b64_tr_b16 v[54:55], v25 offset:28672
    v_mfma_f32_16x16x32_bf16 v[220:223], v[60:63], v[148:151], v[220:223]
    s_waitcnt lgkmcnt(10)
    v_mfma_f32_16x16x32_bf16 v[160:163], v[32:35], v[152:155], v[160:163]
    ds_read_b64_tr_b16 v[56:57], v26 offset:24576
    ds_read_b64_tr_b16 v[58:59], v26 offset:28672
    v_mfma_f32_16x16x32_bf16 v[168:171], v[32:35], v[156:159], v[168:171]
    s_waitcnt lgkmcnt(10)
    v_mfma_f32_16x16x32_bf16 v[164:167], v[36:39], v[152:155], v[164:167]
    ds_read_b64_tr_b16 v[60:61], v27 offset:24576
    ds_read_b64_tr_b16 v[62:63], v27 offset:28672
    v_mfma_f32_16x16x32_bf16 v[172:175], v[36:39], v[156:159], v[172:175]
    s_waitcnt lgkmcnt(10)
    v_mfma_f32_16x16x32_bf16 v[176:179], v[40:43], v[152:155], v[176:179]
    s_waitcnt lgkmcnt(0)
    s_waitcnt vmcnt(52)
    s_barrier
    s_setprio 2
    v_add_u32 v20, 0, v8
    ds_read_b64_tr_b16 v[32:33], v20 offset:0
    ds_read_b64_tr_b16 v[34:35], v20 offset:4096
    v_mfma_f32_16x16x32_bf16 v[184:187], v[40:43], v[156:159], v[184:187]
    v_mfma_f32_16x16x32_bf16 v[180:183], v[44:47], v[152:155], v[180:183]
    v_add_u32 v21, 0, v13
    ds_read_b64_tr_b16 v[36:37], v21 offset:0
    ds_read_b64_tr_b16 v[38:39], v21 offset:4096
    v_mfma_f32_16x16x32_bf16 v[188:191], v[44:47], v[156:159], v[188:191]
    s_add_u32 m0, s67, 131072
    s_add_u32 s63, s74, 786432
    buffer_load_dwordx4 v3, s[16:19], s63 offen lds
    v_mfma_f32_16x16x32_bf16 v[192:195], v[48:51], v[152:155], v[192:195]
    v_add_u32 v22, 0, v14
    ds_read_b64_tr_b16 v[40:41], v22 offset:0
    ds_read_b64_tr_b16 v[42:43], v22 offset:4096
    v_mfma_f32_16x16x32_bf16 v[200:203], v[48:51], v[156:159], v[200:203]
    v_mfma_f32_16x16x32_bf16 v[196:199], v[52:55], v[152:155], v[196:199]
    v_add_u32 v23, 0, v15
    ds_read_b64_tr_b16 v[44:45], v23 offset:0
    ds_read_b64_tr_b16 v[46:47], v23 offset:4096
    v_mfma_f32_16x16x32_bf16 v[204:207], v[52:55], v[156:159], v[204:207]
    s_add_u32 m0, s67, 139264
    s_add_u32 s63, s74, 819200
    buffer_load_dwordx4 v3, s[16:19], s63 offen lds
    v_mfma_f32_16x16x32_bf16 v[208:211], v[56:59], v[152:155], v[208:211]
    v_add_u32 v24, 0, v16
    ds_read_b64_tr_b16 v[48:49], v24 offset:0
    ds_read_b64_tr_b16 v[50:51], v24 offset:4096
    v_mfma_f32_16x16x32_bf16 v[216:219], v[56:59], v[156:159], v[216:219]
    v_mfma_f32_16x16x32_bf16 v[212:215], v[60:63], v[152:155], v[212:215]
    v_add_u32 v25, 0, v17
    ds_read_b64_tr_b16 v[52:53], v25 offset:0
    ds_read_b64_tr_b16 v[54:55], v25 offset:4096
    v_mfma_f32_16x16x32_bf16 v[220:223], v[60:63], v[156:159], v[220:223]
    s_add_u32 m0, s67, 147456
    s_add_u32 s63, s74, 851968
    buffer_load_dwordx4 v3, s[16:19], s63 offen lds
    s_waitcnt lgkmcnt(10)
    s_waitcnt vmcnt(23)
    v_mfma_f32_16x16x32_bf16 v[160:163], v[32:35], v[96:99], v[160:163]
    v_add_u32 v26, 0, v18
    ds_read_b64_tr_b16 v[56:57], v26 offset:0
    ds_read_b64_tr_b16 v[58:59], v26 offset:4096
    v_mfma_f32_16x16x32_bf16 v[168:171], v[32:35], v[100:103], v[168:171]
    s_waitcnt lgkmcnt(10)
    v_mfma_f32_16x16x32_bf16 v[164:167], v[36:39], v[96:99], v[164:167]
    v_add_u32 v27, 0, v19
    ds_read_b64_tr_b16 v[60:61], v27 offset:0
    ds_read_b64_tr_b16 v[62:63], v27 offset:4096
    v_mfma_f32_16x16x32_bf16 v[172:175], v[36:39], v[100:103], v[172:175]
    s_add_u32 m0, s67, 155648
    s_add_u32 s63, s74, 884736
    buffer_load_dwordx4 v3, s[16:19], s63 offen lds
    s_waitcnt lgkmcnt(10)
    v_mfma_f32_16x16x32_bf16 v[176:179], v[40:43], v[96:99], v[176:179]
    ds_read_b64_tr_b16 v[32:33], v20 offset:8192
    ds_read_b64_tr_b16 v[34:35], v20 offset:12288
    v_mfma_f32_16x16x32_bf16 v[184:187], v[40:43], v[100:103], v[184:187]
    s_waitcnt lgkmcnt(10)
    v_mfma_f32_16x16x32_bf16 v[180:183], v[44:47], v[96:99], v[180:183]
    ds_read_b64_tr_b16 v[36:37], v21 offset:8192
    ds_read_b64_tr_b16 v[38:39], v21 offset:12288
    v_mfma_f32_16x16x32_bf16 v[188:191], v[44:47], v[100:103], v[188:191]
    s_add_u32 s63, s73, 40960
    buffer_load_dwordx4 v[128:131], v12, s[20:23], s63 offen sc1
    buffer_load_dwordx4 v[132:135], v12, s[20:23], s63 offen offset:256 sc1
    s_waitcnt lgkmcnt(10)
    v_mfma_f32_16x16x32_bf16 v[192:195], v[48:51], v[96:99], v[192:195]
    ds_read_b64_tr_b16 v[40:41], v22 offset:8192
    ds_read_b64_tr_b16 v[42:43], v22 offset:12288
    v_mfma_f32_16x16x32_bf16 v[200:203], v[48:51], v[100:103], v[200:203]
    s_waitcnt lgkmcnt(10)
    v_mfma_f32_16x16x32_bf16 v[196:199], v[52:55], v[96:99], v[196:199]
    ds_read_b64_tr_b16 v[44:45], v23 offset:8192
    ds_read_b64_tr_b16 v[46:47], v23 offset:12288
    v_mfma_f32_16x16x32_bf16 v[204:207], v[52:55], v[100:103], v[204:207]
    s_setprio 1
    s_add_u32 s63, s73, 43008
    buffer_load_dwordx4 v[136:139], v12, s[20:23], s63 offen sc1
    buffer_load_dwordx4 v[140:143], v12, s[20:23], s63 offen offset:256 sc1
    s_waitcnt lgkmcnt(10)
    v_mfma_f32_16x16x32_bf16 v[208:211], v[56:59], v[96:99], v[208:211]
    ds_read_b64_tr_b16 v[48:49], v24 offset:8192
    ds_read_b64_tr_b16 v[50:51], v24 offset:12288
    v_mfma_f32_16x16x32_bf16 v[216:219], v[56:59], v[100:103], v[216:219]
    s_waitcnt lgkmcnt(10)
    v_mfma_f32_16x16x32_bf16 v[212:215], v[60:63], v[96:99], v[212:215]
    ds_read_b64_tr_b16 v[52:53], v25 offset:8192
    ds_read_b64_tr_b16 v[54:55], v25 offset:12288
    v_mfma_f32_16x16x32_bf16 v[220:223], v[60:63], v[100:103], v[220:223]
    s_add_u32 s63, s73, 45056
    buffer_load_dwordx4 v[144:147], v12, s[20:23], s63 offen sc1
    buffer_load_dwordx4 v[148:151], v12, s[20:23], s63 offen offset:256 sc1
    s_waitcnt lgkmcnt(10)
    v_mfma_f32_16x16x32_bf16 v[160:163], v[32:35], v[104:107], v[160:163]
    ds_read_b64_tr_b16 v[56:57], v26 offset:8192
    ds_read_b64_tr_b16 v[58:59], v26 offset:12288
    v_mfma_f32_16x16x32_bf16 v[168:171], v[32:35], v[108:111], v[168:171]
    s_waitcnt lgkmcnt(10)
    v_mfma_f32_16x16x32_bf16 v[164:167], v[36:39], v[104:107], v[164:167]
    ds_read_b64_tr_b16 v[60:61], v27 offset:8192
    ds_read_b64_tr_b16 v[62:63], v27 offset:12288
    v_mfma_f32_16x16x32_bf16 v[172:175], v[36:39], v[108:111], v[172:175]
    s_add_u32 s63, s73, 47104
    buffer_load_dwordx4 v[152:155], v12, s[20:23], s63 offen sc1
    buffer_load_dwordx4 v[156:159], v12, s[20:23], s63 offen offset:256 sc1
    s_waitcnt lgkmcnt(10)
    v_mfma_f32_16x16x32_bf16 v[176:179], v[40:43], v[104:107], v[176:179]
    ds_read_b64_tr_b16 v[32:33], v20 offset:16384
    ds_read_b64_tr_b16 v[34:35], v20 offset:20480
    v_mfma_f32_16x16x32_bf16 v[184:187], v[40:43], v[108:111], v[184:187]
    s_waitcnt lgkmcnt(10)
    v_mfma_f32_16x16x32_bf16 v[180:183], v[44:47], v[104:107], v[180:183]
    ds_read_b64_tr_b16 v[36:37], v21 offset:16384
    ds_read_b64_tr_b16 v[38:39], v21 offset:20480
    v_mfma_f32_16x16x32_bf16 v[188:191], v[44:47], v[108:111], v[188:191]
    s_waitcnt lgkmcnt(10)
    v_mfma_f32_16x16x32_bf16 v[192:195], v[48:51], v[104:107], v[192:195]
    ds_read_b64_tr_b16 v[40:41], v22 offset:16384
    ds_read_b64_tr_b16 v[42:43], v22 offset:20480
    v_mfma_f32_16x16x32_bf16 v[200:203], v[48:51], v[108:111], v[200:203]
    s_waitcnt lgkmcnt(10)
    v_mfma_f32_16x16x32_bf16 v[196:199], v[52:55], v[104:107], v[196:199]
    ds_read_b64_tr_b16 v[44:45], v23 offset:16384
    ds_read_b64_tr_b16 v[46:47], v23 offset:20480
    v_mfma_f32_16x16x32_bf16 v[204:207], v[52:55], v[108:111], v[204:207]
    s_waitcnt lgkmcnt(10)
    v_mfma_f32_16x16x32_bf16 v[208:211], v[56:59], v[104:107], v[208:211]
    ds_read_b64_tr_b16 v[48:49], v24 offset:16384
    ds_read_b64_tr_b16 v[50:51], v24 offset:20480
    v_mfma_f32_16x16x32_bf16 v[216:219], v[56:59], v[108:111], v[216:219]
    s_waitcnt lgkmcnt(10)
    v_mfma_f32_16x16x32_bf16 v[212:215], v[60:63], v[104:107], v[212:215]
    ds_read_b64_tr_b16 v[52:53], v25 offset:16384
    ds_read_b64_tr_b16 v[54:55], v25 offset:20480
    v_mfma_f32_16x16x32_bf16 v[220:223], v[60:63], v[108:111], v[220:223]
    s_setprio 0
    s_waitcnt lgkmcnt(10)
    v_mfma_f32_16x16x32_bf16 v[160:163], v[32:35], v[112:115], v[160:163]
    ds_read_b64_tr_b16 v[56:57], v26 offset:16384
    ds_read_b64_tr_b16 v[58:59], v26 offset:20480
    v_mfma_f32_16x16x32_bf16 v[168:171], v[32:35], v[116:119], v[168:171]
    s_waitcnt lgkmcnt(10)
    v_mfma_f32_16x16x32_bf16 v[164:167], v[36:39], v[112:115], v[164:167]
    ds_read_b64_tr_b16 v[60:61], v27 offset:16384
    ds_read_b64_tr_b16 v[62:63], v27 offset:20480
    v_mfma_f32_16x16x32_bf16 v[172:175], v[36:39], v[116:119], v[172:175]
    s_waitcnt lgkmcnt(10)
    v_mfma_f32_16x16x32_bf16 v[176:179], v[40:43], v[112:115], v[176:179]
    ds_read_b64_tr_b16 v[32:33], v20 offset:24576
    ds_read_b64_tr_b16 v[34:35], v20 offset:28672
    v_mfma_f32_16x16x32_bf16 v[184:187], v[40:43], v[116:119], v[184:187]
    s_waitcnt lgkmcnt(10)
    v_mfma_f32_16x16x32_bf16 v[180:183], v[44:47], v[112:115], v[180:183]
    ds_read_b64_tr_b16 v[36:37], v21 offset:24576
    ds_read_b64_tr_b16 v[38:39], v21 offset:28672
    v_mfma_f32_16x16x32_bf16 v[188:191], v[44:47], v[116:119], v[188:191]
    s_waitcnt lgkmcnt(10)
    v_mfma_f32_16x16x32_bf16 v[192:195], v[48:51], v[112:115], v[192:195]
    ds_read_b64_tr_b16 v[40:41], v22 offset:24576
    ds_read_b64_tr_b16 v[42:43], v22 offset:28672
    v_mfma_f32_16x16x32_bf16 v[200:203], v[48:51], v[116:119], v[200:203]
    s_waitcnt lgkmcnt(10)
    v_mfma_f32_16x16x32_bf16 v[196:199], v[52:55], v[112:115], v[196:199]
    ds_read_b64_tr_b16 v[44:45], v23 offset:24576
    ds_read_b64_tr_b16 v[46:47], v23 offset:28672
    v_mfma_f32_16x16x32_bf16 v[204:207], v[52:55], v[116:119], v[204:207]
    s_waitcnt lgkmcnt(10)
    v_mfma_f32_16x16x32_bf16 v[208:211], v[56:59], v[112:115], v[208:211]
    ds_read_b64_tr_b16 v[48:49], v24 offset:24576
    ds_read_b64_tr_b16 v[50:51], v24 offset:28672
    v_mfma_f32_16x16x32_bf16 v[216:219], v[56:59], v[116:119], v[216:219]
    s_waitcnt lgkmcnt(10)
    v_mfma_f32_16x16x32_bf16 v[212:215], v[60:63], v[112:115], v[212:215]
    ds_read_b64_tr_b16 v[52:53], v25 offset:24576
    ds_read_b64_tr_b16 v[54:55], v25 offset:28672
    v_mfma_f32_16x16x32_bf16 v[220:223], v[60:63], v[116:119], v[220:223]
    s_waitcnt lgkmcnt(10)
    v_mfma_f32_16x16x32_bf16 v[160:163], v[32:35], v[120:123], v[160:163]
    ds_read_b64_tr_b16 v[56:57], v26 offset:24576
    ds_read_b64_tr_b16 v[58:59], v26 offset:28672
    v_mfma_f32_16x16x32_bf16 v[168:171], v[32:35], v[124:127], v[168:171]
    s_waitcnt lgkmcnt(10)
    v_mfma_f32_16x16x32_bf16 v[164:167], v[36:39], v[120:123], v[164:167]
    ds_read_b64_tr_b16 v[60:61], v27 offset:24576
    ds_read_b64_tr_b16 v[62:63], v27 offset:28672
    v_mfma_f32_16x16x32_bf16 v[172:175], v[36:39], v[124:127], v[172:175]
    s_waitcnt lgkmcnt(10)
    v_mfma_f32_16x16x32_bf16 v[176:179], v[40:43], v[120:123], v[176:179]
    s_waitcnt lgkmcnt(0)
    s_waitcnt vmcnt(60)
    s_barrier
    s_setprio 2
    v_add_u32 v20, 32768, v8
    ds_read_b64_tr_b16 v[32:33], v20 offset:0
    ds_read_b64_tr_b16 v[34:35], v20 offset:4096
    v_mfma_f32_16x16x32_bf16 v[184:187], v[40:43], v[124:127], v[184:187]
    v_mfma_f32_16x16x32_bf16 v[180:183], v[44:47], v[120:123], v[180:183]
    v_add_u32 v21, 32768, v13
    ds_read_b64_tr_b16 v[36:37], v21 offset:0
    ds_read_b64_tr_b16 v[38:39], v21 offset:4096
    v_mfma_f32_16x16x32_bf16 v[188:191], v[44:47], v[124:127], v[188:191]
    s_add_u32 m0, s67, 0
    s_add_u32 s63, s74, 917504
    buffer_load_dwordx4 v3, s[16:19], s63 offen lds
    v_mfma_f32_16x16x32_bf16 v[192:195], v[48:51], v[120:123], v[192:195]
    v_add_u32 v22, 32768, v14
    ds_read_b64_tr_b16 v[40:41], v22 offset:0
    ds_read_b64_tr_b16 v[42:43], v22 offset:4096
    v_mfma_f32_16x16x32_bf16 v[200:203], v[48:51], v[124:127], v[200:203]
    v_mfma_f32_16x16x32_bf16 v[196:199], v[52:55], v[120:123], v[196:199]
    v_add_u32 v23, 32768, v15
    ds_read_b64_tr_b16 v[44:45], v23 offset:0
    ds_read_b64_tr_b16 v[46:47], v23 offset:4096
    v_mfma_f32_16x16x32_bf16 v[204:207], v[52:55], v[124:127], v[204:207]
    s_add_u32 m0, s67, 8192
    s_add_u32 s63, s74, 950272
    buffer_load_dwordx4 v3, s[16:19], s63 offen lds
    v_mfma_f32_16x16x32_bf16 v[208:211], v[56:59], v[120:123], v[208:211]
    v_add_u32 v24, 32768, v16
    ds_read_b64_tr_b16 v[48:49], v24 offset:0
    ds_read_b64_tr_b16 v[50:51], v24 offset:4096
    v_mfma_f32_16x16x32_bf16 v[216:219], v[56:59], v[124:127], v[216:219]
    v_mfma_f32_16x16x32_bf16 v[212:215], v[60:63], v[120:123], v[212:215]
    v_add_u32 v25, 32768, v17
    ds_read_b64_tr_b16 v[52:53], v25 offset:0
    ds_read_b64_tr_b16 v[54:55], v25 offset:4096
    v_mfma_f32_16x16x32_bf16 v[220:223], v[60:63], v[124:127], v[220:223]
    s_add_u32 m0, s67, 16384
    s_add_u32 s63, s74, 983040
    buffer_load_dwordx4 v3, s[16:19], s63 offen lds
    s_waitcnt lgkmcnt(10)
    s_waitcnt vmcnt(27)
    v_mfma_f32_16x16x32_bf16 v[160:163], v[32:35], v[64:67], v[160:163]
    v_add_u32 v26, 32768, v18
    ds_read_b64_tr_b16 v[56:57], v26 offset:0
    ds_read_b64_tr_b16 v[58:59], v26 offset:4096
    v_mfma_f32_16x16x32_bf16 v[168:171], v[32:35], v[68:71], v[168:171]
    s_waitcnt lgkmcnt(10)
    v_mfma_f32_16x16x32_bf16 v[164:167], v[36:39], v[64:67], v[164:167]
    v_add_u32 v27, 32768, v19
    ds_read_b64_tr_b16 v[60:61], v27 offset:0
    ds_read_b64_tr_b16 v[62:63], v27 offset:4096
    v_mfma_f32_16x16x32_bf16 v[172:175], v[36:39], v[68:71], v[172:175]
    s_add_u32 m0, s67, 24576
    s_add_u32 s63, s74, 1015808
    buffer_load_dwordx4 v3, s[16:19], s63 offen lds
    s_waitcnt lgkmcnt(10)
    v_mfma_f32_16x16x32_bf16 v[176:179], v[40:43], v[64:67], v[176:179]
    ds_read_b64_tr_b16 v[32:33], v20 offset:8192
    ds_read_b64_tr_b16 v[34:35], v20 offset:12288
    v_mfma_f32_16x16x32_bf16 v[184:187], v[40:43], v[68:71], v[184:187]
    s_waitcnt lgkmcnt(10)
    v_mfma_f32_16x16x32_bf16 v[180:183], v[44:47], v[64:67], v[180:183]
    ds_read_b64_tr_b16 v[36:37], v21 offset:8192
    ds_read_b64_tr_b16 v[38:39], v21 offset:12288
    v_mfma_f32_16x16x32_bf16 v[188:191], v[44:47], v[68:71], v[188:191]
    s_add_u32 s63, s73, 49152
    buffer_load_dwordx4 v[96:99], v12, s[20:23], s63 offen sc1
    buffer_load_dwordx4 v[100:103], v12, s[20:23], s63 offen offset:256 sc1
    s_waitcnt lgkmcnt(10)
    v_mfma_f32_16x16x32_bf16 v[192:195], v[48:51], v[64:67], v[192:195]
    ds_read_b64_tr_b16 v[40:41], v22 offset:8192
    ds_read_b64_tr_b16 v[42:43], v22 offset:12288
    v_mfma_f32_16x16x32_bf16 v[200:203], v[48:51], v[68:71], v[200:203]
    s_waitcnt lgkmcnt(10)
    v_mfma_f32_16x16x32_bf16 v[196:199], v[52:55], v[64:67], v[196:199]
    ds_read_b64_tr_b16 v[44:45], v23 offset:8192
    ds_read_b64_tr_b16 v[46:47], v23 offset:12288
    v_mfma_f32_16x16x32_bf16 v[204:207], v[52:55], v[68:71], v[204:207]
    s_setprio 1
    s_add_u32 s63, s73, 51200
    buffer_load_dwordx4 v[104:107], v12, s[20:23], s63 offen sc1
    buffer_load_dwordx4 v[108:111], v12, s[20:23], s63 offen offset:256 sc1
    s_waitcnt lgkmcnt(10)
    v_mfma_f32_16x16x32_bf16 v[208:211], v[56:59], v[64:67], v[208:211]
    ds_read_b64_tr_b16 v[48:49], v24 offset:8192
    ds_read_b64_tr_b16 v[50:51], v24 offset:12288
    v_mfma_f32_16x16x32_bf16 v[216:219], v[56:59], v[68:71], v[216:219]
    s_waitcnt lgkmcnt(10)
    v_mfma_f32_16x16x32_bf16 v[212:215], v[60:63], v[64:67], v[212:215]
    ds_read_b64_tr_b16 v[52:53], v25 offset:8192
    ds_read_b64_tr_b16 v[54:55], v25 offset:12288
    v_mfma_f32_16x16x32_bf16 v[220:223], v[60:63], v[68:71], v[220:223]
    s_add_u32 s63, s73, 53248
    buffer_load_dwordx4 v[112:115], v12, s[20:23], s63 offen sc1
    buffer_load_dwordx4 v[116:119], v12, s[20:23], s63 offen offset:256 sc1
    s_waitcnt lgkmcnt(10)
    v_mfma_f32_16x16x32_bf16 v[160:163], v[32:35], v[72:75], v[160:163]
    ds_read_b64_tr_b16 v[56:57], v26 offset:8192
    ds_read_b64_tr_b16 v[58:59], v26 offset:12288
    v_mfma_f32_16x16x32_bf16 v[168:171], v[32:35], v[76:79], v[168:171]
    s_waitcnt lgkmcnt(10)
    v_mfma_f32_16x16x32_bf16 v[164:167], v[36:39], v[72:75], v[164:167]
    ds_read_b64_tr_b16 v[60:61], v27 offset:8192
    ds_read_b64_tr_b16 v[62:63], v27 offset:12288
    v_mfma_f32_16x16x32_bf16 v[172:175], v[36:39], v[76:79], v[172:175]
    s_add_u32 s63, s73, 55296
    buffer_load_dwordx4 v[120:123], v12, s[20:23], s63 offen sc1
    buffer_load_dwordx4 v[124:127], v12, s[20:23], s63 offen offset:256 sc1
    s_waitcnt lgkmcnt(10)
    v_mfma_f32_16x16x32_bf16 v[176:179], v[40:43], v[72:75], v[176:179]
    ds_read_b64_tr_b16 v[32:33], v20 offset:16384
    ds_read_b64_tr_b16 v[34:35], v20 offset:20480
    v_mfma_f32_16x16x32_bf16 v[184:187], v[40:43], v[76:79], v[184:187]
    s_waitcnt lgkmcnt(10)
    v_mfma_f32_16x16x32_bf16 v[180:183], v[44:47], v[72:75], v[180:183]
    ds_read_b64_tr_b16 v[36:37], v21 offset:16384
    ds_read_b64_tr_b16 v[38:39], v21 offset:20480
    v_mfma_f32_16x16x32_bf16 v[188:191], v[44:47], v[76:79], v[188:191]
    s_waitcnt lgkmcnt(10)
    v_mfma_f32_16x16x32_bf16 v[192:195], v[48:51], v[72:75], v[192:195]
    ds_read_b64_tr_b16 v[40:41], v22 offset:16384
    ds_read_b64_tr_b16 v[42:43], v22 offset:20480
    v_mfma_f32_16x16x32_bf16 v[200:203], v[48:51], v[76:79], v[200:203]
    s_waitcnt lgkmcnt(10)
    v_mfma_f32_16x16x32_bf16 v[196:199], v[52:55], v[72:75], v[196:199]
    ds_read_b64_tr_b16 v[44:45], v23 offset:16384
    ds_read_b64_tr_b16 v[46:47], v23 offset:20480
    v_mfma_f32_16x16x32_bf16 v[204:207], v[52:55], v[76:79], v[204:207]
    s_waitcnt lgkmcnt(10)
    v_mfma_f32_16x16x32_bf16 v[208:211], v[56:59], v[72:75], v[208:211]
    ds_read_b64_tr_b16 v[48:49], v24 offset:16384
    ds_read_b64_tr_b16 v[50:51], v24 offset:20480
    v_mfma_f32_16x16x32_bf16 v[216:219], v[56:59], v[76:79], v[216:219]
    s_waitcnt lgkmcnt(10)
    v_mfma_f32_16x16x32_bf16 v[212:215], v[60:63], v[72:75], v[212:215]
    ds_read_b64_tr_b16 v[52:53], v25 offset:16384
    ds_read_b64_tr_b16 v[54:55], v25 offset:20480
    v_mfma_f32_16x16x32_bf16 v[220:223], v[60:63], v[76:79], v[220:223]
    s_setprio 0
    s_waitcnt lgkmcnt(10)
    v_mfma_f32_16x16x32_bf16 v[160:163], v[32:35], v[80:83], v[160:163]
    ds_read_b64_tr_b16 v[56:57], v26 offset:16384
    ds_read_b64_tr_b16 v[58:59], v26 offset:20480
    v_mfma_f32_16x16x32_bf16 v[168:171], v[32:35], v[84:87], v[168:171]
    s_waitcnt lgkmcnt(10)
    v_mfma_f32_16x16x32_bf16 v[164:167], v[36:39], v[80:83], v[164:167]
    ds_read_b64_tr_b16 v[60:61], v27 offset:16384
    ds_read_b64_tr_b16 v[62:63], v27 offset:20480
    v_mfma_f32_16x16x32_bf16 v[172:175], v[36:39], v[84:87], v[172:175]
    s_waitcnt lgkmcnt(10)
    v_mfma_f32_16x16x32_bf16 v[176:179], v[40:43], v[80:83], v[176:179]
    ds_read_b64_tr_b16 v[32:33], v20 offset:24576
    ds_read_b64_tr_b16 v[34:35], v20 offset:28672
    v_mfma_f32_16x16x32_bf16 v[184:187], v[40:43], v[84:87], v[184:187]
    s_waitcnt lgkmcnt(10)
    v_mfma_f32_16x16x32_bf16 v[180:183], v[44:47], v[80:83], v[180:183]
    ds_read_b64_tr_b16 v[36:37], v21 offset:24576
    ds_read_b64_tr_b16 v[38:39], v21 offset:28672
    v_mfma_f32_16x16x32_bf16 v[188:191], v[44:47], v[84:87], v[188:191]
    s_waitcnt lgkmcnt(10)
    v_mfma_f32_16x16x32_bf16 v[192:195], v[48:51], v[80:83], v[192:195]
    ds_read_b64_tr_b16 v[40:41], v22 offset:24576
    ds_read_b64_tr_b16 v[42:43], v22 offset:28672
    v_mfma_f32_16x16x32_bf16 v[200:203], v[48:51], v[84:87], v[200:203]
    s_waitcnt lgkmcnt(10)
    v_mfma_f32_16x16x32_bf16 v[196:199], v[52:55], v[80:83], v[196:199]
    ds_read_b64_tr_b16 v[44:45], v23 offset:24576
    ds_read_b64_tr_b16 v[46:47], v23 offset:28672
    v_mfma_f32_16x16x32_bf16 v[204:207], v[52:55], v[84:87], v[204:207]
    s_waitcnt lgkmcnt(10)
    v_mfma_f32_16x16x32_bf16 v[208:211], v[56:59], v[80:83], v[208:211]
    ds_read_b64_tr_b16 v[48:49], v24 offset:24576
    ds_read_b64_tr_b16 v[50:51], v24 offset:28672
    v_mfma_f32_16x16x32_bf16 v[216:219], v[56:59], v[84:87], v[216:219]
    s_waitcnt lgkmcnt(10)
    v_mfma_f32_16x16x32_bf16 v[212:215], v[60:63], v[80:83], v[212:215]
    ds_read_b64_tr_b16 v[52:53], v25 offset:24576
    ds_read_b64_tr_b16 v[54:55], v25 offset:28672
    v_mfma_f32_16x16x32_bf16 v[220:223], v[60:63], v[84:87], v[220:223]
    s_waitcnt lgkmcnt(10)
    v_mfma_f32_16x16x32_bf16 v[160:163], v[32:35], v[88:91], v[160:163]
    ds_read_b64_tr_b16 v[56:57], v26 offset:24576
    ds_read_b64_tr_b16 v[58:59], v26 offset:28672
    v_mfma_f32_16x16x32_bf16 v[168:171], v[32:35], v[92:95], v[168:171]
    s_waitcnt lgkmcnt(10)
    v_mfma_f32_16x16x32_bf16 v[164:167], v[36:39], v[88:91], v[164:167]
    ds_read_b64_tr_b16 v[60:61], v27 offset:24576
    ds_read_b64_tr_b16 v[62:63], v27 offset:28672
    v_mfma_f32_16x16x32_bf16 v[172:175], v[36:39], v[92:95], v[172:175]
    s_waitcnt lgkmcnt(10)
    v_mfma_f32_16x16x32_bf16 v[176:179], v[40:43], v[88:91], v[176:179]
    s_waitcnt lgkmcnt(0)
    s_waitcnt vmcnt(63)
    s_barrier
    s_setprio 2
    v_add_u32 v20, 65536, v8
    ds_read_b64_tr_b16 v[32:33], v20 offset:0
    ds_read_b64_tr_b16 v[34:35], v20 offset:4096
    v_mfma_f32_16x16x32_bf16 v[184:187], v[40:43], v[92:95], v[184:187]
    v_mfma_f32_16x16x32_bf16 v[180:183], v[44:47], v[88:91], v[180:183]
    v_add_u32 v21, 65536, v13
    ds_read_b64_tr_b16 v[36:37], v21 offset:0
    ds_read_b64_tr_b16 v[38:39], v21 offset:4096
    v_mfma_f32_16x16x32_bf16 v[188:191], v[44:47], v[92:95], v[188:191]
    v_mfma_f32_16x16x32_bf16 v[192:195], v[48:51], v[88:91], v[192:195]
    v_add_u32 v22, 65536, v14
    ds_read_b64_tr_b16 v[40:41], v22 offset:0
    ds_read_b64_tr_b16 v[42:43], v22 offset:4096
    v_mfma_f32_16x16x32_bf16 v[200:203], v[48:51], v[92:95], v[200:203]
    v_mfma_f32_16x16x32_bf16 v[196:199], v[52:55], v[88:91], v[196:199]
    v_add_u32 v23, 65536, v15
    ds_read_b64_tr_b16 v[44:45], v23 offset:0
    ds_read_b64_tr_b16 v[46:47], v23 offset:4096
    v_mfma_f32_16x16x32_bf16 v[204:207], v[52:55], v[92:95], v[204:207]
    v_mfma_f32_16x16x32_bf16 v[208:211], v[56:59], v[88:91], v[208:211]
    v_add_u32 v24, 65536, v16
    ds_read_b64_tr_b16 v[48:49], v24 offset:0
    ds_read_b64_tr_b16 v[50:51], v24 offset:4096
    v_mfma_f32_16x16x32_bf16 v[216:219], v[56:59], v[92:95], v[216:219]
    v_mfma_f32_16x16x32_bf16 v[212:215], v[60:63], v[88:91], v[212:215]
    v_add_u32 v25, 65536, v17
    ds_read_b64_tr_b16 v[52:53], v25 offset:0
    ds_read_b64_tr_b16 v[54:55], v25 offset:4096
    v_mfma_f32_16x16x32_bf16 v[220:223], v[60:63], v[92:95], v[220:223]
    s_waitcnt lgkmcnt(10)
    s_waitcnt vmcnt(24)
    v_mfma_f32_16x16x32_bf16 v[160:163], v[32:35], v[224:227], v[160:163]
    v_add_u32 v26, 65536, v18
    ds_read_b64_tr_b16 v[56:57], v26 offset:0
    ds_read_b64_tr_b16 v[58:59], v26 offset:4096
    v_mfma_f32_16x16x32_bf16 v[168:171], v[32:35], v[228:231], v[168:171]
    s_waitcnt lgkmcnt(10)
    v_mfma_f32_16x16x32_bf16 v[164:167], v[36:39], v[224:227], v[164:167]
    v_add_u32 v27, 65536, v19
    ds_read_b64_tr_b16 v[60:61], v27 offset:0
    ds_read_b64_tr_b16 v[62:63], v27 offset:4096
    v_mfma_f32_16x16x32_bf16 v[172:175], v[36:39], v[228:231], v[172:175]
    s_add_u32 s63, s73, 57344
    buffer_load_dwordx4 v[64:67], v12, s[20:23], s63 offen sc1
    buffer_load_dwordx4 v[68:71], v12, s[20:23], s63 offen offset:256 sc1
    s_waitcnt lgkmcnt(10)
    v_mfma_f32_16x16x32_bf16 v[176:179], v[40:43], v[224:227], v[176:179]
    ds_read_b64_tr_b16 v[32:33], v20 offset:8192
    ds_read_b64_tr_b16 v[34:35], v20 offset:12288
    v_mfma_f32_16x16x32_bf16 v[184:187], v[40:43], v[228:231], v[184:187]
    s_waitcnt lgkmcnt(10)
    v_mfma_f32_16x16x32_bf16 v[180:183], v[44:47], v[224:227], v[180:183]
    ds_read_b64_tr_b16 v[36:37], v21 offset:8192
    ds_read_b64_tr_b16 v[38:39], v21 offset:12288
    v_mfma_f32_16x16x32_bf16 v[188:191], v[44:47], v[228:231], v[188:191]
    s_add_u32 s63, s73, 59392
    buffer_load_dwordx4 v[72:75], v12, s[20:23], s63 offen sc1
    buffer_load_dwordx4 v[76:79], v12, s[20:23], s63 offen offset:256 sc1
    s_waitcnt lgkmcnt(10)
    v_mfma_f32_16x16x32_bf16 v[192:195], v[48:51], v[224:227], v[192:195]
    ds_read_b64_tr_b16 v[40:41], v22 offset:8192
    ds_read_b64_tr_b16 v[42:43], v22 offset:12288
    v_mfma_f32_16x16x32_bf16 v[200:203], v[48:51], v[228:231], v[200:203]
    s_waitcnt lgkmcnt(10)
    v_mfma_f32_16x16x32_bf16 v[196:199], v[52:55], v[224:227], v[196:199]
    ds_read_b64_tr_b16 v[44:45], v23 offset:8192
    ds_read_b64_tr_b16 v[46:47], v23 offset:12288
    v_mfma_f32_16x16x32_bf16 v[204:207], v[52:55], v[228:231], v[204:207]
    s_setprio 1
    s_add_u32 s63, s73, 61440
    buffer_load_dwordx4 v[80:83], v12, s[20:23], s63 offen sc1
    buffer_load_dwordx4 v[84:87], v12, s[20:23], s63 offen offset:256 sc1
    s_waitcnt lgkmcnt(10)
    v_mfma_f32_16x16x32_bf16 v[208:211], v[56:59], v[224:227], v[208:211]
    ds_read_b64_tr_b16 v[48:49], v24 offset:8192
    ds_read_b64_tr_b16 v[50:51], v24 offset:12288
    v_mfma_f32_16x16x32_bf16 v[216:219], v[56:59], v[228:231], v[216:219]
    s_waitcnt lgkmcnt(10)
    v_mfma_f32_16x16x32_bf16 v[212:215], v[60:63], v[224:227], v[212:215]
    ds_read_b64_tr_b16 v[52:53], v25 offset:8192
    ds_read_b64_tr_b16 v[54:55], v25 offset:12288
    v_mfma_f32_16x16x32_bf16 v[220:223], v[60:63], v[228:231], v[220:223]
    s_add_u32 s63, s73, 63488
    buffer_load_dwordx4 v[88:91], v12, s[20:23], s63 offen sc1
    buffer_load_dwordx4 v[92:95], v12, s[20:23], s63 offen offset:256 sc1
    s_waitcnt lgkmcnt(10)
    v_mfma_f32_16x16x32_bf16 v[160:163], v[32:35], v[232:235], v[160:163]
    ds_read_b64_tr_b16 v[56:57], v26 offset:8192
    ds_read_b64_tr_b16 v[58:59], v26 offset:12288
    v_mfma_f32_16x16x32_bf16 v[168:171], v[32:35], v[236:239], v[168:171]
    s_waitcnt lgkmcnt(10)
    v_mfma_f32_16x16x32_bf16 v[164:167], v[36:39], v[232:235], v[164:167]
    ds_read_b64_tr_b16 v[60:61], v27 offset:8192
    ds_read_b64_tr_b16 v[62:63], v27 offset:12288
    v_mfma_f32_16x16x32_bf16 v[172:175], v[36:39], v[236:239], v[172:175]
    s_waitcnt lgkmcnt(10)
    v_mfma_f32_16x16x32_bf16 v[176:179], v[40:43], v[232:235], v[176:179]
    ds_read_b64_tr_b16 v[32:33], v20 offset:16384
    ds_read_b64_tr_b16 v[34:35], v20 offset:20480
    v_mfma_f32_16x16x32_bf16 v[184:187], v[40:43], v[236:239], v[184:187]
    s_waitcnt lgkmcnt(10)
    v_mfma_f32_16x16x32_bf16 v[180:183], v[44:47], v[232:235], v[180:183]
    ds_read_b64_tr_b16 v[36:37], v21 offset:16384
    ds_read_b64_tr_b16 v[38:39], v21 offset:20480
    v_mfma_f32_16x16x32_bf16 v[188:191], v[44:47], v[236:239], v[188:191]
    s_waitcnt lgkmcnt(10)
    v_mfma_f32_16x16x32_bf16 v[192:195], v[48:51], v[232:235], v[192:195]
    ds_read_b64_tr_b16 v[40:41], v22 offset:16384
    ds_read_b64_tr_b16 v[42:43], v22 offset:20480
    v_mfma_f32_16x16x32_bf16 v[200:203], v[48:51], v[236:239], v[200:203]
    s_waitcnt lgkmcnt(10)
    v_mfma_f32_16x16x32_bf16 v[196:199], v[52:55], v[232:235], v[196:199]
    ds_read_b64_tr_b16 v[44:45], v23 offset:16384
    ds_read_b64_tr_b16 v[46:47], v23 offset:20480
    v_mfma_f32_16x16x32_bf16 v[204:207], v[52:55], v[236:239], v[204:207]
    s_waitcnt lgkmcnt(10)
    v_mfma_f32_16x16x32_bf16 v[208:211], v[56:59], v[232:235], v[208:211]
    ds_read_b64_tr_b16 v[48:49], v24 offset:16384
    ds_read_b64_tr_b16 v[50:51], v24 offset:20480
    v_mfma_f32_16x16x32_bf16 v[216:219], v[56:59], v[236:239], v[216:219]
    s_waitcnt lgkmcnt(10)
    v_mfma_f32_16x16x32_bf16 v[212:215], v[60:63], v[232:235], v[212:215]
    ds_read_b64_tr_b16 v[52:53], v25 offset:16384
    ds_read_b64_tr_b16 v[54:55], v25 offset:20480
    v_mfma_f32_16x16x32_bf16 v[220:223], v[60:63], v[236:239], v[220:223]
    s_setprio 0
    s_waitcnt lgkmcnt(10)
    v_mfma_f32_16x16x32_bf16 v[160:163], v[32:35], v[240:243], v[160:163]
    ds_read_b64_tr_b16 v[56:57], v26 offset:16384
    ds_read_b64_tr_b16 v[58:59], v26 offset:20480
    v_mfma_f32_16x16x32_bf16 v[168:171], v[32:35], v[244:247], v[168:171]
    s_waitcnt lgkmcnt(10)
    v_mfma_f32_16x16x32_bf16 v[164:167], v[36:39], v[240:243], v[164:167]
    ds_read_b64_tr_b16 v[60:61], v27 offset:16384
    ds_read_b64_tr_b16 v[62:63], v27 offset:20480
    v_mfma_f32_16x16x32_bf16 v[172:175], v[36:39], v[244:247], v[172:175]
    s_waitcnt lgkmcnt(10)
    v_mfma_f32_16x16x32_bf16 v[176:179], v[40:43], v[240:243], v[176:179]
    ds_read_b64_tr_b16 v[32:33], v20 offset:24576
    ds_read_b64_tr_b16 v[34:35], v20 offset:28672
    v_mfma_f32_16x16x32_bf16 v[184:187], v[40:43], v[244:247], v[184:187]
    s_waitcnt lgkmcnt(10)
    v_mfma_f32_16x16x32_bf16 v[180:183], v[44:47], v[240:243], v[180:183]
    ds_read_b64_tr_b16 v[36:37], v21 offset:24576
    ds_read_b64_tr_b16 v[38:39], v21 offset:28672
    v_mfma_f32_16x16x32_bf16 v[188:191], v[44:47], v[244:247], v[188:191]
    s_waitcnt lgkmcnt(10)
    v_mfma_f32_16x16x32_bf16 v[192:195], v[48:51], v[240:243], v[192:195]
    ds_read_b64_tr_b16 v[40:41], v22 offset:24576
    ds_read_b64_tr_b16 v[42:43], v22 offset:28672
    v_mfma_f32_16x16x32_bf16 v[200:203], v[48:51], v[244:247], v[200:203]
    s_waitcnt lgkmcnt(10)
    v_mfma_f32_16x16x32_bf16 v[196:199], v[52:55], v[240:243], v[196:199]
    ds_read_b64_tr_b16 v[44:45], v23 offset:24576
    ds_read_b64_tr_b16 v[46:47], v23 offset:28672
    v_mfma_f32_16x16x32_bf16 v[204:207], v[52:55], v[244:247], v[204:207]
    s_waitcnt lgkmcnt(10)
    v_mfma_f32_16x16x32_bf16 v[208:211], v[56:59], v[240:243], v[208:211]
    ds_read_b64_tr_b16 v[48:49], v24 offset:24576
    ds_read_b64_tr_b16 v[50:51], v24 offset:28672
    v_mfma_f32_16x16x32_bf16 v[216:219], v[56:59], v[244:247], v[216:219]
    s_waitcnt lgkmcnt(10)
    v_mfma_f32_16x16x32_bf16 v[212:215], v[60:63], v[240:243], v[212:215]
    ds_read_b64_tr_b16 v[52:53], v25 offset:24576
    ds_read_b64_tr_b16 v[54:55], v25 offset:28672
    v_mfma_f32_16x16x32_bf16 v[220:223], v[60:63], v[244:247], v[220:223]
    s_waitcnt lgkmcnt(10)
    v_mfma_f32_16x16x32_bf16 v[160:163], v[32:35], v[248:251], v[160:163]
    ds_read_b64_tr_b16 v[56:57], v26 offset:24576
    ds_read_b64_tr_b16 v[58:59], v26 offset:28672
    v_mfma_f32_16x16x32_bf16 v[168:171], v[32:35], v[252:255], v[168:171]
    s_waitcnt lgkmcnt(10)
    v_mfma_f32_16x16x32_bf16 v[164:167], v[36:39], v[248:251], v[164:167]
    ds_read_b64_tr_b16 v[60:61], v27 offset:24576
    ds_read_b64_tr_b16 v[62:63], v27 offset:28672
    v_mfma_f32_16x16x32_bf16 v[172:175], v[36:39], v[252:255], v[172:175]
    s_waitcnt lgkmcnt(10)
    v_mfma_f32_16x16x32_bf16 v[176:179], v[40:43], v[248:251], v[176:179]
    s_waitcnt lgkmcnt(0)
    s_waitcnt vmcnt(40)
    s_barrier
    s_setprio 2
    v_add_u32 v20, 98304, v8
    ds_read_b64_tr_b16 v[32:33], v20 offset:0
    ds_read_b64_tr_b16 v[34:35], v20 offset:4096
    v_mfma_f32_16x16x32_bf16 v[184:187], v[40:43], v[252:255], v[184:187]
    v_mfma_f32_16x16x32_bf16 v[180:183], v[44:47], v[248:251], v[180:183]
    v_add_u32 v21, 98304, v13
    ds_read_b64_tr_b16 v[36:37], v21 offset:0
    ds_read_b64_tr_b16 v[38:39], v21 offset:4096
    v_mfma_f32_16x16x32_bf16 v[188:191], v[44:47], v[252:255], v[188:191]
    v_mfma_f32_16x16x32_bf16 v[192:195], v[48:51], v[248:251], v[192:195]
    v_add_u32 v22, 98304, v14
    ds_read_b64_tr_b16 v[40:41], v22 offset:0
    ds_read_b64_tr_b16 v[42:43], v22 offset:4096
    v_mfma_f32_16x16x32_bf16 v[200:203], v[48:51], v[252:255], v[200:203]
    v_mfma_f32_16x16x32_bf16 v[196:199], v[52:55], v[248:251], v[196:199]
    v_add_u32 v23, 98304, v15
    ds_read_b64_tr_b16 v[44:45], v23 offset:0
    ds_read_b64_tr_b16 v[46:47], v23 offset:4096
    v_mfma_f32_16x16x32_bf16 v[204:207], v[52:55], v[252:255], v[204:207]
    v_mfma_f32_16x16x32_bf16 v[208:211], v[56:59], v[248:251], v[208:211]
    v_add_u32 v24, 98304, v16
    ds_read_b64_tr_b16 v[48:49], v24 offset:0
    ds_read_b64_tr_b16 v[50:51], v24 offset:4096
    v_mfma_f32_16x16x32_bf16 v[216:219], v[56:59], v[252:255], v[216:219]
    v_mfma_f32_16x16x32_bf16 v[212:215], v[60:63], v[248:251], v[212:215]
    v_add_u32 v25, 98304, v17
    ds_read_b64_tr_b16 v[52:53], v25 offset:0
    ds_read_b64_tr_b16 v[54:55], v25 offset:4096
    v_mfma_f32_16x16x32_bf16 v[220:223], v[60:63], v[252:255], v[220:223]
    s_waitcnt lgkmcnt(10)
    s_waitcnt vmcnt(20)
    v_mfma_f32_16x16x32_bf16 v[160:163], v[32:35], v[128:131], v[160:163]
    v_add_u32 v26, 98304, v18
    ds_read_b64_tr_b16 v[56:57], v26 offset:0
    ds_read_b64_tr_b16 v[58:59], v26 offset:4096
    v_mfma_f32_16x16x32_bf16 v[168:171], v[32:35], v[132:135], v[168:171]
    s_waitcnt lgkmcnt(10)
    v_mfma_f32_16x16x32_bf16 v[164:167], v[36:39], v[128:131], v[164:167]
    v_add_u32 v27, 98304, v19
    ds_read_b64_tr_b16 v[60:61], v27 offset:0
    ds_read_b64_tr_b16 v[62:63], v27 offset:4096
    v_mfma_f32_16x16x32_bf16 v[172:175], v[36:39], v[132:135], v[172:175]
    s_waitcnt lgkmcnt(10)
    v_mfma_f32_16x16x32_bf16 v[176:179], v[40:43], v[128:131], v[176:179]
    ds_read_b64_tr_b16 v[32:33], v20 offset:8192
    ds_read_b64_tr_b16 v[34:35], v20 offset:12288
    v_mfma_f32_16x16x32_bf16 v[184:187], v[40:43], v[132:135], v[184:187]
    s_waitcnt lgkmcnt(10)
    v_mfma_f32_16x16x32_bf16 v[180:183], v[44:47], v[128:131], v[180:183]
    ds_read_b64_tr_b16 v[36:37], v21 offset:8192
    ds_read_b64_tr_b16 v[38:39], v21 offset:12288
    v_mfma_f32_16x16x32_bf16 v[188:191], v[44:47], v[132:135], v[188:191]
    s_waitcnt lgkmcnt(10)
    v_mfma_f32_16x16x32_bf16 v[192:195], v[48:51], v[128:131], v[192:195]
    ds_read_b64_tr_b16 v[40:41], v22 offset:8192
    ds_read_b64_tr_b16 v[42:43], v22 offset:12288
    v_mfma_f32_16x16x32_bf16 v[200:203], v[48:51], v[132:135], v[200:203]
    s_waitcnt lgkmcnt(10)
    v_mfma_f32_16x16x32_bf16 v[196:199], v[52:55], v[128:131], v[196:199]
    ds_read_b64_tr_b16 v[44:45], v23 offset:8192
    ds_read_b64_tr_b16 v[46:47], v23 offset:12288
    v_mfma_f32_16x16x32_bf16 v[204:207], v[52:55], v[132:135], v[204:207]
    s_setprio 1
    s_waitcnt lgkmcnt(10)
    v_mfma_f32_16x16x32_bf16 v[208:211], v[56:59], v[128:131], v[208:211]
    ds_read_b64_tr_b16 v[48:49], v24 offset:8192
    ds_read_b64_tr_b16 v[50:51], v24 offset:12288
    v_mfma_f32_16x16x32_bf16 v[216:219], v[56:59], v[132:135], v[216:219]
    s_waitcnt lgkmcnt(10)
    v_mfma_f32_16x16x32_bf16 v[212:215], v[60:63], v[128:131], v[212:215]
    ds_read_b64_tr_b16 v[52:53], v25 offset:8192
    ds_read_b64_tr_b16 v[54:55], v25 offset:12288
    v_mfma_f32_16x16x32_bf16 v[220:223], v[60:63], v[132:135], v[220:223]
    s_waitcnt lgkmcnt(10)
    v_mfma_f32_16x16x32_bf16 v[160:163], v[32:35], v[136:139], v[160:163]
    ds_read_b64_tr_b16 v[56:57], v26 offset:8192
    ds_read_b64_tr_b16 v[58:59], v26 offset:12288
    v_mfma_f32_16x16x32_bf16 v[168:171], v[32:35], v[140:143], v[168:171]
    s_waitcnt lgkmcnt(10)
    v_mfma_f32_16x16x32_bf16 v[164:167], v[36:39], v[136:139], v[164:167]
    ds_read_b64_tr_b16 v[60:61], v27 offset:8192
    ds_read_b64_tr_b16 v[62:63], v27 offset:12288
    v_mfma_f32_16x16x32_bf16 v[172:175], v[36:39], v[140:143], v[172:175]
    s_waitcnt lgkmcnt(10)
    v_mfma_f32_16x16x32_bf16 v[176:179], v[40:43], v[136:139], v[176:179]
    ds_read_b64_tr_b16 v[32:33], v20 offset:16384
    ds_read_b64_tr_b16 v[34:35], v20 offset:20480
    v_mfma_f32_16x16x32_bf16 v[184:187], v[40:43], v[140:143], v[184:187]
    s_waitcnt lgkmcnt(10)
    v_mfma_f32_16x16x32_bf16 v[180:183], v[44:47], v[136:139], v[180:183]
    ds_read_b64_tr_b16 v[36:37], v21 offset:16384
    ds_read_b64_tr_b16 v[38:39], v21 offset:20480
    v_mfma_f32_16x16x32_bf16 v[188:191], v[44:47], v[140:143], v[188:191]
    s_waitcnt lgkmcnt(10)
    v_mfma_f32_16x16x32_bf16 v[192:195], v[48:51], v[136:139], v[192:195]
    ds_read_b64_tr_b16 v[40:41], v22 offset:16384
    ds_read_b64_tr_b16 v[42:43], v22 offset:20480
    v_mfma_f32_16x16x32_bf16 v[200:203], v[48:51], v[140:143], v[200:203]
    s_waitcnt lgkmcnt(10)
    v_mfma_f32_16x16x32_bf16 v[196:199], v[52:55], v[136:139], v[196:199]
    ds_read_b64_tr_b16 v[44:45], v23 offset:16384
    ds_read_b64_tr_b16 v[46:47], v23 offset:20480
    v_mfma_f32_16x16x32_bf16 v[204:207], v[52:55], v[140:143], v[204:207]
    s_waitcnt lgkmcnt(10)
    v_mfma_f32_16x16x32_bf16 v[208:211], v[56:59], v[136:139], v[208:211]
    ds_read_b64_tr_b16 v[48:49], v24 offset:16384
    ds_read_b64_tr_b16 v[50:51], v24 offset:20480
    v_mfma_f32_16x16x32_bf16 v[216:219], v[56:59], v[140:143], v[216:219]
    s_waitcnt lgkmcnt(10)
    v_mfma_f32_16x16x32_bf16 v[212:215], v[60:63], v[136:139], v[212:215]
    ds_read_b64_tr_b16 v[52:53], v25 offset:16384
    ds_read_b64_tr_b16 v[54:55], v25 offset:20480
    v_mfma_f32_16x16x32_bf16 v[220:223], v[60:63], v[140:143], v[220:223]
    s_setprio 0
    s_waitcnt lgkmcnt(10)
    v_mfma_f32_16x16x32_bf16 v[160:163], v[32:35], v[144:147], v[160:163]
    ds_read_b64_tr_b16 v[56:57], v26 offset:16384
    ds_read_b64_tr_b16 v[58:59], v26 offset:20480
    v_mfma_f32_16x16x32_bf16 v[168:171], v[32:35], v[148:151], v[168:171]
    s_waitcnt lgkmcnt(10)
    v_mfma_f32_16x16x32_bf16 v[164:167], v[36:39], v[144:147], v[164:167]
    ds_read_b64_tr_b16 v[60:61], v27 offset:16384
    ds_read_b64_tr_b16 v[62:63], v27 offset:20480
    v_mfma_f32_16x16x32_bf16 v[172:175], v[36:39], v[148:151], v[172:175]
    s_waitcnt lgkmcnt(10)
    v_mfma_f32_16x16x32_bf16 v[176:179], v[40:43], v[144:147], v[176:179]
    ds_read_b64_tr_b16 v[32:33], v20 offset:24576
    ds_read_b64_tr_b16 v[34:35], v20 offset:28672
    v_mfma_f32_16x16x32_bf16 v[184:187], v[40:43], v[148:151], v[184:187]
    s_waitcnt lgkmcnt(10)
    v_mfma_f32_16x16x32_bf16 v[180:183], v[44:47], v[144:147], v[180:183]
    ds_read_b64_tr_b16 v[36:37], v21 offset:24576
    ds_read_b64_tr_b16 v[38:39], v21 offset:28672
    v_mfma_f32_16x16x32_bf16 v[188:191], v[44:47], v[148:151], v[188:191]
    s_waitcnt lgkmcnt(10)
    v_mfma_f32_16x16x32_bf16 v[192:195], v[48:51], v[144:147], v[192:195]
    ds_read_b64_tr_b16 v[40:41], v22 offset:24576
    ds_read_b64_tr_b16 v[42:43], v22 offset:28672
    v_mfma_f32_16x16x32_bf16 v[200:203], v[48:51], v[148:151], v[200:203]
    s_waitcnt lgkmcnt(10)
    v_mfma_f32_16x16x32_bf16 v[196:199], v[52:55], v[144:147], v[196:199]
    ds_read_b64_tr_b16 v[44:45], v23 offset:24576
    ds_read_b64_tr_b16 v[46:47], v23 offset:28672
    v_mfma_f32_16x16x32_bf16 v[204:207], v[52:55], v[148:151], v[204:207]
    s_waitcnt lgkmcnt(10)
    v_mfma_f32_16x16x32_bf16 v[208:211], v[56:59], v[144:147], v[208:211]
    ds_read_b64_tr_b16 v[48:49], v24 offset:24576
    ds_read_b64_tr_b16 v[50:51], v24 offset:28672
    v_mfma_f32_16x16x32_bf16 v[216:219], v[56:59], v[148:151], v[216:219]
    s_waitcnt lgkmcnt(10)
    v_mfma_f32_16x16x32_bf16 v[212:215], v[60:63], v[144:147], v[212:215]
    ds_read_b64_tr_b16 v[52:53], v25 offset:24576
    ds_read_b64_tr_b16 v[54:55], v25 offset:28672
    v_mfma_f32_16x16x32_bf16 v[220:223], v[60:63], v[148:151], v[220:223]
    s_waitcnt lgkmcnt(10)
    v_mfma_f32_16x16x32_bf16 v[160:163], v[32:35], v[152:155], v[160:163]
    ds_read_b64_tr_b16 v[56:57], v26 offset:24576
    ds_read_b64_tr_b16 v[58:59], v26 offset:28672
    v_mfma_f32_16x16x32_bf16 v[168:171], v[32:35], v[156:159], v[168:171]
    s_waitcnt lgkmcnt(10)
    v_mfma_f32_16x16x32_bf16 v[164:167], v[36:39], v[152:155], v[164:167]
    ds_read_b64_tr_b16 v[60:61], v27 offset:24576
    ds_read_b64_tr_b16 v[62:63], v27 offset:28672
    v_mfma_f32_16x16x32_bf16 v[172:175], v[36:39], v[156:159], v[172:175]
    s_waitcnt lgkmcnt(10)
    v_mfma_f32_16x16x32_bf16 v[176:179], v[40:43], v[152:155], v[176:179]
    s_waitcnt lgkmcnt(0)
    s_waitcnt vmcnt(28)
    s_barrier
    s_setprio 2
    v_add_u32 v20, 131072, v8
    ds_read_b64_tr_b16 v[32:33], v20 offset:0
    ds_read_b64_tr_b16 v[34:35], v20 offset:4096
    v_mfma_f32_16x16x32_bf16 v[184:187], v[40:43], v[156:159], v[184:187]
    v_mfma_f32_16x16x32_bf16 v[180:183], v[44:47], v[152:155], v[180:183]
    v_add_u32 v21, 131072, v13
    ds_read_b64_tr_b16 v[36:37], v21 offset:0
    ds_read_b64_tr_b16 v[38:39], v21 offset:4096
    v_mfma_f32_16x16x32_bf16 v[188:191], v[44:47], v[156:159], v[188:191]
    v_mfma_f32_16x16x32_bf16 v[192:195], v[48:51], v[152:155], v[192:195]
    v_add_u32 v22, 131072, v14
    ds_read_b64_tr_b16 v[40:41], v22 offset:0
    ds_read_b64_tr_b16 v[42:43], v22 offset:4096
    v_mfma_f32_16x16x32_bf16 v[200:203], v[48:51], v[156:159], v[200:203]
    v_mfma_f32_16x16x32_bf16 v[196:199], v[52:55], v[152:155], v[196:199]
    v_add_u32 v23, 131072, v15
    ds_read_b64_tr_b16 v[44:45], v23 offset:0
    ds_read_b64_tr_b16 v[46:47], v23 offset:4096
    v_mfma_f32_16x16x32_bf16 v[204:207], v[52:55], v[156:159], v[204:207]
    v_mfma_f32_16x16x32_bf16 v[208:211], v[56:59], v[152:155], v[208:211]
    v_add_u32 v24, 131072, v16
    ds_read_b64_tr_b16 v[48:49], v24 offset:0
    ds_read_b64_tr_b16 v[50:51], v24 offset:4096
    v_mfma_f32_16x16x32_bf16 v[216:219], v[56:59], v[156:159], v[216:219]
    v_mfma_f32_16x16x32_bf16 v[212:215], v[60:63], v[152:155], v[212:215]
    v_add_u32 v25, 131072, v17
    ds_read_b64_tr_b16 v[52:53], v25 offset:0
    ds_read_b64_tr_b16 v[54:55], v25 offset:4096
    v_mfma_f32_16x16x32_bf16 v[220:223], v[60:63], v[156:159], v[220:223]
    s_waitcnt lgkmcnt(10)
    s_waitcnt vmcnt(8)
    v_mfma_f32_16x16x32_bf16 v[160:163], v[32:35], v[96:99], v[160:163]
    v_add_u32 v26, 131072, v18
    ds_read_b64_tr_b16 v[56:57], v26 offset:0
    ds_read_b64_tr_b16 v[58:59], v26 offset:4096
    v_mfma_f32_16x16x32_bf16 v[168:171], v[32:35], v[100:103], v[168:171]
    s_waitcnt lgkmcnt(10)
    v_mfma_f32_16x16x32_bf16 v[164:167], v[36:39], v[96:99], v[164:167]
    v_add_u32 v27, 131072, v19
    ds_read_b64_tr_b16 v[60:61], v27 offset:0
    ds_read_b64_tr_b16 v[62:63], v27 offset:4096
    v_mfma_f32_16x16x32_bf16 v[172:175], v[36:39], v[100:103], v[172:175]
    s_waitcnt lgkmcnt(10)
    v_mfma_f32_16x16x32_bf16 v[176:179], v[40:43], v[96:99], v[176:179]
    ds_read_b64_tr_b16 v[32:33], v20 offset:8192
    ds_read_b64_tr_b16 v[34:35], v20 offset:12288
    v_mfma_f32_16x16x32_bf16 v[184:187], v[40:43], v[100:103], v[184:187]
    s_waitcnt lgkmcnt(10)
    v_mfma_f32_16x16x32_bf16 v[180:183], v[44:47], v[96:99], v[180:183]
    ds_read_b64_tr_b16 v[36:37], v21 offset:8192
    ds_read_b64_tr_b16 v[38:39], v21 offset:12288
    v_mfma_f32_16x16x32_bf16 v[188:191], v[44:47], v[100:103], v[188:191]
    s_waitcnt lgkmcnt(10)
    v_mfma_f32_16x16x32_bf16 v[192:195], v[48:51], v[96:99], v[192:195]
    ds_read_b64_tr_b16 v[40:41], v22 offset:8192
    ds_read_b64_tr_b16 v[42:43], v22 offset:12288
    v_mfma_f32_16x16x32_bf16 v[200:203], v[48:51], v[100:103], v[200:203]
    s_waitcnt lgkmcnt(10)
    v_mfma_f32_16x16x32_bf16 v[196:199], v[52:55], v[96:99], v[196:199]
    ds_read_b64_tr_b16 v[44:45], v23 offset:8192
    ds_read_b64_tr_b16 v[46:47], v23 offset:12288
    v_mfma_f32_16x16x32_bf16 v[204:207], v[52:55], v[100:103], v[204:207]
    s_setprio 1
    s_waitcnt lgkmcnt(10)
    v_mfma_f32_16x16x32_bf16 v[208:211], v[56:59], v[96:99], v[208:211]
    ds_read_b64_tr_b16 v[48:49], v24 offset:8192
    ds_read_b64_tr_b16 v[50:51], v24 offset:12288
    v_mfma_f32_16x16x32_bf16 v[216:219], v[56:59], v[100:103], v[216:219]
    s_waitcnt lgkmcnt(10)
    v_mfma_f32_16x16x32_bf16 v[212:215], v[60:63], v[96:99], v[212:215]
    ds_read_b64_tr_b16 v[52:53], v25 offset:8192
    ds_read_b64_tr_b16 v[54:55], v25 offset:12288
    v_mfma_f32_16x16x32_bf16 v[220:223], v[60:63], v[100:103], v[220:223]
    s_waitcnt lgkmcnt(10)
    v_mfma_f32_16x16x32_bf16 v[160:163], v[32:35], v[104:107], v[160:163]
    ds_read_b64_tr_b16 v[56:57], v26 offset:8192
    ds_read_b64_tr_b16 v[58:59], v26 offset:12288
    v_mfma_f32_16x16x32_bf16 v[168:171], v[32:35], v[108:111], v[168:171]
    s_waitcnt lgkmcnt(10)
    v_mfma_f32_16x16x32_bf16 v[164:167], v[36:39], v[104:107], v[164:167]
    ds_read_b64_tr_b16 v[60:61], v27 offset:8192
    ds_read_b64_tr_b16 v[62:63], v27 offset:12288
    v_mfma_f32_16x16x32_bf16 v[172:175], v[36:39], v[108:111], v[172:175]
    s_waitcnt lgkmcnt(10)
    v_mfma_f32_16x16x32_bf16 v[176:179], v[40:43], v[104:107], v[176:179]
    ds_read_b64_tr_b16 v[32:33], v20 offset:16384
    ds_read_b64_tr_b16 v[34:35], v20 offset:20480
    v_mfma_f32_16x16x32_bf16 v[184:187], v[40:43], v[108:111], v[184:187]
    s_waitcnt lgkmcnt(10)
    v_mfma_f32_16x16x32_bf16 v[180:183], v[44:47], v[104:107], v[180:183]
    ds_read_b64_tr_b16 v[36:37], v21 offset:16384
    ds_read_b64_tr_b16 v[38:39], v21 offset:20480
    v_mfma_f32_16x16x32_bf16 v[188:191], v[44:47], v[108:111], v[188:191]
    s_waitcnt lgkmcnt(10)
    v_mfma_f32_16x16x32_bf16 v[192:195], v[48:51], v[104:107], v[192:195]
    ds_read_b64_tr_b16 v[40:41], v22 offset:16384
    ds_read_b64_tr_b16 v[42:43], v22 offset:20480
    v_mfma_f32_16x16x32_bf16 v[200:203], v[48:51], v[108:111], v[200:203]
    s_waitcnt lgkmcnt(10)
    v_mfma_f32_16x16x32_bf16 v[196:199], v[52:55], v[104:107], v[196:199]
    ds_read_b64_tr_b16 v[44:45], v23 offset:16384
    ds_read_b64_tr_b16 v[46:47], v23 offset:20480
    v_mfma_f32_16x16x32_bf16 v[204:207], v[52:55], v[108:111], v[204:207]
    s_waitcnt lgkmcnt(10)
    v_mfma_f32_16x16x32_bf16 v[208:211], v[56:59], v[104:107], v[208:211]
    ds_read_b64_tr_b16 v[48:49], v24 offset:16384
    ds_read_b64_tr_b16 v[50:51], v24 offset:20480
    v_mfma_f32_16x16x32_bf16 v[216:219], v[56:59], v[108:111], v[216:219]
    s_waitcnt lgkmcnt(10)
    v_mfma_f32_16x16x32_bf16 v[212:215], v[60:63], v[104:107], v[212:215]
    ds_read_b64_tr_b16 v[52:53], v25 offset:16384
    ds_read_b64_tr_b16 v[54:55], v25 offset:20480
    v_mfma_f32_16x16x32_bf16 v[220:223], v[60:63], v[108:111], v[220:223]
    s_setprio 0
    s_waitcnt lgkmcnt(10)
    v_mfma_f32_16x16x32_bf16 v[160:163], v[32:35], v[112:115], v[160:163]
    ds_read_b64_tr_b16 v[56:57], v26 offset:16384
    ds_read_b64_tr_b16 v[58:59], v26 offset:20480
    v_mfma_f32_16x16x32_bf16 v[168:171], v[32:35], v[116:119], v[168:171]
    s_waitcnt lgkmcnt(10)
    v_mfma_f32_16x16x32_bf16 v[164:167], v[36:39], v[112:115], v[164:167]
    ds_read_b64_tr_b16 v[60:61], v27 offset:16384
    ds_read_b64_tr_b16 v[62:63], v27 offset:20480
    v_mfma_f32_16x16x32_bf16 v[172:175], v[36:39], v[116:119], v[172:175]
    s_waitcnt lgkmcnt(10)
    v_mfma_f32_16x16x32_bf16 v[176:179], v[40:43], v[112:115], v[176:179]
    ds_read_b64_tr_b16 v[32:33], v20 offset:24576
    ds_read_b64_tr_b16 v[34:35], v20 offset:28672
    v_mfma_f32_16x16x32_bf16 v[184:187], v[40:43], v[116:119], v[184:187]
    s_waitcnt lgkmcnt(10)
    v_mfma_f32_16x16x32_bf16 v[180:183], v[44:47], v[112:115], v[180:183]
    ds_read_b64_tr_b16 v[36:37], v21 offset:24576
    ds_read_b64_tr_b16 v[38:39], v21 offset:28672
    v_mfma_f32_16x16x32_bf16 v[188:191], v[44:47], v[116:119], v[188:191]
    s_waitcnt lgkmcnt(10)
    v_mfma_f32_16x16x32_bf16 v[192:195], v[48:51], v[112:115], v[192:195]
    ds_read_b64_tr_b16 v[40:41], v22 offset:24576
    ds_read_b64_tr_b16 v[42:43], v22 offset:28672
    v_mfma_f32_16x16x32_bf16 v[200:203], v[48:51], v[116:119], v[200:203]
    s_waitcnt lgkmcnt(10)
    v_mfma_f32_16x16x32_bf16 v[196:199], v[52:55], v[112:115], v[196:199]
    ds_read_b64_tr_b16 v[44:45], v23 offset:24576
    ds_read_b64_tr_b16 v[46:47], v23 offset:28672
    v_mfma_f32_16x16x32_bf16 v[204:207], v[52:55], v[116:119], v[204:207]
    s_waitcnt lgkmcnt(10)
    v_mfma_f32_16x16x32_bf16 v[208:211], v[56:59], v[112:115], v[208:211]
    ds_read_b64_tr_b16 v[48:49], v24 offset:24576
    ds_read_b64_tr_b16 v[50:51], v24 offset:28672
    v_mfma_f32_16x16x32_bf16 v[216:219], v[56:59], v[116:119], v[216:219]
    s_waitcnt lgkmcnt(10)
    v_mfma_f32_16x16x32_bf16 v[212:215], v[60:63], v[112:115], v[212:215]
    ds_read_b64_tr_b16 v[52:53], v25 offset:24576
    ds_read_b64_tr_b16 v[54:55], v25 offset:28672
    v_mfma_f32_16x16x32_bf16 v[220:223], v[60:63], v[116:119], v[220:223]
    s_waitcnt lgkmcnt(10)
    v_mfma_f32_16x16x32_bf16 v[160:163], v[32:35], v[120:123], v[160:163]
    ds_read_b64_tr_b16 v[56:57], v26 offset:24576
    ds_read_b64_tr_b16 v[58:59], v26 offset:28672
    v_mfma_f32_16x16x32_bf16 v[168:171], v[32:35], v[124:127], v[168:171]
    s_waitcnt lgkmcnt(10)
    v_mfma_f32_16x16x32_bf16 v[164:167], v[36:39], v[120:123], v[164:167]
    ds_read_b64_tr_b16 v[60:61], v27 offset:24576
    ds_read_b64_tr_b16 v[62:63], v27 offset:28672
    v_mfma_f32_16x16x32_bf16 v[172:175], v[36:39], v[124:127], v[172:175]
    s_waitcnt lgkmcnt(10)
    v_mfma_f32_16x16x32_bf16 v[176:179], v[40:43], v[120:123], v[176:179]
    s_waitcnt lgkmcnt(0)
    s_waitcnt vmcnt(16)
    s_barrier
    s_setprio 2
    v_add_u32 v20, 0, v8
    ds_read_b64_tr_b16 v[32:33], v20 offset:0
    ds_read_b64_tr_b16 v[34:35], v20 offset:4096
    v_mfma_f32_16x16x32_bf16 v[184:187], v[40:43], v[124:127], v[184:187]
    v_mfma_f32_16x16x32_bf16 v[180:183], v[44:47], v[120:123], v[180:183]
    v_add_u32 v21, 0, v13
    ds_read_b64_tr_b16 v[36:37], v21 offset:0
    ds_read_b64_tr_b16 v[38:39], v21 offset:4096
    v_mfma_f32_16x16x32_bf16 v[188:191], v[44:47], v[124:127], v[188:191]
    v_mfma_f32_16x16x32_bf16 v[192:195], v[48:51], v[120:123], v[192:195]
    v_add_u32 v22, 0, v14
    ds_read_b64_tr_b16 v[40:41], v22 offset:0
    ds_read_b64_tr_b16 v[42:43], v22 offset:4096
    v_mfma_f32_16x16x32_bf16 v[200:203], v[48:51], v[124:127], v[200:203]
    v_mfma_f32_16x16x32_bf16 v[196:199], v[52:55], v[120:123], v[196:199]
    v_add_u32 v23, 0, v15
    ds_read_b64_tr_b16 v[44:45], v23 offset:0
    ds_read_b64_tr_b16 v[46:47], v23 offset:4096
    v_mfma_f32_16x16x32_bf16 v[204:207], v[52:55], v[124:127], v[204:207]
    v_mfma_f32_16x16x32_bf16 v[208:211], v[56:59], v[120:123], v[208:211]
    v_add_u32 v24, 0, v16
    ds_read_b64_tr_b16 v[48:49], v24 offset:0
    ds_read_b64_tr_b16 v[50:51], v24 offset:4096
    v_mfma_f32_16x16x32_bf16 v[216:219], v[56:59], v[124:127], v[216:219]
    v_mfma_f32_16x16x32_bf16 v[212:215], v[60:63], v[120:123], v[212:215]
    v_add_u32 v25, 0, v17
    ds_read_b64_tr_b16 v[52:53], v25 offset:0
    ds_read_b64_tr_b16 v[54:55], v25 offset:4096
    v_mfma_f32_16x16x32_bf16 v[220:223], v[60:63], v[124:127], v[220:223]
    s_waitcnt lgkmcnt(10)
    s_waitcnt vmcnt(0)
    v_mfma_f32_16x16x32_bf16 v[160:163], v[32:35], v[64:67], v[160:163]
    v_add_u32 v26, 0, v18
    ds_read_b64_tr_b16 v[56:57], v26 offset:0
    ds_read_b64_tr_b16 v[58:59], v26 offset:4096
    v_mfma_f32_16x16x32_bf16 v[168:171], v[32:35], v[68:71], v[168:171]
    s_waitcnt lgkmcnt(10)
    v_mfma_f32_16x16x32_bf16 v[164:167], v[36:39], v[64:67], v[164:167]
    v_add_u32 v27, 0, v19
    ds_read_b64_tr_b16 v[60:61], v27 offset:0
    ds_read_b64_tr_b16 v[62:63], v27 offset:4096
    v_mfma_f32_16x16x32_bf16 v[172:175], v[36:39], v[68:71], v[172:175]
    s_waitcnt lgkmcnt(10)
    v_mfma_f32_16x16x32_bf16 v[176:179], v[40:43], v[64:67], v[176:179]
    ds_read_b64_tr_b16 v[32:33], v20 offset:8192
    ds_read_b64_tr_b16 v[34:35], v20 offset:12288
    v_mfma_f32_16x16x32_bf16 v[184:187], v[40:43], v[68:71], v[184:187]
    s_waitcnt lgkmcnt(10)
    v_mfma_f32_16x16x32_bf16 v[180:183], v[44:47], v[64:67], v[180:183]
    ds_read_b64_tr_b16 v[36:37], v21 offset:8192
    ds_read_b64_tr_b16 v[38:39], v21 offset:12288
    v_mfma_f32_16x16x32_bf16 v[188:191], v[44:47], v[68:71], v[188:191]
    s_waitcnt lgkmcnt(10)
    v_mfma_f32_16x16x32_bf16 v[192:195], v[48:51], v[64:67], v[192:195]
    ds_read_b64_tr_b16 v[40:41], v22 offset:8192
    ds_read_b64_tr_b16 v[42:43], v22 offset:12288
    v_mfma_f32_16x16x32_bf16 v[200:203], v[48:51], v[68:71], v[200:203]
    s_waitcnt lgkmcnt(10)
    v_mfma_f32_16x16x32_bf16 v[196:199], v[52:55], v[64:67], v[196:199]
    ds_read_b64_tr_b16 v[44:45], v23 offset:8192
    ds_read_b64_tr_b16 v[46:47], v23 offset:12288
    v_mfma_f32_16x16x32_bf16 v[204:207], v[52:55], v[68:71], v[204:207]
    s_setprio 1
    s_waitcnt lgkmcnt(10)
    v_mfma_f32_16x16x32_bf16 v[208:211], v[56:59], v[64:67], v[208:211]
    ds_read_b64_tr_b16 v[48:49], v24 offset:8192
    ds_read_b64_tr_b16 v[50:51], v24 offset:12288
    v_mfma_f32_16x16x32_bf16 v[216:219], v[56:59], v[68:71], v[216:219]
    s_waitcnt lgkmcnt(10)
    v_mfma_f32_16x16x32_bf16 v[212:215], v[60:63], v[64:67], v[212:215]
    ds_read_b64_tr_b16 v[52:53], v25 offset:8192
    ds_read_b64_tr_b16 v[54:55], v25 offset:12288
    v_mfma_f32_16x16x32_bf16 v[220:223], v[60:63], v[68:71], v[220:223]
    s_waitcnt lgkmcnt(10)
    v_mfma_f32_16x16x32_bf16 v[160:163], v[32:35], v[72:75], v[160:163]
    ds_read_b64_tr_b16 v[56:57], v26 offset:8192
    ds_read_b64_tr_b16 v[58:59], v26 offset:12288
    v_mfma_f32_16x16x32_bf16 v[168:171], v[32:35], v[76:79], v[168:171]
    s_waitcnt lgkmcnt(10)
    v_mfma_f32_16x16x32_bf16 v[164:167], v[36:39], v[72:75], v[164:167]
    ds_read_b64_tr_b16 v[60:61], v27 offset:8192
    ds_read_b64_tr_b16 v[62:63], v27 offset:12288
    v_mfma_f32_16x16x32_bf16 v[172:175], v[36:39], v[76:79], v[172:175]
    s_waitcnt lgkmcnt(10)
    v_mfma_f32_16x16x32_bf16 v[176:179], v[40:43], v[72:75], v[176:179]
    ds_read_b64_tr_b16 v[32:33], v20 offset:16384
    ds_read_b64_tr_b16 v[34:35], v20 offset:20480
    v_mfma_f32_16x16x32_bf16 v[184:187], v[40:43], v[76:79], v[184:187]
    s_waitcnt lgkmcnt(10)
    v_mfma_f32_16x16x32_bf16 v[180:183], v[44:47], v[72:75], v[180:183]
    ds_read_b64_tr_b16 v[36:37], v21 offset:16384
    ds_read_b64_tr_b16 v[38:39], v21 offset:20480
    v_mfma_f32_16x16x32_bf16 v[188:191], v[44:47], v[76:79], v[188:191]
    s_waitcnt lgkmcnt(10)
    v_mfma_f32_16x16x32_bf16 v[192:195], v[48:51], v[72:75], v[192:195]
    ds_read_b64_tr_b16 v[40:41], v22 offset:16384
    ds_read_b64_tr_b16 v[42:43], v22 offset:20480
    v_mfma_f32_16x16x32_bf16 v[200:203], v[48:51], v[76:79], v[200:203]
    s_waitcnt lgkmcnt(10)
    v_mfma_f32_16x16x32_bf16 v[196:199], v[52:55], v[72:75], v[196:199]
    ds_read_b64_tr_b16 v[44:45], v23 offset:16384
    ds_read_b64_tr_b16 v[46:47], v23 offset:20480
    v_mfma_f32_16x16x32_bf16 v[204:207], v[52:55], v[76:79], v[204:207]
    s_waitcnt lgkmcnt(10)
    v_mfma_f32_16x16x32_bf16 v[208:211], v[56:59], v[72:75], v[208:211]
    ds_read_b64_tr_b16 v[48:49], v24 offset:16384
    ds_read_b64_tr_b16 v[50:51], v24 offset:20480
    v_mfma_f32_16x16x32_bf16 v[216:219], v[56:59], v[76:79], v[216:219]
    s_waitcnt lgkmcnt(10)
    v_mfma_f32_16x16x32_bf16 v[212:215], v[60:63], v[72:75], v[212:215]
    ds_read_b64_tr_b16 v[52:53], v25 offset:16384
    ds_read_b64_tr_b16 v[54:55], v25 offset:20480
    v_mfma_f32_16x16x32_bf16 v[220:223], v[60:63], v[76:79], v[220:223]
    s_setprio 0
    s_waitcnt lgkmcnt(10)
    v_mfma_f32_16x16x32_bf16 v[160:163], v[32:35], v[80:83], v[160:163]
    ds_read_b64_tr_b16 v[56:57], v26 offset:16384
    ds_read_b64_tr_b16 v[58:59], v26 offset:20480
    v_mfma_f32_16x16x32_bf16 v[168:171], v[32:35], v[84:87], v[168:171]
    s_waitcnt lgkmcnt(10)
    v_mfma_f32_16x16x32_bf16 v[164:167], v[36:39], v[80:83], v[164:167]
    ds_read_b64_tr_b16 v[60:61], v27 offset:16384
    ds_read_b64_tr_b16 v[62:63], v27 offset:20480
    v_mfma_f32_16x16x32_bf16 v[172:175], v[36:39], v[84:87], v[172:175]
    s_waitcnt lgkmcnt(10)
    v_mfma_f32_16x16x32_bf16 v[176:179], v[40:43], v[80:83], v[176:179]
    ds_read_b64_tr_b16 v[32:33], v20 offset:24576
    ds_read_b64_tr_b16 v[34:35], v20 offset:28672
    v_mfma_f32_16x16x32_bf16 v[184:187], v[40:43], v[84:87], v[184:187]
    s_waitcnt lgkmcnt(10)
    v_mfma_f32_16x16x32_bf16 v[180:183], v[44:47], v[80:83], v[180:183]
    ds_read_b64_tr_b16 v[36:37], v21 offset:24576
    ds_read_b64_tr_b16 v[38:39], v21 offset:28672
    v_mfma_f32_16x16x32_bf16 v[188:191], v[44:47], v[84:87], v[188:191]
    s_waitcnt lgkmcnt(10)
    v_mfma_f32_16x16x32_bf16 v[192:195], v[48:51], v[80:83], v[192:195]
    ds_read_b64_tr_b16 v[40:41], v22 offset:24576
    ds_read_b64_tr_b16 v[42:43], v22 offset:28672
    v_mfma_f32_16x16x32_bf16 v[200:203], v[48:51], v[84:87], v[200:203]
    s_waitcnt lgkmcnt(10)
    v_mfma_f32_16x16x32_bf16 v[196:199], v[52:55], v[80:83], v[196:199]
    ds_read_b64_tr_b16 v[44:45], v23 offset:24576
    ds_read_b64_tr_b16 v[46:47], v23 offset:28672
    v_mfma_f32_16x16x32_bf16 v[204:207], v[52:55], v[84:87], v[204:207]
    s_waitcnt lgkmcnt(10)
    v_mfma_f32_16x16x32_bf16 v[208:211], v[56:59], v[80:83], v[208:211]
    ds_read_b64_tr_b16 v[48:49], v24 offset:24576
    ds_read_b64_tr_b16 v[50:51], v24 offset:28672
    v_mfma_f32_16x16x32_bf16 v[216:219], v[56:59], v[84:87], v[216:219]
    s_waitcnt lgkmcnt(10)
    v_mfma_f32_16x16x32_bf16 v[212:215], v[60:63], v[80:83], v[212:215]
    ds_read_b64_tr_b16 v[52:53], v25 offset:24576
    ds_read_b64_tr_b16 v[54:55], v25 offset:28672
    v_mfma_f32_16x16x32_bf16 v[220:223], v[60:63], v[84:87], v[220:223]
    s_waitcnt lgkmcnt(10)
    v_mfma_f32_16x16x32_bf16 v[160:163], v[32:35], v[88:91], v[160:163]
    ds_read_b64_tr_b16 v[56:57], v26 offset:24576
    ds_read_b64_tr_b16 v[58:59], v26 offset:28672
    v_mfma_f32_16x16x32_bf16 v[168:171], v[32:35], v[92:95], v[168:171]
    s_waitcnt lgkmcnt(10)
    v_mfma_f32_16x16x32_bf16 v[164:167], v[36:39], v[88:91], v[164:167]
    ds_read_b64_tr_b16 v[60:61], v27 offset:24576
    ds_read_b64_tr_b16 v[62:63], v27 offset:28672
    v_mfma_f32_16x16x32_bf16 v[172:175], v[36:39], v[92:95], v[172:175]
    s_waitcnt lgkmcnt(10)
    v_mfma_f32_16x16x32_bf16 v[176:179], v[40:43], v[88:91], v[176:179]
    v_mfma_f32_16x16x32_bf16 v[184:187], v[40:43], v[92:95], v[184:187]
    s_waitcnt lgkmcnt(8)
    v_mfma_f32_16x16x32_bf16 v[180:183], v[44:47], v[88:91], v[180:183]
    v_mfma_f32_16x16x32_bf16 v[188:191], v[44:47], v[92:95], v[188:191]
    s_waitcnt lgkmcnt(6)
    v_mfma_f32_16x16x32_bf16 v[192:195], v[48:51], v[88:91], v[192:195]
    v_mfma_f32_16x16x32_bf16 v[200:203], v[48:51], v[92:95], v[200:203]
    s_waitcnt lgkmcnt(4)
    v_mfma_f32_16x16x32_bf16 v[196:199], v[52:55], v[88:91], v[196:199]
    v_mfma_f32_16x16x32_bf16 v[204:207], v[52:55], v[92:95], v[204:207]
    s_waitcnt lgkmcnt(2)
    v_mfma_f32_16x16x32_bf16 v[208:211], v[56:59], v[88:91], v[208:211]
    v_mfma_f32_16x16x32_bf16 v[216:219], v[56:59], v[92:95], v[216:219]
    s_waitcnt lgkmcnt(0)
    v_mfma_f32_16x16x32_bf16 v[212:215], v[60:63], v[88:91], v[212:215]
    v_mfma_f32_16x16x32_bf16 v[220:223], v[60:63], v[92:95], v[220:223]
    s_lshl_b32 s69, s78, 21
    s_lshl_b32 s70, s71, 15
    s_add_u32 s69, s69, s70
    s_lshl_b32 s70, s66, 13
    s_add_u32 s69, s69, s70
    s_lshl_b32 s51, s65, 7
    s_lshl_b32 s70, s66, 4
    s_add_u32 s51, s51, s70
    s_lshl_b32 s70, s78, 2
    s_add_u32 s51, s51, s70
    s_add_u32 s51, s51, 10240
    s_add_u32 s63, s69, 0
    v_cvt_pk_bf16_f32 v160, v160, v161
    v_cvt_pk_bf16_f32 v161, v162, v163
    v_cvt_pk_bf16_f32 v162, v164, v165
    v_cvt_pk_bf16_f32 v163, v166, v167
    buffer_store_dwordx4 v[160:163], v2, s[24:27], s63 offen offset:0 sc1
    v_cvt_pk_bf16_f32 v168, v168, v169
    v_cvt_pk_bf16_f32 v169, v170, v171
    v_cvt_pk_bf16_f32 v170, v172, v173
    v_cvt_pk_bf16_f32 v171, v174, v175
    buffer_store_dwordx4 v[168:171], v2, s[24:27], s63 offen offset:1024 sc1
    s_add_u32 s63, s69, 2048
    v_cvt_pk_bf16_f32 v176, v176, v177
    v_cvt_pk_bf16_f32 v177, v178, v179
    v_cvt_pk_bf16_f32 v178, v180, v181
    v_cvt_pk_bf16_f32 v179, v182, v183
    buffer_store_dwordx4 v[176:179], v2, s[24:27], s63 offen offset:0 sc1
    v_cvt_pk_bf16_f32 v184, v184, v185
    v_cvt_pk_bf16_f32 v185, v186, v187
    v_cvt_pk_bf16_f32 v186, v188, v189
    v_cvt_pk_bf16_f32 v187, v190, v191
    buffer_store_dwordx4 v[184:187], v2, s[24:27], s63 offen offset:1024 sc1
    s_add_u32 s63, s69, 4096
    v_cvt_pk_bf16_f32 v192, v192, v193
    v_cvt_pk_bf16_f32 v193, v194, v195
    v_cvt_pk_bf16_f32 v194, v196, v197
    v_cvt_pk_bf16_f32 v195, v198, v199
    buffer_store_dwordx4 v[192:195], v2, s[24:27], s63 offen offset:0 sc1
    v_cvt_pk_bf16_f32 v200, v200, v201
    v_cvt_pk_bf16_f32 v201, v202, v203
    v_cvt_pk_bf16_f32 v202, v204, v205
    v_cvt_pk_bf16_f32 v203, v206, v207
    buffer_store_dwordx4 v[200:203], v2, s[24:27], s63 offen offset:1024 sc1
    s_add_u32 s63, s69, 6144
    v_cvt_pk_bf16_f32 v208, v208, v209
    v_cvt_pk_bf16_f32 v209, v210, v211
    v_cvt_pk_bf16_f32 v210, v212, v213
    v_cvt_pk_bf16_f32 v211, v214, v215
    buffer_store_dwordx4 v[208:211], v2, s[24:27], s63 offen offset:0 sc1
    v_cvt_pk_bf16_f32 v216, v216, v217
    v_cvt_pk_bf16_f32 v217, v218, v219
    v_cvt_pk_bf16_f32 v218, v220, v221
    v_cvt_pk_bf16_f32 v219, v222, v223
    buffer_store_dwordx4 v[216:219], v2, s[24:27], s63 offen offset:1024 sc1
P4:
    s_load_dwordx2 s[4:5], s[0:1], 80
    s_load_dwordx2 s[6:7], s[0:1], 96
    s_and_b32 s41, s2, 7
    s_lshr_b32 s47, s2, 3
    s_and_b32 s43, s47, 7
    s_lshr_b32 s42, s47, 3
    s_lshl_b32 s48, s41, 2
    s_add_u32 s42, s42, s48
    s_and_b32 s45, s56, 1
    s_lshr_b32 s46, s56, 1
    v_lshrrev_b32 v3, 3, v1
    v_and_b32 v4, 7, v1
    v_lshrrev_b32 v5, 1, v4
    v_and_b32 v4, 1, v4
    v_lshrrev_b32 v6, 1, v3
    v_xor_b32 v5, v5, v6
    v_lshlrev_b32 v5, 5, v5
    v_lshlrev_b32 v4, 4, v4
    v_add_u32 v5, v5, v4
    v_lshlrev_b32 v3, 10, v3
    v_add_u32 v3, v3, v5
    s_mul_i32 s64, s46, 224*1024
    s_lshl_b32 s48, s45, 13
    s_add_u32 s64, s64, s48
    s_lshl_b32 s48, s43, 7
    s_add_u32 s64, s64, s48
    s_mul_i32 s65, s46, 224*128
    s_lshl_b32 s48, s45, 10
    s_add_u32 s66, s65, s48
    s_lshl_b32 s47, s42, 1
    s_add_u32 s47, s47, s45
    s_mul_i32 s67, s47, 57344
    s_mul_i32 s48, s46, 14*1024
    s_add_u32 s67, s67, s48
    s_lshl_b32 s68, s47, 15
    s_lshl_b32 s48, s43, 12
    s_add_u32 s68, s68, s48
    s_lshl_b32 s48, s46, 21
    s_add_u32 s68, s68, s48
    v_and_b32 v6, 15, v1
    v_lshrrev_b32 v4, 2, v6
    v_lshrrev_b32 v5, 4, v1
    v_lshlrev_b32 v8, 2, v5
    v_add_u32 v4, v4, v8
    v_lshrrev_b32 v8, 1, v4
    v_and_b32 v8, 3, v8
    v_lshlrev_b32 v8, 5, v8
    v_lshlrev_b32 v4, 7, v4
    v_add_u32 v4, v4, v8
    v_and_b32 v8, 3, v1
    v_lshlrev_b32 v8, 3, v8
    v_add_u32 v4, v4, v8
    v_add_u32 v120, s65, v4
    v_xor_b32 v121, 32, v120
    v_xor_b32 v122, 64, v120
    v_xor_b32 v123, 96, v120
    v_lshlrev_b32 v7, 2, v6
    s_lshl_b32 s69, s47, 7
    s_lshr_b32 s70, s42, 2
    s_lshl_b32 s70, s70, 7
    s_lshr_b32 s48, s43, 1
    s_lshl_b32 s48, s48, 4
    s_add_u32 s70, s70, s48
    s_add_u32 s70, s70, 10240
    s_lshr_b32 s71, s42, 1
    s_lshl_b32 s71, s71, 7
    s_add_u32 s71, s71, 6128
    v_min_u32 v11, 10, v1
    v_lshlrev_b32 v11, 2, v11
    v_add_u32 v13, s70, v11
    v_add_u32 v11, s71, v11
    v_cmp_gt_u32 vcc, 4, v1
    s_nop 1
    v_cndmask_b32 v11, v11, v13, vcc
    s_waitcnt vmcnt(0) lgkmcnt(0)
    s_barrier
    s_cmp_lt_i32 s51, 0
    s_cbranch_scc1 P4_nosig
    s_cmp_eq_u32 s56, 0
    s_cbranch_scc0 M_sig_329
    s_add_u32 s52, s14, 0x6400000
    s_addc_u32 s53, s15, 0
    s_mov_b32 s54, 0x4000
    s_mov_b32 s55, 0x00020000
    v_mov_b32 v9, s3
    v_mov_b32 v10, 0
    s_mov_b64 exec, 1
    buffer_store_dword v9, v10, s[52:55], s51 offen sc1
    s_mov_b64 exec, -1
M_sig_329:
P4_nosig:
    s_mov_b32 s16, s4
    s_mov_b32 s17, s5
    s_mov_b32 s18, 0xe0000
    s_mov_b32 s19, 0x00020000
    s_add_u32 s52, s14, 0x6400000
    s_addc_u32 s53, s15, 0
    s_mov_b32 s54, 0x4000
    s_mov_b32 s55, 0x00020000
    s_add_u32 m0, s66, 0
    s_add_u32 s63, s64, 0
    buffer_load_dwordx4 v3, s[16:19], s63 offen lds
    s_add_u32 m0, s66, 2048
    s_add_u32 s63, s64, 16384
    buffer_load_dwordx4 v3, s[16:19], s63 offen lds
    s_add_u32 m0, s66, 4096
    s_add_u32 s63, s64, 32768
    buffer_load_dwordx4 v3, s[16:19], s63 offen lds
    s_add_u32 m0, s66, 6144
    s_add_u32 s63, s64, 49152
    buffer_load_dwordx4 v3, s[16:19], s63 offen lds
    s_add_u32 m0, s66, 8192
    s_add_u32 s63, s64, 65536
    buffer_load_dwordx4 v3, s[16:19], s63 offen lds
    s_add_u32 m0, s66, 10240
    s_add_u32 s63, s64, 81920
    buffer_load_dwordx4 v3, s[16:19], s63 offen lds
    s_add_u32 m0, s66, 12288
    s_add_u32 s63, s64, 98304
    buffer_load_dwordx4 v3, s[16:19], s63 offen lds
    s_add_u32 m0, s66, 14336
    s_add_u32 s63, s64, 114688
    buffer_load_dwordx4 v3, s[16:19], s63 offen lds
    s_add_u32 m0, s66, 16384
    s_add_u32 s63, s64, 131072
    buffer_load_dwordx4 v3, s[16:19], s63 offen lds
    s_add_u32 m0, s66, 18432
    s_add_u32 s63, s64, 147456
    buffer_load_dwordx4 v3, s[16:19], s63 offen lds
    s_add_u32 m0, s66, 20480
    s_add_u32 s63, s64, 163840
    buffer_load_dwordx4 v3, s[16:19], s63 offen lds
    s_add_u32 m0, s66, 22528
    s_add_u32 s63, s64, 180224
    buffer_load_dwordx4 v3, s[16:19], s63 offen lds
    s_add_u32 m0, s66, 24576
    s_add_u32 s63, s64, 196608
    buffer_load_dwordx4 v3, s[16:19], s63 offen lds
    s_add_u32 m0, s66, 26624
    s_add_u32 s63, s64, 212992
    buffer_load_dwordx4 v3, s[16:19], s63 offen lds
    s_add_u32 s20, s14, 0x3800000
    s_addc_u32 s21, s15, 0
    s_mov_b32 s22, 0x380000
    s_mov_b32 s23, 0x00020000
    s_add_u32 s24, s14, 0x4000000
    s_addc_u32 s25, s15, 0
    s_mov_b32 s26, 0x1000000
    s_mov_b32 s27, 0x00020000
    s_add_u32 s28, s14, 0x3c00000
    s_addc_u32 s29, s15, 0
    s_mov_b32 s30, 0x2000
    s_mov_b32 s31, 0x00020000
    s_mov_b32 s32, s6
    s_mov_b32 s33, s7
    s_mov_b32 s34, 0x200000
    s_mov_b32 s35, 0x00020000
    s_cmp_eq_u32 s56, 0
    s_cbranch_scc0 P4_go
    s_mov_b32 s97, 0
P4_poll:
    buffer_load_dword v13, v11, s[52:55], 0 offen sc1
    s_waitcnt vmcnt(0)
    v_cmp_ne_u32 vcc, s3, v13
    s_add_u32 s97, s97, 1
    s_cbranch_vccz P4_go
    s_cmp_ge_u32 s97, 0x40000
    s_cbranch_scc1 P4_go
    s_sleep 4
    s_branch P4_poll
P4_go:
    s_waitcnt vmcnt(0)
    s_barrier
    s_add_u32 s63, s67, 0
    buffer_load_dwordx4 v[64:67], v12, s[20:23], s63 offen offset:0 sc1
    buffer_load_dwordx4 v[68:71], v12, s[20:23], s63 offen offset:256 sc1
    s_add_u32 s63, s67, 2048
    buffer_load_dwordx4 v[72:75], v12, s[20:23], s63 offen offset:0 sc1
    buffer_load_dwordx4 v[76:79], v12, s[20:23], s63 offen offset:256 sc1
    s_add_u32 s63, s67, 4096
    buffer_load_dwordx4 v[80:83], v12, s[20:23], s63 offen offset:0 sc1
    buffer_load_dwordx4 v[84:87], v12, s[20:23], s63 offen offset:256 sc1
    s_add_u32 s63, s67, 6144
    buffer_load_dwordx4 v[88:91], v12, s[20:23], s63 offen offset:0 sc1
    buffer_load_dwordx4 v[92:95], v12, s[20:23], s63 offen offset:256 sc1
    s_add_u32 s63, s67, 8192
    buffer_load_dwordx4 v[96:99], v12, s[20:23], s63 offen offset:0 sc1
    buffer_load_dwordx4 v[100:103], v12, s[20:23], s63 offen offset:256 sc1
    s_add_u32 s63, s67, 10240
    buffer_load_dwordx4 v[104:107], v12, s[20:23], s63 offen offset:0 sc1
    buffer_load_dwordx4 v[108:111], v12, s[20:23], s63 offen offset:256 sc1
    s_add_u32 s63, s67, 12288
    buffer_load_dwordx4 v[112:115], v12, s[20:23], s63 offen offset:0 sc1
    buffer_load_dwordx4 v[116:119], v12, s[20:23], s63 offen offset:256 sc1
    buffer_load_dwordx4 v[48:51], v2, s[24:27], s68 offen offset:0 sc1
    buffer_load_dwordx4 v[52:55], v2, s[24:27], s68 offen offset:1024 sc1
    buffer_load_dwordx4 v[56:59], v2, s[24:27], s68 offen offset:2048 sc1
    buffer_load_dwordx4 v[60:63], v2, s[24:27], s68 offen offset:3072 sc1
    buffer_load_dword v14, v7, s[28:31], s69 offen sc1
    buffer_load_dword v15, v7, s[28:31], s69 offen offset:64 sc1
    ds_read_b64_tr_b16 v[160:161], v120 offset:0
    ds_read_b64_tr_b16 v[162:163], v120 offset:2048
    ds_read_b64_tr_b16 v[164:165], v121 offset:0
    ds_read_b64_tr_b16 v[166:167], v121 offset:2048
    ds_read_b64_tr_b16 v[168:169], v122 offset:0
    ds_read_b64_tr_b16 v[170:171], v122 offset:2048
    ds_read_b64_tr_b16 v[172:173], v123 offset:0
    ds_read_b64_tr_b16 v[174:175], v123 offset:2048
    ds_read_b64_tr_b16 v[176:177], v120 offset:4096
    ds_read_b64_tr_b16 v[178:179], v120 offset:6144
    ds_read_b64_tr_b16 v[180:181], v121 offset:4096
    ds_read_b64_tr_b16 v[182:183], v121 offset:6144
    s_waitcnt vmcnt(18) lgkmcnt(10)
    v_mfma_f32_16x16x32_bf16 v[16:19], v[160:163], v[64:67], 0
    ds_read_b64_tr_b16 v[184:185], v122 offset:4096
    ds_read_b64_tr_b16 v[186:187], v122 offset:6144
    v_mfma_f32_16x16x32_bf16 v[24:27], v[160:163], v[68:71], 0
    s_waitcnt lgkmcnt(10)
    v_mfma_f32_16x16x32_bf16 v[20:23], v[164:167], v[64:67], 0
    ds_read_b64_tr_b16 v[188:189], v123 offset:4096
    ds_read_b64_tr_b16 v[190:191], v123 offset:6144
    v_mfma_f32_16x16x32_bf16 v[28:31], v[164:167], v[68:71], 0
    s_waitcnt lgkmcnt(10)
    v_mfma_f32_16x16x32_bf16 v[32:35], v[168:171], v[64:67], 0
    ds_read_b64_tr_b16 v[160:161], v120 offset:8192
    ds_read_b64_tr_b16 v[162:163], v120 offset:10240
    v_mfma_f32_16x16x32_bf16 v[40:43], v[168:171], v[68:71], 0
    s_waitcnt lgkmcnt(10)
    v_mfma_f32_16x16x32_bf16 v[36:39], v[172:175], v[64:67], 0
    ds_read_b64_tr_b16 v[164:165], v121 offset:8192
    ds_read_b64_tr_b16 v[166:167], v121 offset:10240
    v_mfma_f32_16x16x32_bf16 v[44:47], v[172:175], v[68:71], 0
    s_waitcnt vmcnt(16) lgkmcnt(10)
    v_mfma_f32_16x16x32_bf16 v[16:19], v[176:179], v[72:75], v[16:19]
    ds_read_b64_tr_b16 v[168:169], v122 offset:8192
    ds_read_b64_tr_b16 v[170:171], v122 offset:10240
    v_mfma_f32_16x16x32_bf16 v[24:27], v[176:179], v[76:79], v[24:27]
    s_waitcnt lgkmcnt(10)
    v_mfma_f32_16x16x32_bf16 v[20:23], v[180:183], v[72:75], v[20:23]
    ds_read_b64_tr_b16 v[172:173], v123 offset:8192
    ds_read_b64_tr_b16 v[174:175], v123 offset:10240
    v_mfma_f32_16x16x32_bf16 v[28:31], v[180:183], v[76:79], v[28:31]
    s_waitcnt lgkmcnt(10)
    v_mfma_f32_16x16x32_bf16 v[32:35], v[184:187], v[72:75], v[32:35]
    ds_read_b64_tr_b16 v[176:177], v120 offset:12288
    ds_read_b64_tr_b16 v[178:179], v120 offset:14336
    v_mfma_f32_16x16x32_bf16 v[40:43], v[184:187], v[76:79], v[40:43]
    s_waitcnt lgkmcnt(10)
    v_mfma_f32_16x16x32_bf16 v[36:39], v[188:191], v[72:75], v[36:39]
    ds_read_b64_tr_b16 v[180:181], v121 offset:12288
    ds_read_b64_tr_b16 v[182:183], v121 offset:14336
    v_mfma_f32_16x16x32_bf16 v[44:47], v[188:191], v[76:79], v[44:47]
    s_waitcnt vmcnt(14) lgkmcnt(10)
    v_mfma_f32_16x16x32_bf16 v[16:19], v[160:163], v[80:83], v[16:19]
    ds_read_b64_tr_b16 v[184:185], v122 offset:12288
    ds_read_b64_tr_b16 v[186:187], v122 offset:14336
    v_mfma_f32_16x16x32_bf16 v[24:27], v[160:163], v[84:87], v[24:27]
    s_waitcnt lgkmcnt(10)
    v_mfma_f32_16x16x32_bf16 v[20:23], v[164:167], v[80:83], v[20:23]
    ds_read_b64_tr_b16 v[188:189], v123 offset:12288
    ds_read_b64_tr_b16 v[190:191], v123 offset:14336
    v_mfma_f32_16x16x32_bf16 v[28:31], v[164:167], v[84:87], v[28:31]
    s_waitcnt lgkmcnt(10)
    v_mfma_f32_16x16x32_bf16 v[32:35], v[168:171], v[80:83], v[32:35]
    ds_read_b64_tr_b16 v[160:161], v120 offset:16384
    ds_read_b64_tr_b16 v[162:163], v120 offset:18432
    v_mfma_f32_16x16x32_bf16 v[40:43], v[168:171], v[84:87], v[40:43]
    s_waitcnt lgkmcnt(10)
    v_mfma_f32_16x16x32_bf16 v[36:39], v[172:175], v[80:83], v[36:39]
    ds_read_b64_tr_b16 v[164:165], v121 offset:16384
    ds_read_b64_tr_b16 v[166:167], v121 offset:18432
    v_mfma_f32_16x16x32_bf16 v[44:47], v[172:175], v[84:87], v[44:47]
    s_waitcnt vmcnt(12) lgkmcnt(10)
    v_mfma_f32_16x16x32_bf16 v[16:19], v[176:179], v[88:91], v[16:19]
    ds_read_b64_tr_b16 v[168:169], v122 offset:16384
    ds_read_b64_tr_b16 v[170:171], v122 offset:18432
    v_mfma_f32_16x16x32_bf16 v[24:27], v[176:179], v[92:95], v[24:27]
    s_waitcnt lgkmcnt(10)
    v_mfma_f32_16x16x32_bf16 v[20:23], v[180:183], v[88:91], v[20:23]
    ds_read_b64_tr_b16 v[172:173], v123 offset:16384
    ds_read_b64_tr_b16 v[174:175], v123 offset:18432
    v_mfma_f32_16x16x32_bf16 v[28:31], v[180:183], v[92:95], v[28:31]
    s_waitcnt lgkmcnt(10)
    v_mfma_f32_16x16x32_bf16 v[32:35], v[184:187], v[88:91], v[32:35]
    ds_read_b64_tr_b16 v[176:177], v120 offset:20480
    ds_read_b64_tr_b16 v[178:179], v120 offset:22528
    v_mfma_f32_16x16x32_bf16 v[40:43], v[184:187], v[92:95], v[40:43]
    s_waitcnt lgkmcnt(10)
    v_mfma_f32_16x16x32_bf16 v[36:39], v[188:191], v[88:91], v[36:39]
    ds_read_b64_tr_b16 v[180:181], v121 offset:20480
    ds_read_b64_tr_b16 v[182:183], v121 offset:22528
    v_mfma_f32_16x16x32_bf16 v[44:47], v[188:191], v[92:95], v[44:47]
    s_waitcnt vmcnt(10) lgkmcnt(10)
    v_mfma_f32_16x16x32_bf16 v[16:19], v[160:163], v[96:99], v[16:19]
    ds_read_b64_tr_b16 v[184:185], v122 offset:20480
    ds_read_b64_tr_b16 v[186:187], v122 offset:22528
    v_mfma_f32_16x16x32_bf16 v[24:27], v[160:163], v[100:103], v[24:27]
    s_waitcnt lgkmcnt(10)
    v_mfma_f32_16x16x32_bf16 v[20:23], v[164:167], v[96:99], v[20:23]
    ds_read_b64_tr_b16 v[188:189], v123 offset:20480
    ds_read_b64_tr_b16 v[190:191], v123 offset:22528
    v_mfma_f32_16x16x32_bf16 v[28:31], v[164:167], v[100:103], v[28:31]
    s_waitcnt lgkmcnt(10)
    v_mfma_f32_16x16x32_bf16 v[32:35], v[168:171], v[96:99], v[32:35]
    ds_read_b64_tr_b16 v[160:161], v120 offset:24576
    ds_read_b64_tr_b16 v[162:163], v120 offset:26624
    v_mfma_f32_16x16x32_bf16 v[40:43], v[168:171], v[100:103], v[40:43]
    s_waitcnt lgkmcnt(10)
    v_mfma_f32_16x16x32_bf16 v[36:39], v[172:175], v[96:99], v[36:39]
    ds_read_b64_tr_b16 v[164:165], v121 offset:24576
    ds_read_b64_tr_b16 v[166:167], v121 offset:26624
    v_mfma_f32_16x16x32_bf16 v[44:47], v[172:175], v[100:103], v[44:47]
    s_waitcnt vmcnt(8) lgkmcnt(10)
    v_mfma_f32_16x16x32_bf16 v[16:19], v[176:179], v[104:107], v[16:19]
    ds_read_b64_tr_b16 v[168:169], v122 offset:24576
    ds_read_b64_tr_b16 v[170:171], v122 offset:26624
    v_mfma_f32_16x16x32_bf16 v[24:27], v[176:179], v[108:111], v[24:27]
    s_waitcnt lgkmcnt(10)
    v_mfma_f32_16x16x32_bf16 v[20:23], v[180:183], v[104:107], v[20:23]
    ds_read_b64_tr_b16 v[172:173], v123 offset:24576
    ds_read_b64_tr_b16 v[174:175], v123 offset:26624
    v_mfma_f32_16x16x32_bf16 v[28:31], v[180:183], v[108:111], v[28:31]
    s_waitcnt lgkmcnt(10)
    v_mfma_f32_16x16x32_bf16 v[32:35], v[184:187], v[104:107], v[32:35]
    v_mfma_f32_16x16x32_bf16 v[40:43], v[184:187], v[108:111], v[40:43]
    s_waitcnt lgkmcnt(8)
    v_mfma_f32_16x16x32_bf16 v[36:39], v[188:191], v[104:107], v[36:39]
    v_mfma_f32_16x16x32_bf16 v[44:47], v[188:191], v[108:111], v[44:47]
    s_waitcnt vmcnt(6) lgkmcnt(6)
    v_mfma_f32_16x16x32_bf16 v[16:19], v[160:163], v[112:115], v[16:19]
    v_mfma_f32_16x16x32_bf16 v[24:27], v[160:163], v[116:119], v[24:27]
    s_waitcnt lgkmcnt(4)
    v_mfma_f32_16x16x32_bf16 v[20:23], v[164:167], v[112:115], v[20:23]
    v_mfma_f32_16x16x32_bf16 v[28:31], v[164:167], v[116:119], v[28:31]
    s_waitcnt lgkmcnt(2)
    v_mfma_f32_16x16x32_bf16 v[32:35], v[168:171], v[112:115], v[32:35]
    v_mfma_f32_16x16x32_bf16 v[40:43], v[168:171], v[116:119], v[40:43]
    s_waitcnt lgkmcnt(0)
    v_mfma_f32_16x16x32_bf16 v[36:39], v[172:175], v[112:115], v[36:39]
    v_mfma_f32_16x16x32_bf16 v[44:47], v[172:175], v[116:119], v[44:47]
    s_lshl_b32 s48, s56, 13
    v_add_u32 v8, s48, v2
    s_waitcnt vmcnt(0)
    v_lshlrev_b32 v128, 16, v48
    v_and_b32 v129, 0xffff0000, v48
    v_lshlrev_b32 v130, 16, v49
    v_and_b32 v131, 0xffff0000, v49
    v_lshlrev_b32 v132, 16, v50
    v_and_b32 v133, 0xffff0000, v50
    v_lshlrev_b32 v134, 16, v51
    v_and_b32 v135, 0xffff0000, v51
    v_lshlrev_b32 v136, 16, v52
    v_and_b32 v137, 0xffff0000, v52
    v_lshlrev_b32 v138, 16, v53
    v_and_b32 v139, 0xffff0000, v53
    v_lshlrev_b32 v140, 16, v54
    v_and_b32 v141, 0xffff0000, v54
    v_lshlrev_b32 v142, 16, v55
    v_and_b32 v143, 0xffff0000, v55
    v_lshlrev_b32 v144, 16, v56
    v_and_b32 v145, 0xffff0000, v56
    v_lshlrev_b32 v146, 16, v57
    v_and_b32 v147, 0xffff0000, v57
    v_lshlrev_b32 v148, 16, v58
    v_and_b32 v149, 0xffff0000, v58
    v_lshlrev_b32 v150, 16, v59
    v_and_b32 v151, 0xffff0000, v59
    v_lshlrev_b32 v152, 16, v60
    v_and_b32 v153, 0xffff0000, v60
    v_lshlrev_b32 v154, 16, v61
    v_and_b32 v155, 0xffff0000, v61
    v_lshlrev_b32 v156, 16, v62
    v_and_b32 v157, 0xffff0000, v62
    v_lshlrev_b32 v158, 16, v63
    v_and_b32 v159, 0xffff0000, v63
    s_barrier
    v_sub_f32 v128, v128, v16
    v_sub_f32 v129, v129, v17
    v_sub_f32 v130, v130, v18
    v_sub_f32 v131, v131, v19
    v_sub_f32 v132, v132, v20
    v_sub_f32 v133, v133, v21
    v_sub_f32 v134, v134, v22
    v_sub_f32 v135, v135, v23
    v_sub_f32 v136, v136, v24
    v_sub_f32 v137, v137, v25
    v_sub_f32 v138, v138, v26
    v_sub_f32 v139, v139, v27
    v_sub_f32 v140, v140, v28
    v_sub_f32 v141, v141, v29
    v_sub_f32 v142, v142, v30
    v_sub_f32 v143, v143, v31
    v_sub_f32 v144, v144, v32
    v_sub_f32 v145, v145, v33
    v_sub_f32 v146, v146, v34
    v_sub_f32 v147, v147, v35
    v_sub_f32 v148, v148, v36
    v_sub_f32 v149, v149, v37
    v_sub_f32 v150, v150, v38
    v_sub_f32 v151, v151, v39
    v_sub_f32 v152, v152, v40
    v_sub_f32 v153, v153, v41
    v_sub_f32 v154, v154, v42
    v_sub_f32 v155, v155, v43
    v_sub_f32 v156, v156, v44
    v_sub_f32 v157, v157, v45
    v_sub_f32 v158, v158, v46
    v_sub_f32 v159, v159, v47
    v_fma_f32 v128, v128, v14, v16
    v_fma_f32 v129, v129, v14, v17
    v_fma_f32 v130, v130, v14, v18
    v_fma_f32 v131, v131, v14, v19
    v_fma_f32 v132, v132, v14, v20
    v_fma_f32 v133, v133, v14, v21
    v_fma_f32 v134, v134, v14, v22
    v_fma_f32 v135, v135, v14, v23
    v_fma_f32 v136, v136, v15, v24
    v_fma_f32 v137, v137, v15, v25
    v_fma_f32 v138, v138, v15, v26
    v_fma_f32 v139, v139, v15, v27
    v_fma_f32 v140, v140, v15, v28
    v_fma_f32 v141, v141, v15, v29
    v_fma_f32 v142, v142, v15, v30
    v_fma_f32 v143, v143, v15, v31
    v_fma_f32 v144, v144, v14, v32
    v_fma_f32 v145, v145, v14, v33
    v_fma_f32 v146, v146, v14, v34
    v_fma_f32 v147, v147, v14, v35
    v_fma_f32 v148, v148, v14, v36
    v_fma_f32 v149, v149, v14, v37
    v_fma_f32 v150, v150, v14, v38
    v_fma_f32 v151, v151, v14, v39
    v_fma_f32 v152, v152, v15, v40
    v_fma_f32 v153, v153, v15, v41
    v_fma_f32 v154, v154, v15, v42
    v_fma_f32 v155, v155, v15, v43
    v_fma_f32 v156, v156, v15, v44
    v_fma_f32 v157, v157, v15, v45
    v_fma_f32 v158, v158, v15, v46
    v_fma_f32 v159, v159, v15, v47
    ds_write_b128 v8, v[128:131] offset:0
    ds_write_b128 v8, v[132:135] offset:1024
    ds_write_b128 v8, v[136:139] offset:2048
    ds_write_b128 v8, v[140:143] offset:3072
    ds_write_b128 v8, v[144:147] offset:4096
    ds_write_b128 v8, v[148:151] offset:5120
    ds_write_b128 v8, v[152:155] offset:6144
    ds_write_b128 v8, v[156:159] offset:7168
    s_lshl_b32 s48, s45, 13
    s_lshl_b32 s49, s46, 11
    s_add_u32 s48, s48, s49
    v_add_u32 v9, s48, v2
    v_lshlrev_b32 v6, 10, v6
    v_and_b32 v10, 1, v5
    v_lshlrev_b32 v10, 5, v10
    v_lshrrev_b32 v5, 1, v5
    v_lshlrev_b32 v5, 4, v5
    v_add3_u32 v6, v6, v10, v5
    s_lshl_b32 s48, s47, 15
    s_lshl_b32 s49, s43, 7
    s_add_u32 s48, s48, s49
    s_lshr_b32 s49, s46, 1
    s_lshl_b32 s49, s49, 6
    s_add_u32 s48, s48, s49
    s_and_b32 s49, s46, 1
    s_lshl_b32 s49, s49, 14
    s_add_u32 s48, s48, s49
    s_waitcnt lgkmcnt(0)
    s_barrier
    ds_read_b128 v[64:67], v9 offset:0
    ds_read_b128 v[68:71], v9 offset:1024
    ds_read_b128 v[72:75], v9 offset:16384
    ds_read_b128 v[76:79], v9 offset:17408
    ds_read_b128 v[80:83], v9 offset:32768
    ds_read_b128 v[84:87], v9 offset:33792
    ds_read_b128 v[88:91], v9 offset:49152
    ds_read_b128 v[92:95], v9 offset:50176
    s_waitcnt lgkmcnt(4)
    v_add_f32 v64, v64, v72
    v_add_f32 v65, v65, v73
    v_add_f32 v66, v66, v74
    v_add_f32 v67, v67, v75
    v_add_f32 v68, v68, v76
    v_add_f32 v69, v69, v77
    v_add_f32 v70, v70, v78
    v_add_f32 v71, v71, v79
    s_waitcnt lgkmcnt(0)
    v_add_f32 v80, v80, v88
    v_add_f32 v81, v81, v89
    v_add_f32 v82, v82, v90
    v_add_f32 v83, v83, v91
    v_add_f32 v84, v84, v92
    v_add_f32 v85, v85, v93
    v_add_f32 v86, v86, v94
    v_add_f32 v87, v87, v95
    v_add_f32 v64, v64, v80
    v_add_f32 v65, v65, v81
    v_add_f32 v66, v66, v82
    v_add_f32 v67, v67, v83
    v_add_f32 v68, v68, v84
    v_add_f32 v69, v69, v85
    v_add_f32 v70, v70, v86
    v_add_f32 v71, v71, v87
    v_cvt_pk_bf16_f32 v64, v64, v65
    v_cvt_pk_bf16_f32 v65, v66, v67
    v_cvt_pk_bf16_f32 v66, v68, v69
    v_cvt_pk_bf16_f32 v67, v70, v71
    s_nop 1
    v_permlane16_swap_b32 v64, v66
    v_permlane16_swap_b32 v65, v67
    buffer_store_dwordx4 v[64:67], v6, s[32:35], s48 offen
M_fin:
M_end:
    s_endpgm
A_fc_82:
    s_lshr_b32 s51, s59, 1
    s_lshl_b32 s51, s51, 7
    s_cmp_eq_u32 s56, 0
    s_cbranch_scc0 M_poll_84
    s_add_u32 s52, s14, 0x6400000
    s_addc_u32 s53, s15, 0
    s_mov_b32 s54, 0x4000
    s_mov_b32 s55, 0x00020000
    s_mov_b32 s97, 0
    v_and_b32 v10, 15, v1
    v_lshlrev_b32 v10, 2, v10
M_pl_85:
    buffer_load_dword v9, v10, s[52:55], s51 offen sc1
    s_waitcnt vmcnt(0)
    v_cmp_ne_u32 vcc, s3, v9
    s_add_u32 s97, s97, 1
    s_cbranch_vccz M_pd_86
    s_cmp_ge_u32 s97, 0x40000
    s_cbranch_scc1 M_pd_86
    s_sleep 4
    s_branch M_pl_85
M_pd_86:
M_poll_84:
    s_branch A_fcret_83
A_fc_88:
    s_lshr_b32 s63, s2, 4
    s_sub_u32 s51, 15, s63
    s_min_u32 s51, s51, s63
    s_lshl_b32 s51, s51, 7
    s_add_u32 s51, s51, 4096
    s_cmp_eq_u32 s56, 0
    s_cbranch_scc0 M_poll_90
    s_add_u32 s52, s14, 0x6400000
    s_addc_u32 s53, s15, 0
    s_mov_b32 s54, 0x4000
    s_mov_b32 s55, 0x00020000
    s_mov_b32 s97, 0
    v_and_b32 v10, 31, v1
    v_lshlrev_b32 v10, 2, v10
M_pl_91:
    buffer_load_dword v9, v10, s[52:55], s51 offen sc1
    s_waitcnt vmcnt(0)
    v_cmp_ne_u32 vcc, s3, v9
    s_add_u32 s97, s97, 1
    s_cbranch_vccz M_pd_92
    s_cmp_ge_u32 s97, 0x40000
    s_cbranch_scc1 M_pd_92
    s_sleep 4
    s_branch M_pl_91
M_pd_92:
M_poll_90:
    s_branch A_fcret_89
A_slow_98:
    v_max3_f32 v8, v96, v97, v98
    v_max3_f32 v8, v8, v99, v100
    v_max3_f32 v8, v8, v101, v102
    v_max3_f32 v8, v8, v103, v112
    v_max3_f32 v8, v8, v113, v114
    v_max3_f32 v8, v8, v115, v116
    v_max3_f32 v8, v8, v117, v118
    v_max_f32 v8, v8, v119
    v_max3_f32 v14, v104, v105, v106
    v_max3_f32 v14, v14, v107, v108
    v_max3_f32 v14, v14, v109, v110
    v_max3_f32 v14, v14, v111, v120
    v_max3_f32 v14, v14, v121, v122
    v_max3_f32 v14, v14, v123, v124
    v_max3_f32 v14, v14, v125, v126
    v_max_f32 v14, v14, v127
    v_mov_b32 v9, v8
    v_mov_b32 v10, v14
    s_nop 1
    v_permlane16_swap_b32 v8, v9
    v_permlane16_swap_b32 v14, v10
    s_nop 1
    v_max_f32 v8, v8, v9
    v_max_f32 v14, v14, v10
    v_mov_b32 v9, v8
    v_mov_b32 v10, v14
    s_nop 1
    v_permlane32_swap_b32 v8, v9
    v_permlane32_swap_b32 v14, v10
    s_nop 1
    v_max_f32 v8, v8, v9
    v_max_f32 v14, v14, v10
    s_cmp_eq_u32 s101, 1
    s_cbranch_scc1 A_sf_100
    v_max_f32 v8, 0, v8
    v_sub_f32 v9, 0, v8
    v_exp_f32 v11, v9
    v_max_f32 v14, 0, v14
    v_sub_f32 v10, 0, v14
    v_exp_f32 v7, v10
    s_or_b32 s98, s98, 1
    s_branch A_sj_101
A_sf_100:
    v_max_f32 v8, 0xf149f2ca, v8
    v_max_f32 v14, 0xf149f2ca, v14
A_sj_101:
    v_add_f32 v5, v5, v8
    v_add_f32 v6, v6, v14
    v_sub_f32 v96, v96, v8
    v_sub_f32 v97, v97, v8
    v_sub_f32 v98, v98, v8
    v_sub_f32 v99, v99, v8
    v_sub_f32 v100, v100, v8
    v_sub_f32 v101, v101, v8
    v_sub_f32 v102, v102, v8
    v_sub_f32 v103, v103, v8
    v_sub_f32 v104, v104, v14
    v_sub_f32 v105, v105, v14
    v_sub_f32 v106, v106, v14
    v_sub_f32 v107, v107, v14
    v_sub_f32 v108, v108, v14
    v_sub_f32 v109, v109, v14
    v_sub_f32 v110, v110, v14
    v_sub_f32 v111, v111, v14
    v_sub_f32 v112, v112, v8
    v_sub_f32 v113, v113, v8
    v_sub_f32 v114, v114, v8
    v_sub_f32 v115, v115, v8
    v_sub_f32 v116, v116, v8
    v_sub_f32 v117, v117, v8
    v_sub_f32 v118, v118, v8
    v_sub_f32 v119, v119, v8
    v_sub_f32 v120, v120, v14
    v_sub_f32 v121, v121, v14
    v_sub_f32 v122, v122, v14
    v_sub_f32 v123, v123, v14
    v_sub_f32 v124, v124, v14
    v_sub_f32 v125, v125, v14
    v_sub_f32 v126, v126, v14
    v_sub_f32 v127, v127, v14
    v_sub_f32 v16, 0, v5
    v_sub_f32 v17, 0, v5
    v_sub_f32 v18, 0, v5
    v_sub_f32 v19, 0, v5
    v_sub_f32 v20, 0, v6
    v_sub_f32 v21, 0, v6
    v_sub_f32 v22, 0, v6
    v_sub_f32 v23, 0, v6
    s_branch A_slowret_99
A_resc_102:
    s_nop 15
    s_cmp_eq_u32 s98, 2
    s_mov_b32 s98, 0
    s_cbranch_scc1 A_fin_104
    v_mul_f32 v160, v160, v11
    v_mul_f32 v161, v161, v11
    v_mul_f32 v162, v162, v11
    v_mul_f32 v163, v163, v11
    v_mul_f32 v164, v164, v11
    v_mul_f32 v165, v165, v11
    v_mul_f32 v166, v166, v11
    v_mul_f32 v167, v167, v11
    v_mul_f32 v168, v168, v7
    v_mul_f32 v169, v169, v7
    v_mul_f32 v170, v170, v7
    v_mul_f32 v171, v171, v7
    v_mul_f32 v172, v172, v7
    v_mul_f32 v173, v173, v7
    v_mul_f32 v174, v174, v7
    v_mul_f32 v175, v175, v7
    v_mul_f32 v176, v176, v11
    v_mul_f32 v177, v177, v11
    v_mul_f32 v178, v178, v11
    v_mul_f32 v179, v179, v11
    v_mul_f32 v180, v180, v11
    v_mul_f32 v181, v181, v11
    v_mul_f32 v182, v182, v11
    v_mul_f32 v183, v183, v11
    v_mul_f32 v184, v184, v7
    v_mul_f32 v185, v185, v7
    v_mul_f32 v186, v186, v7
    v_mul_f32 v187, v187, v7
    v_mul_f32 v188, v188, v7
    v_mul_f32 v189, v189, v7
    v_mul_f32 v190, v190, v7
    v_mul_f32 v191, v191, v7
    v_mul_f32 v192, v192, v11
    v_mul_f32 v193, v193, v11
    v_mul_f32 v194, v194, v11
    v_mul_f32 v195, v195, v11
    v_mul_f32 v196, v196, v11
    v_mul_f32 v197, v197, v11
    v_mul_f32 v198, v198, v11
    v_mul_f32 v199, v199, v11
    v_mul_f32 v200, v200, v7
    v_mul_f32 v201, v201, v7
    v_mul_f32 v202, v202, v7
    v_mul_f32 v203, v203, v7
    v_mul_f32 v204, v204, v7
    v_mul_f32 v205, v205, v7
    v_mul_f32 v206, v206, v7
    v_mul_f32 v207, v207, v7
    v_mul_f32 v208, v208, v11
    v_mul_f32 v209, v209, v11
    v_mul_f32 v210, v210, v11
    v_mul_f32 v211, v211, v11
    v_mul_f32 v212, v212, v11
    v_mul_f32 v213, v213, v11
    v_mul_f32 v214, v214, v11
    v_mul_f32 v215, v215, v11
    v_mul_f32 v216, v216, v7
    v_mul_f32 v217, v217, v7
    v_mul_f32 v218, v218, v7
    v_mul_f32 v219, v219, v7
    v_mul_f32 v220, v220, v7
    v_mul_f32 v221, v221, v7
    v_mul_f32 v222, v222, v7
    v_mul_f32 v223, v223, v7
    v_mul_f32 v24, v24, v11
    v_mul_f32 v25, v25, v11
    v_mul_f32 v26, v26, v11
    v_mul_f32 v27, v27, v11
    v_mul_f32 v28, v28, v7
    v_mul_f32 v29, v29, v7
    v_mul_f32 v30, v30, v7
    v_mul_f32 v31, v31, v7
    s_branch A_rescret_103
A_fin_104:
    v_rcp_f32 v9, v24
    v_rcp_f32 v10, v28
    v_mov_b32 v24, 0
    v_mov_b32 v25, 0
    v_mov_b32 v26, 0
    v_mov_b32 v27, 0
    v_mov_b32 v28, 0
    v_mov_b32 v29, 0
    v_mov_b32 v30, 0
    v_mov_b32 v31, 0
    s_lshl_b32 s63, s60, 2
    s_add_u32 s63, s63, s58
    s_lshl_b32 s63, s63, 18
    s_lshl_b32 s96, s59, 13
    s_add_u32 s63, s63, s96
    v_mul_f32 v160, v160, v9
    v_mul_f32 v161, v161, v9
    v_mul_f32 v162, v162, v9
    v_mul_f32 v163, v163, v9
    v_mul_f32 v164, v164, v9
    v_mul_f32 v165, v165, v9
    v_mul_f32 v166, v166, v9
    v_mul_f32 v167, v167, v9
    v_mul_f32 v168, v168, v10
    v_mul_f32 v169, v169, v10
    v_mul_f32 v170, v170, v10
    v_mul_f32 v171, v171, v10
    v_mul_f32 v172, v172, v10
    v_mul_f32 v173, v173, v10
    v_mul_f32 v174, v174, v10
    v_mul_f32 v175, v175, v10
    s_add_u32 s96, s63, 0
    v_cvt_pk_bf16_f32 v160, v160, v161
    v_cvt_pk_bf16_f32 v161, v162, v163
    v_cvt_pk_bf16_f32 v162, v164, v165
    v_cvt_pk_bf16_f32 v163, v166, v167
    buffer_store_dwordx4 v[160:163], v12, s[28:31], s96 offen offset:0 sc1
    v_cvt_pk_bf16_f32 v168, v168, v169
    v_cvt_pk_bf16_f32 v169, v170, v171
    v_cvt_pk_bf16_f32 v170, v172, v173
    v_cvt_pk_bf16_f32 v171, v174, v175
    buffer_store_dwordx4 v[168:171], v12, s[28:31], s96 offen offset:256 sc1
    v_mov_b32 v164, 0
    v_mov_b32 v165, 0
    v_mov_b32 v166, 0
    v_mov_b32 v167, 0
    v_mov_b32 v172, 0
    v_mov_b32 v173, 0
    v_mov_b32 v174, 0
    v_mov_b32 v175, 0
    v_mov_b32 v160, 0
    v_mov_b32 v161, 0
    v_mov_b32 v162, 0
    v_mov_b32 v163, 0
    v_mov_b32 v168, 0
    v_mov_b32 v169, 0
    v_mov_b32 v170, 0
    v_mov_b32 v171, 0
    v_mul_f32 v176, v176, v9
    v_mul_f32 v177, v177, v9
    v_mul_f32 v178, v178, v9
    v_mul_f32 v179, v179, v9
    v_mul_f32 v180, v180, v9
    v_mul_f32 v181, v181, v9
    v_mul_f32 v182, v182, v9
    v_mul_f32 v183, v183, v9
    v_mul_f32 v184, v184, v10
    v_mul_f32 v185, v185, v10
    v_mul_f32 v186, v186, v10
    v_mul_f32 v187, v187, v10
    v_mul_f32 v188, v188, v10
    v_mul_f32 v189, v189, v10
    v_mul_f32 v190, v190, v10
    v_mul_f32 v191, v191, v10
    s_add_u32 s96, s63, 2048
    v_cvt_pk_bf16_f32 v176, v176, v177
    v_cvt_pk_bf16_f32 v177, v178, v179
    v_cvt_pk_bf16_f32 v178, v180, v181
    v_cvt_pk_bf16_f32 v179, v182, v183
    buffer_store_dwordx4 v[176:179], v12, s[28:31], s96 offen offset:0 sc1
    v_cvt_pk_bf16_f32 v184, v184, v185
    v_cvt_pk_bf16_f32 v185, v186, v187
    v_cvt_pk_bf16_f32 v186, v188, v189
    v_cvt_pk_bf16_f32 v187, v190, v191
    buffer_store_dwordx4 v[184:187], v12, s[28:31], s96 offen offset:256 sc1
    v_mov_b32 v180, 0
    v_mov_b32 v181, 0
    v_mov_b32 v182, 0
    v_mov_b32 v183, 0
    v_mov_b32 v188, 0
    v_mov_b32 v189, 0
    v_mov_b32 v190, 0
    v_mov_b32 v191, 0
    v_mov_b32 v176, 0
    v_mov_b32 v177, 0
    v_mov_b32 v178, 0
    v_mov_b32 v179, 0
    v_mov_b32 v184, 0
    v_mov_b32 v185, 0
    v_mov_b32 v186, 0
    v_mov_b32 v187, 0
    v_mul_f32 v192, v192, v9
    v_mul_f32 v193, v193, v9
    v_mul_f32 v194, v194, v9
    v_mul_f32 v195, v195, v9
    v_mul_f32 v196, v196, v9
    v_mul_f32 v197, v197, v9
    v_mul_f32 v198, v198, v9
    v_mul_f32 v199, v199, v9
    v_mul_f32 v200, v200, v10
    v_mul_f32 v201, v201, v10
    v_mul_f32 v202, v202, v10
    v_mul_f32 v203, v203, v10
    v_mul_f32 v204, v204, v10
    v_mul_f32 v205, v205, v10
    v_mul_f32 v206, v206, v10
    v_mul_f32 v207, v207, v10
    s_add_u32 s96, s63, 4096
    v_cvt_pk_bf16_f32 v192, v192, v193
    v_cvt_pk_bf16_f32 v193, v194, v195
    v_cvt_pk_bf16_f32 v194, v196, v197
    v_cvt_pk_bf16_f32 v195, v198, v199
    buffer_store_dwordx4 v[192:195], v12, s[28:31], s96 offen offset:0 sc1
    v_cvt_pk_bf16_f32 v200, v200, v201
    v_cvt_pk_bf16_f32 v201, v202, v203
    v_cvt_pk_bf16_f32 v202, v204, v205
    v_cvt_pk_bf16_f32 v203, v206, v207
    buffer_store_dwordx4 v[200:203], v12, s[28:31], s96 offen offset:256 sc1
    v_mov_b32 v196, 0
    v_mov_b32 v197, 0
    v_mov_b32 v198, 0
    v_mov_b32 v199, 0
    v_mov_b32 v204, 0
    v_mov_b32 v205, 0
    v_mov_b32 v206, 0
    v_mov_b32 v207, 0
    v_mov_b32 v192, 0
    v_mov_b32 v193, 0
    v_mov_b32 v194, 0
    v_mov_b32 v195, 0
    v_mov_b32 v200, 0
    v_mov_b32 v201, 0
    v_mov_b32 v202, 0
    v_mov_b32 v203, 0
    v_mul_f32 v208, v208, v9
    v_mul_f32 v209, v209, v9
    v_mul_f32 v210, v210, v9
    v_mul_f32 v211, v211, v9
    v_mul_f32 v212, v212, v9
    v_mul_f32 v213, v213, v9
    v_mul_f32 v214, v214, v9
    v_mul_f32 v215, v215, v9
    v_mul_f32 v216, v216, v10
    v_mul_f32 v217, v217, v10
    v_mul_f32 v218, v218, v10
    v_mul_f32 v219, v219, v10
    v_mul_f32 v220, v220, v10
    v_mul_f32 v221, v221, v10
    v_mul_f32 v222, v222, v10
    v_mul_f32 v223, v223, v10
    s_add_u32 s96, s63, 6144
    v_cvt_pk_bf16_f32 v208, v208, v209
    v_cvt_pk_bf16_f32 v209, v210, v211
    v_cvt_pk_bf16_f32 v210, v212, v213
    v_cvt_pk_bf16_f32 v211, v214, v215
    buffer_store_dwordx4 v[208:211], v12, s[28:31], s96 offen offset:0 sc1
    v_cvt_pk_bf16_f32 v216, v216, v217
    v_cvt_pk_bf16_f32 v217, v218, v219
    v_cvt_pk_bf16_f32 v218, v220, v221
    v_cvt_pk_bf16_f32 v219, v222, v223
    buffer_store_dwordx4 v[216:219], v12, s[28:31], s96 offen offset:256 sc1
    v_mov_b32 v212, 0
    v_mov_b32 v213, 0
    v_mov_b32 v214, 0
    v_mov_b32 v215, 0
    v_mov_b32 v220, 0
    v_mov_b32 v221, 0
    v_mov_b32 v222, 0
    v_mov_b32 v223, 0
    v_mov_b32 v208, 0
    v_mov_b32 v209, 0
    v_mov_b32 v210, 0
    v_mov_b32 v211, 0
    v_mov_b32 v216, 0
    v_mov_b32 v217, 0
    v_mov_b32 v218, 0
    v_mov_b32 v219, 0
    s_branch A_rescret_103
A_evb_110:
    s_add_u32 s63, s62, 1
    s_mov_b32 s100, -16
    s_sub_u32 s96, s63, s61
    s_add_u32 s96, s96, 2
    s_cmp_lt_u32 s96, 2
    s_cselect_b32 s97, s57, 0
    s_lshl_b32 s96, s96, 1
    s_sub_u32 s96, s96, s58
    s_lshl_b32 s96, s96, 1
    s_cmp_eq_u32 s97, 1
    s_cselect_b32 s100, s96, s100
    s_lshl_b32 s96, s57, 1
    s_sub_u32 s96, s96, s58
    s_lshl_b32 s96, s96, 1
    s_cmp_eq_u32 s63, 16
    s_cselect_b32 s100, s96, s100
    s_cmp_eq_u32 s63, s61
    s_cselect_b32 s101, s57, 0
    s_cmp_eq_u32 s63, 0
    s_cselect_b32 s101, 1, s101
    s_add_u32 s63, s62, 2
    s_cmp_eq_u32 s63, s61
    s_cselect_b32 s63, s57, 0
    s_cmp_eq_u32 s63, 0
    s_cbranch_scc1 A_noq_112
    ds_read_b128 v[32:35], v15 offset:0
    ds_read_b128 v[36:39], v15 offset:1024
    ds_read_b128 v[40:43], v15 offset:2048
    ds_read_b128 v[44:47], v15 offset:3072
    ds_read_b128 v[48:51], v15 offset:4096
    ds_read_b128 v[52:55], v15 offset:5120
    ds_read_b128 v[56:59], v15 offset:6144
    ds_read_b128 v[60:63], v15 offset:7168
    s_waitcnt lgkmcnt(0)
A_noq_112:
    s_lshl_b32 s63, s101, 1
    s_or_b32 s98, s98, s63
    s_cmp_ge_i32 s100, -3
    s_cbranch_scc0 A_evbret_111
    v_and_b32 v9, 15, v1
    v_lshrrev_b32 v10, 4, v1
    v_lshlrev_b32 v10, 2, v10
    s_lshl_b32 s63, s100, 4
    v_sub_u32 v9, v9, v10
    v_subrev_u32 v9, s63, v9
    v_cmp_le_i32 s[64:65], -16, v9
    v_cmp_le_i32 s[66:67], -15, v9
    v_cmp_le_i32 s[68:69], -14, v9
    v_cmp_le_i32 s[70:71], -13, v9
    v_cmp_le_i32 s[72:73], 0, v9
    v_cmp_le_i32 s[74:75], 1, v9
    v_cmp_le_i32 s[76:77], 2, v9
    v_cmp_le_i32 s[78:79], 3, v9
    v_cmp_le_i32 s[80:81], 16, v9
    v_cmp_le_i32 s[82:83], 17, v9
    v_cmp_le_i32 s[84:85], 18, v9
    v_cmp_le_i32 s[86:87], 19, v9
    v_cmp_le_i32 s[88:89], 32, v9
    v_cmp_le_i32 s[90:91], 33, v9
    v_cmp_le_i32 s[92:93], 34, v9
    v_cmp_le_i32 s[94:95], 35, v9
    v_cndmask_b32 v136, v13, v136, s[64:65]
    v_cndmask_b32 v137, v13, v137, s[66:67]
    v_cndmask_b32 v138, v13, v138, s[68:69]
    v_cndmask_b32 v139, v13, v139, s[70:71]
    v_cmp_le_i32 s[64:65], 48, v9
    v_cmp_le_i32 s[66:67], 49, v9
    v_cmp_le_i32 s[68:69], 50, v9
    v_cmp_le_i32 s[70:71], 51, v9
    v_cndmask_b32 v128, v13, v128, s[72:73]
    v_cndmask_b32 v129, v13, v129, s[74:75]
    v_cndmask_b32 v130, v13, v130, s[76:77]
    v_cndmask_b32 v131, v13, v131, s[78:79]
    v_cndmask_b32 v140, v13, v140, s[72:73]
    v_cndmask_b32 v141, v13, v141, s[74:75]
    v_cndmask_b32 v142, v13, v142, s[76:77]
    v_cndmask_b32 v143, v13, v143, s[78:79]
    v_cndmask_b32 v132, v13, v132, s[80:81]
    v_cndmask_b32 v133, v13, v133, s[82:83]
    v_cndmask_b32 v134, v13, v134, s[84:85]
    v_cndmask_b32 v135, v13, v135, s[86:87]
    v_cndmask_b32 v152, v13, v152, s[80:81]
    v_cndmask_b32 v153, v13, v153, s[82:83]
    v_cndmask_b32 v154, v13, v154, s[84:85]
    v_cndmask_b32 v155, v13, v155, s[86:87]
    v_cndmask_b32 v144, v13, v144, s[88:89]
    v_cndmask_b32 v145, v13, v145, s[90:91]
    v_cndmask_b32 v146, v13, v146, s[92:93]
    v_cndmask_b32 v147, v13, v147, s[94:95]
    v_cndmask_b32 v156, v13, v156, s[88:89]
    v_cndmask_b32 v157, v13, v157, s[90:91]
    v_cndmask_b32 v158, v13, v158, s[92:93]
    v_cndmask_b32 v159, v13, v159, s[94:95]
    v_cndmask_b32 v148, v13, v148, s[64:65]
    v_cndmask_b32 v149, v13, v149, s[66:67]
    v_cndmask_b32 v150, v13, v150, s[68:69]
    v_cndmask_b32 v151, v13, v151, s[70:71]
    s_branch A_evbret_111
A_slow_113:
    v_max3_f32 v8, v128, v129, v130
    v_max3_f32 v8, v8, v131, v132
    v_max3_f32 v8, v8, v133, v134
    v_max3_f32 v8, v8, v135, v144
    v_max3_f32 v8, v8, v145, v146
    v_max3_f32 v8, v8, v147, v148
    v_max3_f32 v8, v8, v149, v150
    v_max_f32 v8, v8, v151
    v_max3_f32 v14, v136, v137, v138
    v_max3_f32 v14, v14, v139, v140
    v_max3_f32 v14, v14, v141, v142
    v_max3_f32 v14, v14, v143, v152
    v_max3_f32 v14, v14, v153, v154
    v_max3_f32 v14, v14, v155, v156
    v_max3_f32 v14, v14, v157, v158
    v_max_f32 v14, v14, v159
    v_mov_b32 v9, v8
    v_mov_b32 v10, v14
    s_nop 1
    v_permlane16_swap_b32 v8, v9
    v_permlane16_swap_b32 v14, v10
    s_nop 1
    v_max_f32 v8, v8, v9
    v_max_f32 v14, v14, v10
    v_mov_b32 v9, v8
    v_mov_b32 v10, v14
    s_nop 1
    v_permlane32_swap_b32 v8, v9
    v_permlane32_swap_b32 v14, v10
    s_nop 1
    v_max_f32 v8, v8, v9
    v_max_f32 v14, v14, v10
    s_cmp_eq_u32 s101, 1
    s_cbranch_scc1 A_sf_115
    v_max_f32 v8, 0, v8
    v_sub_f32 v9, 0, v8
    v_exp_f32 v11, v9
    v_max_f32 v14, 0, v14
    v_sub_f32 v10, 0, v14
    v_exp_f32 v7, v10
    s_or_b32 s98, s98, 1
    s_branch A_sj_116
A_sf_115:
    v_max_f32 v8, 0xf149f2ca, v8
    v_max_f32 v14, 0xf149f2ca, v14
A_sj_116:
    v_add_f32 v5, v5, v8
    v_add_f32 v6, v6, v14
    v_sub_f32 v128, v128, v8
    v_sub_f32 v129, v129, v8
    v_sub_f32 v130, v130, v8
    v_sub_f32 v131, v131, v8
    v_sub_f32 v132, v132, v8
    v_sub_f32 v133, v133, v8
    v_sub_f32 v134, v134, v8
    v_sub_f32 v135, v135, v8
    v_sub_f32 v136, v136, v14
    v_sub_f32 v137, v137, v14
    v_sub_f32 v138, v138, v14
    v_sub_f32 v139, v139, v14
    v_sub_f32 v140, v140, v14
    v_sub_f32 v141, v141, v14
    v_sub_f32 v142, v142, v14
    v_sub_f32 v143, v143, v14
    v_sub_f32 v144, v144, v8
    v_sub_f32 v145, v145, v8
    v_sub_f32 v146, v146, v8
    v_sub_f32 v147, v147, v8
    v_sub_f32 v148, v148, v8
    v_sub_f32 v149, v149, v8
    v_sub_f32 v150, v150, v8
    v_sub_f32 v151, v151, v8
    v_sub_f32 v152, v152, v14
    v_sub_f32 v153, v153, v14
    v_sub_f32 v154, v154, v14
    v_sub_f32 v155, v155, v14
    v_sub_f32 v156, v156, v14
    v_sub_f32 v157, v157, v14
    v_sub_f32 v158, v158, v14
    v_sub_f32 v159, v159, v14
    v_sub_f32 v16, 0, v5
    v_sub_f32 v17, 0, v5
    v_sub_f32 v18, 0, v5
    v_sub_f32 v19, 0, v5
    v_sub_f32 v20, 0, v6
    v_sub_f32 v21, 0, v6
    v_sub_f32 v22, 0, v6
    v_sub_f32 v23, 0, v6
    s_branch A_slowret_114
A_resc_120:
    s_nop 15
    s_cmp_eq_u32 s98, 2
    s_mov_b32 s98, 0
    s_cbranch_scc1 A_fin_122
    v_mul_f32 v160, v160, v11
    v_mul_f32 v161, v161, v11
    v_mul_f32 v162, v162, v11
    v_mul_f32 v163, v163, v11
    v_mul_f32 v164, v164, v11
    v_mul_f32 v165, v165, v11
    v_mul_f32 v166, v166, v11
    v_mul_f32 v167, v167, v11
    v_mul_f32 v168, v168, v7
    v_mul_f32 v169, v169, v7
    v_mul_f32 v170, v170, v7
    v_mul_f32 v171, v171, v7
    v_mul_f32 v172, v172, v7
    v_mul_f32 v173, v173, v7
    v_mul_f32 v174, v174, v7
    v_mul_f32 v175, v175, v7
    v_mul_f32 v176, v176, v11
    v_mul_f32 v177, v177, v11
    v_mul_f32 v178, v178, v11
    v_mul_f32 v179, v179, v11
    v_mul_f32 v180, v180, v11
    v_mul_f32 v181, v181, v11
    v_mul_f32 v182, v182, v11
    v_mul_f32 v183, v183, v11
    v_mul_f32 v184, v184, v7
    v_mul_f32 v185, v185, v7
    v_mul_f32 v186, v186, v7
    v_mul_f32 v187, v187, v7
    v_mul_f32 v188, v188, v7
    v_mul_f32 v189, v189, v7
    v_mul_f32 v190, v190, v7
    v_mul_f32 v191, v191, v7
    v_mul_f32 v192, v192, v11
    v_mul_f32 v193, v193, v11
    v_mul_f32 v194, v194, v11
    v_mul_f32 v195, v195, v11
    v_mul_f32 v196, v196, v11
    v_mul_f32 v197, v197, v11
    v_mul_f32 v198, v198, v11
    v_mul_f32 v199, v199, v11
    v_mul_f32 v200, v200, v7
    v_mul_f32 v201, v201, v7
    v_mul_f32 v202, v202, v7
    v_mul_f32 v203, v203, v7
    v_mul_f32 v204, v204, v7
    v_mul_f32 v205, v205, v7
    v_mul_f32 v206, v206, v7
    v_mul_f32 v207, v207, v7
    v_mul_f32 v208, v208, v11
    v_mul_f32 v209, v209, v11
    v_mul_f32 v210, v210, v11
    v_mul_f32 v211, v211, v11
    v_mul_f32 v212, v212, v11
    v_mul_f32 v213, v213, v11
    v_mul_f32 v214, v214, v11
    v_mul_f32 v215, v215, v11
    v_mul_f32 v216, v216, v7
    v_mul_f32 v217, v217, v7
    v_mul_f32 v218, v218, v7
    v_mul_f32 v219, v219, v7
    v_mul_f32 v220, v220, v7
    v_mul_f32 v221, v221, v7
    v_mul_f32 v222, v222, v7
    v_mul_f32 v223, v223, v7
    v_mul_f32 v24, v24, v11
    v_mul_f32 v25, v25, v11
    v_mul_f32 v26, v26, v11
    v_mul_f32 v27, v27, v11
    v_mul_f32 v28, v28, v7
    v_mul_f32 v29, v29, v7
    v_mul_f32 v30, v30, v7
    v_mul_f32 v31, v31, v7
    s_branch A_rescret_121
A_fin_122:
    v_rcp_f32 v9, v24
    v_rcp_f32 v10, v28
    v_mov_b32 v24, 0
    v_mov_b32 v25, 0
    v_mov_b32 v26, 0
    v_mov_b32 v27, 0
    v_mov_b32 v28, 0
    v_mov_b32 v29, 0
    v_mov_b32 v30, 0
    v_mov_b32 v31, 0
    s_lshl_b32 s63, s60, 2
    s_add_u32 s63, s63, s58
    s_lshl_b32 s63, s63, 18
    s_lshl_b32 s96, s59, 13
    s_add_u32 s63, s63, s96
    v_mul_f32 v160, v160, v9
    v_mul_f32 v161, v161, v9
    v_mul_f32 v162, v162, v9
    v_mul_f32 v163, v163, v9
    v_mul_f32 v164, v164, v9
    v_mul_f32 v165, v165, v9
    v_mul_f32 v166, v166, v9
    v_mul_f32 v167, v167, v9
    v_mul_f32 v168, v168, v10
    v_mul_f32 v169, v169, v10
    v_mul_f32 v170, v170, v10
    v_mul_f32 v171, v171, v10
    v_mul_f32 v172, v172, v10
    v_mul_f32 v173, v173, v10
    v_mul_f32 v174, v174, v10
    v_mul_f32 v175, v175, v10
    s_add_u32 s96, s63, 0
    v_cvt_pk_bf16_f32 v160, v160, v161
    v_cvt_pk_bf16_f32 v161, v162, v163
    v_cvt_pk_bf16_f32 v162, v164, v165
    v_cvt_pk_bf16_f32 v163, v166, v167
    buffer_store_dwordx4 v[160:163], v12, s[28:31], s96 offen offset:0 sc1
    v_cvt_pk_bf16_f32 v168, v168, v169
    v_cvt_pk_bf16_f32 v169, v170, v171
    v_cvt_pk_bf16_f32 v170, v172, v173
    v_cvt_pk_bf16_f32 v171, v174, v175
    buffer_store_dwordx4 v[168:171], v12, s[28:31], s96 offen offset:256 sc1
    v_mov_b32 v164, 0
    v_mov_b32 v165, 0
    v_mov_b32 v166, 0
    v_mov_b32 v167, 0
    v_mov_b32 v172, 0
    v_mov_b32 v173, 0
    v_mov_b32 v174, 0
    v_mov_b32 v175, 0
    v_mov_b32 v160, 0
    v_mov_b32 v161, 0
    v_mov_b32 v162, 0
    v_mov_b32 v163, 0
    v_mov_b32 v168, 0
    v_mov_b32 v169, 0
    v_mov_b32 v170, 0
    v_mov_b32 v171, 0
    v_mul_f32 v176, v176, v9
    v_mul_f32 v177, v177, v9
    v_mul_f32 v178, v178, v9
    v_mul_f32 v179, v179, v9
    v_mul_f32 v180, v180, v9
    v_mul_f32 v181, v181, v9
    v_mul_f32 v182, v182, v9
    v_mul_f32 v183, v183, v9
    v_mul_f32 v184, v184, v10
    v_mul_f32 v185, v185, v10
    v_mul_f32 v186, v186, v10
    v_mul_f32 v187, v187, v10
    v_mul_f32 v188, v188, v10
    v_mul_f32 v189, v189, v10
    v_mul_f32 v190, v190, v10
    v_mul_f32 v191, v191, v10
    s_add_u32 s96, s63, 2048
    v_cvt_pk_bf16_f32 v176, v176, v177
    v_cvt_pk_bf16_f32 v177, v178, v179
    v_cvt_pk_bf16_f32 v178, v180, v181
    v_cvt_pk_bf16_f32 v179, v182, v183
    buffer_store_dwordx4 v[176:179], v12, s[28:31], s96 offen offset:0 sc1
    v_cvt_pk_bf16_f32 v184, v184, v185
    v_cvt_pk_bf16_f32 v185, v186, v187
    v_cvt_pk_bf16_f32 v186, v188, v189
    v_cvt_pk_bf16_f32 v187, v190, v191
    buffer_store_dwordx4 v[184:187], v12, s[28:31], s96 offen offset:256 sc1
    v_mov_b32 v180, 0
    v_mov_b32 v181, 0
    v_mov_b32 v182, 0
    v_mov_b32 v183, 0
    v_mov_b32 v188, 0
    v_mov_b32 v189, 0
    v_mov_b32 v190, 0
    v_mov_b32 v191, 0
    v_mov_b32 v176, 0
    v_mov_b32 v177, 0
    v_mov_b32 v178, 0
    v_mov_b32 v179, 0
    v_mov_b32 v184, 0
    v_mov_b32 v185, 0
    v_mov_b32 v186, 0
    v_mov_b32 v187, 0
    v_mul_f32 v192, v192, v9
    v_mul_f32 v193, v193, v9
    v_mul_f32 v194, v194, v9
    v_mul_f32 v195, v195, v9
    v_mul_f32 v196, v196, v9
    v_mul_f32 v197, v197, v9
    v_mul_f32 v198, v198, v9
    v_mul_f32 v199, v199, v9
    v_mul_f32 v200, v200, v10
    v_mul_f32 v201, v201, v10
    v_mul_f32 v202, v202, v10
    v_mul_f32 v203, v203, v10
    v_mul_f32 v204, v204, v10
    v_mul_f32 v205, v205, v10
    v_mul_f32 v206, v206, v10
    v_mul_f32 v207, v207, v10
    s_add_u32 s96, s63, 4096
    v_cvt_pk_bf16_f32 v192, v192, v193
    v_cvt_pk_bf16_f32 v193, v194, v195
    v_cvt_pk_bf16_f32 v194, v196, v197
    v_cvt_pk_bf16_f32 v195, v198, v199
    buffer_store_dwordx4 v[192:195], v12, s[28:31], s96 offen offset:0 sc1
    v_cvt_pk_bf16_f32 v200, v200, v201
    v_cvt_pk_bf16_f32 v201, v202, v203
    v_cvt_pk_bf16_f32 v202, v204, v205
    v_cvt_pk_bf16_f32 v203, v206, v207
    buffer_store_dwordx4 v[200:203], v12, s[28:31], s96 offen offset:256 sc1
    v_mov_b32 v196, 0
    v_mov_b32 v197, 0
    v_mov_b32 v198, 0
    v_mov_b32 v199, 0
    v_mov_b32 v204, 0
    v_mov_b32 v205, 0
    v_mov_b32 v206, 0
    v_mov_b32 v207, 0
    v_mov_b32 v192, 0
    v_mov_b32 v193, 0
    v_mov_b32 v194, 0
    v_mov_b32 v195, 0
    v_mov_b32 v200, 0
    v_mov_b32 v201, 0
    v_mov_b32 v202, 0
    v_mov_b32 v203, 0
    v_mul_f32 v208, v208, v9
    v_mul_f32 v209, v209, v9
    v_mul_f32 v210, v210, v9
    v_mul_f32 v211, v211, v9
    v_mul_f32 v212, v212, v9
    v_mul_f32 v213, v213, v9
    v_mul_f32 v214, v214, v9
    v_mul_f32 v215, v215, v9
    v_mul_f32 v216, v216, v10
    v_mul_f32 v217, v217, v10
    v_mul_f32 v218, v218, v10
    v_mul_f32 v219, v219, v10
    v_mul_f32 v220, v220, v10
    v_mul_f32 v221, v221, v10
    v_mul_f32 v222, v222, v10
    v_mul_f32 v223, v223, v10
    s_add_u32 s96, s63, 6144
    v_cvt_pk_bf16_f32 v208, v208, v209
    v_cvt_pk_bf16_f32 v209, v210, v211
    v_cvt_pk_bf16_f32 v210, v212, v213
    v_cvt_pk_bf16_f32 v211, v214, v215
    buffer_store_dwordx4 v[208:211], v12, s[28:31], s96 offen offset:0 sc1
    v_cvt_pk_bf16_f32 v216, v216, v217
    v_cvt_pk_bf16_f32 v217, v218, v219
    v_cvt_pk_bf16_f32 v218, v220, v221
    v_cvt_pk_bf16_f32 v219, v222, v223
    buffer_store_dwordx4 v[216:219], v12, s[28:31], s96 offen offset:256 sc1
    v_mov_b32 v212, 0
    v_mov_b32 v213, 0
    v_mov_b32 v214, 0
    v_mov_b32 v215, 0
    v_mov_b32 v220, 0
    v_mov_b32 v221, 0
    v_mov_b32 v222, 0
    v_mov_b32 v223, 0
    v_mov_b32 v208, 0
    v_mov_b32 v209, 0
    v_mov_b32 v210, 0
    v_mov_b32 v211, 0
    v_mov_b32 v216, 0
    v_mov_b32 v217, 0
    v_mov_b32 v218, 0
    v_mov_b32 v219, 0
    s_branch A_rescret_121
A_evb_128:
    s_add_u32 s63, s62, 1
    s_mov_b32 s100, -16
    s_sub_u32 s96, s63, s61
    s_add_u32 s96, s96, 2
    s_cmp_lt_u32 s96, 2
    s_cselect_b32 s97, s57, 0
    s_lshl_b32 s96, s96, 1
    s_sub_u32 s96, s96, s58
    s_lshl_b32 s96, s96, 1
    s_cmp_eq_u32 s97, 1
    s_cselect_b32 s100, s96, s100
    s_lshl_b32 s96, s57, 1
    s_sub_u32 s96, s96, s58
    s_lshl_b32 s96, s96, 1
    s_cmp_eq_u32 s63, 16
    s_cselect_b32 s100, s96, s100
    s_cmp_eq_u32 s63, s61
    s_cselect_b32 s101, s57, 0
    s_cmp_eq_u32 s63, 0
    s_cselect_b32 s101, 1, s101
    s_add_u32 s63, s62, 2
    s_cmp_eq_u32 s63, s61
    s_cselect_b32 s63, s57, 0
    s_cmp_eq_u32 s63, 0
    s_cbranch_scc1 A_noq_130
    ds_read_b128 v[32:35], v15 offset:0
    ds_read_b128 v[36:39], v15 offset:1024
    ds_read_b128 v[40:43], v15 offset:2048
    ds_read_b128 v[44:47], v15 offset:3072
    ds_read_b128 v[48:51], v15 offset:4096
    ds_read_b128 v[52:55], v15 offset:5120
    ds_read_b128 v[56:59], v15 offset:6144
    ds_read_b128 v[60:63], v15 offset:7168
    s_waitcnt lgkmcnt(0)
A_noq_130:
    s_lshl_b32 s63, s101, 1
    s_or_b32 s98, s98, s63
    s_cmp_ge_i32 s100, -3
    s_cbranch_scc0 A_evbret_129
    v_and_b32 v9, 15, v1
    v_lshrrev_b32 v10, 4, v1
    v_lshlrev_b32 v10, 2, v10
    s_lshl_b32 s63, s100, 4
    v_sub_u32 v9, v9, v10
    v_subrev_u32 v9, s63, v9
    v_cmp_le_i32 s[64:65], -16, v9
    v_cmp_le_i32 s[66:67], -15, v9
    v_cmp_le_i32 s[68:69], -14, v9
    v_cmp_le_i32 s[70:71], -13, v9
    v_cmp_le_i32 s[72:73], 0, v9
    v_cmp_le_i32 s[74:75], 1, v9
    v_cmp_le_i32 s[76:77], 2, v9
    v_cmp_le_i32 s[78:79], 3, v9
    v_cmp_le_i32 s[80:81], 16, v9
    v_cmp_le_i32 s[82:83], 17, v9
    v_cmp_le_i32 s[84:85], 18, v9
    v_cmp_le_i32 s[86:87], 19, v9
    v_cmp_le_i32 s[88:89], 32, v9
    v_cmp_le_i32 s[90:91], 33, v9
    v_cmp_le_i32 s[92:93], 34, v9
    v_cmp_le_i32 s[94:95], 35, v9
    v_cndmask_b32 v104, v13, v104, s[64:65]
    v_cndmask_b32 v105, v13, v105, s[66:67]
    v_cndmask_b32 v106, v13, v106, s[68:69]
    v_cndmask_b32 v107, v13, v107, s[70:71]
    v_cmp_le_i32 s[64:65], 48, v9
    v_cmp_le_i32 s[66:67], 49, v9
    v_cmp_le_i32 s[68:69], 50, v9
    v_cmp_le_i32 s[70:71], 51, v9
    v_cndmask_b32 v96, v13, v96, s[72:73]
    v_cndmask_b32 v97, v13, v97, s[74:75]
    v_cndmask_b32 v98, v13, v98, s[76:77]
    v_cndmask_b32 v99, v13, v99, s[78:79]
    v_cndmask_b32 v108, v13, v108, s[72:73]
    v_cndmask_b32 v109, v13, v109, s[74:75]
    v_cndmask_b32 v110, v13, v110, s[76:77]
    v_cndmask_b32 v111, v13, v111, s[78:79]
    v_cndmask_b32 v100, v13, v100, s[80:81]
    v_cndmask_b32 v101, v13, v101, s[82:83]
    v_cndmask_b32 v102, v13, v102, s[84:85]
    v_cndmask_b32 v103, v13, v103, s[86:87]
    v_cndmask_b32 v120, v13, v120, s[80:81]
    v_cndmask_b32 v121, v13, v121, s[82:83]
    v_cndmask_b32 v122, v13, v122, s[84:85]
    v_cndmask_b32 v123, v13, v123, s[86:87]
    v_cndmask_b32 v112, v13, v112, s[88:89]
    v_cndmask_b32 v113, v13, v113, s[90:91]
    v_cndmask_b32 v114, v13, v114, s[92:93]
    v_cndmask_b32 v115, v13, v115, s[94:95]
    v_cndmask_b32 v124, v13, v124, s[88:89]
    v_cndmask_b32 v125, v13, v125, s[90:91]
    v_cndmask_b32 v126, v13, v126, s[92:93]
    v_cndmask_b32 v127, v13, v127, s[94:95]
    v_cndmask_b32 v116, v13, v116, s[64:65]
    v_cndmask_b32 v117, v13, v117, s[66:67]
    v_cndmask_b32 v118, v13, v118, s[68:69]
    v_cndmask_b32 v119, v13, v119, s[70:71]
    s_branch A_evbret_129
A_slow_131:
    v_max3_f32 v8, v96, v97, v98
    v_max3_f32 v8, v8, v99, v100
    v_max3_f32 v8, v8, v101, v102
    v_max3_f32 v8, v8, v103, v112
    v_max3_f32 v8, v8, v113, v114
    v_max3_f32 v8, v8, v115, v116
    v_max3_f32 v8, v8, v117, v118
    v_max_f32 v8, v8, v119
    v_max3_f32 v14, v104, v105, v106
    v_max3_f32 v14, v14, v107, v108
    v_max3_f32 v14, v14, v109, v110
    v_max3_f32 v14, v14, v111, v120
    v_max3_f32 v14, v14, v121, v122
    v_max3_f32 v14, v14, v123, v124
    v_max3_f32 v14, v14, v125, v126
    v_max_f32 v14, v14, v127
    v_mov_b32 v9, v8
    v_mov_b32 v10, v14
    s_nop 1
    v_permlane16_swap_b32 v8, v9
    v_permlane16_swap_b32 v14, v10
    s_nop 1
    v_max_f32 v8, v8, v9
    v_max_f32 v14, v14, v10
    v_mov_b32 v9, v8
    v_mov_b32 v10, v14
    s_nop 1
    v_permlane32_swap_b32 v8, v9
    v_permlane32_swap_b32 v14, v10
    s_nop 1
    v_max_f32 v8, v8, v9
    v_max_f32 v14, v14, v10
    s_cmp_eq_u32 s101, 1
    s_cbranch_scc1 A_sf_133
    v_max_f32 v8, 0, v8
    v_sub_f32 v9, 0, v8
    v_exp_f32 v11, v9
    v_max_f32 v14, 0, v14
    v_sub_f32 v10, 0, v14
    v_exp_f32 v7, v10
    s_or_b32 s98, s98, 1
    s_branch A_sj_134
A_sf_133:
    v_max_f32 v8, 0xf149f2ca, v8
    v_max_f32 v14, 0xf149f2ca, v14
A_sj_134:
    v_add_f32 v5, v5, v8
    v_add_f32 v6, v6, v14
    v_sub_f32 v96, v96, v8
    v_sub_f32 v97, v97, v8
    v_sub_f32 v98, v98, v8
    v_sub_f32 v99, v99, v8
    v_sub_f32 v100, v100, v8
    v_sub_f32 v101, v101, v8
    v_sub_f32 v102, v102, v8
    v_sub_f32 v103, v103, v8
    v_sub_f32 v104, v104, v14
    v_sub_f32 v105, v105, v14
    v_sub_f32 v106, v106, v14
    v_sub_f32 v107, v107, v14
    v_sub_f32 v108, v108, v14
    v_sub_f32 v109, v109, v14
    v_sub_f32 v110, v110, v14
    v_sub_f32 v111, v111, v14
    v_sub_f32 v112, v112, v8
    v_sub_f32 v113, v113, v8
    v_sub_f32 v114, v114, v8
    v_sub_f32 v115, v115, v8
    v_sub_f32 v116, v116, v8
    v_sub_f32 v117, v117, v8
    v_sub_f32 v118, v118, v8
    v_sub_f32 v119, v119, v8
    v_sub_f32 v120, v120, v14
    v_sub_f32 v121, v121, v14
    v_sub_f32 v122, v122, v14
    v_sub_f32 v123, v123, v14
    v_sub_f32 v124, v124, v14
    v_sub_f32 v125, v125, v14
    v_sub_f32 v126, v126, v14
    v_sub_f32 v127, v127, v14
    v_sub_f32 v16, 0, v5
    v_sub_f32 v17, 0, v5
    v_sub_f32 v18, 0, v5
    v_sub_f32 v19, 0, v5
    v_sub_f32 v20, 0, v6
    v_sub_f32 v21, 0, v6
    v_sub_f32 v22, 0, v6
    v_sub_f32 v23, 0, v6
    s_branch A_slowret_132
A_resc_138:
    s_nop 15
    s_cmp_eq_u32 s98, 2
    s_mov_b32 s98, 0
    s_cbranch_scc1 A_fin_140
    v_mul_f32 v160, v160, v11
    v_mul_f32 v161, v161, v11
    v_mul_f32 v162, v162, v11
    v_mul_f32 v163, v163, v11
    v_mul_f32 v164, v164, v11
    v_mul_f32 v165, v165, v11
    v_mul_f32 v166, v166, v11
    v_mul_f32 v167, v167, v11
    v_mul_f32 v168, v168, v7
    v_mul_f32 v169, v169, v7
    v_mul_f32 v170, v170, v7
    v_mul_f32 v171, v171, v7
    v_mul_f32 v172, v172, v7
    v_mul_f32 v173, v173, v7
    v_mul_f32 v174, v174, v7
    v_mul_f32 v175, v175, v7
    v_mul_f32 v176, v176, v11
    v_mul_f32 v177, v177, v11
    v_mul_f32 v178, v178, v11
    v_mul_f32 v179, v179, v11
    v_mul_f32 v180, v180, v11
    v_mul_f32 v181, v181, v11
    v_mul_f32 v182, v182, v11
    v_mul_f32 v183, v183, v11
    v_mul_f32 v184, v184, v7
    v_mul_f32 v185, v185, v7
    v_mul_f32 v186, v186, v7
    v_mul_f32 v187, v187, v7
    v_mul_f32 v188, v188, v7
    v_mul_f32 v189, v189, v7
    v_mul_f32 v190, v190, v7
    v_mul_f32 v191, v191, v7
    v_mul_f32 v192, v192, v11
    v_mul_f32 v193, v193, v11
    v_mul_f32 v194, v194, v11
    v_mul_f32 v195, v195, v11
    v_mul_f32 v196, v196, v11
    v_mul_f32 v197, v197, v11
    v_mul_f32 v198, v198, v11
    v_mul_f32 v199, v199, v11
    v_mul_f32 v200, v200, v7
    v_mul_f32 v201, v201, v7
    v_mul_f32 v202, v202, v7
    v_mul_f32 v203, v203, v7
    v_mul_f32 v204, v204, v7
    v_mul_f32 v205, v205, v7
    v_mul_f32 v206, v206, v7
    v_mul_f32 v207, v207, v7
    v_mul_f32 v208, v208, v11
    v_mul_f32 v209, v209, v11
    v_mul_f32 v210, v210, v11
    v_mul_f32 v211, v211, v11
    v_mul_f32 v212, v212, v11
    v_mul_f32 v213, v213, v11
    v_mul_f32 v214, v214, v11
    v_mul_f32 v215, v215, v11
    v_mul_f32 v216, v216, v7
    v_mul_f32 v217, v217, v7
    v_mul_f32 v218, v218, v7
    v_mul_f32 v219, v219, v7
    v_mul_f32 v220, v220, v7
    v_mul_f32 v221, v221, v7
    v_mul_f32 v222, v222, v7
    v_mul_f32 v223, v223, v7
    v_mul_f32 v24, v24, v11
    v_mul_f32 v25, v25, v11
    v_mul_f32 v26, v26, v11
    v_mul_f32 v27, v27, v11
    v_mul_f32 v28, v28, v7
    v_mul_f32 v29, v29, v7
    v_mul_f32 v30, v30, v7
    v_mul_f32 v31, v31, v7
    s_branch A_rescret_139
A_fin_140:
    v_rcp_f32 v9, v24
    v_rcp_f32 v10, v28
    v_mov_b32 v24, 0
    v_mov_b32 v25, 0
    v_mov_b32 v26, 0
    v_mov_b32 v27, 0
    v_mov_b32 v28, 0
    v_mov_b32 v29, 0
    v_mov_b32 v30, 0
    v_mov_b32 v31, 0
    s_lshl_b32 s63, s60, 2
    s_add_u32 s63, s63, s58
    s_lshl_b32 s63, s63, 18
    s_lshl_b32 s96, s59, 13
    s_add_u32 s63, s63, s96
    v_mul_f32 v160, v160, v9
    v_mul_f32 v161, v161, v9
    v_mul_f32 v162, v162, v9
    v_mul_f32 v163, v163, v9
    v_mul_f32 v164, v164, v9
    v_mul_f32 v165, v165, v9
    v_mul_f32 v166, v166, v9
    v_mul_f32 v167, v167, v9
    v_mul_f32 v168, v168, v10
    v_mul_f32 v169, v169, v10
    v_mul_f32 v170, v170, v10
    v_mul_f32 v171, v171, v10
    v_mul_f32 v172, v172, v10
    v_mul_f32 v173, v173, v10
    v_mul_f32 v174, v174, v10
    v_mul_f32 v175, v175, v10
    s_add_u32 s96, s63, 0
    v_cvt_pk_bf16_f32 v160, v160, v161
    v_cvt_pk_bf16_f32 v161, v162, v163
    v_cvt_pk_bf16_f32 v162, v164, v165
    v_cvt_pk_bf16_f32 v163, v166, v167
    buffer_store_dwordx4 v[160:163], v12, s[28:31], s96 offen offset:0 sc1
    v_cvt_pk_bf16_f32 v168, v168, v169
    v_cvt_pk_bf16_f32 v169, v170, v171
    v_cvt_pk_bf16_f32 v170, v172, v173
    v_cvt_pk_bf16_f32 v171, v174, v175
    buffer_store_dwordx4 v[168:171], v12, s[28:31], s96 offen offset:256 sc1
    v_mov_b32 v164, 0
    v_mov_b32 v165, 0
    v_mov_b32 v166, 0
    v_mov_b32 v167, 0
    v_mov_b32 v172, 0
    v_mov_b32 v173, 0
    v_mov_b32 v174, 0
    v_mov_b32 v175, 0
    v_mov_b32 v160, 0
    v_mov_b32 v161, 0
    v_mov_b32 v162, 0
    v_mov_b32 v163, 0
    v_mov_b32 v168, 0
    v_mov_b32 v169, 0
    v_mov_b32 v170, 0
    v_mov_b32 v171, 0
    v_mul_f32 v176, v176, v9
    v_mul_f32 v177, v177, v9
    v_mul_f32 v178, v178, v9
    v_mul_f32 v179, v179, v9
    v_mul_f32 v180, v180, v9
    v_mul_f32 v181, v181, v9
    v_mul_f32 v182, v182, v9
    v_mul_f32 v183, v183, v9
    v_mul_f32 v184, v184, v10
    v_mul_f32 v185, v185, v10
    v_mul_f32 v186, v186, v10
    v_mul_f32 v187, v187, v10
    v_mul_f32 v188, v188, v10
    v_mul_f32 v189, v189, v10
    v_mul_f32 v190, v190, v10
    v_mul_f32 v191, v191, v10
    s_add_u32 s96, s63, 2048
    v_cvt_pk_bf16_f32 v176, v176, v177
    v_cvt_pk_bf16_f32 v177, v178, v179
    v_cvt_pk_bf16_f32 v178, v180, v181
    v_cvt_pk_bf16_f32 v179, v182, v183
    buffer_store_dwordx4 v[176:179], v12, s[28:31], s96 offen offset:0 sc1
    v_cvt_pk_bf16_f32 v184, v184, v185
    v_cvt_pk_bf16_f32 v185, v186, v187
    v_cvt_pk_bf16_f32 v186, v188, v189
    v_cvt_pk_bf16_f32 v187, v190, v191
    buffer_store_dwordx4 v[184:187], v12, s[28:31], s96 offen offset:256 sc1
    v_mov_b32 v180, 0
    v_mov_b32 v181, 0
    v_mov_b32 v182, 0
    v_mov_b32 v183, 0
    v_mov_b32 v188, 0
    v_mov_b32 v189, 0
    v_mov_b32 v190, 0
    v_mov_b32 v191, 0
    v_mov_b32 v176, 0
    v_mov_b32 v177, 0
    v_mov_b32 v178, 0
    v_mov_b32 v179, 0
    v_mov_b32 v184, 0
    v_mov_b32 v185, 0
    v_mov_b32 v186, 0
    v_mov_b32 v187, 0
    v_mul_f32 v192, v192, v9
    v_mul_f32 v193, v193, v9
    v_mul_f32 v194, v194, v9
    v_mul_f32 v195, v195, v9
    v_mul_f32 v196, v196, v9
    v_mul_f32 v197, v197, v9
    v_mul_f32 v198, v198, v9
    v_mul_f32 v199, v199, v9
    v_mul_f32 v200, v200, v10
    v_mul_f32 v201, v201, v10
    v_mul_f32 v202, v202, v10
    v_mul_f32 v203, v203, v10
    v_mul_f32 v204, v204, v10
    v_mul_f32 v205, v205, v10
    v_mul_f32 v206, v206, v10
    v_mul_f32 v207, v207, v10
    s_add_u32 s96, s63, 4096
    v_cvt_pk_bf16_f32 v192, v192, v193
    v_cvt_pk_bf16_f32 v193, v194, v195
    v_cvt_pk_bf16_f32 v194, v196, v197
    v_cvt_pk_bf16_f32 v195, v198, v199
    buffer_store_dwordx4 v[192:195], v12, s[28:31], s96 offen offset:0 sc1
    v_cvt_pk_bf16_f32 v200, v200, v201
    v_cvt_pk_bf16_f32 v201, v202, v203
    v_cvt_pk_bf16_f32 v202, v204, v205
    v_cvt_pk_bf16_f32 v203, v206, v207
    buffer_store_dwordx4 v[200:203], v12, s[28:31], s96 offen offset:256 sc1
    v_mov_b32 v196, 0
    v_mov_b32 v197, 0
    v_mov_b32 v198, 0
    v_mov_b32 v199, 0
    v_mov_b32 v204, 0
    v_mov_b32 v205, 0
    v_mov_b32 v206, 0
    v_mov_b32 v207, 0
    v_mov_b32 v192, 0
    v_mov_b32 v193, 0
    v_mov_b32 v194, 0
    v_mov_b32 v195, 0
    v_mov_b32 v200, 0
    v_mov_b32 v201, 0
    v_mov_b32 v202, 0
    v_mov_b32 v203, 0
    v_mul_f32 v208, v208, v9
    v_mul_f32 v209, v209, v9
    v_mul_f32 v210, v210, v9
    v_mul_f32 v211, v211, v9
    v_mul_f32 v212, v212, v9
    v_mul_f32 v213, v213, v9
    v_mul_f32 v214, v214, v9
    v_mul_f32 v215, v215, v9
    v_mul_f32 v216, v216, v10
    v_mul_f32 v217, v217, v10
    v_mul_f32 v218, v218, v10
    v_mul_f32 v219, v219, v10
    v_mul_f32 v220, v220, v10
    v_mul_f32 v221, v221, v10
    v_mul_f32 v222, v222, v10
    v_mul_f32 v223, v223, v10
    s_add_u32 s96, s63, 6144
    v_cvt_pk_bf16_f32 v208, v208, v209
    v_cvt_pk_bf16_f32 v209, v210, v211
    v_cvt_pk_bf16_f32 v210, v212, v213
    v_cvt_pk_bf16_f32 v211, v214, v215
    buffer_store_dwordx4 v[208:211], v12, s[28:31], s96 offen offset:0 sc1
    v_cvt_pk_bf16_f32 v216, v216, v217
    v_cvt_pk_bf16_f32 v217, v218, v219
    v_cvt_pk_bf16_f32 v218, v220, v221
    v_cvt_pk_bf16_f32 v219, v222, v223
    buffer_store_dwordx4 v[216:219], v12, s[28:31], s96 offen offset:256 sc1
    v_mov_b32 v212, 0
    v_mov_b32 v213, 0
    v_mov_b32 v214, 0
    v_mov_b32 v215, 0
    v_mov_b32 v220, 0
    v_mov_b32 v221, 0
    v_mov_b32 v222, 0
    v_mov_b32 v223, 0
    v_mov_b32 v208, 0
    v_mov_b32 v209, 0
    v_mov_b32 v210, 0
    v_mov_b32 v211, 0
    v_mov_b32 v216, 0
    v_mov_b32 v217, 0
    v_mov_b32 v218, 0
    v_mov_b32 v219, 0
    s_branch A_rescret_139
A_evb_146:
    s_add_u32 s63, s62, 1
    s_mov_b32 s100, -16
    s_sub_u32 s96, s63, s61
    s_add_u32 s96, s96, 2
    s_cmp_lt_u32 s96, 2
    s_cselect_b32 s97, s57, 0
    s_lshl_b32 s96, s96, 1
    s_sub_u32 s96, s96, s58
    s_lshl_b32 s96, s96, 1
    s_cmp_eq_u32 s97, 1
    s_cselect_b32 s100, s96, s100
    s_lshl_b32 s96, s57, 1
    s_sub_u32 s96, s96, s58
    s_lshl_b32 s96, s96, 1
    s_cmp_eq_u32 s63, 16
    s_cselect_b32 s100, s96, s100
    s_cmp_eq_u32 s63, s61
    s_cselect_b32 s101, s57, 0
    s_cmp_eq_u32 s63, 0
    s_cselect_b32 s101, 1, s101
    s_add_u32 s63, s62, 2
    s_cmp_eq_u32 s63, s61
    s_cselect_b32 s63, s57, 0
    s_cmp_eq_u32 s63, 0
    s_cbranch_scc1 A_noq_148
    ds_read_b128 v[32:35], v15 offset:0
    ds_read_b128 v[36:39], v15 offset:1024
    ds_read_b128 v[40:43], v15 offset:2048
    ds_read_b128 v[44:47], v15 offset:3072
    ds_read_b128 v[48:51], v15 offset:4096
    ds_read_b128 v[52:55], v15 offset:5120
    ds_read_b128 v[56:59], v15 offset:6144
    ds_read_b128 v[60:63], v15 offset:7168
    s_waitcnt lgkmcnt(0)
A_noq_148:
    s_lshl_b32 s63, s101, 1
    s_or_b32 s98, s98, s63
    s_cmp_ge_i32 s100, -3
    s_cbranch_scc0 A_evbret_147
    v_and_b32 v9, 15, v1
    v_lshrrev_b32 v10, 4, v1
    v_lshlrev_b32 v10, 2, v10
    s_lshl_b32 s63, s100, 4
    v_sub_u32 v9, v9, v10
    v_subrev_u32 v9, s63, v9
    v_cmp_le_i32 s[64:65], -16, v9
    v_cmp_le_i32 s[66:67], -15, v9
    v_cmp_le_i32 s[68:69], -14, v9
    v_cmp_le_i32 s[70:71], -13, v9
    v_cmp_le_i32 s[72:73], 0, v9
    v_cmp_le_i32 s[74:75], 1, v9
    v_cmp_le_i32 s[76:77], 2, v9
    v_cmp_le_i32 s[78:79], 3, v9
    v_cmp_le_i32 s[80:81], 16, v9
    v_cmp_le_i32 s[82:83], 17, v9
    v_cmp_le_i32 s[84:85], 18, v9
    v_cmp_le_i32 s[86:87], 19, v9
    v_cmp_le_i32 s[88:89], 32, v9
    v_cmp_le_i32 s[90:91], 33, v9
    v_cmp_le_i32 s[92:93], 34, v9
    v_cmp_le_i32 s[94:95], 35, v9
    v_cndmask_b32 v136, v13, v136, s[64:65]
    v_cndmask_b32 v137, v13, v137, s[66:67]
    v_cndmask_b32 v138, v13, v138, s[68:69]
    v_cndmask_b32 v139, v13, v139, s[70:71]
    v_cmp_le_i32 s[64:65], 48, v9
    v_cmp_le_i32 s[66:67], 49, v9
    v_cmp_le_i32 s[68:69], 50, v9
    v_cmp_le_i32 s[70:71], 51, v9
    v_cndmask_b32 v128, v13, v128, s[72:73]
    v_cndmask_b32 v129, v13, v129, s[74:75]
    v_cndmask_b32 v130, v13, v130, s[76:77]
    v_cndmask_b32 v131, v13, v131, s[78:79]
    v_cndmask_b32 v140, v13, v140, s[72:73]
    v_cndmask_b32 v141, v13, v141, s[74:75]
    v_cndmask_b32 v142, v13, v142, s[76:77]
    v_cndmask_b32 v143, v13, v143, s[78:79]
    v_cndmask_b32 v132, v13, v132, s[80:81]
    v_cndmask_b32 v133, v13, v133, s[82:83]
    v_cndmask_b32 v134, v13, v134, s[84:85]
    v_cndmask_b32 v135, v13, v135, s[86:87]
    v_cndmask_b32 v152, v13, v152, s[80:81]
    v_cndmask_b32 v153, v13, v153, s[82:83]
    v_cndmask_b32 v154, v13, v154, s[84:85]
    v_cndmask_b32 v155, v13, v155, s[86:87]
    v_cndmask_b32 v144, v13, v144, s[88:89]
    v_cndmask_b32 v145, v13, v145, s[90:91]
    v_cndmask_b32 v146, v13, v146, s[92:93]
    v_cndmask_b32 v147, v13, v147, s[94:95]
    v_cndmask_b32 v156, v13, v156, s[88:89]
    v_cndmask_b32 v157, v13, v157, s[90:91]
    v_cndmask_b32 v158, v13, v158, s[92:93]
    v_cndmask_b32 v159, v13, v159, s[94:95]
    v_cndmask_b32 v148, v13, v148, s[64:65]
    v_cndmask_b32 v149, v13, v149, s[66:67]
    v_cndmask_b32 v150, v13, v150, s[68:69]
    v_cndmask_b32 v151, v13, v151, s[70:71]
    s_branch A_evbret_147
A_slow_149:
    v_max3_f32 v8, v128, v129, v130
    v_max3_f32 v8, v8, v131, v132
    v_max3_f32 v8, v8, v133, v134
    v_max3_f32 v8, v8, v135, v144
    v_max3_f32 v8, v8, v145, v146
    v_max3_f32 v8, v8, v147, v148
    v_max3_f32 v8, v8, v149, v150
    v_max_f32 v8, v8, v151
    v_max3_f32 v14, v136, v137, v138
    v_max3_f32 v14, v14, v139, v140
    v_max3_f32 v14, v14, v141, v142
    v_max3_f32 v14, v14, v143, v152
    v_max3_f32 v14, v14, v153, v154
    v_max3_f32 v14, v14, v155, v156
    v_max3_f32 v14, v14, v157, v158
    v_max_f32 v14, v14, v159
    v_mov_b32 v9, v8
    v_mov_b32 v10, v14
    s_nop 1
    v_permlane16_swap_b32 v8, v9
    v_permlane16_swap_b32 v14, v10
    s_nop 1
    v_max_f32 v8, v8, v9
    v_max_f32 v14, v14, v10
    v_mov_b32 v9, v8
    v_mov_b32 v10, v14
    s_nop 1
    v_permlane32_swap_b32 v8, v9
    v_permlane32_swap_b32 v14, v10
    s_nop 1
    v_max_f32 v8, v8, v9
    v_max_f32 v14, v14, v10
    s_cmp_eq_u32 s101, 1
    s_cbranch_scc1 A_sf_151
    v_max_f32 v8, 0, v8
    v_sub_f32 v9, 0, v8
    v_exp_f32 v11, v9
    v_max_f32 v14, 0, v14
    v_sub_f32 v10, 0, v14
    v_exp_f32 v7, v10
    s_or_b32 s98, s98, 1
    s_branch A_sj_152
A_sf_151:
    v_max_f32 v8, 0xf149f2ca, v8
    v_max_f32 v14, 0xf149f2ca, v14
A_sj_152:
    v_add_f32 v5, v5, v8
    v_add_f32 v6, v6, v14
    v_sub_f32 v128, v128, v8
    v_sub_f32 v129, v129, v8
    v_sub_f32 v130, v130, v8
    v_sub_f32 v131, v131, v8
    v_sub_f32 v132, v132, v8
    v_sub_f32 v133, v133, v8
    v_sub_f32 v134, v134, v8
    v_sub_f32 v135, v135, v8
    v_sub_f32 v136, v136, v14
    v_sub_f32 v137, v137, v14
    v_sub_f32 v138, v138, v14
    v_sub_f32 v139, v139, v14
    v_sub_f32 v140, v140, v14
    v_sub_f32 v141, v141, v14
    v_sub_f32 v142, v142, v14
    v_sub_f32 v143, v143, v14
    v_sub_f32 v144, v144, v8
    v_sub_f32 v145, v145, v8
    v_sub_f32 v146, v146, v8
    v_sub_f32 v147, v147, v8
    v_sub_f32 v148, v148, v8
    v_sub_f32 v149, v149, v8
    v_sub_f32 v150, v150, v8
    v_sub_f32 v151, v151, v8
    v_sub_f32 v152, v152, v14
    v_sub_f32 v153, v153, v14
    v_sub_f32 v154, v154, v14
    v_sub_f32 v155, v155, v14
    v_sub_f32 v156, v156, v14
    v_sub_f32 v157, v157, v14
    v_sub_f32 v158, v158, v14
    v_sub_f32 v159, v159, v14
    v_sub_f32 v16, 0, v5
    v_sub_f32 v17, 0, v5
    v_sub_f32 v18, 0, v5
    v_sub_f32 v19, 0, v5
    v_sub_f32 v20, 0, v6
    v_sub_f32 v21, 0, v6
    v_sub_f32 v22, 0, v6
    v_sub_f32 v23, 0, v6
    s_branch A_slowret_150
A_resc_156:
    s_nop 15
    s_cmp_eq_u32 s98, 2
    s_mov_b32 s98, 0
    s_cbranch_scc1 A_fin_158
    v_mul_f32 v160, v160, v11
    v_mul_f32 v161, v161, v11
    v_mul_f32 v162, v162, v11
    v_mul_f32 v163, v163, v11
    v_mul_f32 v164, v164, v11
    v_mul_f32 v165, v165, v11
    v_mul_f32 v166, v166, v11
    v_mul_f32 v167, v167, v11
    v_mul_f32 v168, v168, v7
    v_mul_f32 v169, v169, v7
    v_mul_f32 v170, v170, v7
    v_mul_f32 v171, v171, v7
    v_mul_f32 v172, v172, v7
    v_mul_f32 v173, v173, v7
    v_mul_f32 v174, v174, v7
    v_mul_f32 v175, v175, v7
    v_mul_f32 v176, v176, v11
    v_mul_f32 v177, v177, v11
    v_mul_f32 v178, v178, v11
    v_mul_f32 v179, v179, v11
    v_mul_f32 v180, v180, v11
    v_mul_f32 v181, v181, v11
    v_mul_f32 v182, v182, v11
    v_mul_f32 v183, v183, v11
    v_mul_f32 v184, v184, v7
    v_mul_f32 v185, v185, v7
    v_mul_f32 v186, v186, v7
    v_mul_f32 v187, v187, v7
    v_mul_f32 v188, v188, v7
    v_mul_f32 v189, v189, v7
    v_mul_f32 v190, v190, v7
    v_mul_f32 v191, v191, v7
    v_mul_f32 v192, v192, v11
    v_mul_f32 v193, v193, v11
    v_mul_f32 v194, v194, v11
    v_mul_f32 v195, v195, v11
    v_mul_f32 v196, v196, v11
    v_mul_f32 v197, v197, v11
    v_mul_f32 v198, v198, v11
    v_mul_f32 v199, v199, v11
    v_mul_f32 v200, v200, v7
    v_mul_f32 v201, v201, v7
    v_mul_f32 v202, v202, v7
    v_mul_f32 v203, v203, v7
    v_mul_f32 v204, v204, v7
    v_mul_f32 v205, v205, v7
    v_mul_f32 v206, v206, v7
    v_mul_f32 v207, v207, v7
    v_mul_f32 v208, v208, v11
    v_mul_f32 v209, v209, v11
    v_mul_f32 v210, v210, v11
    v_mul_f32 v211, v211, v11
    v_mul_f32 v212, v212, v11
    v_mul_f32 v213, v213, v11
    v_mul_f32 v214, v214, v11
    v_mul_f32 v215, v215, v11
    v_mul_f32 v216, v216, v7
    v_mul_f32 v217, v217, v7
    v_mul_f32 v218, v218, v7
    v_mul_f32 v219, v219, v7
    v_mul_f32 v220, v220, v7
    v_mul_f32 v221, v221, v7
    v_mul_f32 v222, v222, v7
    v_mul_f32 v223, v223, v7
    v_mul_f32 v24, v24, v11
    v_mul_f32 v25, v25, v11
    v_mul_f32 v26, v26, v11
    v_mul_f32 v27, v27, v11
    v_mul_f32 v28, v28, v7
    v_mul_f32 v29, v29, v7
    v_mul_f32 v30, v30, v7
    v_mul_f32 v31, v31, v7
    s_branch A_rescret_157
A_fin_158:
    v_rcp_f32 v9, v24
    v_rcp_f32 v10, v28
    v_mov_b32 v24, 0
    v_mov_b32 v25, 0
    v_mov_b32 v26, 0
    v_mov_b32 v27, 0
    v_mov_b32 v28, 0
    v_mov_b32 v29, 0
    v_mov_b32 v30, 0
    v_mov_b32 v31, 0
    s_lshl_b32 s63, s60, 2
    s_add_u32 s63, s63, s58
    s_lshl_b32 s63, s63, 18
    s_lshl_b32 s96, s59, 13
    s_add_u32 s63, s63, s96
    v_mul_f32 v160, v160, v9
    v_mul_f32 v161, v161, v9
    v_mul_f32 v162, v162, v9
    v_mul_f32 v163, v163, v9
    v_mul_f32 v164, v164, v9
    v_mul_f32 v165, v165, v9
    v_mul_f32 v166, v166, v9
    v_mul_f32 v167, v167, v9
    v_mul_f32 v168, v168, v10
    v_mul_f32 v169, v169, v10
    v_mul_f32 v170, v170, v10
    v_mul_f32 v171, v171, v10
    v_mul_f32 v172, v172, v10
    v_mul_f32 v173, v173, v10
    v_mul_f32 v174, v174, v10
    v_mul_f32 v175, v175, v10
    s_add_u32 s96, s63, 0
    v_cvt_pk_bf16_f32 v160, v160, v161
    v_cvt_pk_bf16_f32 v161, v162, v163
    v_cvt_pk_bf16_f32 v162, v164, v165
    v_cvt_pk_bf16_f32 v163, v166, v167
    buffer_store_dwordx4 v[160:163], v12, s[28:31], s96 offen offset:0 sc1
    v_cvt_pk_bf16_f32 v168, v168, v169
    v_cvt_pk_bf16_f32 v169, v170, v171
    v_cvt_pk_bf16_f32 v170, v172, v173
    v_cvt_pk_bf16_f32 v171, v174, v175
    buffer_store_dwordx4 v[168:171], v12, s[28:31], s96 offen offset:256 sc1
    v_mov_b32 v164, 0
    v_mov_b32 v165, 0
    v_mov_b32 v166, 0
    v_mov_b32 v167, 0
    v_mov_b32 v172, 0
    v_mov_b32 v173, 0
    v_mov_b32 v174, 0
    v_mov_b32 v175, 0
    v_mov_b32 v160, 0
    v_mov_b32 v161, 0
    v_mov_b32 v162, 0
    v_mov_b32 v163, 0
    v_mov_b32 v168, 0
    v_mov_b32 v169, 0
    v_mov_b32 v170, 0
    v_mov_b32 v171, 0
    v_mul_f32 v176, v176, v9
    v_mul_f32 v177, v177, v9
    v_mul_f32 v178, v178, v9
    v_mul_f32 v179, v179, v9
    v_mul_f32 v180, v180, v9
    v_mul_f32 v181, v181, v9
    v_mul_f32 v182, v182, v9
    v_mul_f32 v183, v183, v9
    v_mul_f32 v184, v184, v10
    v_mul_f32 v185, v185, v10
    v_mul_f32 v186, v186, v10
    v_mul_f32 v187, v187, v10
    v_mul_f32 v188, v188, v10
    v_mul_f32 v189, v189, v10
    v_mul_f32 v190, v190, v10
    v_mul_f32 v191, v191, v10
    s_add_u32 s96, s63, 2048
    v_cvt_pk_bf16_f32 v176, v176, v177
    v_cvt_pk_bf16_f32 v177, v178, v179
    v_cvt_pk_bf16_f32 v178, v180, v181
    v_cvt_pk_bf16_f32 v179, v182, v183
    buffer_store_dwordx4 v[176:179], v12, s[28:31], s96 offen offset:0 sc1
    v_cvt_pk_bf16_f32 v184, v184, v185
    v_cvt_pk_bf16_f32 v185, v186, v187
    v_cvt_pk_bf16_f32 v186, v188, v189
    v_cvt_pk_bf16_f32 v187, v190, v191
    buffer_store_dwordx4 v[184:187], v12, s[28:31], s96 offen offset:256 sc1
    v_mov_b32 v180, 0
    v_mov_b32 v181, 0
    v_mov_b32 v182, 0
    v_mov_b32 v183, 0
    v_mov_b32 v188, 0
    v_mov_b32 v189, 0
    v_mov_b32 v190, 0
    v_mov_b32 v191, 0
    v_mov_b32 v176, 0
    v_mov_b32 v177, 0
    v_mov_b32 v178, 0
    v_mov_b32 v179, 0
    v_mov_b32 v184, 0
    v_mov_b32 v185, 0
    v_mov_b32 v186, 0
    v_mov_b32 v187, 0
    v_mul_f32 v192, v192, v9
    v_mul_f32 v193, v193, v9
    v_mul_f32 v194, v194, v9
    v_mul_f32 v195, v195, v9
    v_mul_f32 v196, v196, v9
    v_mul_f32 v197, v197, v9
    v_mul_f32 v198, v198, v9
    v_mul_f32 v199, v199, v9
    v_mul_f32 v200, v200, v10
    v_mul_f32 v201, v201, v10
    v_mul_f32 v202, v202, v10
    v_mul_f32 v203, v203, v10
    v_mul_f32 v204, v204, v10
    v_mul_f32 v205, v205, v10
    v_mul_f32 v206, v206, v10
    v_mul_f32 v207, v207, v10
    s_add_u32 s96, s63, 4096
    v_cvt_pk_bf16_f32 v192, v192, v193
    v_cvt_pk_bf16_f32 v193, v194, v195
    v_cvt_pk_bf16_f32 v194, v196, v197
    v_cvt_pk_bf16_f32 v195, v198, v199
    buffer_store_dwordx4 v[192:195], v12, s[28:31], s96 offen offset:0 sc1
    v_cvt_pk_bf16_f32 v200, v200, v201
    v_cvt_pk_bf16_f32 v201, v202, v203
    v_cvt_pk_bf16_f32 v202, v204, v205
    v_cvt_pk_bf16_f32 v203, v206, v207
    buffer_store_dwordx4 v[200:203], v12, s[28:31], s96 offen offset:256 sc1
    v_mov_b32 v196, 0
    v_mov_b32 v197, 0
    v_mov_b32 v198, 0
    v_mov_b32 v199, 0
    v_mov_b32 v204, 0
    v_mov_b32 v205, 0
    v_mov_b32 v206, 0
    v_mov_b32 v207, 0
    v_mov_b32 v192, 0
    v_mov_b32 v193, 0
    v_mov_b32 v194, 0
    v_mov_b32 v195, 0
    v_mov_b32 v200, 0
    v_mov_b32 v201, 0
    v_mov_b32 v202, 0
    v_mov_b32 v203, 0
    v_mul_f32 v208, v208, v9
    v_mul_f32 v209, v209, v9
    v_mul_f32 v210, v210, v9
    v_mul_f32 v211, v211, v9
    v_mul_f32 v212, v212, v9
    v_mul_f32 v213, v213, v9
    v_mul_f32 v214, v214, v9
    v_mul_f32 v215, v215, v9
    v_mul_f32 v216, v216, v10
    v_mul_f32 v217, v217, v10
    v_mul_f32 v218, v218, v10
    v_mul_f32 v219, v219, v10
    v_mul_f32 v220, v220, v10
    v_mul_f32 v221, v221, v10
    v_mul_f32 v222, v222, v10
    v_mul_f32 v223, v223, v10
    s_add_u32 s96, s63, 6144
    v_cvt_pk_bf16_f32 v208, v208, v209
    v_cvt_pk_bf16_f32 v209, v210, v211
    v_cvt_pk_bf16_f32 v210, v212, v213
    v_cvt_pk_bf16_f32 v211, v214, v215
    buffer_store_dwordx4 v[208:211], v12, s[28:31], s96 offen offset:0 sc1
    v_cvt_pk_bf16_f32 v216, v216, v217
    v_cvt_pk_bf16_f32 v217, v218, v219
    v_cvt_pk_bf16_f32 v218, v220, v221
    v_cvt_pk_bf16_f32 v219, v222, v223
    buffer_store_dwordx4 v[216:219], v12, s[28:31], s96 offen offset:256 sc1
    v_mov_b32 v212, 0
    v_mov_b32 v213, 0
    v_mov_b32 v214, 0
    v_mov_b32 v215, 0
    v_mov_b32 v220, 0
    v_mov_b32 v221, 0
    v_mov_b32 v222, 0
    v_mov_b32 v223, 0
    v_mov_b32 v208, 0
    v_mov_b32 v209, 0
    v_mov_b32 v210, 0
    v_mov_b32 v211, 0
    v_mov_b32 v216, 0
    v_mov_b32 v217, 0
    v_mov_b32 v218, 0
    v_mov_b32 v219, 0
    s_branch A_rescret_157
A_evb_164:
    s_add_u32 s63, s62, 1
    s_mov_b32 s100, -16
    s_sub_u32 s96, s63, s61
    s_add_u32 s96, s96, 2
    s_cmp_lt_u32 s96, 2
    s_cselect_b32 s97, s57, 0
    s_lshl_b32 s96, s96, 1
    s_sub_u32 s96, s96, s58
    s_lshl_b32 s96, s96, 1
    s_cmp_eq_u32 s97, 1
    s_cselect_b32 s100, s96, s100
    s_lshl_b32 s96, s57, 1
    s_sub_u32 s96, s96, s58
    s_lshl_b32 s96, s96, 1
    s_cmp_eq_u32 s63, 16
    s_cselect_b32 s100, s96, s100
    s_cmp_eq_u32 s63, s61
    s_cselect_b32 s101, s57, 0
    s_cmp_eq_u32 s63, 0
    s_cselect_b32 s101, 1, s101
    s_add_u32 s63, s62, 2
    s_cmp_eq_u32 s63, s61
    s_cselect_b32 s63, s57, 0
    s_cmp_eq_u32 s63, 0
    s_cbranch_scc1 A_noq_166
    ds_read_b128 v[32:35], v15 offset:0
    ds_read_b128 v[36:39], v15 offset:1024
    ds_read_b128 v[40:43], v15 offset:2048
    ds_read_b128 v[44:47], v15 offset:3072
    ds_read_b128 v[48:51], v15 offset:4096
    ds_read_b128 v[52:55], v15 offset:5120
    ds_read_b128 v[56:59], v15 offset:6144
    ds_read_b128 v[60:63], v15 offset:7168
    s_waitcnt lgkmcnt(0)
A_noq_166:
    s_lshl_b32 s63, s101, 1
    s_or_b32 s98, s98, s63
    s_cmp_ge_i32 s100, -3
    s_cbranch_scc0 A_evbret_165
    v_and_b32 v9, 15, v1
    v_lshrrev_b32 v10, 4, v1
    v_lshlrev_b32 v10, 2, v10
    s_lshl_b32 s63, s100, 4
    v_sub_u32 v9, v9, v10
    v_subrev_u32 v9, s63, v9
    v_cmp_le_i32 s[64:65], -16, v9
    v_cmp_le_i32 s[66:67], -15, v9
    v_cmp_le_i32 s[68:69], -14, v9
    v_cmp_le_i32 s[70:71], -13, v9
    v_cmp_le_i32 s[72:73], 0, v9
    v_cmp_le_i32 s[74:75], 1, v9
    v_cmp_le_i32 s[76:77], 2, v9
    v_cmp_le_i32 s[78:79], 3, v9
    v_cmp_le_i32 s[80:81], 16, v9
    v_cmp_le_i32 s[82:83], 17, v9
    v_cmp_le_i32 s[84:85], 18, v9
    v_cmp_le_i32 s[86:87], 19, v9
    v_cmp_le_i32 s[88:89], 32, v9
    v_cmp_le_i32 s[90:91], 33, v9
    v_cmp_le_i32 s[92:93], 34, v9
    v_cmp_le_i32 s[94:95], 35, v9
    v_cndmask_b32 v104, v13, v104, s[64:65]
    v_cndmask_b32 v105, v13, v105, s[66:67]
    v_cndmask_b32 v106, v13, v106, s[68:69]
    v_cndmask_b32 v107, v13, v107, s[70:71]
    v_cmp_le_i32 s[64:65], 48, v9
    v_cmp_le_i32 s[66:67], 49, v9
    v_cmp_le_i32 s[68:69], 50, v9
    v_cmp_le_i32 s[70:71], 51, v9
    v_cndmask_b32 v96, v13, v96, s[72:73]
    v_cndmask_b32 v97, v13, v97, s[74:75]
    v_cndmask_b32 v98, v13, v98, s[76:77]
    v_cndmask_b32 v99, v13, v99, s[78:79]
    v_cndmask_b32 v108, v13, v108, s[72:73]
    v_cndmask_b32 v109, v13, v109, s[74:75]
    v_cndmask_b32 v110, v13, v110, s[76:77]
    v_cndmask_b32 v111, v13, v111, s[78:79]
    v_cndmask_b32 v100, v13, v100, s[80:81]
    v_cndmask_b32 v101, v13, v101, s[82:83]
    v_cndmask_b32 v102, v13, v102, s[84:85]
    v_cndmask_b32 v103, v13, v103, s[86:87]
    v_cndmask_b32 v120, v13, v120, s[80:81]
    v_cndmask_b32 v121, v13, v121, s[82:83]
    v_cndmask_b32 v122, v13, v122, s[84:85]
    v_cndmask_b32 v123, v13, v123, s[86:87]
    v_cndmask_b32 v112, v13, v112, s[88:89]
    v_cndmask_b32 v113, v13, v113, s[90:91]
    v_cndmask_b32 v114, v13, v114, s[92:93]
    v_cndmask_b32 v115, v13, v115, s[94:95]
    v_cndmask_b32 v124, v13, v124, s[88:89]
    v_cndmask_b32 v125, v13, v125, s[90:91]
    v_cndmask_b32 v126, v13, v126, s[92:93]
    v_cndmask_b32 v127, v13, v127, s[94:95]
    v_cndmask_b32 v116, v13, v116, s[64:65]
    v_cndmask_b32 v117, v13, v117, s[66:67]
    v_cndmask_b32 v118, v13, v118, s[68:69]
    v_cndmask_b32 v119, v13, v119, s[70:71]
    s_branch A_evbret_165
A_slow_167:
    v_max3_f32 v8, v96, v97, v98
    v_max3_f32 v8, v8, v99, v100
    v_max3_f32 v8, v8, v101, v102
    v_max3_f32 v8, v8, v103, v112
    v_max3_f32 v8, v8, v113, v114
    v_max3_f32 v8, v8, v115, v116
    v_max3_f32 v8, v8, v117, v118
    v_max_f32 v8, v8, v119
    v_max3_f32 v14, v104, v105, v106
    v_max3_f32 v14, v14, v107, v108
    v_max3_f32 v14, v14, v109, v110
    v_max3_f32 v14, v14, v111, v120
    v_max3_f32 v14, v14, v121, v122
    v_max3_f32 v14, v14, v123, v124
    v_max3_f32 v14, v14, v125, v126
    v_max_f32 v14, v14, v127
    v_mov_b32 v9, v8
    v_mov_b32 v10, v14
    s_nop 1
    v_permlane16_swap_b32 v8, v9
    v_permlane16_swap_b32 v14, v10
    s_nop 1
    v_max_f32 v8, v8, v9
    v_max_f32 v14, v14, v10
    v_mov_b32 v9, v8
    v_mov_b32 v10, v14
    s_nop 1
    v_permlane32_swap_b32 v8, v9
    v_permlane32_swap_b32 v14, v10
    s_nop 1
    v_max_f32 v8, v8, v9
    v_max_f32 v14, v14, v10
    s_cmp_eq_u32 s101, 1
    s_cbranch_scc1 A_sf_169
    v_max_f32 v8, 0, v8
    v_sub_f32 v9, 0, v8
    v_exp_f32 v11, v9
    v_max_f32 v14, 0, v14
    v_sub_f32 v10, 0, v14
    v_exp_f32 v7, v10
    s_or_b32 s98, s98, 1
    s_branch A_sj_170
A_sf_169:
    v_max_f32 v8, 0xf149f2ca, v8
    v_max_f32 v14, 0xf149f2ca, v14
A_sj_170:
    v_add_f32 v5, v5, v8
    v_add_f32 v6, v6, v14
    v_sub_f32 v96, v96, v8
    v_sub_f32 v97, v97, v8
    v_sub_f32 v98, v98, v8
    v_sub_f32 v99, v99, v8
    v_sub_f32 v100, v100, v8
    v_sub_f32 v101, v101, v8
    v_sub_f32 v102, v102, v8
    v_sub_f32 v103, v103, v8
    v_sub_f32 v104, v104, v14
    v_sub_f32 v105, v105, v14
    v_sub_f32 v106, v106, v14
    v_sub_f32 v107, v107, v14
    v_sub_f32 v108, v108, v14
    v_sub_f32 v109, v109, v14
    v_sub_f32 v110, v110, v14
    v_sub_f32 v111, v111, v14
    v_sub_f32 v112, v112, v8
    v_sub_f32 v113, v113, v8
    v_sub_f32 v114, v114, v8
    v_sub_f32 v115, v115, v8
    v_sub_f32 v116, v116, v8
    v_sub_f32 v117, v117, v8
    v_sub_f32 v118, v118, v8
    v_sub_f32 v119, v119, v8
    v_sub_f32 v120, v120, v14
    v_sub_f32 v121, v121, v14
    v_sub_f32 v122, v122, v14
    v_sub_f32 v123, v123, v14
    v_sub_f32 v124, v124, v14
    v_sub_f32 v125, v125, v14
    v_sub_f32 v126, v126, v14
    v_sub_f32 v127, v127, v14
    v_sub_f32 v16, 0, v5
    v_sub_f32 v17, 0, v5
    v_sub_f32 v18, 0, v5
    v_sub_f32 v19, 0, v5
    v_sub_f32 v20, 0, v6
    v_sub_f32 v21, 0, v6
    v_sub_f32 v22, 0, v6
    v_sub_f32 v23, 0, v6
    s_branch A_slowret_168
A_resc_174:
    s_nop 15
    s_cmp_eq_u32 s98, 2
    s_mov_b32 s98, 0
    s_cbranch_scc1 A_fin_176
    v_mul_f32 v160, v160, v11
    v_mul_f32 v161, v161, v11
    v_mul_f32 v162, v162, v11
    v_mul_f32 v163, v163, v11
    v_mul_f32 v164, v164, v11
    v_mul_f32 v165, v165, v11
    v_mul_f32 v166, v166, v11
    v_mul_f32 v167, v167, v11
    v_mul_f32 v168, v168, v7
    v_mul_f32 v169, v169, v7
    v_mul_f32 v170, v170, v7
    v_mul_f32 v171, v171, v7
    v_mul_f32 v172, v172, v7
    v_mul_f32 v173, v173, v7
    v_mul_f32 v174, v174, v7
    v_mul_f32 v175, v175, v7
    v_mul_f32 v176, v176, v11
    v_mul_f32 v177, v177, v11
    v_mul_f32 v178, v178, v11
    v_mul_f32 v179, v179, v11
    v_mul_f32 v180, v180, v11
    v_mul_f32 v181, v181, v11
    v_mul_f32 v182, v182, v11
    v_mul_f32 v183, v183, v11
    v_mul_f32 v184, v184, v7
    v_mul_f32 v185, v185, v7
    v_mul_f32 v186, v186, v7
    v_mul_f32 v187, v187, v7
    v_mul_f32 v188, v188, v7
    v_mul_f32 v189, v189, v7
    v_mul_f32 v190, v190, v7
    v_mul_f32 v191, v191, v7
    v_mul_f32 v192, v192, v11
    v_mul_f32 v193, v193, v11
    v_mul_f32 v194, v194, v11
    v_mul_f32 v195, v195, v11
    v_mul_f32 v196, v196, v11
    v_mul_f32 v197, v197, v11
    v_mul_f32 v198, v198, v11
    v_mul_f32 v199, v199, v11
    v_mul_f32 v200, v200, v7
    v_mul_f32 v201, v201, v7
    v_mul_f32 v202, v202, v7
    v_mul_f32 v203, v203, v7
    v_mul_f32 v204, v204, v7
    v_mul_f32 v205, v205, v7
    v_mul_f32 v206, v206, v7
    v_mul_f32 v207, v207, v7
    v_mul_f32 v208, v208, v11
    v_mul_f32 v209, v209, v11
    v_mul_f32 v210, v210, v11
    v_mul_f32 v211, v211, v11
    v_mul_f32 v212, v212, v11
    v_mul_f32 v213, v213, v11
    v_mul_f32 v214, v214, v11
    v_mul_f32 v215, v215, v11
    v_mul_f32 v216, v216, v7
    v_mul_f32 v217, v217, v7
    v_mul_f32 v218, v218, v7
    v_mul_f32 v219, v219, v7
    v_mul_f32 v220, v220, v7
    v_mul_f32 v221, v221, v7
    v_mul_f32 v222, v222, v7
    v_mul_f32 v223, v223, v7
    v_mul_f32 v24, v24, v11
    v_mul_f32 v25, v25, v11
    v_mul_f32 v26, v26, v11
    v_mul_f32 v27, v27, v11
    v_mul_f32 v28, v28, v7
    v_mul_f32 v29, v29, v7
    v_mul_f32 v30, v30, v7
    v_mul_f32 v31, v31, v7
    s_branch A_rescret_175
A_fin_176:
    v_rcp_f32 v9, v24
    v_rcp_f32 v10, v28
    v_mov_b32 v24, 0
    v_mov_b32 v25, 0
    v_mov_b32 v26, 0
    v_mov_b32 v27, 0
    v_mov_b32 v28, 0
    v_mov_b32 v29, 0
    v_mov_b32 v30, 0
    v_mov_b32 v31, 0
    s_lshl_b32 s63, s60, 2
    s_add_u32 s63, s63, s58
    s_lshl_b32 s63, s63, 18
    s_lshl_b32 s96, s59, 13
    s_add_u32 s63, s63, s96
    v_mul_f32 v160, v160, v9
    v_mul_f32 v161, v161, v9
    v_mul_f32 v162, v162, v9
    v_mul_f32 v163, v163, v9
    v_mul_f32 v164, v164, v9
    v_mul_f32 v165, v165, v9
    v_mul_f32 v166, v166, v9
    v_mul_f32 v167, v167, v9
    v_mul_f32 v168, v168, v10
    v_mul_f32 v169, v169, v10
    v_mul_f32 v170, v170, v10
    v_mul_f32 v171, v171, v10
    v_mul_f32 v172, v172, v10
    v_mul_f32 v173, v173, v10
    v_mul_f32 v174, v174, v10
    v_mul_f32 v175, v175, v10
    s_add_u32 s96, s63, 0
    v_cvt_pk_bf16_f32 v160, v160, v161
    v_cvt_pk_bf16_f32 v161, v162, v163
    v_cvt_pk_bf16_f32 v162, v164, v165
    v_cvt_pk_bf16_f32 v163, v166, v167
    buffer_store_dwordx4 v[160:163], v12, s[28:31], s96 offen offset:0 sc1
    v_cvt_pk_bf16_f32 v168, v168, v169
    v_cvt_pk_bf16_f32 v169, v170, v171
    v_cvt_pk_bf16_f32 v170, v172, v173
    v_cvt_pk_bf16_f32 v171, v174, v175
    buffer_store_dwordx4 v[168:171], v12, s[28:31], s96 offen offset:256 sc1
    v_mov_b32 v164, 0
    v_mov_b32 v165, 0
    v_mov_b32 v166, 0
    v_mov_b32 v167, 0
    v_mov_b32 v172, 0
    v_mov_b32 v173, 0
    v_mov_b32 v174, 0
    v_mov_b32 v175, 0
    v_mov_b32 v160, 0
    v_mov_b32 v161, 0
    v_mov_b32 v162, 0
    v_mov_b32 v163, 0
    v_mov_b32 v168, 0
    v_mov_b32 v169, 0
    v_mov_b32 v170, 0
    v_mov_b32 v171, 0
    v_mul_f32 v176, v176, v9
    v_mul_f32 v177, v177, v9
    v_mul_f32 v178, v178, v9
    v_mul_f32 v179, v179, v9
    v_mul_f32 v180, v180, v9
    v_mul_f32 v181, v181, v9
    v_mul_f32 v182, v182, v9
    v_mul_f32 v183, v183, v9
    v_mul_f32 v184, v184, v10
    v_mul_f32 v185, v185, v10
    v_mul_f32 v186, v186, v10
    v_mul_f32 v187, v187, v10
    v_mul_f32 v188, v188, v10
    v_mul_f32 v189, v189, v10
    v_mul_f32 v190, v190, v10
    v_mul_f32 v191, v191, v10
    s_add_u32 s96, s63, 2048
    v_cvt_pk_bf16_f32 v176, v176, v177
    v_cvt_pk_bf16_f32 v177, v178, v179
    v_cvt_pk_bf16_f32 v178, v180, v181
    v_cvt_pk_bf16_f32 v179, v182, v183
    buffer_store_dwordx4 v[176:179], v12, s[28:31], s96 offen offset:0 sc1
    v_cvt_pk_bf16_f32 v184, v184, v185
    v_cvt_pk_bf16_f32 v185, v186, v187
    v_cvt_pk_bf16_f32 v186, v188, v189
    v_cvt_pk_bf16_f32 v187, v190, v191
    buffer_store_dwordx4 v[184:187], v12, s[28:31], s96 offen offset:256 sc1
    v_mov_b32 v180, 0
    v_mov_b32 v181, 0
    v_mov_b32 v182, 0
    v_mov_b32 v183, 0
    v_mov_b32 v188, 0
    v_mov_b32 v189, 0
    v_mov_b32 v190, 0
    v_mov_b32 v191, 0
    v_mov_b32 v176, 0
    v_mov_b32 v177, 0
    v_mov_b32 v178, 0
    v_mov_b32 v179, 0
    v_mov_b32 v184, 0
    v_mov_b32 v185, 0
    v_mov_b32 v186, 0
    v_mov_b32 v187, 0
    v_mul_f32 v192, v192, v9
    v_mul_f32 v193, v193, v9
    v_mul_f32 v194, v194, v9
    v_mul_f32 v195, v195, v9
    v_mul_f32 v196, v196, v9
    v_mul_f32 v197, v197, v9
    v_mul_f32 v198, v198, v9
    v_mul_f32 v199, v199, v9
    v_mul_f32 v200, v200, v10
    v_mul_f32 v201, v201, v10
    v_mul_f32 v202, v202, v10
    v_mul_f32 v203, v203, v10
    v_mul_f32 v204, v204, v10
    v_mul_f32 v205, v205, v10
    v_mul_f32 v206, v206, v10
    v_mul_f32 v207, v207, v10
    s_add_u32 s96, s63, 4096
    v_cvt_pk_bf16_f32 v192, v192, v193
    v_cvt_pk_bf16_f32 v193, v194, v195
    v_cvt_pk_bf16_f32 v194, v196, v197
    v_cvt_pk_bf16_f32 v195, v198, v199
    buffer_store_dwordx4 v[192:195], v12, s[28:31], s96 offen offset:0 sc1
    v_cvt_pk_bf16_f32 v200, v200, v201
    v_cvt_pk_bf16_f32 v201, v202, v203
    v_cvt_pk_bf16_f32 v202, v204, v205
    v_cvt_pk_bf16_f32 v203, v206, v207
    buffer_store_dwordx4 v[200:203], v12, s[28:31], s96 offen offset:256 sc1
    v_mov_b32 v196, 0
    v_mov_b32 v197, 0
    v_mov_b32 v198, 0
    v_mov_b32 v199, 0
    v_mov_b32 v204, 0
    v_mov_b32 v205, 0
    v_mov_b32 v206, 0
    v_mov_b32 v207, 0
    v_mov_b32 v192, 0
    v_mov_b32 v193, 0
    v_mov_b32 v194, 0
    v_mov_b32 v195, 0
    v_mov_b32 v200, 0
    v_mov_b32 v201, 0
    v_mov_b32 v202, 0
    v_mov_b32 v203, 0
    v_mul_f32 v208, v208, v9
    v_mul_f32 v209, v209, v9
    v_mul_f32 v210, v210, v9
    v_mul_f32 v211, v211, v9
    v_mul_f32 v212, v212, v9
    v_mul_f32 v213, v213, v9
    v_mul_f32 v214, v214, v9
    v_mul_f32 v215, v215, v9
    v_mul_f32 v216, v216, v10
    v_mul_f32 v217, v217, v10
    v_mul_f32 v218, v218, v10
    v_mul_f32 v219, v219, v10
    v_mul_f32 v220, v220, v10
    v_mul_f32 v221, v221, v10
    v_mul_f32 v222, v222, v10
    v_mul_f32 v223, v223, v10
    s_add_u32 s96, s63, 6144
    v_cvt_pk_bf16_f32 v208, v208, v209
    v_cvt_pk_bf16_f32 v209, v210, v211
    v_cvt_pk_bf16_f32 v210, v212, v213
    v_cvt_pk_bf16_f32 v211, v214, v215
    buffer_store_dwordx4 v[208:211], v12, s[28:31], s96 offen offset:0 sc1
    v_cvt_pk_bf16_f32 v216, v216, v217
    v_cvt_pk_bf16_f32 v217, v218, v219
    v_cvt_pk_bf16_f32 v218, v220, v221
    v_cvt_pk_bf16_f32 v219, v222, v223
    buffer_store_dwordx4 v[216:219], v12, s[28:31], s96 offen offset:256 sc1
    v_mov_b32 v212, 0
    v_mov_b32 v213, 0
    v_mov_b32 v214, 0
    v_mov_b32 v215, 0
    v_mov_b32 v220, 0
    v_mov_b32 v221, 0
    v_mov_b32 v222, 0
    v_mov_b32 v223, 0
    v_mov_b32 v208, 0
    v_mov_b32 v209, 0
    v_mov_b32 v210, 0
    v_mov_b32 v211, 0
    v_mov_b32 v216, 0
    v_mov_b32 v217, 0
    v_mov_b32 v218, 0
    v_mov_b32 v219, 0
    s_branch A_rescret_175
A_evb_182:
    s_add_u32 s63, s62, 1
    s_mov_b32 s100, -16
    s_sub_u32 s96, s63, s61
    s_add_u32 s96, s96, 2
    s_cmp_lt_u32 s96, 2
    s_cselect_b32 s97, s57, 0
    s_lshl_b32 s96, s96, 1
    s_sub_u32 s96, s96, s58
    s_lshl_b32 s96, s96, 1
    s_cmp_eq_u32 s97, 1
    s_cselect_b32 s100, s96, s100
    s_lshl_b32 s96, s57, 1
    s_sub_u32 s96, s96, s58
    s_lshl_b32 s96, s96, 1
    s_cmp_eq_u32 s63, 16
    s_cselect_b32 s100, s96, s100
    s_cmp_eq_u32 s63, s61
    s_cselect_b32 s101, s57, 0
    s_cmp_eq_u32 s63, 0
    s_cselect_b32 s101, 1, s101
    s_add_u32 s63, s62, 2
    s_cmp_eq_u32 s63, s61
    s_cselect_b32 s63, s57, 0
    s_cmp_eq_u32 s63, 0
    s_cbranch_scc1 A_noq_184
    ds_read_b128 v[32:35], v15 offset:0
    ds_read_b128 v[36:39], v15 offset:1024
    ds_read_b128 v[40:43], v15 offset:2048
    ds_read_b128 v[44:47], v15 offset:3072
    ds_read_b128 v[48:51], v15 offset:4096
    ds_read_b128 v[52:55], v15 offset:5120
    ds_read_b128 v[56:59], v15 offset:6144
    ds_read_b128 v[60:63], v15 offset:7168
    s_waitcnt lgkmcnt(0)
A_noq_184:
    s_lshl_b32 s63, s101, 1
    s_or_b32 s98, s98, s63
    s_cmp_ge_i32 s100, -3
    s_cbranch_scc0 A_evbret_183
    v_and_b32 v9, 15, v1
    v_lshrrev_b32 v10, 4, v1
    v_lshlrev_b32 v10, 2, v10
    s_lshl_b32 s63, s100, 4
    v_sub_u32 v9, v9, v10
    v_subrev_u32 v9, s63, v9
    v_cmp_le_i32 s[64:65], -16, v9
    v_cmp_le_i32 s[66:67], -15, v9
    v_cmp_le_i32 s[68:69], -14, v9
    v_cmp_le_i32 s[70:71], -13, v9
    v_cmp_le_i32 s[72:73], 0, v9
    v_cmp_le_i32 s[74:75], 1, v9
    v_cmp_le_i32 s[76:77], 2, v9
    v_cmp_le_i32 s[78:79], 3, v9
    v_cmp_le_i32 s[80:81], 16, v9
    v_cmp_le_i32 s[82:83], 17, v9
    v_cmp_le_i32 s[84:85], 18, v9
    v_cmp_le_i32 s[86:87], 19, v9
    v_cmp_le_i32 s[88:89], 32, v9
    v_cmp_le_i32 s[90:91], 33, v9
    v_cmp_le_i32 s[92:93], 34, v9
    v_cmp_le_i32 s[94:95], 35, v9
    v_cndmask_b32 v136, v13, v136, s[64:65]
    v_cndmask_b32 v137, v13, v137, s[66:67]
    v_cndmask_b32 v138, v13, v138, s[68:69]
    v_cndmask_b32 v139, v13, v139, s[70:71]
    v_cmp_le_i32 s[64:65], 48, v9
    v_cmp_le_i32 s[66:67], 49, v9
    v_cmp_le_i32 s[68:69], 50, v9
    v_cmp_le_i32 s[70:71], 51, v9
    v_cndmask_b32 v128, v13, v128, s[72:73]
    v_cndmask_b32 v129, v13, v129, s[74:75]
    v_cndmask_b32 v130, v13, v130, s[76:77]
    v_cndmask_b32 v131, v13, v131, s[78:79]
    v_cndmask_b32 v140, v13, v140, s[72:73]
    v_cndmask_b32 v141, v13, v141, s[74:75]
    v_cndmask_b32 v142, v13, v142, s[76:77]
    v_cndmask_b32 v143, v13, v143, s[78:79]
    v_cndmask_b32 v132, v13, v132, s[80:81]
    v_cndmask_b32 v133, v13, v133, s[82:83]
    v_cndmask_b32 v134, v13, v134, s[84:85]
    v_cndmask_b32 v135, v13, v135, s[86:87]
    v_cndmask_b32 v152, v13, v152, s[80:81]
    v_cndmask_b32 v153, v13, v153, s[82:83]
    v_cndmask_b32 v154, v13, v154, s[84:85]
    v_cndmask_b32 v155, v13, v155, s[86:87]
    v_cndmask_b32 v144, v13, v144, s[88:89]
    v_cndmask_b32 v145, v13, v145, s[90:91]
    v_cndmask_b32 v146, v13, v146, s[92:93]
    v_cndmask_b32 v147, v13, v147, s[94:95]
    v_cndmask_b32 v156, v13, v156, s[88:89]
    v_cndmask_b32 v157, v13, v157, s[90:91]
    v_cndmask_b32 v158, v13, v158, s[92:93]
    v_cndmask_b32 v159, v13, v159, s[94:95]
    v_cndmask_b32 v148, v13, v148, s[64:65]
    v_cndmask_b32 v149, v13, v149, s[66:67]
    v_cndmask_b32 v150, v13, v150, s[68:69]
    v_cndmask_b32 v151, v13, v151, s[70:71]
    s_branch A_evbret_183
A_slow_185:
    v_max3_f32 v8, v128, v129, v130
    v_max3_f32 v8, v8, v131, v132
    v_max3_f32 v8, v8, v133, v134
    v_max3_f32 v8, v8, v135, v144
    v_max3_f32 v8, v8, v145, v146
    v_max3_f32 v8, v8, v147, v148
    v_max3_f32 v8, v8, v149, v150
    v_max_f32 v8, v8, v151
    v_max3_f32 v14, v136, v137, v138
    v_max3_f32 v14, v14, v139, v140
    v_max3_f32 v14, v14, v141, v142
    v_max3_f32 v14, v14, v143, v152
    v_max3_f32 v14, v14, v153, v154
    v_max3_f32 v14, v14, v155, v156
    v_max3_f32 v14, v14, v157, v158
    v_max_f32 v14, v14, v159
    v_mov_b32 v9, v8
    v_mov_b32 v10, v14
    s_nop 1
    v_permlane16_swap_b32 v8, v9
    v_permlane16_swap_b32 v14, v10
    s_nop 1
    v_max_f32 v8, v8, v9
    v_max_f32 v14, v14, v10
    v_mov_b32 v9, v8
    v_mov_b32 v10, v14
    s_nop 1
    v_permlane32_swap_b32 v8, v9
    v_permlane32_swap_b32 v14, v10
    s_nop 1
    v_max_f32 v8, v8, v9
    v_max_f32 v14, v14, v10
    s_cmp_eq_u32 s101, 1
    s_cbranch_scc1 A_sf_187
    v_max_f32 v8, 0, v8
    v_sub_f32 v9, 0, v8
    v_exp_f32 v11, v9
    v_max_f32 v14, 0, v14
    v_sub_f32 v10, 0, v14
    v_exp_f32 v7, v10
    s_or_b32 s98, s98, 1
    s_branch A_sj_188
A_sf_187:
    v_max_f32 v8, 0xf149f2ca, v8
    v_max_f32 v14, 0xf149f2ca, v14
A_sj_188:
    v_add_f32 v5, v5, v8
    v_add_f32 v6, v6, v14
    v_sub_f32 v128, v128, v8
    v_sub_f32 v129, v129, v8
    v_sub_f32 v130, v130, v8
    v_sub_f32 v131, v131, v8
    v_sub_f32 v132, v132, v8
    v_sub_f32 v133, v133, v8
    v_sub_f32 v134, v134, v8
    v_sub_f32 v135, v135, v8
    v_sub_f32 v136, v136, v14
    v_sub_f32 v137, v137, v14
    v_sub_f32 v138, v138, v14
    v_sub_f32 v139, v139, v14
    v_sub_f32 v140, v140, v14
    v_sub_f32 v141, v141, v14
    v_sub_f32 v142, v142, v14
    v_sub_f32 v143, v143, v14
    v_sub_f32 v144, v144, v8
    v_sub_f32 v145, v145, v8
    v_sub_f32 v146, v146, v8
    v_sub_f32 v147, v147, v8
    v_sub_f32 v148, v148, v8
    v_sub_f32 v149, v149, v8
    v_sub_f32 v150, v150, v8
    v_sub_f32 v151, v151, v8
    v_sub_f32 v152, v152, v14
    v_sub_f32 v153, v153, v14
    v_sub_f32 v154, v154, v14
    v_sub_f32 v155, v155, v14
    v_sub_f32 v156, v156, v14
    v_sub_f32 v157, v157, v14
    v_sub_f32 v158, v158, v14
    v_sub_f32 v159, v159, v14
    v_sub_f32 v16, 0, v5
    v_sub_f32 v17, 0, v5
    v_sub_f32 v18, 0, v5
    v_sub_f32 v19, 0, v5
    v_sub_f32 v20, 0, v6
    v_sub_f32 v21, 0, v6
    v_sub_f32 v22, 0, v6
    v_sub_f32 v23, 0, v6
    s_branch A_slowret_186
A_resc_192:
    s_nop 15
    s_cmp_eq_u32 s98, 2
    s_mov_b32 s98, 0
    s_cbranch_scc1 A_fin_194
    v_mul_f32 v160, v160, v11
    v_mul_f32 v161, v161, v11
    v_mul_f32 v162, v162, v11
    v_mul_f32 v163, v163, v11
    v_mul_f32 v164, v164, v11
    v_mul_f32 v165, v165, v11
    v_mul_f32 v166, v166, v11
    v_mul_f32 v167, v167, v11
    v_mul_f32 v168, v168, v7
    v_mul_f32 v169, v169, v7
    v_mul_f32 v170, v170, v7
    v_mul_f32 v171, v171, v7
    v_mul_f32 v172, v172, v7
    v_mul_f32 v173, v173, v7
    v_mul_f32 v174, v174, v7
    v_mul_f32 v175, v175, v7
    v_mul_f32 v176, v176, v11
    v_mul_f32 v177, v177, v11
    v_mul_f32 v178, v178, v11
    v_mul_f32 v179, v179, v11
    v_mul_f32 v180, v180, v11
    v_mul_f32 v181, v181, v11
    v_mul_f32 v182, v182, v11
    v_mul_f32 v183, v183, v11
    v_mul_f32 v184, v184, v7
    v_mul_f32 v185, v185, v7
    v_mul_f32 v186, v186, v7
    v_mul_f32 v187, v187, v7
    v_mul_f32 v188, v188, v7
    v_mul_f32 v189, v189, v7
    v_mul_f32 v190, v190, v7
    v_mul_f32 v191, v191, v7
    v_mul_f32 v192, v192, v11
    v_mul_f32 v193, v193, v11
    v_mul_f32 v194, v194, v11
    v_mul_f32 v195, v195, v11
    v_mul_f32 v196, v196, v11
    v_mul_f32 v197, v197, v11
    v_mul_f32 v198, v198, v11
    v_mul_f32 v199, v199, v11
    v_mul_f32 v200, v200, v7
    v_mul_f32 v201, v201, v7
    v_mul_f32 v202, v202, v7
    v_mul_f32 v203, v203, v7
    v_mul_f32 v204, v204, v7
    v_mul_f32 v205, v205, v7
    v_mul_f32 v206, v206, v7
    v_mul_f32 v207, v207, v7
    v_mul_f32 v208, v208, v11
    v_mul_f32 v209, v209, v11
    v_mul_f32 v210, v210, v11
    v_mul_f32 v211, v211, v11
    v_mul_f32 v212, v212, v11
    v_mul_f32 v213, v213, v11
    v_mul_f32 v214, v214, v11
    v_mul_f32 v215, v215, v11
    v_mul_f32 v216, v216, v7
    v_mul_f32 v217, v217, v7
    v_mul_f32 v218, v218, v7
    v_mul_f32 v219, v219, v7
    v_mul_f32 v220, v220, v7
    v_mul_f32 v221, v221, v7
    v_mul_f32 v222, v222, v7
    v_mul_f32 v223, v223, v7
    v_mul_f32 v24, v24, v11
    v_mul_f32 v25, v25, v11
    v_mul_f32 v26, v26, v11
    v_mul_f32 v27, v27, v11
    v_mul_f32 v28, v28, v7
    v_mul_f32 v29, v29, v7
    v_mul_f32 v30, v30, v7
    v_mul_f32 v31, v31, v7
    s_branch A_rescret_193
A_fin_194:
    v_rcp_f32 v9, v24
    v_rcp_f32 v10, v28
    v_mov_b32 v24, 0
    v_mov_b32 v25, 0
    v_mov_b32 v26, 0
    v_mov_b32 v27, 0
    v_mov_b32 v28, 0
    v_mov_b32 v29, 0
    v_mov_b32 v30, 0
    v_mov_b32 v31, 0
    s_lshl_b32 s63, s60, 2
    s_add_u32 s63, s63, s58
    s_lshl_b32 s63, s63, 18
    s_lshl_b32 s96, s59, 13
    s_add_u32 s63, s63, s96
    v_mul_f32 v160, v160, v9
    v_mul_f32 v161, v161, v9
    v_mul_f32 v162, v162, v9
    v_mul_f32 v163, v163, v9
    v_mul_f32 v164, v164, v9
    v_mul_f32 v165, v165, v9
    v_mul_f32 v166, v166, v9
    v_mul_f32 v167, v167, v9
    v_mul_f32 v168, v168, v10
    v_mul_f32 v169, v169, v10
    v_mul_f32 v170, v170, v10
    v_mul_f32 v171, v171, v10
    v_mul_f32 v172, v172, v10
    v_mul_f32 v173, v173, v10
    v_mul_f32 v174, v174, v10
    v_mul_f32 v175, v175, v10
    s_add_u32 s96, s63, 0
    v_cvt_pk_bf16_f32 v160, v160, v161
    v_cvt_pk_bf16_f32 v161, v162, v163
    v_cvt_pk_bf16_f32 v162, v164, v165
    v_cvt_pk_bf16_f32 v163, v166, v167
    buffer_store_dwordx4 v[160:163], v12, s[28:31], s96 offen offset:0 sc1
    v_cvt_pk_bf16_f32 v168, v168, v169
    v_cvt_pk_bf16_f32 v169, v170, v171
    v_cvt_pk_bf16_f32 v170, v172, v173
    v_cvt_pk_bf16_f32 v171, v174, v175
    buffer_store_dwordx4 v[168:171], v12, s[28:31], s96 offen offset:256 sc1
    v_mov_b32 v164, 0
    v_mov_b32 v165, 0
    v_mov_b32 v166, 0
    v_mov_b32 v167, 0
    v_mov_b32 v172, 0
    v_mov_b32 v173, 0
    v_mov_b32 v174, 0
    v_mov_b32 v175, 0
    v_mov_b32 v160, 0
    v_mov_b32 v161, 0
    v_mov_b32 v162, 0
    v_mov_b32 v163, 0
    v_mov_b32 v168, 0
    v_mov_b32 v169, 0
    v_mov_b32 v170, 0
    v_mov_b32 v171, 0
    v_mul_f32 v176, v176, v9
    v_mul_f32 v177, v177, v9
    v_mul_f32 v178, v178, v9
    v_mul_f32 v179, v179, v9
    v_mul_f32 v180, v180, v9
    v_mul_f32 v181, v181, v9
    v_mul_f32 v182, v182, v9
    v_mul_f32 v183, v183, v9
    v_mul_f32 v184, v184, v10
    v_mul_f32 v185, v185, v10
    v_mul_f32 v186, v186, v10
    v_mul_f32 v187, v187, v10
    v_mul_f32 v188, v188, v10
    v_mul_f32 v189, v189, v10
    v_mul_f32 v190, v190, v10
    v_mul_f32 v191, v191, v10
    s_add_u32 s96, s63, 2048
    v_cvt_pk_bf16_f32 v176, v176, v177
    v_cvt_pk_bf16_f32 v177, v178, v179
    v_cvt_pk_bf16_f32 v178, v180, v181
    v_cvt_pk_bf16_f32 v179, v182, v183
    buffer_store_dwordx4 v[176:179], v12, s[28:31], s96 offen offset:0 sc1
    v_cvt_pk_bf16_f32 v184, v184, v185
    v_cvt_pk_bf16_f32 v185, v186, v187
    v_cvt_pk_bf16_f32 v186, v188, v189
    v_cvt_pk_bf16_f32 v187, v190, v191
    buffer_store_dwordx4 v[184:187], v12, s[28:31], s96 offen offset:256 sc1
    v_mov_b32 v180, 0
    v_mov_b32 v181, 0
    v_mov_b32 v182, 0
    v_mov_b32 v183, 0
    v_mov_b32 v188, 0
    v_mov_b32 v189, 0
    v_mov_b32 v190, 0
    v_mov_b32 v191, 0
    v_mov_b32 v176, 0
    v_mov_b32 v177, 0
    v_mov_b32 v178, 0
    v_mov_b32 v179, 0
    v_mov_b32 v184, 0
    v_mov_b32 v185, 0
    v_mov_b32 v186, 0
    v_mov_b32 v187, 0
    v_mul_f32 v192, v192, v9
    v_mul_f32 v193, v193, v9
    v_mul_f32 v194, v194, v9
    v_mul_f32 v195, v195, v9
    v_mul_f32 v196, v196, v9
    v_mul_f32 v197, v197, v9
    v_mul_f32 v198, v198, v9
    v_mul_f32 v199, v199, v9
    v_mul_f32 v200, v200, v10
    v_mul_f32 v201, v201, v10
    v_mul_f32 v202, v202, v10
    v_mul_f32 v203, v203, v10
    v_mul_f32 v204, v204, v10
    v_mul_f32 v205, v205, v10
    v_mul_f32 v206, v206, v10
    v_mul_f32 v207, v207, v10
    s_add_u32 s96, s63, 4096
    v_cvt_pk_bf16_f32 v192, v192, v193
    v_cvt_pk_bf16_f32 v193, v194, v195
    v_cvt_pk_bf16_f32 v194, v196, v197
    v_cvt_pk_bf16_f32 v195, v198, v199
    buffer_store_dwordx4 v[192:195], v12, s[28:31], s96 offen offset:0 sc1
    v_cvt_pk_bf16_f32 v200, v200, v201
    v_cvt_pk_bf16_f32 v201, v202, v203
    v_cvt_pk_bf16_f32 v202, v204, v205
    v_cvt_pk_bf16_f32 v203, v206, v207
    buffer_store_dwordx4 v[200:203], v12, s[28:31], s96 offen offset:256 sc1
    v_mov_b32 v196, 0
    v_mov_b32 v197, 0
    v_mov_b32 v198, 0
    v_mov_b32 v199, 0
    v_mov_b32 v204, 0
    v_mov_b32 v205, 0
    v_mov_b32 v206, 0
    v_mov_b32 v207, 0
    v_mov_b32 v192, 0
    v_mov_b32 v193, 0
    v_mov_b32 v194, 0
    v_mov_b32 v195, 0
    v_mov_b32 v200, 0
    v_mov_b32 v201, 0
    v_mov_b32 v202, 0
    v_mov_b32 v203, 0
    v_mul_f32 v208, v208, v9
    v_mul_f32 v209, v209, v9
    v_mul_f32 v210, v210, v9
    v_mul_f32 v211, v211, v9
    v_mul_f32 v212, v212, v9
    v_mul_f32 v213, v213, v9
    v_mul_f32 v214, v214, v9
    v_mul_f32 v215, v215, v9
    v_mul_f32 v216, v216, v10
    v_mul_f32 v217, v217, v10
    v_mul_f32 v218, v218, v10
    v_mul_f32 v219, v219, v10
    v_mul_f32 v220, v220, v10
    v_mul_f32 v221, v221, v10
    v_mul_f32 v222, v222, v10
    v_mul_f32 v223, v223, v10
    s_add_u32 s96, s63, 6144
    v_cvt_pk_bf16_f32 v208, v208, v209
    v_cvt_pk_bf16_f32 v209, v210, v211
    v_cvt_pk_bf16_f32 v210, v212, v213
    v_cvt_pk_bf16_f32 v211, v214, v215
    buffer_store_dwordx4 v[208:211], v12, s[28:31], s96 offen offset:0 sc1
    v_cvt_pk_bf16_f32 v216, v216, v217
    v_cvt_pk_bf16_f32 v217, v218, v219
    v_cvt_pk_bf16_f32 v218, v220, v221
    v_cvt_pk_bf16_f32 v219, v222, v223
    buffer_store_dwordx4 v[216:219], v12, s[28:31], s96 offen offset:256 sc1
    v_mov_b32 v212, 0
    v_mov_b32 v213, 0
    v_mov_b32 v214, 0
    v_mov_b32 v215, 0
    v_mov_b32 v220, 0
    v_mov_b32 v221, 0
    v_mov_b32 v222, 0
    v_mov_b32 v223, 0
    v_mov_b32 v208, 0
    v_mov_b32 v209, 0
    v_mov_b32 v210, 0
    v_mov_b32 v211, 0
    v_mov_b32 v216, 0
    v_mov_b32 v217, 0
    v_mov_b32 v218, 0
    v_mov_b32 v219, 0
    s_branch A_rescret_193
A_evb_200:
    s_add_u32 s63, s62, 1
    s_mov_b32 s100, -16
    s_sub_u32 s96, s63, s61
    s_add_u32 s96, s96, 2
    s_cmp_lt_u32 s96, 2
    s_cselect_b32 s97, s57, 0
    s_lshl_b32 s96, s96, 1
    s_sub_u32 s96, s96, s58
    s_lshl_b32 s96, s96, 1
    s_cmp_eq_u32 s97, 1
    s_cselect_b32 s100, s96, s100
    s_lshl_b32 s96, s57, 1
    s_sub_u32 s96, s96, s58
    s_lshl_b32 s96, s96, 1
    s_cmp_eq_u32 s63, 16
    s_cselect_b32 s100, s96, s100
    s_cmp_eq_u32 s63, s61
    s_cselect_b32 s101, s57, 0
    s_cmp_eq_u32 s63, 0
    s_cselect_b32 s101, 1, s101
    s_add_u32 s63, s62, 2
    s_cmp_eq_u32 s63, s61
    s_cselect_b32 s63, s57, 0
    s_cmp_eq_u32 s63, 0
    s_cbranch_scc1 A_noq_202
    ds_read_b128 v[32:35], v15 offset:0
    ds_read_b128 v[36:39], v15 offset:1024
    ds_read_b128 v[40:43], v15 offset:2048
    ds_read_b128 v[44:47], v15 offset:3072
    ds_read_b128 v[48:51], v15 offset:4096
    ds_read_b128 v[52:55], v15 offset:5120
    ds_read_b128 v[56:59], v15 offset:6144
    ds_read_b128 v[60:63], v15 offset:7168
    s_waitcnt lgkmcnt(0)
A_noq_202:
    s_lshl_b32 s63, s101, 1
    s_or_b32 s98, s98, s63
    s_cmp_ge_i32 s100, -3
    s_cbranch_scc0 A_evbret_201
    v_and_b32 v9, 15, v1
    v_lshrrev_b32 v10, 4, v1
    v_lshlrev_b32 v10, 2, v10
    s_lshl_b32 s63, s100, 4
    v_sub_u32 v9, v9, v10
    v_subrev_u32 v9, s63, v9
    v_cmp_le_i32 s[64:65], -16, v9
    v_cmp_le_i32 s[66:67], -15, v9
    v_cmp_le_i32 s[68:69], -14, v9
    v_cmp_le_i32 s[70:71], -13, v9
    v_cmp_le_i32 s[72:73], 0, v9
    v_cmp_le_i32 s[74:75], 1, v9
    v_cmp_le_i32 s[76:77], 2, v9
    v_cmp_le_i32 s[78:79], 3, v9
    v_cmp_le_i32 s[80:81], 16, v9
    v_cmp_le_i32 s[82:83], 17, v9
    v_cmp_le_i32 s[84:85], 18, v9
    v_cmp_le_i32 s[86:87], 19, v9
    v_cmp_le_i32 s[88:89], 32, v9
    v_cmp_le_i32 s[90:91], 33, v9
    v_cmp_le_i32 s[92:93], 34, v9
    v_cmp_le_i32 s[94:95], 35, v9
    v_cndmask_b32 v104, v13, v104, s[64:65]
    v_cndmask_b32 v105, v13, v105, s[66:67]
    v_cndmask_b32 v106, v13, v106, s[68:69]
    v_cndmask_b32 v107, v13, v107, s[70:71]
    v_cmp_le_i32 s[64:65], 48, v9
    v_cmp_le_i32 s[66:67], 49, v9
    v_cmp_le_i32 s[68:69], 50, v9
    v_cmp_le_i32 s[70:71], 51, v9
    v_cndmask_b32 v96, v13, v96, s[72:73]
    v_cndmask_b32 v97, v13, v97, s[74:75]
    v_cndmask_b32 v98, v13, v98, s[76:77]
    v_cndmask_b32 v99, v13, v99, s[78:79]
    v_cndmask_b32 v108, v13, v108, s[72:73]
    v_cndmask_b32 v109, v13, v109, s[74:75]
    v_cndmask_b32 v110, v13, v110, s[76:77]
    v_cndmask_b32 v111, v13, v111, s[78:79]
    v_cndmask_b32 v100, v13, v100, s[80:81]
    v_cndmask_b32 v101, v13, v101, s[82:83]
    v_cndmask_b32 v102, v13, v102, s[84:85]
    v_cndmask_b32 v103, v13, v103, s[86:87]
    v_cndmask_b32 v120, v13, v120, s[80:81]
    v_cndmask_b32 v121, v13, v121, s[82:83]
    v_cndmask_b32 v122, v13, v122, s[84:85]
    v_cndmask_b32 v123, v13, v123, s[86:87]
    v_cndmask_b32 v112, v13, v112, s[88:89]
    v_cndmask_b32 v113, v13, v113, s[90:91]
    v_cndmask_b32 v114, v13, v114, s[92:93]
    v_cndmask_b32 v115, v13, v115, s[94:95]
    v_cndmask_b32 v124, v13, v124, s[88:89]
    v_cndmask_b32 v125, v13, v125, s[90:91]
    v_cndmask_b32 v126, v13, v126, s[92:93]
    v_cndmask_b32 v127, v13, v127, s[94:95]
    v_cndmask_b32 v116, v13, v116, s[64:65]
    v_cndmask_b32 v117, v13, v117, s[66:67]
    v_cndmask_b32 v118, v13, v118, s[68:69]
    v_cndmask_b32 v119, v13, v119, s[70:71]
    s_branch A_evbret_201
A_slow_203:
    v_max3_f32 v8, v96, v97, v98
    v_max3_f32 v8, v8, v99, v100
    v_max3_f32 v8, v8, v101, v102
    v_max3_f32 v8, v8, v103, v112
    v_max3_f32 v8, v8, v113, v114
    v_max3_f32 v8, v8, v115, v116
    v_max3_f32 v8, v8, v117, v118
    v_max_f32 v8, v8, v119
    v_max3_f32 v14, v104, v105, v106
    v_max3_f32 v14, v14, v107, v108
    v_max3_f32 v14, v14, v109, v110
    v_max3_f32 v14, v14, v111, v120
    v_max3_f32 v14, v14, v121, v122
    v_max3_f32 v14, v14, v123, v124
    v_max3_f32 v14, v14, v125, v126
    v_max_f32 v14, v14, v127
    v_mov_b32 v9, v8
    v_mov_b32 v10, v14
    s_nop 1
    v_permlane16_swap_b32 v8, v9
    v_permlane16_swap_b32 v14, v10
    s_nop 1
    v_max_f32 v8, v8, v9
    v_max_f32 v14, v14, v10
    v_mov_b32 v9, v8
    v_mov_b32 v10, v14
    s_nop 1
    v_permlane32_swap_b32 v8, v9
    v_permlane32_swap_b32 v14, v10
    s_nop 1
    v_max_f32 v8, v8, v9
    v_max_f32 v14, v14, v10
    s_cmp_eq_u32 s101, 1
    s_cbranch_scc1 A_sf_205
    v_max_f32 v8, 0, v8
    v_sub_f32 v9, 0, v8
    v_exp_f32 v11, v9
    v_max_f32 v14, 0, v14
    v_sub_f32 v10, 0, v14
    v_exp_f32 v7, v10
    s_or_b32 s98, s98, 1
    s_branch A_sj_206
A_sf_205:
    v_max_f32 v8, 0xf149f2ca, v8
    v_max_f32 v14, 0xf149f2ca, v14
A_sj_206:
    v_add_f32 v5, v5, v8
    v_add_f32 v6, v6, v14
    v_sub_f32 v96, v96, v8
    v_sub_f32 v97, v97, v8
    v_sub_f32 v98, v98, v8
    v_sub_f32 v99, v99, v8
    v_sub_f32 v100, v100, v8
    v_sub_f32 v101, v101, v8
    v_sub_f32 v102, v102, v8
    v_sub_f32 v103, v103, v8
    v_sub_f32 v104, v104, v14
    v_sub_f32 v105, v105, v14
    v_sub_f32 v106, v106, v14
    v_sub_f32 v107, v107, v14
    v_sub_f32 v108, v108, v14
    v_sub_f32 v109, v109, v14
    v_sub_f32 v110, v110, v14
    v_sub_f32 v111, v111, v14
    v_sub_f32 v112, v112, v8
    v_sub_f32 v113, v113, v8
    v_sub_f32 v114, v114, v8
    v_sub_f32 v115, v115, v8
    v_sub_f32 v116, v116, v8
    v_sub_f32 v117, v117, v8
    v_sub_f32 v118, v118, v8
    v_sub_f32 v119, v119, v8
    v_sub_f32 v120, v120, v14
    v_sub_f32 v121, v121, v14
    v_sub_f32 v122, v122, v14
    v_sub_f32 v123, v123, v14
    v_sub_f32 v124, v124, v14
    v_sub_f32 v125, v125, v14
    v_sub_f32 v126, v126, v14
    v_sub_f32 v127, v127, v14
    v_sub_f32 v16, 0, v5
    v_sub_f32 v17, 0, v5
    v_sub_f32 v18, 0, v5
    v_sub_f32 v19, 0, v5
    v_sub_f32 v20, 0, v6
    v_sub_f32 v21, 0, v6
    v_sub_f32 v22, 0, v6
    v_sub_f32 v23, 0, v6
    s_branch A_slowret_204
A_resc_210:
    s_nop 15
    s_cmp_eq_u32 s98, 2
    s_mov_b32 s98, 0
    s_cbranch_scc1 A_fin_212
    v_mul_f32 v160, v160, v11
    v_mul_f32 v161, v161, v11
    v_mul_f32 v162, v162, v11
    v_mul_f32 v163, v163, v11
    v_mul_f32 v164, v164, v11
    v_mul_f32 v165, v165, v11
    v_mul_f32 v166, v166, v11
    v_mul_f32 v167, v167, v11
    v_mul_f32 v168, v168, v7
    v_mul_f32 v169, v169, v7
    v_mul_f32 v170, v170, v7
    v_mul_f32 v171, v171, v7
    v_mul_f32 v172, v172, v7
    v_mul_f32 v173, v173, v7
    v_mul_f32 v174, v174, v7
    v_mul_f32 v175, v175, v7
    v_mul_f32 v176, v176, v11
    v_mul_f32 v177, v177, v11
    v_mul_f32 v178, v178, v11
    v_mul_f32 v179, v179, v11
    v_mul_f32 v180, v180, v11
    v_mul_f32 v181, v181, v11
    v_mul_f32 v182, v182, v11
    v_mul_f32 v183, v183, v11
    v_mul_f32 v184, v184, v7
    v_mul_f32 v185, v185, v7
    v_mul_f32 v186, v186, v7
    v_mul_f32 v187, v187, v7
    v_mul_f32 v188, v188, v7
    v_mul_f32 v189, v189, v7
    v_mul_f32 v190, v190, v7
    v_mul_f32 v191, v191, v7
    v_mul_f32 v192, v192, v11
    v_mul_f32 v193, v193, v11
    v_mul_f32 v194, v194, v11
    v_mul_f32 v195, v195, v11
    v_mul_f32 v196, v196, v11
    v_mul_f32 v197, v197, v11
    v_mul_f32 v198, v198, v11
    v_mul_f32 v199, v199, v11
    v_mul_f32 v200, v200, v7
    v_mul_f32 v201, v201, v7
    v_mul_f32 v202, v202, v7
    v_mul_f32 v203, v203, v7
    v_mul_f32 v204, v204, v7
    v_mul_f32 v205, v205, v7
    v_mul_f32 v206, v206, v7
    v_mul_f32 v207, v207, v7
    v_mul_f32 v208, v208, v11
    v_mul_f32 v209, v209, v11
    v_mul_f32 v210, v210, v11
    v_mul_f32 v211, v211, v11
    v_mul_f32 v212, v212, v11
    v_mul_f32 v213, v213, v11
    v_mul_f32 v214, v214, v11
    v_mul_f32 v215, v215, v11
    v_mul_f32 v216, v216, v7
    v_mul_f32 v217, v217, v7
    v_mul_f32 v218, v218, v7
    v_mul_f32 v219, v219, v7
    v_mul_f32 v220, v220, v7
    v_mul_f32 v221, v221, v7
    v_mul_f32 v222, v222, v7
    v_mul_f32 v223, v223, v7
    v_mul_f32 v24, v24, v11
    v_mul_f32 v25, v25, v11
    v_mul_f32 v26, v26, v11
    v_mul_f32 v27, v27, v11
    v_mul_f32 v28, v28, v7
    v_mul_f32 v29, v29, v7
    v_mul_f32 v30, v30, v7
    v_mul_f32 v31, v31, v7
    s_branch A_rescret_211
A_fin_212:
    v_rcp_f32 v9, v24
    v_rcp_f32 v10, v28
    v_mov_b32 v24, 0
    v_mov_b32 v25, 0
    v_mov_b32 v26, 0
    v_mov_b32 v27, 0
    v_mov_b32 v28, 0
    v_mov_b32 v29, 0
    v_mov_b32 v30, 0
    v_mov_b32 v31, 0
    s_lshl_b32 s63, s60, 2
    s_add_u32 s63, s63, s58
    s_lshl_b32 s63, s63, 18
    s_lshl_b32 s96, s59, 13
    s_add_u32 s63, s63, s96
    v_mul_f32 v160, v160, v9
    v_mul_f32 v161, v161, v9
    v_mul_f32 v162, v162, v9
    v_mul_f32 v163, v163, v9
    v_mul_f32 v164, v164, v9
    v_mul_f32 v165, v165, v9
    v_mul_f32 v166, v166, v9
    v_mul_f32 v167, v167, v9
    v_mul_f32 v168, v168, v10
    v_mul_f32 v169, v169, v10
    v_mul_f32 v170, v170, v10
    v_mul_f32 v171, v171, v10
    v_mul_f32 v172, v172, v10
    v_mul_f32 v173, v173, v10
    v_mul_f32 v174, v174, v10
    v_mul_f32 v175, v175, v10
    s_add_u32 s96, s63, 0
    v_cvt_pk_bf16_f32 v160, v160, v161
    v_cvt_pk_bf16_f32 v161, v162, v163
    v_cvt_pk_bf16_f32 v162, v164, v165
    v_cvt_pk_bf16_f32 v163, v166, v167
    buffer_store_dwordx4 v[160:163], v12, s[28:31], s96 offen offset:0 sc1
    v_cvt_pk_bf16_f32 v168, v168, v169
    v_cvt_pk_bf16_f32 v169, v170, v171
    v_cvt_pk_bf16_f32 v170, v172, v173
    v_cvt_pk_bf16_f32 v171, v174, v175
    buffer_store_dwordx4 v[168:171], v12, s[28:31], s96 offen offset:256 sc1
    v_mov_b32 v164, 0
    v_mov_b32 v165, 0
    v_mov_b32 v166, 0
    v_mov_b32 v167, 0
    v_mov_b32 v172, 0
    v_mov_b32 v173, 0
    v_mov_b32 v174, 0
    v_mov_b32 v175, 0
    v_mov_b32 v160, 0
    v_mov_b32 v161, 0
    v_mov_b32 v162, 0
    v_mov_b32 v163, 0
    v_mov_b32 v168, 0
    v_mov_b32 v169, 0
    v_mov_b32 v170, 0
    v_mov_b32 v171, 0
    v_mul_f32 v176, v176, v9
    v_mul_f32 v177, v177, v9
    v_mul_f32 v178, v178, v9
    v_mul_f32 v179, v179, v9
    v_mul_f32 v180, v180, v9
    v_mul_f32 v181, v181, v9
    v_mul_f32 v182, v182, v9
    v_mul_f32 v183, v183, v9
    v_mul_f32 v184, v184, v10
    v_mul_f32 v185, v185, v10
    v_mul_f32 v186, v186, v10
    v_mul_f32 v187, v187, v10
    v_mul_f32 v188, v188, v10
    v_mul_f32 v189, v189, v10
    v_mul_f32 v190, v190, v10
    v_mul_f32 v191, v191, v10
    s_add_u32 s96, s63, 2048
    v_cvt_pk_bf16_f32 v176, v176, v177
    v_cvt_pk_bf16_f32 v177, v178, v179
    v_cvt_pk_bf16_f32 v178, v180, v181
    v_cvt_pk_bf16_f32 v179, v182, v183
    buffer_store_dwordx4 v[176:179], v12, s[28:31], s96 offen offset:0 sc1
    v_cvt_pk_bf16_f32 v184, v184, v185
    v_cvt_pk_bf16_f32 v185, v186, v187
    v_cvt_pk_bf16_f32 v186, v188, v189
    v_cvt_pk_bf16_f32 v187, v190, v191
    buffer_store_dwordx4 v[184:187], v12, s[28:31], s96 offen offset:256 sc1
    v_mov_b32 v180, 0
    v_mov_b32 v181, 0
    v_mov_b32 v182, 0
    v_mov_b32 v183, 0
    v_mov_b32 v188, 0
    v_mov_b32 v189, 0
    v_mov_b32 v190, 0
    v_mov_b32 v191, 0
    v_mov_b32 v176, 0
    v_mov_b32 v177, 0
    v_mov_b32 v178, 0
    v_mov_b32 v179, 0
    v_mov_b32 v184, 0
    v_mov_b32 v185, 0
    v_mov_b32 v186, 0
    v_mov_b32 v187, 0
    v_mul_f32 v192, v192, v9
    v_mul_f32 v193, v193, v9
    v_mul_f32 v194, v194, v9
    v_mul_f32 v195, v195, v9
    v_mul_f32 v196, v196, v9
    v_mul_f32 v197, v197, v9
    v_mul_f32 v198, v198, v9
    v_mul_f32 v199, v199, v9
    v_mul_f32 v200, v200, v10
    v_mul_f32 v201, v201, v10
    v_mul_f32 v202, v202, v10
    v_mul_f32 v203, v203, v10
    v_mul_f32 v204, v204, v10
    v_mul_f32 v205, v205, v10
    v_mul_f32 v206, v206, v10
    v_mul_f32 v207, v207, v10
    s_add_u32 s96, s63, 4096
    v_cvt_pk_bf16_f32 v192, v192, v193
    v_cvt_pk_bf16_f32 v193, v194, v195
    v_cvt_pk_bf16_f32 v194, v196, v197
    v_cvt_pk_bf16_f32 v195, v198, v199
    buffer_store_dwordx4 v[192:195], v12, s[28:31], s96 offen offset:0 sc1
    v_cvt_pk_bf16_f32 v200, v200, v201
    v_cvt_pk_bf16_f32 v201, v202, v203
    v_cvt_pk_bf16_f32 v202, v204, v205
    v_cvt_pk_bf16_f32 v203, v206, v207
    buffer_store_dwordx4 v[200:203], v12, s[28:31], s96 offen offset:256 sc1
    v_mov_b32 v196, 0
    v_mov_b32 v197, 0
    v_mov_b32 v198, 0
    v_mov_b32 v199, 0
    v_mov_b32 v204, 0
    v_mov_b32 v205, 0
    v_mov_b32 v206, 0
    v_mov_b32 v207, 0
    v_mov_b32 v192, 0
    v_mov_b32 v193, 0
    v_mov_b32 v194, 0
    v_mov_b32 v195, 0
    v_mov_b32 v200, 0
    v_mov_b32 v201, 0
    v_mov_b32 v202, 0
    v_mov_b32 v203, 0
    v_mul_f32 v208, v208, v9
    v_mul_f32 v209, v209, v9
    v_mul_f32 v210, v210, v9
    v_mul_f32 v211, v211, v9
    v_mul_f32 v212, v212, v9
    v_mul_f32 v213, v213, v9
    v_mul_f32 v214, v214, v9
    v_mul_f32 v215, v215, v9
    v_mul_f32 v216, v216, v10
    v_mul_f32 v217, v217, v10
    v_mul_f32 v218, v218, v10
    v_mul_f32 v219, v219, v10
    v_mul_f32 v220, v220, v10
    v_mul_f32 v221, v221, v10
    v_mul_f32 v222, v222, v10
    v_mul_f32 v223, v223, v10
    s_add_u32 s96, s63, 6144
    v_cvt_pk_bf16_f32 v208, v208, v209
    v_cvt_pk_bf16_f32 v209, v210, v211
    v_cvt_pk_bf16_f32 v210, v212, v213
    v_cvt_pk_bf16_f32 v211, v214, v215
    buffer_store_dwordx4 v[208:211], v12, s[28:31], s96 offen offset:0 sc1
    v_cvt_pk_bf16_f32 v216, v216, v217
    v_cvt_pk_bf16_f32 v217, v218, v219
    v_cvt_pk_bf16_f32 v218, v220, v221
    v_cvt_pk_bf16_f32 v219, v222, v223
    buffer_store_dwordx4 v[216:219], v12, s[28:31], s96 offen offset:256 sc1
    v_mov_b32 v212, 0
    v_mov_b32 v213, 0
    v_mov_b32 v214, 0
    v_mov_b32 v215, 0
    v_mov_b32 v220, 0
    v_mov_b32 v221, 0
    v_mov_b32 v222, 0
    v_mov_b32 v223, 0
    v_mov_b32 v208, 0
    v_mov_b32 v209, 0
    v_mov_b32 v210, 0
    v_mov_b32 v211, 0
    v_mov_b32 v216, 0
    v_mov_b32 v217, 0
    v_mov_b32 v218, 0
    v_mov_b32 v219, 0
    s_branch A_rescret_211
A_evb_218:
    s_add_u32 s63, s62, 1
    s_mov_b32 s100, -16
    s_sub_u32 s96, s63, s61
    s_add_u32 s96, s96, 2
    s_cmp_lt_u32 s96, 2
    s_cselect_b32 s97, s57, 0
    s_lshl_b32 s96, s96, 1
    s_sub_u32 s96, s96, s58
    s_lshl_b32 s96, s96, 1
    s_cmp_eq_u32 s97, 1
    s_cselect_b32 s100, s96, s100
    s_lshl_b32 s96, s57, 1
    s_sub_u32 s96, s96, s58
    s_lshl_b32 s96, s96, 1
    s_cmp_eq_u32 s63, 16
    s_cselect_b32 s100, s96, s100
    s_cmp_eq_u32 s63, s61
    s_cselect_b32 s101, s57, 0
    s_cmp_eq_u32 s63, 0
    s_cselect_b32 s101, 1, s101
    s_add_u32 s63, s62, 2
    s_cmp_eq_u32 s63, s61
    s_cselect_b32 s63, s57, 0
    s_cmp_eq_u32 s63, 0
    s_cbranch_scc1 A_noq_220
    ds_read_b128 v[32:35], v15 offset:0
    ds_read_b128 v[36:39], v15 offset:1024
    ds_read_b128 v[40:43], v15 offset:2048
    ds_read_b128 v[44:47], v15 offset:3072
    ds_read_b128 v[48:51], v15 offset:4096
    ds_read_b128 v[52:55], v15 offset:5120
    ds_read_b128 v[56:59], v15 offset:6144
    ds_read_b128 v[60:63], v15 offset:7168
    s_waitcnt lgkmcnt(0)
A_noq_220:
    s_lshl_b32 s63, s101, 1
    s_or_b32 s98, s98, s63
    s_cmp_ge_i32 s100, -3
    s_cbranch_scc0 A_evbret_219
    v_and_b32 v9, 15, v1
    v_lshrrev_b32 v10, 4, v1
    v_lshlrev_b32 v10, 2, v10
    s_lshl_b32 s63, s100, 4
    v_sub_u32 v9, v9, v10
    v_subrev_u32 v9, s63, v9
    v_cmp_le_i32 s[64:65], -16, v9
    v_cmp_le_i32 s[66:67], -15, v9
    v_cmp_le_i32 s[68:69], -14, v9
    v_cmp_le_i32 s[70:71], -13, v9
    v_cmp_le_i32 s[72:73], 0, v9
    v_cmp_le_i32 s[74:75], 1, v9
    v_cmp_le_i32 s[76:77], 2, v9
    v_cmp_le_i32 s[78:79], 3, v9
    v_cmp_le_i32 s[80:81], 16, v9
    v_cmp_le_i32 s[82:83], 17, v9
    v_cmp_le_i32 s[84:85], 18, v9
    v_cmp_le_i32 s[86:87], 19, v9
    v_cmp_le_i32 s[88:89], 32, v9
    v_cmp_le_i32 s[90:91], 33, v9
    v_cmp_le_i32 s[92:93], 34, v9
    v_cmp_le_i32 s[94:95], 35, v9
    v_cndmask_b32 v136, v13, v136, s[64:65]
    v_cndmask_b32 v137, v13, v137, s[66:67]
    v_cndmask_b32 v138, v13, v138, s[68:69]
    v_cndmask_b32 v139, v13, v139, s[70:71]
    v_cmp_le_i32 s[64:65], 48, v9
    v_cmp_le_i32 s[66:67], 49, v9
    v_cmp_le_i32 s[68:69], 50, v9
    v_cmp_le_i32 s[70:71], 51, v9
    v_cndmask_b32 v128, v13, v128, s[72:73]
    v_cndmask_b32 v129, v13, v129, s[74:75]
    v_cndmask_b32 v130, v13, v130, s[76:77]
    v_cndmask_b32 v131, v13, v131, s[78:79]
    v_cndmask_b32 v140, v13, v140, s[72:73]
    v_cndmask_b32 v141, v13, v141, s[74:75]
    v_cndmask_b32 v142, v13, v142, s[76:77]
    v_cndmask_b32 v143, v13, v143, s[78:79]
    v_cndmask_b32 v132, v13, v132, s[80:81]
    v_cndmask_b32 v133, v13, v133, s[82:83]
    v_cndmask_b32 v134, v13, v134, s[84:85]
    v_cndmask_b32 v135, v13, v135, s[86:87]
    v_cndmask_b32 v152, v13, v152, s[80:81]
    v_cndmask_b32 v153, v13, v153, s[82:83]
    v_cndmask_b32 v154, v13, v154, s[84:85]
    v_cndmask_b32 v155, v13, v155, s[86:87]
    v_cndmask_b32 v144, v13, v144, s[88:89]
    v_cndmask_b32 v145, v13, v145, s[90:91]
    v_cndmask_b32 v146, v13, v146, s[92:93]
    v_cndmask_b32 v147, v13, v147, s[94:95]
    v_cndmask_b32 v156, v13, v156, s[88:89]
    v_cndmask_b32 v157, v13, v157, s[90:91]
    v_cndmask_b32 v158, v13, v158, s[92:93]
    v_cndmask_b32 v159, v13, v159, s[94:95]
    v_cndmask_b32 v148, v13, v148, s[64:65]
    v_cndmask_b32 v149, v13, v149, s[66:67]
    v_cndmask_b32 v150, v13, v150, s[68:69]
    v_cndmask_b32 v151, v13, v151, s[70:71]
    s_branch A_evbret_219
A_slow_221:
    v_max3_f32 v8, v128, v129, v130
    v_max3_f32 v8, v8, v131, v132
    v_max3_f32 v8, v8, v133, v134
    v_max3_f32 v8, v8, v135, v144
    v_max3_f32 v8, v8, v145, v146
    v_max3_f32 v8, v8, v147, v148
    v_max3_f32 v8, v8, v149, v150
    v_max_f32 v8, v8, v151
    v_max3_f32 v14, v136, v137, v138
    v_max3_f32 v14, v14, v139, v140
    v_max3_f32 v14, v14, v141, v142
    v_max3_f32 v14, v14, v143, v152
    v_max3_f32 v14, v14, v153, v154
    v_max3_f32 v14, v14, v155, v156
    v_max3_f32 v14, v14, v157, v158
    v_max_f32 v14, v14, v159
    v_mov_b32 v9, v8
    v_mov_b32 v10, v14
    s_nop 1
    v_permlane16_swap_b32 v8, v9
    v_permlane16_swap_b32 v14, v10
    s_nop 1
    v_max_f32 v8, v8, v9
    v_max_f32 v14, v14, v10
    v_mov_b32 v9, v8
    v_mov_b32 v10, v14
    s_nop 1
    v_permlane32_swap_b32 v8, v9
    v_permlane32_swap_b32 v14, v10
    s_nop 1
    v_max_f32 v8, v8, v9
    v_max_f32 v14, v14, v10
    s_cmp_eq_u32 s101, 1
    s_cbranch_scc1 A_sf_223
    v_max_f32 v8, 0, v8
    v_sub_f32 v9, 0, v8
    v_exp_f32 v11, v9
    v_max_f32 v14, 0, v14
    v_sub_f32 v10, 0, v14
    v_exp_f32 v7, v10
    s_or_b32 s98, s98, 1
    s_branch A_sj_224
A_sf_223:
    v_max_f32 v8, 0xf149f2ca, v8
    v_max_f32 v14, 0xf149f2ca, v14
A_sj_224:
    v_add_f32 v5, v5, v8
    v_add_f32 v6, v6, v14
    v_sub_f32 v128, v128, v8
    v_sub_f32 v129, v129, v8
    v_sub_f32 v130, v130, v8
    v_sub_f32 v131, v131, v8
    v_sub_f32 v132, v132, v8
    v_sub_f32 v133, v133, v8
    v_sub_f32 v134, v134, v8
    v_sub_f32 v135, v135, v8
    v_sub_f32 v136, v136, v14
    v_sub_f32 v137, v137, v14
    v_sub_f32 v138, v138, v14
    v_sub_f32 v139, v139, v14
    v_sub_f32 v140, v140, v14
    v_sub_f32 v141, v141, v14
    v_sub_f32 v142, v142, v14
    v_sub_f32 v143, v143, v14
    v_sub_f32 v144, v144, v8
    v_sub_f32 v145, v145, v8
    v_sub_f32 v146, v146, v8
    v_sub_f32 v147, v147, v8
    v_sub_f32 v148, v148, v8
    v_sub_f32 v149, v149, v8
    v_sub_f32 v150, v150, v8
    v_sub_f32 v151, v151, v8
    v_sub_f32 v152, v152, v14
    v_sub_f32 v153, v153, v14
    v_sub_f32 v154, v154, v14
    v_sub_f32 v155, v155, v14
    v_sub_f32 v156, v156, v14
    v_sub_f32 v157, v157, v14
    v_sub_f32 v158, v158, v14
    v_sub_f32 v159, v159, v14
    v_sub_f32 v16, 0, v5
    v_sub_f32 v17, 0, v5
    v_sub_f32 v18, 0, v5
    v_sub_f32 v19, 0, v5
    v_sub_f32 v20, 0, v6
    v_sub_f32 v21, 0, v6
    v_sub_f32 v22, 0, v6
    v_sub_f32 v23, 0, v6
    s_branch A_slowret_222
A_resc_228:
    s_nop 15
    s_cmp_eq_u32 s98, 2
    s_mov_b32 s98, 0
    s_cbranch_scc1 A_fin_230
    v_mul_f32 v160, v160, v11
    v_mul_f32 v161, v161, v11
    v_mul_f32 v162, v162, v11
    v_mul_f32 v163, v163, v11
    v_mul_f32 v164, v164, v11
    v_mul_f32 v165, v165, v11
    v_mul_f32 v166, v166, v11
    v_mul_f32 v167, v167, v11
    v_mul_f32 v168, v168, v7
    v_mul_f32 v169, v169, v7
    v_mul_f32 v170, v170, v7
    v_mul_f32 v171, v171, v7
    v_mul_f32 v172, v172, v7
    v_mul_f32 v173, v173, v7
    v_mul_f32 v174, v174, v7
    v_mul_f32 v175, v175, v7
    v_mul_f32 v176, v176, v11
    v_mul_f32 v177, v177, v11
    v_mul_f32 v178, v178, v11
    v_mul_f32 v179, v179, v11
    v_mul_f32 v180, v180, v11
    v_mul_f32 v181, v181, v11
    v_mul_f32 v182, v182, v11
    v_mul_f32 v183, v183, v11
    v_mul_f32 v184, v184, v7
    v_mul_f32 v185, v185, v7
    v_mul_f32 v186, v186, v7
    v_mul_f32 v187, v187, v7
    v_mul_f32 v188, v188, v7
    v_mul_f32 v189, v189, v7
    v_mul_f32 v190, v190, v7
    v_mul_f32 v191, v191, v7
    v_mul_f32 v192, v192, v11
    v_mul_f32 v193, v193, v11
    v_mul_f32 v194, v194, v11
    v_mul_f32 v195, v195, v11
    v_mul_f32 v196, v196, v11
    v_mul_f32 v197, v197, v11
    v_mul_f32 v198, v198, v11
    v_mul_f32 v199, v199, v11
    v_mul_f32 v200, v200, v7
    v_mul_f32 v201, v201, v7
    v_mul_f32 v202, v202, v7
    v_mul_f32 v203, v203, v7
    v_mul_f32 v204, v204, v7
    v_mul_f32 v205, v205, v7
    v_mul_f32 v206, v206, v7
    v_mul_f32 v207, v207, v7
    v_mul_f32 v208, v208, v11
    v_mul_f32 v209, v209, v11
    v_mul_f32 v210, v210, v11
    v_mul_f32 v211, v211, v11
    v_mul_f32 v212, v212, v11
    v_mul_f32 v213, v213, v11
    v_mul_f32 v214, v214, v11
    v_mul_f32 v215, v215, v11
    v_mul_f32 v216, v216, v7
    v_mul_f32 v217, v217, v7
    v_mul_f32 v218, v218, v7
    v_mul_f32 v219, v219, v7
    v_mul_f32 v220, v220, v7
    v_mul_f32 v221, v221, v7
    v_mul_f32 v222, v222, v7
    v_mul_f32 v223, v223, v7
    v_mul_f32 v24, v24, v11
    v_mul_f32 v25, v25, v11
    v_mul_f32 v26, v26, v11
    v_mul_f32 v27, v27, v11
    v_mul_f32 v28, v28, v7
    v_mul_f32 v29, v29, v7
    v_mul_f32 v30, v30, v7
    v_mul_f32 v31, v31, v7
    s_branch A_rescret_229
A_fin_230:
    v_rcp_f32 v9, v24
    v_rcp_f32 v10, v28
    v_mov_b32 v24, 0
    v_mov_b32 v25, 0
    v_mov_b32 v26, 0
    v_mov_b32 v27, 0
    v_mov_b32 v28, 0
    v_mov_b32 v29, 0
    v_mov_b32 v30, 0
    v_mov_b32 v31, 0
    s_lshl_b32 s63, s60, 2
    s_add_u32 s63, s63, s58
    s_lshl_b32 s63, s63, 18
    s_lshl_b32 s96, s59, 13
    s_add_u32 s63, s63, s96
    v_mul_f32 v160, v160, v9
    v_mul_f32 v161, v161, v9
    v_mul_f32 v162, v162, v9
    v_mul_f32 v163, v163, v9
    v_mul_f32 v164, v164, v9
    v_mul_f32 v165, v165, v9
    v_mul_f32 v166, v166, v9
    v_mul_f32 v167, v167, v9
    v_mul_f32 v168, v168, v10
    v_mul_f32 v169, v169, v10
    v_mul_f32 v170, v170, v10
    v_mul_f32 v171, v171, v10
    v_mul_f32 v172, v172, v10
    v_mul_f32 v173, v173, v10
    v_mul_f32 v174, v174, v10
    v_mul_f32 v175, v175, v10
    s_add_u32 s96, s63, 0
    v_cvt_pk_bf16_f32 v160, v160, v161
    v_cvt_pk_bf16_f32 v161, v162, v163
    v_cvt_pk_bf16_f32 v162, v164, v165
    v_cvt_pk_bf16_f32 v163, v166, v167
    buffer_store_dwordx4 v[160:163], v12, s[28:31], s96 offen offset:0 sc1
    v_cvt_pk_bf16_f32 v168, v168, v169
    v_cvt_pk_bf16_f32 v169, v170, v171
    v_cvt_pk_bf16_f32 v170, v172, v173
    v_cvt_pk_bf16_f32 v171, v174, v175
    buffer_store_dwordx4 v[168:171], v12, s[28:31], s96 offen offset:256 sc1
    v_mov_b32 v164, 0
    v_mov_b32 v165, 0
    v_mov_b32 v166, 0
    v_mov_b32 v167, 0
    v_mov_b32 v172, 0
    v_mov_b32 v173, 0
    v_mov_b32 v174, 0
    v_mov_b32 v175, 0
    v_mov_b32 v160, 0
    v_mov_b32 v161, 0
    v_mov_b32 v162, 0
    v_mov_b32 v163, 0
    v_mov_b32 v168, 0
    v_mov_b32 v169, 0
    v_mov_b32 v170, 0
    v_mov_b32 v171, 0
    v_mul_f32 v176, v176, v9
    v_mul_f32 v177, v177, v9
    v_mul_f32 v178, v178, v9
    v_mul_f32 v179, v179, v9
    v_mul_f32 v180, v180, v9
    v_mul_f32 v181, v181, v9
    v_mul_f32 v182, v182, v9
    v_mul_f32 v183, v183, v9
    v_mul_f32 v184, v184, v10
    v_mul_f32 v185, v185, v10
    v_mul_f32 v186, v186, v10
    v_mul_f32 v187, v187, v10
    v_mul_f32 v188, v188, v10
    v_mul_f32 v189, v189, v10
    v_mul_f32 v190, v190, v10
    v_mul_f32 v191, v191, v10
    s_add_u32 s96, s63, 2048
    v_cvt_pk_bf16_f32 v176, v176, v177
    v_cvt_pk_bf16_f32 v177, v178, v179
    v_cvt_pk_bf16_f32 v178, v180, v181
    v_cvt_pk_bf16_f32 v179, v182, v183
    buffer_store_dwordx4 v[176:179], v12, s[28:31], s96 offen offset:0 sc1
    v_cvt_pk_bf16_f32 v184, v184, v185
    v_cvt_pk_bf16_f32 v185, v186, v187
    v_cvt_pk_bf16_f32 v186, v188, v189
    v_cvt_pk_bf16_f32 v187, v190, v191
    buffer_store_dwordx4 v[184:187], v12, s[28:31], s96 offen offset:256 sc1
    v_mov_b32 v180, 0
    v_mov_b32 v181, 0
    v_mov_b32 v182, 0
    v_mov_b32 v183, 0
    v_mov_b32 v188, 0
    v_mov_b32 v189, 0
    v_mov_b32 v190, 0
    v_mov_b32 v191, 0
    v_mov_b32 v176, 0
    v_mov_b32 v177, 0
    v_mov_b32 v178, 0
    v_mov_b32 v179, 0
    v_mov_b32 v184, 0
    v_mov_b32 v185, 0
    v_mov_b32 v186, 0
    v_mov_b32 v187, 0
    v_mul_f32 v192, v192, v9
    v_mul_f32 v193, v193, v9
    v_mul_f32 v194, v194, v9
    v_mul_f32 v195, v195, v9
    v_mul_f32 v196, v196, v9
    v_mul_f32 v197, v197, v9
    v_mul_f32 v198, v198, v9
    v_mul_f32 v199, v199, v9
    v_mul_f32 v200, v200, v10
    v_mul_f32 v201, v201, v10
    v_mul_f32 v202, v202, v10
    v_mul_f32 v203, v203, v10
    v_mul_f32 v204, v204, v10
    v_mul_f32 v205, v205, v10
    v_mul_f32 v206, v206, v10
    v_mul_f32 v207, v207, v10
    s_add_u32 s96, s63, 4096
    v_cvt_pk_bf16_f32 v192, v192, v193
    v_cvt_pk_bf16_f32 v193, v194, v195
    v_cvt_pk_bf16_f32 v194, v196, v197
    v_cvt_pk_bf16_f32 v195, v198, v199
    buffer_store_dwordx4 v[192:195], v12, s[28:31], s96 offen offset:0 sc1
    v_cvt_pk_bf16_f32 v200, v200, v201
    v_cvt_pk_bf16_f32 v201, v202, v203
    v_cvt_pk_bf16_f32 v202, v204, v205
    v_cvt_pk_bf16_f32 v203, v206, v207
    buffer_store_dwordx4 v[200:203], v12, s[28:31], s96 offen offset:256 sc1
    v_mov_b32 v196, 0
    v_mov_b32 v197, 0
    v_mov_b32 v198, 0
    v_mov_b32 v199, 0
    v_mov_b32 v204, 0
    v_mov_b32 v205, 0
    v_mov_b32 v206, 0
    v_mov_b32 v207, 0
    v_mov_b32 v192, 0
    v_mov_b32 v193, 0
    v_mov_b32 v194, 0
    v_mov_b32 v195, 0
    v_mov_b32 v200, 0
    v_mov_b32 v201, 0
    v_mov_b32 v202, 0
    v_mov_b32 v203, 0
    v_mul_f32 v208, v208, v9
    v_mul_f32 v209, v209, v9
    v_mul_f32 v210, v210, v9
    v_mul_f32 v211, v211, v9
    v_mul_f32 v212, v212, v9
    v_mul_f32 v213, v213, v9
    v_mul_f32 v214, v214, v9
    v_mul_f32 v215, v215, v9
    v_mul_f32 v216, v216, v10
    v_mul_f32 v217, v217, v10
    v_mul_f32 v218, v218, v10
    v_mul_f32 v219, v219, v10
    v_mul_f32 v220, v220, v10
    v_mul_f32 v221, v221, v10
    v_mul_f32 v222, v222, v10
    v_mul_f32 v223, v223, v10
    s_add_u32 s96, s63, 6144
    v_cvt_pk_bf16_f32 v208, v208, v209
    v_cvt_pk_bf16_f32 v209, v210, v211
    v_cvt_pk_bf16_f32 v210, v212, v213
    v_cvt_pk_bf16_f32 v211, v214, v215
    buffer_store_dwordx4 v[208:211], v12, s[28:31], s96 offen offset:0 sc1
    v_cvt_pk_bf16_f32 v216, v216, v217
    v_cvt_pk_bf16_f32 v217, v218, v219
    v_cvt_pk_bf16_f32 v218, v220, v221
    v_cvt_pk_bf16_f32 v219, v222, v223
    buffer_store_dwordx4 v[216:219], v12, s[28:31], s96 offen offset:256 sc1
    v_mov_b32 v212, 0
    v_mov_b32 v213, 0
    v_mov_b32 v214, 0
    v_mov_b32 v215, 0
    v_mov_b32 v220, 0
    v_mov_b32 v221, 0
    v_mov_b32 v222, 0
    v_mov_b32 v223, 0
    v_mov_b32 v208, 0
    v_mov_b32 v209, 0
    v_mov_b32 v210, 0
    v_mov_b32 v211, 0
    v_mov_b32 v216, 0
    v_mov_b32 v217, 0
    v_mov_b32 v218, 0
    v_mov_b32 v219, 0
    s_branch A_rescret_229
A_evb_236:
    s_add_u32 s63, s62, 1
    s_mov_b32 s100, -16
    s_sub_u32 s96, s63, s61
    s_add_u32 s96, s96, 2
    s_cmp_lt_u32 s96, 2
    s_cselect_b32 s97, s57, 0
    s_lshl_b32 s96, s96, 1
    s_sub_u32 s96, s96, s58
    s_lshl_b32 s96, s96, 1
    s_cmp_eq_u32 s97, 1
    s_cselect_b32 s100, s96, s100
    s_lshl_b32 s96, s57, 1
    s_sub_u32 s96, s96, s58
    s_lshl_b32 s96, s96, 1
    s_cmp_eq_u32 s63, 16
    s_cselect_b32 s100, s96, s100
    s_cmp_eq_u32 s63, s61
    s_cselect_b32 s101, s57, 0
    s_cmp_eq_u32 s63, 0
    s_cselect_b32 s101, 1, s101
    s_add_u32 s63, s62, 2
    s_cmp_eq_u32 s63, s61
    s_cselect_b32 s63, s57, 0
    s_cmp_eq_u32 s63, 0
    s_cbranch_scc1 A_noq_238
    ds_read_b128 v[32:35], v15 offset:0
    ds_read_b128 v[36:39], v15 offset:1024
    ds_read_b128 v[40:43], v15 offset:2048
    ds_read_b128 v[44:47], v15 offset:3072
    ds_read_b128 v[48:51], v15 offset:4096
    ds_read_b128 v[52:55], v15 offset:5120
    ds_read_b128 v[56:59], v15 offset:6144
    ds_read_b128 v[60:63], v15 offset:7168
    s_waitcnt lgkmcnt(0)
A_noq_238:
    s_lshl_b32 s63, s101, 1
    s_or_b32 s98, s98, s63
    s_cmp_ge_i32 s100, -3
    s_cbranch_scc0 A_evbret_237
    v_and_b32 v9, 15, v1
    v_lshrrev_b32 v10, 4, v1
    v_lshlrev_b32 v10, 2, v10
    s_lshl_b32 s63, s100, 4
    v_sub_u32 v9, v9, v10
    v_subrev_u32 v9, s63, v9
    v_cmp_le_i32 s[64:65], -16, v9
    v_cmp_le_i32 s[66:67], -15, v9
    v_cmp_le_i32 s[68:69], -14, v9
    v_cmp_le_i32 s[70:71], -13, v9
    v_cmp_le_i32 s[72:73], 0, v9
    v_cmp_le_i32 s[74:75], 1, v9
    v_cmp_le_i32 s[76:77], 2, v9
    v_cmp_le_i32 s[78:79], 3, v9
    v_cmp_le_i32 s[80:81], 16, v9
    v_cmp_le_i32 s[82:83], 17, v9
    v_cmp_le_i32 s[84:85], 18, v9
    v_cmp_le_i32 s[86:87], 19, v9
    v_cmp_le_i32 s[88:89], 32, v9
    v_cmp_le_i32 s[90:91], 33, v9
    v_cmp_le_i32 s[92:93], 34, v9
    v_cmp_le_i32 s[94:95], 35, v9
    v_cndmask_b32 v104, v13, v104, s[64:65]
    v_cndmask_b32 v105, v13, v105, s[66:67]
    v_cndmask_b32 v106, v13, v106, s[68:69]
    v_cndmask_b32 v107, v13, v107, s[70:71]
    v_cmp_le_i32 s[64:65], 48, v9
    v_cmp_le_i32 s[66:67], 49, v9
    v_cmp_le_i32 s[68:69], 50, v9
    v_cmp_le_i32 s[70:71], 51, v9
    v_cndmask_b32 v96, v13, v96, s[72:73]
    v_cndmask_b32 v97, v13, v97, s[74:75]
    v_cndmask_b32 v98, v13, v98, s[76:77]
    v_cndmask_b32 v99, v13, v99, s[78:79]
    v_cndmask_b32 v108, v13, v108, s[72:73]
    v_cndmask_b32 v109, v13, v109, s[74:75]
    v_cndmask_b32 v110, v13, v110, s[76:77]
    v_cndmask_b32 v111, v13, v111, s[78:79]
    v_cndmask_b32 v100, v13, v100, s[80:81]
    v_cndmask_b32 v101, v13, v101, s[82:83]
    v_cndmask_b32 v102, v13, v102, s[84:85]
    v_cndmask_b32 v103, v13, v103, s[86:87]
    v_cndmask_b32 v120, v13, v120, s[80:81]
    v_cndmask_b32 v121, v13, v121, s[82:83]
    v_cndmask_b32 v122, v13, v122, s[84:85]
    v_cndmask_b32 v123, v13, v123, s[86:87]
    v_cndmask_b32 v112, v13, v112, s[88:89]
    v_cndmask_b32 v113, v13, v113, s[90:91]
    v_cndmask_b32 v114, v13, v114, s[92:93]
    v_cndmask_b32 v115, v13, v115, s[94:95]
    v_cndmask_b32 v124, v13, v124, s[88:89]
    v_cndmask_b32 v125, v13, v125, s[90:91]
    v_cndmask_b32 v126, v13, v126, s[92:93]
    v_cndmask_b32 v127, v13, v127, s[94:95]
    v_cndmask_b32 v116, v13, v116, s[64:65]
    v_cndmask_b32 v117, v13, v117, s[66:67]
    v_cndmask_b32 v118, v13, v118, s[68:69]
    v_cndmask_b32 v119, v13, v119, s[70:71]
    s_branch A_evbret_237
A_slow_239:
    v_max3_f32 v8, v96, v97, v98
    v_max3_f32 v8, v8, v99, v100
    v_max3_f32 v8, v8, v101, v102
    v_max3_f32 v8, v8, v103, v112
    v_max3_f32 v8, v8, v113, v114
    v_max3_f32 v8, v8, v115, v116
    v_max3_f32 v8, v8, v117, v118
    v_max_f32 v8, v8, v119
    v_max3_f32 v14, v104, v105, v106
    v_max3_f32 v14, v14, v107, v108
    v_max3_f32 v14, v14, v109, v110
    v_max3_f32 v14, v14, v111, v120
    v_max3_f32 v14, v14, v121, v122
    v_max3_f32 v14, v14, v123, v124
    v_max3_f32 v14, v14, v125, v126
    v_max_f32 v14, v14, v127
    v_mov_b32 v9, v8
    v_mov_b32 v10, v14
    s_nop 1
    v_permlane16_swap_b32 v8, v9
    v_permlane16_swap_b32 v14, v10
    s_nop 1
    v_max_f32 v8, v8, v9
    v_max_f32 v14, v14, v10
    v_mov_b32 v9, v8
    v_mov_b32 v10, v14
    s_nop 1
    v_permlane32_swap_b32 v8, v9
    v_permlane32_swap_b32 v14, v10
    s_nop 1
    v_max_f32 v8, v8, v9
    v_max_f32 v14, v14, v10
    s_cmp_eq_u32 s101, 1
    s_cbranch_scc1 A_sf_241
    v_max_f32 v8, 0, v8
    v_sub_f32 v9, 0, v8
    v_exp_f32 v11, v9
    v_max_f32 v14, 0, v14
    v_sub_f32 v10, 0, v14
    v_exp_f32 v7, v10
    s_or_b32 s98, s98, 1
    s_branch A_sj_242
A_sf_241:
    v_max_f32 v8, 0xf149f2ca, v8
    v_max_f32 v14, 0xf149f2ca, v14
A_sj_242:
    v_add_f32 v5, v5, v8
    v_add_f32 v6, v6, v14
    v_sub_f32 v96, v96, v8
    v_sub_f32 v97, v97, v8
    v_sub_f32 v98, v98, v8
    v_sub_f32 v99, v99, v8
    v_sub_f32 v100, v100, v8
    v_sub_f32 v101, v101, v8
    v_sub_f32 v102, v102, v8
    v_sub_f32 v103, v103, v8
    v_sub_f32 v104, v104, v14
    v_sub_f32 v105, v105, v14
    v_sub_f32 v106, v106, v14
    v_sub_f32 v107, v107, v14
    v_sub_f32 v108, v108, v14
    v_sub_f32 v109, v109, v14
    v_sub_f32 v110, v110, v14
    v_sub_f32 v111, v111, v14
    v_sub_f32 v112, v112, v8
    v_sub_f32 v113, v113, v8
    v_sub_f32 v114, v114, v8
    v_sub_f32 v115, v115, v8
    v_sub_f32 v116, v116, v8
    v_sub_f32 v117, v117, v8
    v_sub_f32 v118, v118, v8
    v_sub_f32 v119, v119, v8
    v_sub_f32 v120, v120, v14
    v_sub_f32 v121, v121, v14
    v_sub_f32 v122, v122, v14
    v_sub_f32 v123, v123, v14
    v_sub_f32 v124, v124, v14
    v_sub_f32 v125, v125, v14
    v_sub_f32 v126, v126, v14
    v_sub_f32 v127, v127, v14
    v_sub_f32 v16, 0, v5
    v_sub_f32 v17, 0, v5
    v_sub_f32 v18, 0, v5
    v_sub_f32 v19, 0, v5
    v_sub_f32 v20, 0, v6
    v_sub_f32 v21, 0, v6
    v_sub_f32 v22, 0, v6
    v_sub_f32 v23, 0, v6
    s_branch A_slowret_240
A_resc_246:
    s_nop 15
    s_cmp_eq_u32 s98, 2
    s_mov_b32 s98, 0
    s_cbranch_scc1 A_fin_248
    v_mul_f32 v160, v160, v11
    v_mul_f32 v161, v161, v11
    v_mul_f32 v162, v162, v11
    v_mul_f32 v163, v163, v11
    v_mul_f32 v164, v164, v11
    v_mul_f32 v165, v165, v11
    v_mul_f32 v166, v166, v11
    v_mul_f32 v167, v167, v11
    v_mul_f32 v168, v168, v7
    v_mul_f32 v169, v169, v7
    v_mul_f32 v170, v170, v7
    v_mul_f32 v171, v171, v7
    v_mul_f32 v172, v172, v7
    v_mul_f32 v173, v173, v7
    v_mul_f32 v174, v174, v7
    v_mul_f32 v175, v175, v7
    v_mul_f32 v176, v176, v11
    v_mul_f32 v177, v177, v11
    v_mul_f32 v178, v178, v11
    v_mul_f32 v179, v179, v11
    v_mul_f32 v180, v180, v11
    v_mul_f32 v181, v181, v11
    v_mul_f32 v182, v182, v11
    v_mul_f32 v183, v183, v11
    v_mul_f32 v184, v184, v7
    v_mul_f32 v185, v185, v7
    v_mul_f32 v186, v186, v7
    v_mul_f32 v187, v187, v7
    v_mul_f32 v188, v188, v7
    v_mul_f32 v189, v189, v7
    v_mul_f32 v190, v190, v7
    v_mul_f32 v191, v191, v7
    v_mul_f32 v192, v192, v11
    v_mul_f32 v193, v193, v11
    v_mul_f32 v194, v194, v11
    v_mul_f32 v195, v195, v11
    v_mul_f32 v196, v196, v11
    v_mul_f32 v197, v197, v11
    v_mul_f32 v198, v198, v11
    v_mul_f32 v199, v199, v11
    v_mul_f32 v200, v200, v7
    v_mul_f32 v201, v201, v7
    v_mul_f32 v202, v202, v7
    v_mul_f32 v203, v203, v7
    v_mul_f32 v204, v204, v7
    v_mul_f32 v205, v205, v7
    v_mul_f32 v206, v206, v7
    v_mul_f32 v207, v207, v7
    v_mul_f32 v208, v208, v11
    v_mul_f32 v209, v209, v11
    v_mul_f32 v210, v210, v11
    v_mul_f32 v211, v211, v11
    v_mul_f32 v212, v212, v11
    v_mul_f32 v213, v213, v11
    v_mul_f32 v214, v214, v11
    v_mul_f32 v215, v215, v11
    v_mul_f32 v216, v216, v7
    v_mul_f32 v217, v217, v7
    v_mul_f32 v218, v218, v7
    v_mul_f32 v219, v219, v7
    v_mul_f32 v220, v220, v7
    v_mul_f32 v221, v221, v7
    v_mul_f32 v222, v222, v7
    v_mul_f32 v223, v223, v7
    v_mul_f32 v24, v24, v11
    v_mul_f32 v25, v25, v11
    v_mul_f32 v26, v26, v11
    v_mul_f32 v27, v27, v11
    v_mul_f32 v28, v28, v7
    v_mul_f32 v29, v29, v7
    v_mul_f32 v30, v30, v7
    v_mul_f32 v31, v31, v7
    s_branch A_rescret_247
A_fin_248:
    v_rcp_f32 v9, v24
    v_rcp_f32 v10, v28
    v_mov_b32 v24, 0
    v_mov_b32 v25, 0
    v_mov_b32 v26, 0
    v_mov_b32 v27, 0
    v_mov_b32 v28, 0
    v_mov_b32 v29, 0
    v_mov_b32 v30, 0
    v_mov_b32 v31, 0
    s_lshl_b32 s63, s60, 2
    s_add_u32 s63, s63, s58
    s_lshl_b32 s63, s63, 18
    s_lshl_b32 s96, s59, 13
    s_add_u32 s63, s63, s96
    v_mul_f32 v160, v160, v9
    v_mul_f32 v161, v161, v9
    v_mul_f32 v162, v162, v9
    v_mul_f32 v163, v163, v9
    v_mul_f32 v164, v164, v9
    v_mul_f32 v165, v165, v9
    v_mul_f32 v166, v166, v9
    v_mul_f32 v167, v167, v9
    v_mul_f32 v168, v168, v10
    v_mul_f32 v169, v169, v10
    v_mul_f32 v170, v170, v10
    v_mul_f32 v171, v171, v10
    v_mul_f32 v172, v172, v10
    v_mul_f32 v173, v173, v10
    v_mul_f32 v174, v174, v10
    v_mul_f32 v175, v175, v10
    s_add_u32 s96, s63, 0
    v_cvt_pk_bf16_f32 v160, v160, v161
    v_cvt_pk_bf16_f32 v161, v162, v163
    v_cvt_pk_bf16_f32 v162, v164, v165
    v_cvt_pk_bf16_f32 v163, v166, v167
    buffer_store_dwordx4 v[160:163], v12, s[28:31], s96 offen offset:0 sc1
    v_cvt_pk_bf16_f32 v168, v168, v169
    v_cvt_pk_bf16_f32 v169, v170, v171
    v_cvt_pk_bf16_f32 v170, v172, v173
    v_cvt_pk_bf16_f32 v171, v174, v175
    buffer_store_dwordx4 v[168:171], v12, s[28:31], s96 offen offset:256 sc1
    v_mov_b32 v164, 0
    v_mov_b32 v165, 0
    v_mov_b32 v166, 0
    v_mov_b32 v167, 0
    v_mov_b32 v172, 0
    v_mov_b32 v173, 0
    v_mov_b32 v174, 0
    v_mov_b32 v175, 0
    v_mov_b32 v160, 0
    v_mov_b32 v161, 0
    v_mov_b32 v162, 0
    v_mov_b32 v163, 0
    v_mov_b32 v168, 0
    v_mov_b32 v169, 0
    v_mov_b32 v170, 0
    v_mov_b32 v171, 0
    v_mul_f32 v176, v176, v9
    v_mul_f32 v177, v177, v9
    v_mul_f32 v178, v178, v9
    v_mul_f32 v179, v179, v9
    v_mul_f32 v180, v180, v9
    v_mul_f32 v181, v181, v9
    v_mul_f32 v182, v182, v9
    v_mul_f32 v183, v183, v9
    v_mul_f32 v184, v184, v10
    v_mul_f32 v185, v185, v10
    v_mul_f32 v186, v186, v10
    v_mul_f32 v187, v187, v10
    v_mul_f32 v188, v188, v10
    v_mul_f32 v189, v189, v10
    v_mul_f32 v190, v190, v10
    v_mul_f32 v191, v191, v10
    s_add_u32 s96, s63, 2048
    v_cvt_pk_bf16_f32 v176, v176, v177
    v_cvt_pk_bf16_f32 v177, v178, v179
    v_cvt_pk_bf16_f32 v178, v180, v181
    v_cvt_pk_bf16_f32 v179, v182, v183
    buffer_store_dwordx4 v[176:179], v12, s[28:31], s96 offen offset:0 sc1
    v_cvt_pk_bf16_f32 v184, v184, v185
    v_cvt_pk_bf16_f32 v185, v186, v187
    v_cvt_pk_bf16_f32 v186, v188, v189
    v_cvt_pk_bf16_f32 v187, v190, v191
    buffer_store_dwordx4 v[184:187], v12, s[28:31], s96 offen offset:256 sc1
    v_mov_b32 v180, 0
    v_mov_b32 v181, 0
    v_mov_b32 v182, 0
    v_mov_b32 v183, 0
    v_mov_b32 v188, 0
    v_mov_b32 v189, 0
    v_mov_b32 v190, 0
    v_mov_b32 v191, 0
    v_mov_b32 v176, 0
    v_mov_b32 v177, 0
    v_mov_b32 v178, 0
    v_mov_b32 v179, 0
    v_mov_b32 v184, 0
    v_mov_b32 v185, 0
    v_mov_b32 v186, 0
    v_mov_b32 v187, 0
    v_mul_f32 v192, v192, v9
    v_mul_f32 v193, v193, v9
    v_mul_f32 v194, v194, v9
    v_mul_f32 v195, v195, v9
    v_mul_f32 v196, v196, v9
    v_mul_f32 v197, v197, v9
    v_mul_f32 v198, v198, v9
    v_mul_f32 v199, v199, v9
    v_mul_f32 v200, v200, v10
    v_mul_f32 v201, v201, v10
    v_mul_f32 v202, v202, v10
    v_mul_f32 v203, v203, v10
    v_mul_f32 v204, v204, v10
    v_mul_f32 v205, v205, v10
    v_mul_f32 v206, v206, v10
    v_mul_f32 v207, v207, v10
    s_add_u32 s96, s63, 4096
    v_cvt_pk_bf16_f32 v192, v192, v193
    v_cvt_pk_bf16_f32 v193, v194, v195
    v_cvt_pk_bf16_f32 v194, v196, v197
    v_cvt_pk_bf16_f32 v195, v198, v199
    buffer_store_dwordx4 v[192:195], v12, s[28:31], s96 offen offset:0 sc1
    v_cvt_pk_bf16_f32 v200, v200, v201
    v_cvt_pk_bf16_f32 v201, v202, v203
    v_cvt_pk_bf16_f32 v202, v204, v205
    v_cvt_pk_bf16_f32 v203, v206, v207
    buffer_store_dwordx4 v[200:203], v12, s[28:31], s96 offen offset:256 sc1
    v_mov_b32 v196, 0
    v_mov_b32 v197, 0
    v_mov_b32 v198, 0
    v_mov_b32 v199, 0
    v_mov_b32 v204, 0
    v_mov_b32 v205, 0
    v_mov_b32 v206, 0
    v_mov_b32 v207, 0
    v_mov_b32 v192, 0
    v_mov_b32 v193, 0
    v_mov_b32 v194, 0
    v_mov_b32 v195, 0
    v_mov_b32 v200, 0
    v_mov_b32 v201, 0
    v_mov_b32 v202, 0
    v_mov_b32 v203, 0
    v_mul_f32 v208, v208, v9
    v_mul_f32 v209, v209, v9
    v_mul_f32 v210, v210, v9
    v_mul_f32 v211, v211, v9
    v_mul_f32 v212, v212, v9
    v_mul_f32 v213, v213, v9
    v_mul_f32 v214, v214, v9
    v_mul_f32 v215, v215, v9
    v_mul_f32 v216, v216, v10
    v_mul_f32 v217, v217, v10
    v_mul_f32 v218, v218, v10
    v_mul_f32 v219, v219, v10
    v_mul_f32 v220, v220, v10
    v_mul_f32 v221, v221, v10
    v_mul_f32 v222, v222, v10
    v_mul_f32 v223, v223, v10
    s_add_u32 s96, s63, 6144
    v_cvt_pk_bf16_f32 v208, v208, v209
    v_cvt_pk_bf16_f32 v209, v210, v211
    v_cvt_pk_bf16_f32 v210, v212, v213
    v_cvt_pk_bf16_f32 v211, v214, v215
    buffer_store_dwordx4 v[208:211], v12, s[28:31], s96 offen offset:0 sc1
    v_cvt_pk_bf16_f32 v216, v216, v217
    v_cvt_pk_bf16_f32 v217, v218, v219
    v_cvt_pk_bf16_f32 v218, v220, v221
    v_cvt_pk_bf16_f32 v219, v222, v223
    buffer_store_dwordx4 v[216:219], v12, s[28:31], s96 offen offset:256 sc1
    v_mov_b32 v212, 0
    v_mov_b32 v213, 0
    v_mov_b32 v214, 0
    v_mov_b32 v215, 0
    v_mov_b32 v220, 0
    v_mov_b32 v221, 0
    v_mov_b32 v222, 0
    v_mov_b32 v223, 0
    v_mov_b32 v208, 0
    v_mov_b32 v209, 0
    v_mov_b32 v210, 0
    v_mov_b32 v211, 0
    v_mov_b32 v216, 0
    v_mov_b32 v217, 0
    v_mov_b32 v218, 0
    v_mov_b32 v219, 0
    s_branch A_rescret_247
A_evb_254:
    s_add_u32 s63, s62, 1
    s_mov_b32 s100, -16
    s_sub_u32 s96, s63, s61
    s_add_u32 s96, s96, 2
    s_cmp_lt_u32 s96, 2
    s_cselect_b32 s97, s57, 0
    s_lshl_b32 s96, s96, 1
    s_sub_u32 s96, s96, s58
    s_lshl_b32 s96, s96, 1
    s_cmp_eq_u32 s97, 1
    s_cselect_b32 s100, s96, s100
    s_lshl_b32 s96, s57, 1
    s_sub_u32 s96, s96, s58
    s_lshl_b32 s96, s96, 1
    s_cmp_eq_u32 s63, 16
    s_cselect_b32 s100, s96, s100
    s_cmp_eq_u32 s63, s61
    s_cselect_b32 s101, s57, 0
    s_cmp_eq_u32 s63, 0
    s_cselect_b32 s101, 1, s101
    s_add_u32 s63, s62, 2
    s_cmp_eq_u32 s63, s61
    s_cselect_b32 s63, s57, 0
    s_cmp_eq_u32 s63, 0
    s_cbranch_scc1 A_noq_256
    ds_read_b128 v[32:35], v15 offset:0
    ds_read_b128 v[36:39], v15 offset:1024
    ds_read_b128 v[40:43], v15 offset:2048
    ds_read_b128 v[44:47], v15 offset:3072
    ds_read_b128 v[48:51], v15 offset:4096
    ds_read_b128 v[52:55], v15 offset:5120
    ds_read_b128 v[56:59], v15 offset:6144
    ds_read_b128 v[60:63], v15 offset:7168
    s_waitcnt lgkmcnt(0)
A_noq_256:
    s_lshl_b32 s63, s101, 1
    s_or_b32 s98, s98, s63
    s_cmp_ge_i32 s100, -3
    s_cbranch_scc0 A_evbret_255
    v_and_b32 v9, 15, v1
    v_lshrrev_b32 v10, 4, v1
    v_lshlrev_b32 v10, 2, v10
    s_lshl_b32 s63, s100, 4
    v_sub_u32 v9, v9, v10
    v_subrev_u32 v9, s63, v9
    v_cmp_le_i32 s[64:65], -16, v9
    v_cmp_le_i32 s[66:67], -15, v9
    v_cmp_le_i32 s[68:69], -14, v9
    v_cmp_le_i32 s[70:71], -13, v9
    v_cmp_le_i32 s[72:73], 0, v9
    v_cmp_le_i32 s[74:75], 1, v9
    v_cmp_le_i32 s[76:77], 2, v9
    v_cmp_le_i32 s[78:79], 3, v9
    v_cmp_le_i32 s[80:81], 16, v9
    v_cmp_le_i32 s[82:83], 17, v9
    v_cmp_le_i32 s[84:85], 18, v9
    v_cmp_le_i32 s[86:87], 19, v9
    v_cmp_le_i32 s[88:89], 32, v9
    v_cmp_le_i32 s[90:91], 33, v9
    v_cmp_le_i32 s[92:93], 34, v9
    v_cmp_le_i32 s[94:95], 35, v9
    v_cndmask_b32 v136, v13, v136, s[64:65]
    v_cndmask_b32 v137, v13, v137, s[66:67]
    v_cndmask_b32 v138, v13, v138, s[68:69]
    v_cndmask_b32 v139, v13, v139, s[70:71]
    v_cmp_le_i32 s[64:65], 48, v9
    v_cmp_le_i32 s[66:67], 49, v9
    v_cmp_le_i32 s[68:69], 50, v9
    v_cmp_le_i32 s[70:71], 51, v9
    v_cndmask_b32 v128, v13, v128, s[72:73]
    v_cndmask_b32 v129, v13, v129, s[74:75]
    v_cndmask_b32 v130, v13, v130, s[76:77]
    v_cndmask_b32 v131, v13, v131, s[78:79]
    v_cndmask_b32 v140, v13, v140, s[72:73]
    v_cndmask_b32 v141, v13, v141, s[74:75]
    v_cndmask_b32 v142, v13, v142, s[76:77]
    v_cndmask_b32 v143, v13, v143, s[78:79]
    v_cndmask_b32 v132, v13, v132, s[80:81]
    v_cndmask_b32 v133, v13, v133, s[82:83]
    v_cndmask_b32 v134, v13, v134, s[84:85]
    v_cndmask_b32 v135, v13, v135, s[86:87]
    v_cndmask_b32 v152, v13, v152, s[80:81]
    v_cndmask_b32 v153, v13, v153, s[82:83]
    v_cndmask_b32 v154, v13, v154, s[84:85]
    v_cndmask_b32 v155, v13, v155, s[86:87]
    v_cndmask_b32 v144, v13, v144, s[88:89]
    v_cndmask_b32 v145, v13, v145, s[90:91]
    v_cndmask_b32 v146, v13, v146, s[92:93]
    v_cndmask_b32 v147, v13, v147, s[94:95]
    v_cndmask_b32 v156, v13, v156, s[88:89]
    v_cndmask_b32 v157, v13, v157, s[90:91]
    v_cndmask_b32 v158, v13, v158, s[92:93]
    v_cndmask_b32 v159, v13, v159, s[94:95]
    v_cndmask_b32 v148, v13, v148, s[64:65]
    v_cndmask_b32 v149, v13, v149, s[66:67]
    v_cndmask_b32 v150, v13, v150, s[68:69]
    v_cndmask_b32 v151, v13, v151, s[70:71]
    s_branch A_evbret_255
A_slow_257:
    v_max3_f32 v8, v128, v129, v130
    v_max3_f32 v8, v8, v131, v132
    v_max3_f32 v8, v8, v133, v134
    v_max3_f32 v8, v8, v135, v144
    v_max3_f32 v8, v8, v145, v146
    v_max3_f32 v8, v8, v147, v148
    v_max3_f32 v8, v8, v149, v150
    v_max_f32 v8, v8, v151
    v_max3_f32 v14, v136, v137, v138
    v_max3_f32 v14, v14, v139, v140
    v_max3_f32 v14, v14, v141, v142
    v_max3_f32 v14, v14, v143, v152
    v_max3_f32 v14, v14, v153, v154
    v_max3_f32 v14, v14, v155, v156
    v_max3_f32 v14, v14, v157, v158
    v_max_f32 v14, v14, v159
    v_mov_b32 v9, v8
    v_mov_b32 v10, v14
    s_nop 1
    v_permlane16_swap_b32 v8, v9
    v_permlane16_swap_b32 v14, v10
    s_nop 1
    v_max_f32 v8, v8, v9
    v_max_f32 v14, v14, v10
    v_mov_b32 v9, v8
    v_mov_b32 v10, v14
    s_nop 1
    v_permlane32_swap_b32 v8, v9
    v_permlane32_swap_b32 v14, v10
    s_nop 1
    v_max_f32 v8, v8, v9
    v_max_f32 v14, v14, v10
    s_cmp_eq_u32 s101, 1
    s_cbranch_scc1 A_sf_259
    v_max_f32 v8, 0, v8
    v_sub_f32 v9, 0, v8
    v_exp_f32 v11, v9
    v_max_f32 v14, 0, v14
    v_sub_f32 v10, 0, v14
    v_exp_f32 v7, v10
    s_or_b32 s98, s98, 1
    s_branch A_sj_260
A_sf_259:
    v_max_f32 v8, 0xf149f2ca, v8
    v_max_f32 v14, 0xf149f2ca, v14
A_sj_260:
    v_add_f32 v5, v5, v8
    v_add_f32 v6, v6, v14
    v_sub_f32 v128, v128, v8
    v_sub_f32 v129, v129, v8
    v_sub_f32 v130, v130, v8
    v_sub_f32 v131, v131, v8
    v_sub_f32 v132, v132, v8
    v_sub_f32 v133, v133, v8
    v_sub_f32 v134, v134, v8
    v_sub_f32 v135, v135, v8
    v_sub_f32 v136, v136, v14
    v_sub_f32 v137, v137, v14
    v_sub_f32 v138, v138, v14
    v_sub_f32 v139, v139, v14
    v_sub_f32 v140, v140, v14
    v_sub_f32 v141, v141, v14
    v_sub_f32 v142, v142, v14
    v_sub_f32 v143, v143, v14
    v_sub_f32 v144, v144, v8
    v_sub_f32 v145, v145, v8
    v_sub_f32 v146, v146, v8
    v_sub_f32 v147, v147, v8
    v_sub_f32 v148, v148, v8
    v_sub_f32 v149, v149, v8
    v_sub_f32 v150, v150, v8
    v_sub_f32 v151, v151, v8
    v_sub_f32 v152, v152, v14
    v_sub_f32 v153, v153, v14
    v_sub_f32 v154, v154, v14
    v_sub_f32 v155, v155, v14
    v_sub_f32 v156, v156, v14
    v_sub_f32 v157, v157, v14
    v_sub_f32 v158, v158, v14
    v_sub_f32 v159, v159, v14
    v_sub_f32 v16, 0, v5
    v_sub_f32 v17, 0, v5
    v_sub_f32 v18, 0, v5
    v_sub_f32 v19, 0, v5
    v_sub_f32 v20, 0, v6
    v_sub_f32 v21, 0, v6
    v_sub_f32 v22, 0, v6
    v_sub_f32 v23, 0, v6
    s_branch A_slowret_258
A_resc_264:
    s_nop 15
    s_cmp_eq_u32 s98, 2
    s_mov_b32 s98, 0
    s_cbranch_scc1 A_fin_266
    v_mul_f32 v160, v160, v11
    v_mul_f32 v161, v161, v11
    v_mul_f32 v162, v162, v11
    v_mul_f32 v163, v163, v11
    v_mul_f32 v164, v164, v11
    v_mul_f32 v165, v165, v11
    v_mul_f32 v166, v166, v11
    v_mul_f32 v167, v167, v11
    v_mul_f32 v168, v168, v7
    v_mul_f32 v169, v169, v7
    v_mul_f32 v170, v170, v7
    v_mul_f32 v171, v171, v7
    v_mul_f32 v172, v172, v7
    v_mul_f32 v173, v173, v7
    v_mul_f32 v174, v174, v7
    v_mul_f32 v175, v175, v7
    v_mul_f32 v176, v176, v11
    v_mul_f32 v177, v177, v11
    v_mul_f32 v178, v178, v11
    v_mul_f32 v179, v179, v11
    v_mul_f32 v180, v180, v11
    v_mul_f32 v181, v181, v11
    v_mul_f32 v182, v182, v11
    v_mul_f32 v183, v183, v11
    v_mul_f32 v184, v184, v7
    v_mul_f32 v185, v185, v7
    v_mul_f32 v186, v186, v7
    v_mul_f32 v187, v187, v7
    v_mul_f32 v188, v188, v7
    v_mul_f32 v189, v189, v7
    v_mul_f32 v190, v190, v7
    v_mul_f32 v191, v191, v7
    v_mul_f32 v192, v192, v11
    v_mul_f32 v193, v193, v11
    v_mul_f32 v194, v194, v11
    v_mul_f32 v195, v195, v11
    v_mul_f32 v196, v196, v11
    v_mul_f32 v197, v197, v11
    v_mul_f32 v198, v198, v11
    v_mul_f32 v199, v199, v11
    v_mul_f32 v200, v200, v7
    v_mul_f32 v201, v201, v7
    v_mul_f32 v202, v202, v7
    v_mul_f32 v203, v203, v7
    v_mul_f32 v204, v204, v7
    v_mul_f32 v205, v205, v7
    v_mul_f32 v206, v206, v7
    v_mul_f32 v207, v207, v7
    v_mul_f32 v208, v208, v11
    v_mul_f32 v209, v209, v11
    v_mul_f32 v210, v210, v11
    v_mul_f32 v211, v211, v11
    v_mul_f32 v212, v212, v11
    v_mul_f32 v213, v213, v11
    v_mul_f32 v214, v214, v11
    v_mul_f32 v215, v215, v11
    v_mul_f32 v216, v216, v7
    v_mul_f32 v217, v217, v7
    v_mul_f32 v218, v218, v7
    v_mul_f32 v219, v219, v7
    v_mul_f32 v220, v220, v7
    v_mul_f32 v221, v221, v7
    v_mul_f32 v222, v222, v7
    v_mul_f32 v223, v223, v7
    v_mul_f32 v24, v24, v11
    v_mul_f32 v25, v25, v11
    v_mul_f32 v26, v26, v11
    v_mul_f32 v27, v27, v11
    v_mul_f32 v28, v28, v7
    v_mul_f32 v29, v29, v7
    v_mul_f32 v30, v30, v7
    v_mul_f32 v31, v31, v7
    s_branch A_rescret_265
A_fin_266:
    v_rcp_f32 v9, v24
    v_rcp_f32 v10, v28
    v_mov_b32 v24, 0
    v_mov_b32 v25, 0
    v_mov_b32 v26, 0
    v_mov_b32 v27, 0
    v_mov_b32 v28, 0
    v_mov_b32 v29, 0
    v_mov_b32 v30, 0
    v_mov_b32 v31, 0
    s_lshl_b32 s63, s60, 2
    s_add_u32 s63, s63, s58
    s_lshl_b32 s63, s63, 18
    s_lshl_b32 s96, s59, 13
    s_add_u32 s63, s63, s96
    v_mul_f32 v160, v160, v9
    v_mul_f32 v161, v161, v9
    v_mul_f32 v162, v162, v9
    v_mul_f32 v163, v163, v9
    v_mul_f32 v164, v164, v9
    v_mul_f32 v165, v165, v9
    v_mul_f32 v166, v166, v9
    v_mul_f32 v167, v167, v9
    v_mul_f32 v168, v168, v10
    v_mul_f32 v169, v169, v10
    v_mul_f32 v170, v170, v10
    v_mul_f32 v171, v171, v10
    v_mul_f32 v172, v172, v10
    v_mul_f32 v173, v173, v10
    v_mul_f32 v174, v174, v10
    v_mul_f32 v175, v175, v10
    s_add_u32 s96, s63, 0
    v_cvt_pk_bf16_f32 v160, v160, v161
    v_cvt_pk_bf16_f32 v161, v162, v163
    v_cvt_pk_bf16_f32 v162, v164, v165
    v_cvt_pk_bf16_f32 v163, v166, v167
    buffer_store_dwordx4 v[160:163], v12, s[28:31], s96 offen offset:0 sc1
    v_cvt_pk_bf16_f32 v168, v168, v169
    v_cvt_pk_bf16_f32 v169, v170, v171
    v_cvt_pk_bf16_f32 v170, v172, v173
    v_cvt_pk_bf16_f32 v171, v174, v175
    buffer_store_dwordx4 v[168:171], v12, s[28:31], s96 offen offset:256 sc1
    v_mov_b32 v164, 0
    v_mov_b32 v165, 0
    v_mov_b32 v166, 0
    v_mov_b32 v167, 0
    v_mov_b32 v172, 0
    v_mov_b32 v173, 0
    v_mov_b32 v174, 0
    v_mov_b32 v175, 0
    v_mov_b32 v160, 0
    v_mov_b32 v161, 0
    v_mov_b32 v162, 0
    v_mov_b32 v163, 0
    v_mov_b32 v168, 0
    v_mov_b32 v169, 0
    v_mov_b32 v170, 0
    v_mov_b32 v171, 0
    v_mul_f32 v176, v176, v9
    v_mul_f32 v177, v177, v9
    v_mul_f32 v178, v178, v9
    v_mul_f32 v179, v179, v9
    v_mul_f32 v180, v180, v9
    v_mul_f32 v181, v181, v9
    v_mul_f32 v182, v182, v9
    v_mul_f32 v183, v183, v9
    v_mul_f32 v184, v184, v10
    v_mul_f32 v185, v185, v10
    v_mul_f32 v186, v186, v10
    v_mul_f32 v187, v187, v10
    v_mul_f32 v188, v188, v10
    v_mul_f32 v189, v189, v10
    v_mul_f32 v190, v190, v10
    v_mul_f32 v191, v191, v10
    s_add_u32 s96, s63, 2048
    v_cvt_pk_bf16_f32 v176, v176, v177
    v_cvt_pk_bf16_f32 v177, v178, v179
    v_cvt_pk_bf16_f32 v178, v180, v181
    v_cvt_pk_bf16_f32 v179, v182, v183
    buffer_store_dwordx4 v[176:179], v12, s[28:31], s96 offen offset:0 sc1
    v_cvt_pk_bf16_f32 v184, v184, v185
    v_cvt_pk_bf16_f32 v185, v186, v187
    v_cvt_pk_bf16_f32 v186, v188, v189
    v_cvt_pk_bf16_f32 v187, v190, v191
    buffer_store_dwordx4 v[184:187], v12, s[28:31], s96 offen offset:256 sc1
    v_mov_b32 v180, 0
    v_mov_b32 v181, 0
    v_mov_b32 v182, 0
    v_mov_b32 v183, 0
    v_mov_b32 v188, 0
    v_mov_b32 v189, 0
    v_mov_b32 v190, 0
    v_mov_b32 v191, 0
    v_mov_b32 v176, 0
    v_mov_b32 v177, 0
    v_mov_b32 v178, 0
    v_mov_b32 v179, 0
    v_mov_b32 v184, 0
    v_mov_b32 v185, 0
    v_mov_b32 v186, 0
    v_mov_b32 v187, 0
    v_mul_f32 v192, v192, v9
    v_mul_f32 v193, v193, v9
    v_mul_f32 v194, v194, v9
    v_mul_f32 v195, v195, v9
    v_mul_f32 v196, v196, v9
    v_mul_f32 v197, v197, v9
    v_mul_f32 v198, v198, v9
    v_mul_f32 v199, v199, v9
    v_mul_f32 v200, v200, v10
    v_mul_f32 v201, v201, v10
    v_mul_f32 v202, v202, v10
    v_mul_f32 v203, v203, v10
    v_mul_f32 v204, v204, v10
    v_mul_f32 v205, v205, v10
    v_mul_f32 v206, v206, v10
    v_mul_f32 v207, v207, v10
    s_add_u32 s96, s63, 4096
    v_cvt_pk_bf16_f32 v192, v192, v193
    v_cvt_pk_bf16_f32 v193, v194, v195
    v_cvt_pk_bf16_f32 v194, v196, v197
    v_cvt_pk_bf16_f32 v195, v198, v199
    buffer_store_dwordx4 v[192:195], v12, s[28:31], s96 offen offset:0 sc1
    v_cvt_pk_bf16_f32 v200, v200, v201
    v_cvt_pk_bf16_f32 v201, v202, v203
    v_cvt_pk_bf16_f32 v202, v204, v205
    v_cvt_pk_bf16_f32 v203, v206, v207
    buffer_store_dwordx4 v[200:203], v12, s[28:31], s96 offen offset:256 sc1
    v_mov_b32 v196, 0
    v_mov_b32 v197, 0
    v_mov_b32 v198, 0
    v_mov_b32 v199, 0
    v_mov_b32 v204, 0
    v_mov_b32 v205, 0
    v_mov_b32 v206, 0
    v_mov_b32 v207, 0
    v_mov_b32 v192, 0
    v_mov_b32 v193, 0
    v_mov_b32 v194, 0
    v_mov_b32 v195, 0
    v_mov_b32 v200, 0
    v_mov_b32 v201, 0
    v_mov_b32 v202, 0
    v_mov_b32 v203, 0
    v_mul_f32 v208, v208, v9
    v_mul_f32 v209, v209, v9
    v_mul_f32 v210, v210, v9
    v_mul_f32 v211, v211, v9
    v_mul_f32 v212, v212, v9
    v_mul_f32 v213, v213, v9
    v_mul_f32 v214, v214, v9
    v_mul_f32 v215, v215, v9
    v_mul_f32 v216, v216, v10
    v_mul_f32 v217, v217, v10
    v_mul_f32 v218, v218, v10
    v_mul_f32 v219, v219, v10
    v_mul_f32 v220, v220, v10
    v_mul_f32 v221, v221, v10
    v_mul_f32 v222, v222, v10
    v_mul_f32 v223, v223, v10
    s_add_u32 s96, s63, 6144
    v_cvt_pk_bf16_f32 v208, v208, v209
    v_cvt_pk_bf16_f32 v209, v210, v211
    v_cvt_pk_bf16_f32 v210, v212, v213
    v_cvt_pk_bf16_f32 v211, v214, v215
    buffer_store_dwordx4 v[208:211], v12, s[28:31], s96 offen offset:0 sc1
    v_cvt_pk_bf16_f32 v216, v216, v217
    v_cvt_pk_bf16_f32 v217, v218, v219
    v_cvt_pk_bf16_f32 v218, v220, v221
    v_cvt_pk_bf16_f32 v219, v222, v223
    buffer_store_dwordx4 v[216:219], v12, s[28:31], s96 offen offset:256 sc1
    v_mov_b32 v212, 0
    v_mov_b32 v213, 0
    v_mov_b32 v214, 0
    v_mov_b32 v215, 0
    v_mov_b32 v220, 0
    v_mov_b32 v221, 0
    v_mov_b32 v222, 0
    v_mov_b32 v223, 0
    v_mov_b32 v208, 0
    v_mov_b32 v209, 0
    v_mov_b32 v210, 0
    v_mov_b32 v211, 0
    v_mov_b32 v216, 0
    v_mov_b32 v217, 0
    v_mov_b32 v218, 0
    v_mov_b32 v219, 0
    s_branch A_rescret_265
A_evb_272:
    s_add_u32 s63, s62, 1
    s_mov_b32 s100, -16
    s_sub_u32 s96, s63, s61
    s_add_u32 s96, s96, 2
    s_cmp_lt_u32 s96, 2
    s_cselect_b32 s97, s57, 0
    s_lshl_b32 s96, s96, 1
    s_sub_u32 s96, s96, s58
    s_lshl_b32 s96, s96, 1
    s_cmp_eq_u32 s97, 1
    s_cselect_b32 s100, s96, s100
    s_lshl_b32 s96, s57, 1
    s_sub_u32 s96, s96, s58
    s_lshl_b32 s96, s96, 1
    s_cmp_eq_u32 s63, 16
    s_cselect_b32 s100, s96, s100
    s_cmp_eq_u32 s63, s61
    s_cselect_b32 s101, s57, 0
    s_cmp_eq_u32 s63, 0
    s_cselect_b32 s101, 1, s101
    s_add_u32 s63, s62, 2
    s_cmp_eq_u32 s63, s61
    s_cselect_b32 s63, s57, 0
    s_cmp_eq_u32 s63, 0
    s_cbranch_scc1 A_noq_274
    ds_read_b128 v[32:35], v15 offset:0
    ds_read_b128 v[36:39], v15 offset:1024
    ds_read_b128 v[40:43], v15 offset:2048
    ds_read_b128 v[44:47], v15 offset:3072
    ds_read_b128 v[48:51], v15 offset:4096
    ds_read_b128 v[52:55], v15 offset:5120
    ds_read_b128 v[56:59], v15 offset:6144
    ds_read_b128 v[60:63], v15 offset:7168
    s_waitcnt lgkmcnt(0)
A_noq_274:
    s_lshl_b32 s63, s101, 1
    s_or_b32 s98, s98, s63
    s_cmp_ge_i32 s100, -3
    s_cbranch_scc0 A_evbret_273
    v_and_b32 v9, 15, v1
    v_lshrrev_b32 v10, 4, v1
    v_lshlrev_b32 v10, 2, v10
    s_lshl_b32 s63, s100, 4
    v_sub_u32 v9, v9, v10
    v_subrev_u32 v9, s63, v9
    v_cmp_le_i32 s[64:65], -16, v9
    v_cmp_le_i32 s[66:67], -15, v9
    v_cmp_le_i32 s[68:69], -14, v9
    v_cmp_le_i32 s[70:71], -13, v9
    v_cmp_le_i32 s[72:73], 0, v9
    v_cmp_le_i32 s[74:75], 1, v9
    v_cmp_le_i32 s[76:77], 2, v9
    v_cmp_le_i32 s[78:79], 3, v9
    v_cmp_le_i32 s[80:81], 16, v9
    v_cmp_le_i32 s[82:83], 17, v9
    v_cmp_le_i32 s[84:85], 18, v9
    v_cmp_le_i32 s[86:87], 19, v9
    v_cmp_le_i32 s[88:89], 32, v9
    v_cmp_le_i32 s[90:91], 33, v9
    v_cmp_le_i32 s[92:93], 34, v9
    v_cmp_le_i32 s[94:95], 35, v9
    v_cndmask_b32 v104, v13, v104, s[64:65]
    v_cndmask_b32 v105, v13, v105, s[66:67]
    v_cndmask_b32 v106, v13, v106, s[68:69]
    v_cndmask_b32 v107, v13, v107, s[70:71]
    v_cmp_le_i32 s[64:65], 48, v9
    v_cmp_le_i32 s[66:67], 49, v9
    v_cmp_le_i32 s[68:69], 50, v9
    v_cmp_le_i32 s[70:71], 51, v9
    v_cndmask_b32 v96, v13, v96, s[72:73]
    v_cndmask_b32 v97, v13, v97, s[74:75]
    v_cndmask_b32 v98, v13, v98, s[76:77]
    v_cndmask_b32 v99, v13, v99, s[78:79]
    v_cndmask_b32 v108, v13, v108, s[72:73]
    v_cndmask_b32 v109, v13, v109, s[74:75]
    v_cndmask_b32 v110, v13, v110, s[76:77]
    v_cndmask_b32 v111, v13, v111, s[78:79]
    v_cndmask_b32 v100, v13, v100, s[80:81]
    v_cndmask_b32 v101, v13, v101, s[82:83]
    v_cndmask_b32 v102, v13, v102, s[84:85]
    v_cndmask_b32 v103, v13, v103, s[86:87]
    v_cndmask_b32 v120, v13, v120, s[80:81]
    v_cndmask_b32 v121, v13, v121, s[82:83]
    v_cndmask_b32 v122, v13, v122, s[84:85]
    v_cndmask_b32 v123, v13, v123, s[86:87]
    v_cndmask_b32 v112, v13, v112, s[88:89]
    v_cndmask_b32 v113, v13, v113, s[90:91]
    v_cndmask_b32 v114, v13, v114, s[92:93]
    v_cndmask_b32 v115, v13, v115, s[94:95]
    v_cndmask_b32 v124, v13, v124, s[88:89]
    v_cndmask_b32 v125, v13, v125, s[90:91]
    v_cndmask_b32 v126, v13, v126, s[92:93]
    v_cndmask_b32 v127, v13, v127, s[94:95]
    v_cndmask_b32 v116, v13, v116, s[64:65]
    v_cndmask_b32 v117, v13, v117, s[66:67]
    v_cndmask_b32 v118, v13, v118, s[68:69]
    v_cndmask_b32 v119, v13, v119, s[70:71]
    s_branch A_evbret_273
A_slow_275:
    v_max3_f32 v8, v96, v97, v98
    v_max3_f32 v8, v8, v99, v100
    v_max3_f32 v8, v8, v101, v102
    v_max3_f32 v8, v8, v103, v112
    v_max3_f32 v8, v8, v113, v114
    v_max3_f32 v8, v8, v115, v116
    v_max3_f32 v8, v8, v117, v118
    v_max_f32 v8, v8, v119
    v_max3_f32 v14, v104, v105, v106
    v_max3_f32 v14, v14, v107, v108
    v_max3_f32 v14, v14, v109, v110
    v_max3_f32 v14, v14, v111, v120
    v_max3_f32 v14, v14, v121, v122
    v_max3_f32 v14, v14, v123, v124
    v_max3_f32 v14, v14, v125, v126
    v_max_f32 v14, v14, v127
    v_mov_b32 v9, v8
    v_mov_b32 v10, v14
    s_nop 1
    v_permlane16_swap_b32 v8, v9
    v_permlane16_swap_b32 v14, v10
    s_nop 1
    v_max_f32 v8, v8, v9
    v_max_f32 v14, v14, v10
    v_mov_b32 v9, v8
    v_mov_b32 v10, v14
    s_nop 1
    v_permlane32_swap_b32 v8, v9
    v_permlane32_swap_b32 v14, v10
    s_nop 1
    v_max_f32 v8, v8, v9
    v_max_f32 v14, v14, v10
    s_cmp_eq_u32 s101, 1
    s_cbranch_scc1 A_sf_277
    v_max_f32 v8, 0, v8
    v_sub_f32 v9, 0, v8
    v_exp_f32 v11, v9
    v_max_f32 v14, 0, v14
    v_sub_f32 v10, 0, v14
    v_exp_f32 v7, v10
    s_or_b32 s98, s98, 1
    s_branch A_sj_278
A_sf_277:
    v_max_f32 v8, 0xf149f2ca, v8
    v_max_f32 v14, 0xf149f2ca, v14
A_sj_278:
    v_add_f32 v5, v5, v8
    v_add_f32 v6, v6, v14
    v_sub_f32 v96, v96, v8
    v_sub_f32 v97, v97, v8
    v_sub_f32 v98, v98, v8
    v_sub_f32 v99, v99, v8
    v_sub_f32 v100, v100, v8
    v_sub_f32 v101, v101, v8
    v_sub_f32 v102, v102, v8
    v_sub_f32 v103, v103, v8
    v_sub_f32 v104, v104, v14
    v_sub_f32 v105, v105, v14
    v_sub_f32 v106, v106, v14
    v_sub_f32 v107, v107, v14
    v_sub_f32 v108, v108, v14
    v_sub_f32 v109, v109, v14
    v_sub_f32 v110, v110, v14
    v_sub_f32 v111, v111, v14
    v_sub_f32 v112, v112, v8
    v_sub_f32 v113, v113, v8
    v_sub_f32 v114, v114, v8
    v_sub_f32 v115, v115, v8
    v_sub_f32 v116, v116, v8
    v_sub_f32 v117, v117, v8
    v_sub_f32 v118, v118, v8
    v_sub_f32 v119, v119, v8
    v_sub_f32 v120, v120, v14
    v_sub_f32 v121, v121, v14
    v_sub_f32 v122, v122, v14
    v_sub_f32 v123, v123, v14
    v_sub_f32 v124, v124, v14
    v_sub_f32 v125, v125, v14
    v_sub_f32 v126, v126, v14
    v_sub_f32 v127, v127, v14
    v_sub_f32 v16, 0, v5
    v_sub_f32 v17, 0, v5
    v_sub_f32 v18, 0, v5
    v_sub_f32 v19, 0, v5
    v_sub_f32 v20, 0, v6
    v_sub_f32 v21, 0, v6
    v_sub_f32 v22, 0, v6
    v_sub_f32 v23, 0, v6
    s_branch A_slowret_276
A_resc_282:
    s_nop 15
    s_cmp_eq_u32 s98, 2
    s_mov_b32 s98, 0
    s_cbranch_scc1 A_fin_284
    v_mul_f32 v160, v160, v11
    v_mul_f32 v161, v161, v11
    v_mul_f32 v162, v162, v11
    v_mul_f32 v163, v163, v11
    v_mul_f32 v164, v164, v11
    v_mul_f32 v165, v165, v11
    v_mul_f32 v166, v166, v11
    v_mul_f32 v167, v167, v11
    v_mul_f32 v168, v168, v7
    v_mul_f32 v169, v169, v7
    v_mul_f32 v170, v170, v7
    v_mul_f32 v171, v171, v7
    v_mul_f32 v172, v172, v7
    v_mul_f32 v173, v173, v7
    v_mul_f32 v174, v174, v7
    v_mul_f32 v175, v175, v7
    v_mul_f32 v176, v176, v11
    v_mul_f32 v177, v177, v11
    v_mul_f32 v178, v178, v11
    v_mul_f32 v179, v179, v11
    v_mul_f32 v180, v180, v11
    v_mul_f32 v181, v181, v11
    v_mul_f32 v182, v182, v11
    v_mul_f32 v183, v183, v11
    v_mul_f32 v184, v184, v7
    v_mul_f32 v185, v185, v7
    v_mul_f32 v186, v186, v7
    v_mul_f32 v187, v187, v7
    v_mul_f32 v188, v188, v7
    v_mul_f32 v189, v189, v7
    v_mul_f32 v190, v190, v7
    v_mul_f32 v191, v191, v7
    v_mul_f32 v192, v192, v11
    v_mul_f32 v193, v193, v11
    v_mul_f32 v194, v194, v11
    v_mul_f32 v195, v195, v11
    v_mul_f32 v196, v196, v11
    v_mul_f32 v197, v197, v11
    v_mul_f32 v198, v198, v11
    v_mul_f32 v199, v199, v11
    v_mul_f32 v200, v200, v7
    v_mul_f32 v201, v201, v7
    v_mul_f32 v202, v202, v7
    v_mul_f32 v203, v203, v7
    v_mul_f32 v204, v204, v7
    v_mul_f32 v205, v205, v7
    v_mul_f32 v206, v206, v7
    v_mul_f32 v207, v207, v7
    v_mul_f32 v208, v208, v11
    v_mul_f32 v209, v209, v11
    v_mul_f32 v210, v210, v11
    v_mul_f32 v211, v211, v11
    v_mul_f32 v212, v212, v11
    v_mul_f32 v213, v213, v11
    v_mul_f32 v214, v214, v11
    v_mul_f32 v215, v215, v11
    v_mul_f32 v216, v216, v7
    v_mul_f32 v217, v217, v7
    v_mul_f32 v218, v218, v7
    v_mul_f32 v219, v219, v7
    v_mul_f32 v220, v220, v7
    v_mul_f32 v221, v221, v7
    v_mul_f32 v222, v222, v7
    v_mul_f32 v223, v223, v7
    v_mul_f32 v24, v24, v11
    v_mul_f32 v25, v25, v11
    v_mul_f32 v26, v26, v11
    v_mul_f32 v27, v27, v11
    v_mul_f32 v28, v28, v7
    v_mul_f32 v29, v29, v7
    v_mul_f32 v30, v30, v7
    v_mul_f32 v31, v31, v7
    s_branch A_rescret_283
A_fin_284:
    v_rcp_f32 v9, v24
    v_rcp_f32 v10, v28
    v_mov_b32 v24, 0
    v_mov_b32 v25, 0
    v_mov_b32 v26, 0
    v_mov_b32 v27, 0
    v_mov_b32 v28, 0
    v_mov_b32 v29, 0
    v_mov_b32 v30, 0
    v_mov_b32 v31, 0
    s_lshl_b32 s63, s60, 2
    s_add_u32 s63, s63, s58
    s_lshl_b32 s63, s63, 18
    s_lshl_b32 s96, s59, 13
    s_add_u32 s63, s63, s96
    v_mul_f32 v160, v160, v9
    v_mul_f32 v161, v161, v9
    v_mul_f32 v162, v162, v9
    v_mul_f32 v163, v163, v9
    v_mul_f32 v164, v164, v9
    v_mul_f32 v165, v165, v9
    v_mul_f32 v166, v166, v9
    v_mul_f32 v167, v167, v9
    v_mul_f32 v168, v168, v10
    v_mul_f32 v169, v169, v10
    v_mul_f32 v170, v170, v10
    v_mul_f32 v171, v171, v10
    v_mul_f32 v172, v172, v10
    v_mul_f32 v173, v173, v10
    v_mul_f32 v174, v174, v10
    v_mul_f32 v175, v175, v10
    s_add_u32 s96, s63, 0
    v_cvt_pk_bf16_f32 v160, v160, v161
    v_cvt_pk_bf16_f32 v161, v162, v163
    v_cvt_pk_bf16_f32 v162, v164, v165
    v_cvt_pk_bf16_f32 v163, v166, v167
    buffer_store_dwordx4 v[160:163], v12, s[28:31], s96 offen offset:0 sc1
    v_cvt_pk_bf16_f32 v168, v168, v169
    v_cvt_pk_bf16_f32 v169, v170, v171
    v_cvt_pk_bf16_f32 v170, v172, v173
    v_cvt_pk_bf16_f32 v171, v174, v175
    buffer_store_dwordx4 v[168:171], v12, s[28:31], s96 offen offset:256 sc1
    v_mov_b32 v164, 0
    v_mov_b32 v165, 0
    v_mov_b32 v166, 0
    v_mov_b32 v167, 0
    v_mov_b32 v172, 0
    v_mov_b32 v173, 0
    v_mov_b32 v174, 0
    v_mov_b32 v175, 0
    v_mov_b32 v160, 0
    v_mov_b32 v161, 0
    v_mov_b32 v162, 0
    v_mov_b32 v163, 0
    v_mov_b32 v168, 0
    v_mov_b32 v169, 0
    v_mov_b32 v170, 0
    v_mov_b32 v171, 0
    v_mul_f32 v176, v176, v9
    v_mul_f32 v177, v177, v9
    v_mul_f32 v178, v178, v9
    v_mul_f32 v179, v179, v9
    v_mul_f32 v180, v180, v9
    v_mul_f32 v181, v181, v9
    v_mul_f32 v182, v182, v9
    v_mul_f32 v183, v183, v9
    v_mul_f32 v184, v184, v10
    v_mul_f32 v185, v185, v10
    v_mul_f32 v186, v186, v10
    v_mul_f32 v187, v187, v10
    v_mul_f32 v188, v188, v10
    v_mul_f32 v189, v189, v10
    v_mul_f32 v190, v190, v10
    v_mul_f32 v191, v191, v10
    s_add_u32 s96, s63, 2048
    v_cvt_pk_bf16_f32 v176, v176, v177
    v_cvt_pk_bf16_f32 v177, v178, v179
    v_cvt_pk_bf16_f32 v178, v180, v181
    v_cvt_pk_bf16_f32 v179, v182, v183
    buffer_store_dwordx4 v[176:179], v12, s[28:31], s96 offen offset:0 sc1
    v_cvt_pk_bf16_f32 v184, v184, v185
    v_cvt_pk_bf16_f32 v185, v186, v187
    v_cvt_pk_bf16_f32 v186, v188, v189
    v_cvt_pk_bf16_f32 v187, v190, v191
    buffer_store_dwordx4 v[184:187], v12, s[28:31], s96 offen offset:256 sc1
    v_mov_b32 v180, 0
    v_mov_b32 v181, 0
    v_mov_b32 v182, 0
    v_mov_b32 v183, 0
    v_mov_b32 v188, 0
    v_mov_b32 v189, 0
    v_mov_b32 v190, 0
    v_mov_b32 v191, 0
    v_mov_b32 v176, 0
    v_mov_b32 v177, 0
    v_mov_b32 v178, 0
    v_mov_b32 v179, 0
    v_mov_b32 v184, 0
    v_mov_b32 v185, 0
    v_mov_b32 v186, 0
    v_mov_b32 v187, 0
    v_mul_f32 v192, v192, v9
    v_mul_f32 v193, v193, v9
    v_mul_f32 v194, v194, v9
    v_mul_f32 v195, v195, v9
    v_mul_f32 v196, v196, v9
    v_mul_f32 v197, v197, v9
    v_mul_f32 v198, v198, v9
    v_mul_f32 v199, v199, v9
    v_mul_f32 v200, v200, v10
    v_mul_f32 v201, v201, v10
    v_mul_f32 v202, v202, v10
    v_mul_f32 v203, v203, v10
    v_mul_f32 v204, v204, v10
    v_mul_f32 v205, v205, v10
    v_mul_f32 v206, v206, v10
    v_mul_f32 v207, v207, v10
    s_add_u32 s96, s63, 4096
    v_cvt_pk_bf16_f32 v192, v192, v193
    v_cvt_pk_bf16_f32 v193, v194, v195
    v_cvt_pk_bf16_f32 v194, v196, v197
    v_cvt_pk_bf16_f32 v195, v198, v199
    buffer_store_dwordx4 v[192:195], v12, s[28:31], s96 offen offset:0 sc1
    v_cvt_pk_bf16_f32 v200, v200, v201
    v_cvt_pk_bf16_f32 v201, v202, v203
    v_cvt_pk_bf16_f32 v202, v204, v205
    v_cvt_pk_bf16_f32 v203, v206, v207
    buffer_store_dwordx4 v[200:203], v12, s[28:31], s96 offen offset:256 sc1
    v_mov_b32 v196, 0
    v_mov_b32 v197, 0
    v_mov_b32 v198, 0
    v_mov_b32 v199, 0
    v_mov_b32 v204, 0
    v_mov_b32 v205, 0
    v_mov_b32 v206, 0
    v_mov_b32 v207, 0
    v_mov_b32 v192, 0
    v_mov_b32 v193, 0
    v_mov_b32 v194, 0
    v_mov_b32 v195, 0
    v_mov_b32 v200, 0
    v_mov_b32 v201, 0
    v_mov_b32 v202, 0
    v_mov_b32 v203, 0
    v_mul_f32 v208, v208, v9
    v_mul_f32 v209, v209, v9
    v_mul_f32 v210, v210, v9
    v_mul_f32 v211, v211, v9
    v_mul_f32 v212, v212, v9
    v_mul_f32 v213, v213, v9
    v_mul_f32 v214, v214, v9
    v_mul_f32 v215, v215, v9
    v_mul_f32 v216, v216, v10
    v_mul_f32 v217, v217, v10
    v_mul_f32 v218, v218, v10
    v_mul_f32 v219, v219, v10
    v_mul_f32 v220, v220, v10
    v_mul_f32 v221, v221, v10
    v_mul_f32 v222, v222, v10
    v_mul_f32 v223, v223, v10
    s_add_u32 s96, s63, 6144
    v_cvt_pk_bf16_f32 v208, v208, v209
    v_cvt_pk_bf16_f32 v209, v210, v211
    v_cvt_pk_bf16_f32 v210, v212, v213
    v_cvt_pk_bf16_f32 v211, v214, v215
    buffer_store_dwordx4 v[208:211], v12, s[28:31], s96 offen offset:0 sc1
    v_cvt_pk_bf16_f32 v216, v216, v217
    v_cvt_pk_bf16_f32 v217, v218, v219
    v_cvt_pk_bf16_f32 v218, v220, v221
    v_cvt_pk_bf16_f32 v219, v222, v223
    buffer_store_dwordx4 v[216:219], v12, s[28:31], s96 offen offset:256 sc1
    v_mov_b32 v212, 0
    v_mov_b32 v213, 0
    v_mov_b32 v214, 0
    v_mov_b32 v215, 0
    v_mov_b32 v220, 0
    v_mov_b32 v221, 0
    v_mov_b32 v222, 0
    v_mov_b32 v223, 0
    v_mov_b32 v208, 0
    v_mov_b32 v209, 0
    v_mov_b32 v210, 0
    v_mov_b32 v211, 0
    v_mov_b32 v216, 0
    v_mov_b32 v217, 0
    v_mov_b32 v218, 0
    v_mov_b32 v219, 0
    s_branch A_rescret_283
A_evb_290:
    s_add_u32 s63, s62, 1
    s_mov_b32 s100, -16
    s_sub_u32 s96, s63, s61
    s_add_u32 s96, s96, 2
    s_cmp_lt_u32 s96, 2
    s_cselect_b32 s97, s57, 0
    s_lshl_b32 s96, s96, 1
    s_sub_u32 s96, s96, s58
    s_lshl_b32 s96, s96, 1
    s_cmp_eq_u32 s97, 1
    s_cselect_b32 s100, s96, s100
    s_lshl_b32 s96, s57, 1
    s_sub_u32 s96, s96, s58
    s_lshl_b32 s96, s96, 1
    s_cmp_eq_u32 s63, 16
    s_cselect_b32 s100, s96, s100
    s_cmp_eq_u32 s63, s61
    s_cselect_b32 s101, s57, 0
    s_cmp_eq_u32 s63, 0
    s_cselect_b32 s101, 1, s101
    s_add_u32 s63, s62, 2
    s_cmp_eq_u32 s63, s61
    s_cselect_b32 s63, s57, 0
    s_cmp_eq_u32 s63, 0
    s_cbranch_scc1 A_noq_292
    ds_read_b128 v[32:35], v15 offset:0
    ds_read_b128 v[36:39], v15 offset:1024
    ds_read_b128 v[40:43], v15 offset:2048
    ds_read_b128 v[44:47], v15 offset:3072
    ds_read_b128 v[48:51], v15 offset:4096
    ds_read_b128 v[52:55], v15 offset:5120
    ds_read_b128 v[56:59], v15 offset:6144
    ds_read_b128 v[60:63], v15 offset:7168
    s_waitcnt lgkmcnt(0)
A_noq_292:
    s_lshl_b32 s63, s101, 1
    s_or_b32 s98, s98, s63
    s_cmp_ge_i32 s100, -3
    s_cbranch_scc0 A_evbret_291
    v_and_b32 v9, 15, v1
    v_lshrrev_b32 v10, 4, v1
    v_lshlrev_b32 v10, 2, v10
    s_lshl_b32 s63, s100, 4
    v_sub_u32 v9, v9, v10
    v_subrev_u32 v9, s63, v9
    v_cmp_le_i32 s[64:65], -16, v9
    v_cmp_le_i32 s[66:67], -15, v9
    v_cmp_le_i32 s[68:69], -14, v9
    v_cmp_le_i32 s[70:71], -13, v9
    v_cmp_le_i32 s[72:73], 0, v9
    v_cmp_le_i32 s[74:75], 1, v9
    v_cmp_le_i32 s[76:77], 2, v9
    v_cmp_le_i32 s[78:79], 3, v9
    v_cmp_le_i32 s[80:81], 16, v9
    v_cmp_le_i32 s[82:83], 17, v9
    v_cmp_le_i32 s[84:85], 18, v9
    v_cmp_le_i32 s[86:87], 19, v9
    v_cmp_le_i32 s[88:89], 32, v9
    v_cmp_le_i32 s[90:91], 33, v9
    v_cmp_le_i32 s[92:93], 34, v9
    v_cmp_le_i32 s[94:95], 35, v9
    v_cndmask_b32 v136, v13, v136, s[64:65]
    v_cndmask_b32 v137, v13, v137, s[66:67]
    v_cndmask_b32 v138, v13, v138, s[68:69]
    v_cndmask_b32 v139, v13, v139, s[70:71]
    v_cmp_le_i32 s[64:65], 48, v9
    v_cmp_le_i32 s[66:67], 49, v9
    v_cmp_le_i32 s[68:69], 50, v9
    v_cmp_le_i32 s[70:71], 51, v9
    v_cndmask_b32 v128, v13, v128, s[72:73]
    v_cndmask_b32 v129, v13, v129, s[74:75]
    v_cndmask_b32 v130, v13, v130, s[76:77]
    v_cndmask_b32 v131, v13, v131, s[78:79]
    v_cndmask_b32 v140, v13, v140, s[72:73]
    v_cndmask_b32 v141, v13, v141, s[74:75]
    v_cndmask_b32 v142, v13, v142, s[76:77]
    v_cndmask_b32 v143, v13, v143, s[78:79]
    v_cndmask_b32 v132, v13, v132, s[80:81]
    v_cndmask_b32 v133, v13, v133, s[82:83]
    v_cndmask_b32 v134, v13, v134, s[84:85]
    v_cndmask_b32 v135, v13, v135, s[86:87]
    v_cndmask_b32 v152, v13, v152, s[80:81]
    v_cndmask_b32 v153, v13, v153, s[82:83]
    v_cndmask_b32 v154, v13, v154, s[84:85]
    v_cndmask_b32 v155, v13, v155, s[86:87]
    v_cndmask_b32 v144, v13, v144, s[88:89]
    v_cndmask_b32 v145, v13, v145, s[90:91]
    v_cndmask_b32 v146, v13, v146, s[92:93]
    v_cndmask_b32 v147, v13, v147, s[94:95]
    v_cndmask_b32 v156, v13, v156, s[88:89]
    v_cndmask_b32 v157, v13, v157, s[90:91]
    v_cndmask_b32 v158, v13, v158, s[92:93]
    v_cndmask_b32 v159, v13, v159, s[94:95]
    v_cndmask_b32 v148, v13, v148, s[64:65]
    v_cndmask_b32 v149, v13, v149, s[66:67]
    v_cndmask_b32 v150, v13, v150, s[68:69]
    v_cndmask_b32 v151, v13, v151, s[70:71]
    s_branch A_evbret_291
A_slow_293:
    v_max3_f32 v8, v128, v129, v130
    v_max3_f32 v8, v8, v131, v132
    v_max3_f32 v8, v8, v133, v134
    v_max3_f32 v8, v8, v135, v144
    v_max3_f32 v8, v8, v145, v146
    v_max3_f32 v8, v8, v147, v148
    v_max3_f32 v8, v8, v149, v150
    v_max_f32 v8, v8, v151
    v_max3_f32 v14, v136, v137, v138
    v_max3_f32 v14, v14, v139, v140
    v_max3_f32 v14, v14, v141, v142
    v_max3_f32 v14, v14, v143, v152
    v_max3_f32 v14, v14, v153, v154
    v_max3_f32 v14, v14, v155, v156
    v_max3_f32 v14, v14, v157, v158
    v_max_f32 v14, v14, v159
    v_mov_b32 v9, v8
    v_mov_b32 v10, v14
    s_nop 1
    v_permlane16_swap_b32 v8, v9
    v_permlane16_swap_b32 v14, v10
    s_nop 1
    v_max_f32 v8, v8, v9
    v_max_f32 v14, v14, v10
    v_mov_b32 v9, v8
    v_mov_b32 v10, v14
    s_nop 1
    v_permlane32_swap_b32 v8, v9
    v_permlane32_swap_b32 v14, v10
    s_nop 1
    v_max_f32 v8, v8, v9
    v_max_f32 v14, v14, v10
    s_cmp_eq_u32 s101, 1
    s_cbranch_scc1 A_sf_295
    v_max_f32 v8, 0, v8
    v_sub_f32 v9, 0, v8
    v_exp_f32 v11, v9
    v_max_f32 v14, 0, v14
    v_sub_f32 v10, 0, v14
    v_exp_f32 v7, v10
    s_or_b32 s98, s98, 1
    s_branch A_sj_296
A_sf_295:
    v_max_f32 v8, 0xf149f2ca, v8
    v_max_f32 v14, 0xf149f2ca, v14
A_sj_296:
    v_add_f32 v5, v5, v8
    v_add_f32 v6, v6, v14
    v_sub_f32 v128, v128, v8
    v_sub_f32 v129, v129, v8
    v_sub_f32 v130, v130, v8
    v_sub_f32 v131, v131, v8
    v_sub_f32 v132, v132, v8
    v_sub_f32 v133, v133, v8
    v_sub_f32 v134, v134, v8
    v_sub_f32 v135, v135, v8
    v_sub_f32 v136, v136, v14
    v_sub_f32 v137, v137, v14
    v_sub_f32 v138, v138, v14
    v_sub_f32 v139, v139, v14
    v_sub_f32 v140, v140, v14
    v_sub_f32 v141, v141, v14
    v_sub_f32 v142, v142, v14
    v_sub_f32 v143, v143, v14
    v_sub_f32 v144, v144, v8
    v_sub_f32 v145, v145, v8
    v_sub_f32 v146, v146, v8
    v_sub_f32 v147, v147, v8
    v_sub_f32 v148, v148, v8
    v_sub_f32 v149, v149, v8
    v_sub_f32 v150, v150, v8
    v_sub_f32 v151, v151, v8
    v_sub_f32 v152, v152, v14
    v_sub_f32 v153, v153, v14
    v_sub_f32 v154, v154, v14
    v_sub_f32 v155, v155, v14
    v_sub_f32 v156, v156, v14
    v_sub_f32 v157, v157, v14
    v_sub_f32 v158, v158, v14
    v_sub_f32 v159, v159, v14
    v_sub_f32 v16, 0, v5
    v_sub_f32 v17, 0, v5
    v_sub_f32 v18, 0, v5
    v_sub_f32 v19, 0, v5
    v_sub_f32 v20, 0, v6
    v_sub_f32 v21, 0, v6
    v_sub_f32 v22, 0, v6
    v_sub_f32 v23, 0, v6
    s_branch A_slowret_294
A_resc_300:
    s_nop 15
    s_cmp_eq_u32 s98, 2
    s_mov_b32 s98, 0
    s_cbranch_scc1 A_fin_302
    v_mul_f32 v160, v160, v11
    v_mul_f32 v161, v161, v11
    v_mul_f32 v162, v162, v11
    v_mul_f32 v163, v163, v11
    v_mul_f32 v164, v164, v11
    v_mul_f32 v165, v165, v11
    v_mul_f32 v166, v166, v11
    v_mul_f32 v167, v167, v11
    v_mul_f32 v168, v168, v7
    v_mul_f32 v169, v169, v7
    v_mul_f32 v170, v170, v7
    v_mul_f32 v171, v171, v7
    v_mul_f32 v172, v172, v7
    v_mul_f32 v173, v173, v7
    v_mul_f32 v174, v174, v7
    v_mul_f32 v175, v175, v7
    v_mul_f32 v176, v176, v11
    v_mul_f32 v177, v177, v11
    v_mul_f32 v178, v178, v11
    v_mul_f32 v179, v179, v11
    v_mul_f32 v180, v180, v11
    v_mul_f32 v181, v181, v11
    v_mul_f32 v182, v182, v11
    v_mul_f32 v183, v183, v11
    v_mul_f32 v184, v184, v7
    v_mul_f32 v185, v185, v7
    v_mul_f32 v186, v186, v7
    v_mul_f32 v187, v187, v7
    v_mul_f32 v188, v188, v7
    v_mul_f32 v189, v189, v7
    v_mul_f32 v190, v190, v7
    v_mul_f32 v191, v191, v7
    v_mul_f32 v192, v192, v11
    v_mul_f32 v193, v193, v11
    v_mul_f32 v194, v194, v11
    v_mul_f32 v195, v195, v11
    v_mul_f32 v196, v196, v11
    v_mul_f32 v197, v197, v11
    v_mul_f32 v198, v198, v11
    v_mul_f32 v199, v199, v11
    v_mul_f32 v200, v200, v7
    v_mul_f32 v201, v201, v7
    v_mul_f32 v202, v202, v7
    v_mul_f32 v203, v203, v7
    v_mul_f32 v204, v204, v7
    v_mul_f32 v205, v205, v7
    v_mul_f32 v206, v206, v7
    v_mul_f32 v207, v207, v7
    v_mul_f32 v208, v208, v11
    v_mul_f32 v209, v209, v11
    v_mul_f32 v210, v210, v11
    v_mul_f32 v211, v211, v11
    v_mul_f32 v212, v212, v11
    v_mul_f32 v213, v213, v11
    v_mul_f32 v214, v214, v11
    v_mul_f32 v215, v215, v11
    v_mul_f32 v216, v216, v7
    v_mul_f32 v217, v217, v7
    v_mul_f32 v218, v218, v7
    v_mul_f32 v219, v219, v7
    v_mul_f32 v220, v220, v7
    v_mul_f32 v221, v221, v7
    v_mul_f32 v222, v222, v7
    v_mul_f32 v223, v223, v7
    v_mul_f32 v24, v24, v11
    v_mul_f32 v25, v25, v11
    v_mul_f32 v26, v26, v11
    v_mul_f32 v27, v27, v11
    v_mul_f32 v28, v28, v7
    v_mul_f32 v29, v29, v7
    v_mul_f32 v30, v30, v7
    v_mul_f32 v31, v31, v7
    s_branch A_rescret_301
A_fin_302:
    v_rcp_f32 v9, v24
    v_rcp_f32 v10, v28
    v_mov_b32 v24, 0
    v_mov_b32 v25, 0
    v_mov_b32 v26, 0
    v_mov_b32 v27, 0
    v_mov_b32 v28, 0
    v_mov_b32 v29, 0
    v_mov_b32 v30, 0
    v_mov_b32 v31, 0
    s_lshl_b32 s63, s60, 2
    s_add_u32 s63, s63, s58
    s_lshl_b32 s63, s63, 18
    s_lshl_b32 s96, s59, 13
    s_add_u32 s63, s63, s96
    v_mul_f32 v160, v160, v9
    v_mul_f32 v161, v161, v9
    v_mul_f32 v162, v162, v9
    v_mul_f32 v163, v163, v9
    v_mul_f32 v164, v164, v9
    v_mul_f32 v165, v165, v9
    v_mul_f32 v166, v166, v9
    v_mul_f32 v167, v167, v9
    v_mul_f32 v168, v168, v10
    v_mul_f32 v169, v169, v10
    v_mul_f32 v170, v170, v10
    v_mul_f32 v171, v171, v10
    v_mul_f32 v172, v172, v10
    v_mul_f32 v173, v173, v10
    v_mul_f32 v174, v174, v10
    v_mul_f32 v175, v175, v10
    s_add_u32 s96, s63, 0
    v_cvt_pk_bf16_f32 v160, v160, v161
    v_cvt_pk_bf16_f32 v161, v162, v163
    v_cvt_pk_bf16_f32 v162, v164, v165
    v_cvt_pk_bf16_f32 v163, v166, v167
    buffer_store_dwordx4 v[160:163], v12, s[28:31], s96 offen offset:0 sc1
    v_cvt_pk_bf16_f32 v168, v168, v169
    v_cvt_pk_bf16_f32 v169, v170, v171
    v_cvt_pk_bf16_f32 v170, v172, v173
    v_cvt_pk_bf16_f32 v171, v174, v175
    buffer_store_dwordx4 v[168:171], v12, s[28:31], s96 offen offset:256 sc1
    v_mov_b32 v164, 0
    v_mov_b32 v165, 0
    v_mov_b32 v166, 0
    v_mov_b32 v167, 0
    v_mov_b32 v172, 0
    v_mov_b32 v173, 0
    v_mov_b32 v174, 0
    v_mov_b32 v175, 0
    v_mov_b32 v160, 0
    v_mov_b32 v161, 0
    v_mov_b32 v162, 0
    v_mov_b32 v163, 0
    v_mov_b32 v168, 0
    v_mov_b32 v169, 0
    v_mov_b32 v170, 0
    v_mov_b32 v171, 0
    v_mul_f32 v176, v176, v9
    v_mul_f32 v177, v177, v9
    v_mul_f32 v178, v178, v9
    v_mul_f32 v179, v179, v9
    v_mul_f32 v180, v180, v9
    v_mul_f32 v181, v181, v9
    v_mul_f32 v182, v182, v9
    v_mul_f32 v183, v183, v9
    v_mul_f32 v184, v184, v10
    v_mul_f32 v185, v185, v10
    v_mul_f32 v186, v186, v10
    v_mul_f32 v187, v187, v10
    v_mul_f32 v188, v188, v10
    v_mul_f32 v189, v189, v10
    v_mul_f32 v190, v190, v10
    v_mul_f32 v191, v191, v10
    s_add_u32 s96, s63, 2048
    v_cvt_pk_bf16_f32 v176, v176, v177
    v_cvt_pk_bf16_f32 v177, v178, v179
    v_cvt_pk_bf16_f32 v178, v180, v181
    v_cvt_pk_bf16_f32 v179, v182, v183
    buffer_store_dwordx4 v[176:179], v12, s[28:31], s96 offen offset:0 sc1
    v_cvt_pk_bf16_f32 v184, v184, v185
    v_cvt_pk_bf16_f32 v185, v186, v187
    v_cvt_pk_bf16_f32 v186, v188, v189
    v_cvt_pk_bf16_f32 v187, v190, v191
    buffer_store_dwordx4 v[184:187], v12, s[28:31], s96 offen offset:256 sc1
    v_mov_b32 v180, 0
    v_mov_b32 v181, 0
    v_mov_b32 v182, 0
    v_mov_b32 v183, 0
    v_mov_b32 v188, 0
    v_mov_b32 v189, 0
    v_mov_b32 v190, 0
    v_mov_b32 v191, 0
    v_mov_b32 v176, 0
    v_mov_b32 v177, 0
    v_mov_b32 v178, 0
    v_mov_b32 v179, 0
    v_mov_b32 v184, 0
    v_mov_b32 v185, 0
    v_mov_b32 v186, 0
    v_mov_b32 v187, 0
    v_mul_f32 v192, v192, v9
    v_mul_f32 v193, v193, v9
    v_mul_f32 v194, v194, v9
    v_mul_f32 v195, v195, v9
    v_mul_f32 v196, v196, v9
    v_mul_f32 v197, v197, v9
    v_mul_f32 v198, v198, v9
    v_mul_f32 v199, v199, v9
    v_mul_f32 v200, v200, v10
    v_mul_f32 v201, v201, v10
    v_mul_f32 v202, v202, v10
    v_mul_f32 v203, v203, v10
    v_mul_f32 v204, v204, v10
    v_mul_f32 v205, v205, v10
    v_mul_f32 v206, v206, v10
    v_mul_f32 v207, v207, v10
    s_add_u32 s96, s63, 4096
    v_cvt_pk_bf16_f32 v192, v192, v193
    v_cvt_pk_bf16_f32 v193, v194, v195
    v_cvt_pk_bf16_f32 v194, v196, v197
    v_cvt_pk_bf16_f32 v195, v198, v199
    buffer_store_dwordx4 v[192:195], v12, s[28:31], s96 offen offset:0 sc1
    v_cvt_pk_bf16_f32 v200, v200, v201
    v_cvt_pk_bf16_f32 v201, v202, v203
    v_cvt_pk_bf16_f32 v202, v204, v205
    v_cvt_pk_bf16_f32 v203, v206, v207
    buffer_store_dwordx4 v[200:203], v12, s[28:31], s96 offen offset:256 sc1
    v_mov_b32 v196, 0
    v_mov_b32 v197, 0
    v_mov_b32 v198, 0
    v_mov_b32 v199, 0
    v_mov_b32 v204, 0
    v_mov_b32 v205, 0
    v_mov_b32 v206, 0
    v_mov_b32 v207, 0
    v_mov_b32 v192, 0
    v_mov_b32 v193, 0
    v_mov_b32 v194, 0
    v_mov_b32 v195, 0
    v_mov_b32 v200, 0
    v_mov_b32 v201, 0
    v_mov_b32 v202, 0
    v_mov_b32 v203, 0
    v_mul_f32 v208, v208, v9
    v_mul_f32 v209, v209, v9
    v_mul_f32 v210, v210, v9
    v_mul_f32 v211, v211, v9
    v_mul_f32 v212, v212, v9
    v_mul_f32 v213, v213, v9
    v_mul_f32 v214, v214, v9
    v_mul_f32 v215, v215, v9
    v_mul_f32 v216, v216, v10
    v_mul_f32 v217, v217, v10
    v_mul_f32 v218, v218, v10
    v_mul_f32 v219, v219, v10
    v_mul_f32 v220, v220, v10
    v_mul_f32 v221, v221, v10
    v_mul_f32 v222, v222, v10
    v_mul_f32 v223, v223, v10
    s_add_u32 s96, s63, 6144
    v_cvt_pk_bf16_f32 v208, v208, v209
    v_cvt_pk_bf16_f32 v209, v210, v211
    v_cvt_pk_bf16_f32 v210, v212, v213
    v_cvt_pk_bf16_f32 v211, v214, v215
    buffer_store_dwordx4 v[208:211], v12, s[28:31], s96 offen offset:0 sc1
    v_cvt_pk_bf16_f32 v216, v216, v217
    v_cvt_pk_bf16_f32 v217, v218, v219
    v_cvt_pk_bf16_f32 v218, v220, v221
    v_cvt_pk_bf16_f32 v219, v222, v223
    buffer_store_dwordx4 v[216:219], v12, s[28:31], s96 offen offset:256 sc1
    v_mov_b32 v212, 0
    v_mov_b32 v213, 0
    v_mov_b32 v214, 0
    v_mov_b32 v215, 0
    v_mov_b32 v220, 0
    v_mov_b32 v221, 0
    v_mov_b32 v222, 0
    v_mov_b32 v223, 0
    v_mov_b32 v208, 0
    v_mov_b32 v209, 0
    v_mov_b32 v210, 0
    v_mov_b32 v211, 0
    v_mov_b32 v216, 0
    v_mov_b32 v217, 0
    v_mov_b32 v218, 0
    v_mov_b32 v219, 0
    s_branch A_rescret_301
A_evb_308:
    s_add_u32 s63, s62, 1
    s_mov_b32 s100, -16
    s_sub_u32 s96, s63, s61
    s_add_u32 s96, s96, 2
    s_cmp_lt_u32 s96, 2
    s_cselect_b32 s97, s57, 0
    s_lshl_b32 s96, s96, 1
    s_sub_u32 s96, s96, s58
    s_lshl_b32 s96, s96, 1
    s_cmp_eq_u32 s97, 1
    s_cselect_b32 s100, s96, s100
    s_lshl_b32 s96, s57, 1
    s_sub_u32 s96, s96, s58
    s_lshl_b32 s96, s96, 1
    s_cmp_eq_u32 s63, 16
    s_cselect_b32 s100, s96, s100
    s_cmp_eq_u32 s63, s61
    s_cselect_b32 s101, s57, 0
    s_cmp_eq_u32 s63, 0
    s_cselect_b32 s101, 1, s101
    s_add_u32 s63, s62, 2
    s_cmp_eq_u32 s63, s61
    s_cselect_b32 s63, s57, 0
    s_cmp_eq_u32 s63, 0
    s_cbranch_scc1 A_noq_310
    ds_read_b128 v[32:35], v15 offset:0
    ds_read_b128 v[36:39], v15 offset:1024
    ds_read_b128 v[40:43], v15 offset:2048
    ds_read_b128 v[44:47], v15 offset:3072
    ds_read_b128 v[48:51], v15 offset:4096
    ds_read_b128 v[52:55], v15 offset:5120
    ds_read_b128 v[56:59], v15 offset:6144
    ds_read_b128 v[60:63], v15 offset:7168
    s_waitcnt lgkmcnt(0)
A_noq_310:
    s_lshl_b32 s63, s101, 1
    s_or_b32 s98, s98, s63
    s_cmp_ge_i32 s100, -3
    s_cbranch_scc0 A_evbret_309
    v_and_b32 v9, 15, v1
    v_lshrrev_b32 v10, 4, v1
    v_lshlrev_b32 v10, 2, v10
    s_lshl_b32 s63, s100, 4
    v_sub_u32 v9, v9, v10
    v_subrev_u32 v9, s63, v9
    v_cmp_le_i32 s[64:65], -16, v9
    v_cmp_le_i32 s[66:67], -15, v9
    v_cmp_le_i32 s[68:69], -14, v9
    v_cmp_le_i32 s[70:71], -13, v9
    v_cmp_le_i32 s[72:73], 0, v9
    v_cmp_le_i32 s[74:75], 1, v9
    v_cmp_le_i32 s[76:77], 2, v9
    v_cmp_le_i32 s[78:79], 3, v9
    v_cmp_le_i32 s[80:81], 16, v9
    v_cmp_le_i32 s[82:83], 17, v9
    v_cmp_le_i32 s[84:85], 18, v9
    v_cmp_le_i32 s[86:87], 19, v9
    v_cmp_le_i32 s[88:89], 32, v9
    v_cmp_le_i32 s[90:91], 33, v9
    v_cmp_le_i32 s[92:93], 34, v9
    v_cmp_le_i32 s[94:95], 35, v9
    v_cndmask_b32 v104, v13, v104, s[64:65]
    v_cndmask_b32 v105, v13, v105, s[66:67]
    v_cndmask_b32 v106, v13, v106, s[68:69]
    v_cndmask_b32 v107, v13, v107, s[70:71]
    v_cmp_le_i32 s[64:65], 48, v9
    v_cmp_le_i32 s[66:67], 49, v9
    v_cmp_le_i32 s[68:69], 50, v9
    v_cmp_le_i32 s[70:71], 51, v9
    v_cndmask_b32 v96, v13, v96, s[72:73]
    v_cndmask_b32 v97, v13, v97, s[74:75]
    v_cndmask_b32 v98, v13, v98, s[76:77]
    v_cndmask_b32 v99, v13, v99, s[78:79]
    v_cndmask_b32 v108, v13, v108, s[72:73]
    v_cndmask_b32 v109, v13, v109, s[74:75]
    v_cndmask_b32 v110, v13, v110, s[76:77]
    v_cndmask_b32 v111, v13, v111, s[78:79]
    v_cndmask_b32 v100, v13, v100, s[80:81]
    v_cndmask_b32 v101, v13, v101, s[82:83]
    v_cndmask_b32 v102, v13, v102, s[84:85]
    v_cndmask_b32 v103, v13, v103, s[86:87]
    v_cndmask_b32 v120, v13, v120, s[80:81]
    v_cndmask_b32 v121, v13, v121, s[82:83]
    v_cndmask_b32 v122, v13, v122, s[84:85]
    v_cndmask_b32 v123, v13, v123, s[86:87]
    v_cndmask_b32 v112, v13, v112, s[88:89]
    v_cndmask_b32 v113, v13, v113, s[90:91]
    v_cndmask_b32 v114, v13, v114, s[92:93]
    v_cndmask_b32 v115, v13, v115, s[94:95]
    v_cndmask_b32 v124, v13, v124, s[88:89]
    v_cndmask_b32 v125, v13, v125, s[90:91]
    v_cndmask_b32 v126, v13, v126, s[92:93]
    v_cndmask_b32 v127, v13, v127, s[94:95]
    v_cndmask_b32 v116, v13, v116, s[64:65]
    v_cndmask_b32 v117, v13, v117, s[66:67]
    v_cndmask_b32 v118, v13, v118, s[68:69]
    v_cndmask_b32 v119, v13, v119, s[70:71]
    s_branch A_evbret_309
A_slow_311:
    v_max3_f32 v8, v96, v97, v98
    v_max3_f32 v8, v8, v99, v100
    v_max3_f32 v8, v8, v101, v102
    v_max3_f32 v8, v8, v103, v112
    v_max3_f32 v8, v8, v113, v114
    v_max3_f32 v8, v8, v115, v116
    v_max3_f32 v8, v8, v117, v118
    v_max_f32 v8, v8, v119
    v_max3_f32 v14, v104, v105, v106
    v_max3_f32 v14, v14, v107, v108
    v_max3_f32 v14, v14, v109, v110
    v_max3_f32 v14, v14, v111, v120
    v_max3_f32 v14, v14, v121, v122
    v_max3_f32 v14, v14, v123, v124
    v_max3_f32 v14, v14, v125, v126
    v_max_f32 v14, v14, v127
    v_mov_b32 v9, v8
    v_mov_b32 v10, v14
    s_nop 1
    v_permlane16_swap_b32 v8, v9
    v_permlane16_swap_b32 v14, v10
    s_nop 1
    v_max_f32 v8, v8, v9
    v_max_f32 v14, v14, v10
    v_mov_b32 v9, v8
    v_mov_b32 v10, v14
    s_nop 1
    v_permlane32_swap_b32 v8, v9
    v_permlane32_swap_b32 v14, v10
    s_nop 1
    v_max_f32 v8, v8, v9
    v_max_f32 v14, v14, v10
    s_cmp_eq_u32 s101, 1
    s_cbranch_scc1 A_sf_313
    v_max_f32 v8, 0, v8
    v_sub_f32 v9, 0, v8
    v_exp_f32 v11, v9
    v_max_f32 v14, 0, v14
    v_sub_f32 v10, 0, v14
    v_exp_f32 v7, v10
    s_or_b32 s98, s98, 1
    s_branch A_sj_314
A_sf_313:
    v_max_f32 v8, 0xf149f2ca, v8
    v_max_f32 v14, 0xf149f2ca, v14
A_sj_314:
    v_add_f32 v5, v5, v8
    v_add_f32 v6, v6, v14
    v_sub_f32 v96, v96, v8
    v_sub_f32 v97, v97, v8
    v_sub_f32 v98, v98, v8
    v_sub_f32 v99, v99, v8
    v_sub_f32 v100, v100, v8
    v_sub_f32 v101, v101, v8
    v_sub_f32 v102, v102, v8
    v_sub_f32 v103, v103, v8
    v_sub_f32 v104, v104, v14
    v_sub_f32 v105, v105, v14
    v_sub_f32 v106, v106, v14
    v_sub_f32 v107, v107, v14
    v_sub_f32 v108, v108, v14
    v_sub_f32 v109, v109, v14
    v_sub_f32 v110, v110, v14
    v_sub_f32 v111, v111, v14
    v_sub_f32 v112, v112, v8
    v_sub_f32 v113, v113, v8
    v_sub_f32 v114, v114, v8
    v_sub_f32 v115, v115, v8
    v_sub_f32 v116, v116, v8
    v_sub_f32 v117, v117, v8
    v_sub_f32 v118, v118, v8
    v_sub_f32 v119, v119, v8
    v_sub_f32 v120, v120, v14
    v_sub_f32 v121, v121, v14
    v_sub_f32 v122, v122, v14
    v_sub_f32 v123, v123, v14
    v_sub_f32 v124, v124, v14
    v_sub_f32 v125, v125, v14
    v_sub_f32 v126, v126, v14
    v_sub_f32 v127, v127, v14
    v_sub_f32 v16, 0, v5
    v_sub_f32 v17, 0, v5
    v_sub_f32 v18, 0, v5
    v_sub_f32 v19, 0, v5
    v_sub_f32 v20, 0, v6
    v_sub_f32 v21, 0, v6
    v_sub_f32 v22, 0, v6
    v_sub_f32 v23, 0, v6
    s_branch A_slowret_312
A_resc_318:
    s_nop 15
    s_cmp_eq_u32 s98, 2
    s_mov_b32 s98, 0
    s_cbranch_scc1 A_fin_320
    v_mul_f32 v160, v160, v11
    v_mul_f32 v161, v161, v11
    v_mul_f32 v162, v162, v11
    v_mul_f32 v163, v163, v11
    v_mul_f32 v164, v164, v11
    v_mul_f32 v165, v165, v11
    v_mul_f32 v166, v166, v11
    v_mul_f32 v167, v167, v11
    v_mul_f32 v168, v168, v7
    v_mul_f32 v169, v169, v7
    v_mul_f32 v170, v170, v7
    v_mul_f32 v171, v171, v7
    v_mul_f32 v172, v172, v7
    v_mul_f32 v173, v173, v7
    v_mul_f32 v174, v174, v7
    v_mul_f32 v175, v175, v7
    v_mul_f32 v176, v176, v11
    v_mul_f32 v177, v177, v11
    v_mul_f32 v178, v178, v11
    v_mul_f32 v179, v179, v11
    v_mul_f32 v180, v180, v11
    v_mul_f32 v181, v181, v11
    v_mul_f32 v182, v182, v11
    v_mul_f32 v183, v183, v11
    v_mul_f32 v184, v184, v7
    v_mul_f32 v185, v185, v7
    v_mul_f32 v186, v186, v7
    v_mul_f32 v187, v187, v7
    v_mul_f32 v188, v188, v7
    v_mul_f32 v189, v189, v7
    v_mul_f32 v190, v190, v7
    v_mul_f32 v191, v191, v7
    v_mul_f32 v192, v192, v11
    v_mul_f32 v193, v193, v11
    v_mul_f32 v194, v194, v11
    v_mul_f32 v195, v195, v11
    v_mul_f32 v196, v196, v11
    v_mul_f32 v197, v197, v11
    v_mul_f32 v198, v198, v11
    v_mul_f32 v199, v199, v11
    v_mul_f32 v200, v200, v7
    v_mul_f32 v201, v201, v7
    v_mul_f32 v202, v202, v7
    v_mul_f32 v203, v203, v7
    v_mul_f32 v204, v204, v7
    v_mul_f32 v205, v205, v7
    v_mul_f32 v206, v206, v7
    v_mul_f32 v207, v207, v7
    v_mul_f32 v208, v208, v11
    v_mul_f32 v209, v209, v11
    v_mul_f32 v210, v210, v11
    v_mul_f32 v211, v211, v11
    v_mul_f32 v212, v212, v11
    v_mul_f32 v213, v213, v11
    v_mul_f32 v214, v214, v11
    v_mul_f32 v215, v215, v11
    v_mul_f32 v216, v216, v7
    v_mul_f32 v217, v217, v7
    v_mul_f32 v218, v218, v7
    v_mul_f32 v219, v219, v7
    v_mul_f32 v220, v220, v7
    v_mul_f32 v221, v221, v7
    v_mul_f32 v222, v222, v7
    v_mul_f32 v223, v223, v7
    v_mul_f32 v24, v24, v11
    v_mul_f32 v25, v25, v11
    v_mul_f32 v26, v26, v11
    v_mul_f32 v27, v27, v11
    v_mul_f32 v28, v28, v7
    v_mul_f32 v29, v29, v7
    v_mul_f32 v30, v30, v7
    v_mul_f32 v31, v31, v7
    s_branch A_rescret_319
A_fin_320:
    v_rcp_f32 v9, v24
    v_rcp_f32 v10, v28
    v_mov_b32 v24, 0
    v_mov_b32 v25, 0
    v_mov_b32 v26, 0
    v_mov_b32 v27, 0
    v_mov_b32 v28, 0
    v_mov_b32 v29, 0
    v_mov_b32 v30, 0
    v_mov_b32 v31, 0
    s_lshl_b32 s63, s60, 2
    s_add_u32 s63, s63, s58
    s_lshl_b32 s63, s63, 18
    s_lshl_b32 s96, s59, 13
    s_add_u32 s63, s63, s96
    v_mul_f32 v160, v160, v9
    v_mul_f32 v161, v161, v9
    v_mul_f32 v162, v162, v9
    v_mul_f32 v163, v163, v9
    v_mul_f32 v164, v164, v9
    v_mul_f32 v165, v165, v9
    v_mul_f32 v166, v166, v9
    v_mul_f32 v167, v167, v9
    v_mul_f32 v168, v168, v10
    v_mul_f32 v169, v169, v10
    v_mul_f32 v170, v170, v10
    v_mul_f32 v171, v171, v10
    v_mul_f32 v172, v172, v10
    v_mul_f32 v173, v173, v10
    v_mul_f32 v174, v174, v10
    v_mul_f32 v175, v175, v10
    s_add_u32 s96, s63, 0
    v_cvt_pk_bf16_f32 v160, v160, v161
    v_cvt_pk_bf16_f32 v161, v162, v163
    v_cvt_pk_bf16_f32 v162, v164, v165
    v_cvt_pk_bf16_f32 v163, v166, v167
    buffer_store_dwordx4 v[160:163], v12, s[28:31], s96 offen offset:0 sc1
    v_cvt_pk_bf16_f32 v168, v168, v169
    v_cvt_pk_bf16_f32 v169, v170, v171
    v_cvt_pk_bf16_f32 v170, v172, v173
    v_cvt_pk_bf16_f32 v171, v174, v175
    buffer_store_dwordx4 v[168:171], v12, s[28:31], s96 offen offset:256 sc1
    v_mov_b32 v164, 0
    v_mov_b32 v165, 0
    v_mov_b32 v166, 0
    v_mov_b32 v167, 0
    v_mov_b32 v172, 0
    v_mov_b32 v173, 0
    v_mov_b32 v174, 0
    v_mov_b32 v175, 0
    v_mov_b32 v160, 0
    v_mov_b32 v161, 0
    v_mov_b32 v162, 0
    v_mov_b32 v163, 0
    v_mov_b32 v168, 0
    v_mov_b32 v169, 0
    v_mov_b32 v170, 0
    v_mov_b32 v171, 0
    v_mul_f32 v176, v176, v9
    v_mul_f32 v177, v177, v9
    v_mul_f32 v178, v178, v9
    v_mul_f32 v179, v179, v9
    v_mul_f32 v180, v180, v9
    v_mul_f32 v181, v181, v9
    v_mul_f32 v182, v182, v9
    v_mul_f32 v183, v183, v9
    v_mul_f32 v184, v184, v10
    v_mul_f32 v185, v185, v10
    v_mul_f32 v186, v186, v10
    v_mul_f32 v187, v187, v10
    v_mul_f32 v188, v188, v10
    v_mul_f32 v189, v189, v10
    v_mul_f32 v190, v190, v10
    v_mul_f32 v191, v191, v10
    s_add_u32 s96, s63, 2048
    v_cvt_pk_bf16_f32 v176, v176, v177
    v_cvt_pk_bf16_f32 v177, v178, v179
    v_cvt_pk_bf16_f32 v178, v180, v181
    v_cvt_pk_bf16_f32 v179, v182, v183
    buffer_store_dwordx4 v[176:179], v12, s[28:31], s96 offen offset:0 sc1
    v_cvt_pk_bf16_f32 v184, v184, v185
    v_cvt_pk_bf16_f32 v185, v186, v187
    v_cvt_pk_bf16_f32 v186, v188, v189
    v_cvt_pk_bf16_f32 v187, v190, v191
    buffer_store_dwordx4 v[184:187], v12, s[28:31], s96 offen offset:256 sc1
    v_mov_b32 v180, 0
    v_mov_b32 v181, 0
    v_mov_b32 v182, 0
    v_mov_b32 v183, 0
    v_mov_b32 v188, 0
    v_mov_b32 v189, 0
    v_mov_b32 v190, 0
    v_mov_b32 v191, 0
    v_mov_b32 v176, 0
    v_mov_b32 v177, 0
    v_mov_b32 v178, 0
    v_mov_b32 v179, 0
    v_mov_b32 v184, 0
    v_mov_b32 v185, 0
    v_mov_b32 v186, 0
    v_mov_b32 v187, 0
    v_mul_f32 v192, v192, v9
    v_mul_f32 v193, v193, v9
    v_mul_f32 v194, v194, v9
    v_mul_f32 v195, v195, v9
    v_mul_f32 v196, v196, v9
    v_mul_f32 v197, v197, v9
    v_mul_f32 v198, v198, v9
    v_mul_f32 v199, v199, v9
    v_mul_f32 v200, v200, v10
    v_mul_f32 v201, v201, v10
    v_mul_f32 v202, v202, v10
    v_mul_f32 v203, v203, v10
    v_mul_f32 v204, v204, v10
    v_mul_f32 v205, v205, v10
    v_mul_f32 v206, v206, v10
    v_mul_f32 v207, v207, v10
    s_add_u32 s96, s63, 4096
    v_cvt_pk_bf16_f32 v192, v192, v193
    v_cvt_pk_bf16_f32 v193, v194, v195
    v_cvt_pk_bf16_f32 v194, v196, v197
    v_cvt_pk_bf16_f32 v195, v198, v199
    buffer_store_dwordx4 v[192:195], v12, s[28:31], s96 offen offset:0 sc1
    v_cvt_pk_bf16_f32 v200, v200, v201
    v_cvt_pk_bf16_f32 v201, v202, v203
    v_cvt_pk_bf16_f32 v202, v204, v205
    v_cvt_pk_bf16_f32 v203, v206, v207
    buffer_store_dwordx4 v[200:203], v12, s[28:31], s96 offen offset:256 sc1
    v_mov_b32 v196, 0
    v_mov_b32 v197, 0
    v_mov_b32 v198, 0
    v_mov_b32 v199, 0
    v_mov_b32 v204, 0
    v_mov_b32 v205, 0
    v_mov_b32 v206, 0
    v_mov_b32 v207, 0
    v_mov_b32 v192, 0
    v_mov_b32 v193, 0
    v_mov_b32 v194, 0
    v_mov_b32 v195, 0
    v_mov_b32 v200, 0
    v_mov_b32 v201, 0
    v_mov_b32 v202, 0
    v_mov_b32 v203, 0
    v_mul_f32 v208, v208, v9
    v_mul_f32 v209, v209, v9
    v_mul_f32 v210, v210, v9
    v_mul_f32 v211, v211, v9
    v_mul_f32 v212, v212, v9
    v_mul_f32 v213, v213, v9
    v_mul_f32 v214, v214, v9
    v_mul_f32 v215, v215, v9
    v_mul_f32 v216, v216, v10
    v_mul_f32 v217, v217, v10
    v_mul_f32 v218, v218, v10
    v_mul_f32 v219, v219, v10
    v_mul_f32 v220, v220, v10
    v_mul_f32 v221, v221, v10
    v_mul_f32 v222, v222, v10
    v_mul_f32 v223, v223, v10
    s_add_u32 s96, s63, 6144
    v_cvt_pk_bf16_f32 v208, v208, v209
    v_cvt_pk_bf16_f32 v209, v210, v211
    v_cvt_pk_bf16_f32 v210, v212, v213
    v_cvt_pk_bf16_f32 v211, v214, v215
    buffer_store_dwordx4 v[208:211], v12, s[28:31], s96 offen offset:0 sc1
    v_cvt_pk_bf16_f32 v216, v216, v217
    v_cvt_pk_bf16_f32 v217, v218, v219
    v_cvt_pk_bf16_f32 v218, v220, v221
    v_cvt_pk_bf16_f32 v219, v222, v223
    buffer_store_dwordx4 v[216:219], v12, s[28:31], s96 offen offset:256 sc1
    v_mov_b32 v212, 0
    v_mov_b32 v213, 0
    v_mov_b32 v214, 0
    v_mov_b32 v215, 0
    v_mov_b32 v220, 0
    v_mov_b32 v221, 0
    v_mov_b32 v222, 0
    v_mov_b32 v223, 0
    v_mov_b32 v208, 0
    v_mov_b32 v209, 0
    v_mov_b32 v210, 0
    v_mov_b32 v211, 0
    v_mov_b32 v216, 0
    v_mov_b32 v217, 0
    v_mov_b32 v218, 0
    v_mov_b32 v219, 0
    s_branch A_rescret_319
PC_slow:
    s_mov_b32 s51, 8192
    s_cmp_eq_u32 s56, 0
    s_cbranch_scc0 M_poll_321
    s_add_u32 s52, s14, 0x6400000
    s_addc_u32 s53, s15, 0
    s_mov_b32 s54, 0x4000
    s_mov_b32 s55, 0x00020000
    s_mov_b32 s97, 0
M_pl_322:
    buffer_load_dwordx4 v[36:39], v2, s[52:55], s51 offen sc1
    s_waitcnt vmcnt(0)
    v_xor_b32 v36, s3, v36
    v_xor_b32 v37, s3, v37
    v_xor_b32 v38, s3, v38
    v_xor_b32 v39, s3, v39
    v_or_b32 v36, v36, v37
    v_or3_b32 v36, v36, v38, v39
    v_cmp_ne_u32 vcc, 0, v36
    s_add_u32 s97, s97, 1
    s_cbranch_vccz M_pd_323
    s_cmp_ge_u32 s97, 0x40000
    s_cbranch_scc1 M_pd_323
    s_sleep 4
    s_branch M_pl_322
M_pd_323:
M_poll_321:
    s_branch PC_done
TEXT_END:
.section .rodata,"a"
.p2align 6
.amdhsa_kernel gated_mix__compressed_kv_cla__mixer_gmlp__prompt_kernel
  .amdhsa_next_free_vgpr 256
  .amdhsa_next_free_sgpr 102
  .amdhsa_accum_offset 256
  .amdhsa_group_segment_fixed_size 0
  .amdhsa_kernarg_size 120
  .amdhsa_user_sgpr_count 2
  .amdhsa_user_sgpr_kernarg_segment_ptr 1
  .amdhsa_system_sgpr_workgroup_id_x 1
.end_amdhsa_kernel
```
